```python
import torch

def _softmax(x, axis=-1):
    return torch.softmax(x, dim=axis)
def _gelu(x):
    return torch.nn.functional.gelu(x, approximate="tanh")
def _silu(x):
    return torch.nn.functional.silu(x)
def _sigmoid(x):
    return torch.sigmoid(x)
def _layernorm(x, axis=-1, eps=1e-5):
    m = x.mean(dim=axis, keepdim=True)
    v = x.var(dim=axis, keepdim=True, unbiased=False)
    return (x - m) / torch.sqrt(v + eps)
def _scatter_add(tgt, idx, src, axis=0):
    return tgt.clone().index_add_(axis, idx, src)
def _segment_sum(src, seg, n):
    out = torch.zeros((n,) + src.shape[1:], dtype=src.dtype)
    return out.index_add_(0, seg, src)
def _pad(x, pw):
    flat = tuple(v for pair in reversed(pw) for v in pair)
    return torch.nn.functional.pad(x, flat)

kernel_name = 'concat_heads__gqa_block_cached__mha_block_cached__near_ridge'

def setup_inputs():

    _w = (lambda a: (lambda t: t.to(torch.bfloat16) if t.is_floating_point() else t)(torch.as_tensor(a)))
    def _A_setup():
        B, Sq, D = 16, 160, 512
        Hq, Hkv, Sk, Dh = 32, 32, 512, 128
        assert Hq % Hkv == 0, (Hq, Hkv)
        return {
            "x": _w((lambda *s: torch.randn(*s, dtype=torch.bfloat16) * 0.8)(B, Sq, D)),
            "k_cache": _w((lambda *s: torch.randn(*s, dtype=torch.bfloat16) * 0.8)(B, Hkv, Sk, Dh)),
            "v_cache": _w((lambda *s: torch.randn(*s, dtype=torch.bfloat16) * 0.05)(B, Hkv, Sk, Dh)),
            "wq": _w((lambda *s: torch.randn(*s, dtype=torch.bfloat16) * 0.8)(D, Hq * Dh) * (D ** -0.5)),
            "wo": _w((lambda *s: torch.randn(*s, dtype=torch.bfloat16) * 0.05)(Hq * Dh, D) * ((Hq * Dh) ** -0.5)),
        }
    _A_in = _A_setup()

    def _B_setup():
        B, Sq, D = 16, 160, 512
        H, Sk, Dh = 32, 512, 128
        return {
            "x": _w((lambda *s: torch.randn(*s, dtype=torch.bfloat16) * 0.8)(B, Sq, D)),
            "k_cache": _w((lambda *s: torch.randn(*s, dtype=torch.bfloat16) * 0.8)(B, H, Sk, Dh)),
            "v_cache": _w((lambda *s: torch.randn(*s, dtype=torch.bfloat16) * 0.05)(B, H, Sk, Dh)),
            "wq": _w((lambda *s: torch.randn(*s, dtype=torch.bfloat16) * 0.8)(D, H * Dh) * (D ** -0.5)),
            "wo": _w((lambda *s: torch.randn(*s, dtype=torch.bfloat16) * 0.05)(H * Dh, D) * ((H * Dh) ** -0.5)),
        }
    _B_in = _B_setup()

    return {
        "A_x": _A_in["x"],
        "A_k_cache": _A_in["k_cache"],
        "A_v_cache": _A_in["v_cache"],
        "A_wq": _A_in["wq"],
        "A_wo": _A_in["wo"],
        "B_x": _B_in["x"],
        "B_k_cache": _B_in["k_cache"],
        "B_v_cache": _B_in["v_cache"],
        "B_wq": _B_in["wq"],
        "B_wo": _B_in["wo"],
    }

def reference(A_x, A_k_cache, A_v_cache, A_wq, A_wo, B_x, B_k_cache, B_v_cache, B_wq, B_wo):
    def _A_ref(x, k_cache, v_cache, wq, wo):
        B, Sq, D = x.shape
        Hq, Dh = 32, 128
        Hkv = k_cache.shape[1]
        rep = Hq // Hkv
        q = (lambda x, *d: x.permute(*d))((x @ wq).reshape(B, Sq, Hq, Dh), 0, 2, 1, 3)
        k = (lambda x, n, axis: torch.repeat_interleave(x, n, dim=axis))(k_cache, rep, axis=1)
        v = (lambda x, n, axis: torch.repeat_interleave(x, n, dim=axis))(v_cache, rep, axis=1)
        scores = torch.einsum("bhqd,bhkd->bhqk", q, k) * (Dh ** -0.5)
        p = _softmax(scores, axis=-1)
        o = torch.einsum("bhqk,bhkd->bhqd", p, v)
        return (lambda x, *d: x.permute(*d))(o, 0, 2, 1, 3).reshape(B, Sq, Hq * Dh) @ wo

    def _B_ref(x, k_cache, v_cache, wq, wo):
        B, Sq, D = x.shape
        H, Dh = 32, 128
        q = (lambda x, *d: x.permute(*d))((x @ wq).reshape(B, Sq, H, Dh), 0, 2, 1, 3)
        scores = torch.einsum("bhqd,bhkd->bhqk", q, k_cache) * (Dh ** -0.5)
        p = _softmax(scores, axis=-1)
        o = torch.einsum("bhqk,bhkd->bhqd", p, v_cache)
        return (lambda x, *d: x.permute(*d))(o, 0, 2, 1, 3).reshape(B, Sq, H * Dh) @ wo

    a = _A_ref(A_x, A_k_cache, A_v_cache, A_wq, A_wo)
    b = _B_ref(B_x, B_k_cache, B_v_cache, B_wq, B_wo)
    return torch.concatenate([a, b], axis=-1)
```

```asm
; @launch grid=(256,1,1) block=(512,1,1) lds=163840
.amdgcn_target "amdgcn-amd-amdhsa--gfx950"
.text
.globl concat_heads__gqa_block_cached__mha_block_cached__near_ridge_kernel
.p2align 8
.type concat_heads__gqa_block_cached__mha_block_cached__near_ridge_kernel,@function
concat_heads__gqa_block_cached__mha_block_cached__near_ridge_kernel:

    s_bfe_u32 s30, s2, 0x10002
    s_mul_i32 s33, s30, 40
    s_add_u32 s44, s0, s33
    s_addc_u32 s45, s1, 0
    s_load_dwordx8 s[36:43], s[44:45], 0
    s_load_dwordx2 s[46:47], s[44:45], 32
    s_load_dwordx4 s[48:51], s[0:1], 88
    s_load_dwordx2 s[52:53], s[0:1], 80
    s_cmp_ge_u32 s2, 256
    s_cbranch_scc1 L_k1_end
    v_lshrrev_b32 v1, 6, v0
    s_lshr_b32 s29, s2, 3
    s_xor_b32 s29, s29, 0
    v_readfirstlane_b32 s34, v1
    s_and_b32 s31, s2, 1
    s_lshl_b32 s31, s31, 3
    s_lshr_b32 s33, s29, 2
    s_add_u32 s31, s31, s33
    s_and_b32 s32, s2, 2
    s_lshl_b32 s32, s32, 1
    s_and_b32 s33, s29, 3
    s_add_u32 s32, s32, s33
    s_mov_b32 s87, 0
    s_mov_b32 s86, 0
    s_waitcnt lgkmcnt(0)
    s_mov_b32 s12, s42
    s_mov_b32 s13, s43
    s_mov_b32 s14, 0x400000
    s_mov_b32 s15, 0x20000
    s_mov_b32 s16, s36
    s_mov_b32 s17, s37
    s_mov_b32 s18, 2621440
    s_mov_b32 s19, 0x20000
    s_mov_b32 s0, s52
    s_mov_b32 s1, s53
    s_bitcmp1_b32 s34, 0
    s_cselect_b32 s8, s40, s38
    s_cselect_b32 s9, s41, s39
    s_mov_b32 s10, 67108864
    s_mov_b32 s11, 0x20000
    s_mov_b32 s20, s50
    s_mov_b32 s21, s51
    s_mov_b32 s22, 55574528
    s_mov_b32 s23, 0x20000
    s_mov_b32 s24, s46
    s_mov_b32 s25, s47
    s_mov_b32 s26, 0x400000
    s_mov_b32 s27, 0x20000
    s_mov_b32 s4, s48
    s_mov_b32 s5, s49
    s_mov_b32 s6, 256
    s_mov_b32 s7, 0x20000
L_start:
    s_cmp_lt_u32 s34, 2
    s_cbranch_scc1 L_A3
    s_cmp_lt_u32 s34, 4
    s_cbranch_scc1 L_A2
L_PG:
    v_mbcnt_lo_u32_b32 v250, -1, 0
    v_mbcnt_hi_u32_b32 v250, -1, v250
    s_and_b32 s35, s34, 1
    s_and_b32 s36, s34, 3
    v_lshrrev_b32 v251, 5, v250
    v_lshlrev_b32 v240, 17, v251
    v_bfe_u32 v251, v250, 4, 1
    v_lshl_add_u32 v240, v251, 15, v240
    v_and_b32 v251, 15, v250
    v_lshl_add_u32 v240, v251, 4, v240
    v_lshrrev_b32 v251, 3, v250
    v_lshlrev_b32 v251, 10, v251
    v_lshrrev_b32 v252, 4, v250
    v_and_b32 v253, 7, v250
    v_xor_b32 v252, v252, v253
    v_lshl_add_u32 v241, v252, 4, v251
    s_lshl_b32 s37, s35, 6
    v_xor_b32 v241, s37, v241
    v_xor_b32 v242, 64, v241
    s_lshr_b32 s37, s36, 1
    s_lshl_b32 s37, s37, 16
    s_lshl_b32 s38, s35, 14
    s_add_u32 s37, s37, s38
    s_lshl_b32 s38, s32, 10
    s_add_u32 s37, s37, s38
    s_and_b32 s38, s32, 3
    s_lshl_b32 s38, s38, 8
    s_add_u32 s52, s37, s38
    s_mul_i32 s53, s36, 16448
    s_mul_i32 s54, s31, 163840
    s_mul_i32 s37, s36, 40960
    s_add_u32 s54, s54, s37
    s_mul_i32 s55, s36, 5120
    s_add_u32 m0, s53, 0
    s_add_u32 s37, s52, 0
    buffer_load_dwordx4 v240, s[12:15], s37 offen lds
    s_add_u32 m0, s53, 8224
    s_add_u32 s37, s52, 8192
    buffer_load_dwordx4 v240, s[12:15], s37 offen lds
    s_add_u32 m0, s55, 65760
    s_add_u32 s37, s54, 0
    buffer_load_dwordx4 v241, s[16:19], s37 offen lds
    s_add_u32 m0, s55, 66784
    s_add_u32 s37, s54, 8192
    buffer_load_dwordx4 v242, s[16:19], s37 offen lds
    s_add_u32 m0, s55, 67808
    s_add_u32 s37, s54, 16384
    buffer_load_dwordx4 v241, s[16:19], s37 offen lds
    s_add_u32 m0, s55, 68832
    s_add_u32 s37, s54, 24576
    buffer_load_dwordx4 v242, s[16:19], s37 offen lds
    s_add_u32 m0, s55, 69856
    s_add_u32 s37, s54, 32768
    buffer_load_dwordx4 v241, s[16:19], s37 offen lds
    s_add_u32 m0, s53, 1024
    s_add_u32 s37, s52, 262144
    buffer_load_dwordx4 v240, s[12:15], s37 offen lds
    s_add_u32 m0, s53, 9248
    s_add_u32 s37, s52, 270336
    buffer_load_dwordx4 v240, s[12:15], s37 offen lds
    s_add_u32 m0, s55, 86240
    s_add_u32 s37, s54, 128
    buffer_load_dwordx4 v241, s[16:19], s37 offen lds
    s_add_u32 m0, s55, 87264
    s_add_u32 s37, s54, 8320
    buffer_load_dwordx4 v242, s[16:19], s37 offen lds
    s_add_u32 m0, s55, 88288
    s_add_u32 s37, s54, 16512
    buffer_load_dwordx4 v241, s[16:19], s37 offen lds
    s_add_u32 m0, s55, 89312
    s_add_u32 s37, s54, 24704
    buffer_load_dwordx4 v242, s[16:19], s37 offen lds
    s_add_u32 m0, s55, 90336
    s_add_u32 s37, s54, 32896
    buffer_load_dwordx4 v241, s[16:19], s37 offen lds
    s_add_u32 m0, s53, 2048
    s_add_u32 s37, s52, 524288
    buffer_load_dwordx4 v240, s[12:15], s37 offen lds
    s_add_u32 m0, s53, 10272
    s_add_u32 s37, s52, 532480
    buffer_load_dwordx4 v240, s[12:15], s37 offen lds
    s_waitcnt vmcnt(9) lgkmcnt(0)
    s_barrier
    s_add_u32 m0, s53, 3072
    s_add_u32 s37, s52, 786432
    buffer_load_dwordx4 v240, s[12:15], s37 offen lds
    s_add_u32 m0, s53, 11296
    s_add_u32 s37, s52, 794624
    buffer_load_dwordx4 v240, s[12:15], s37 offen lds
    s_add_u32 m0, s55, 122880
    s_add_u32 s37, s54, 256
    buffer_load_dwordx4 v241, s[16:19], s37 offen lds
    s_add_u32 m0, s55, 123904
    s_add_u32 s37, s54, 8448
    buffer_load_dwordx4 v242, s[16:19], s37 offen lds
    s_add_u32 m0, s55, 124928
    s_add_u32 s37, s54, 16640
    buffer_load_dwordx4 v241, s[16:19], s37 offen lds
    s_waitcnt vmcnt(12) lgkmcnt(0)
    s_barrier
    s_add_u32 m0, s55, 125952
    s_add_u32 s37, s54, 24832
    buffer_load_dwordx4 v242, s[16:19], s37 offen lds
    s_add_u32 m0, s55, 126976
    s_add_u32 s37, s54, 33024
    buffer_load_dwordx4 v241, s[16:19], s37 offen lds
    s_add_u32 m0, s53, 4096
    s_add_u32 s37, s52, 1048576
    buffer_load_dwordx4 v240, s[12:15], s37 offen lds
    s_add_u32 m0, s53, 12320
    s_add_u32 s37, s52, 1056768
    buffer_load_dwordx4 v240, s[12:15], s37 offen lds
    s_add_u32 m0, s53, 5120
    s_add_u32 s37, s52, 1310720
    buffer_load_dwordx4 v240, s[12:15], s37 offen lds
    s_waitcnt vmcnt(10) lgkmcnt(0)
    s_barrier
    s_add_u32 m0, s53, 13344
    s_add_u32 s37, s52, 1318912
    buffer_load_dwordx4 v240, s[12:15], s37 offen lds
    s_add_u32 m0, s55, 143360
    s_add_u32 s37, s54, 384
    buffer_load_dwordx4 v241, s[16:19], s37 offen lds
    s_add_u32 m0, s55, 144384
    s_add_u32 s37, s54, 8576
    buffer_load_dwordx4 v242, s[16:19], s37 offen lds
    s_add_u32 m0, s55, 145408
    s_add_u32 s37, s54, 16768
    buffer_load_dwordx4 v241, s[16:19], s37 offen lds
    s_add_u32 m0, s55, 146432
    s_add_u32 s37, s54, 24960
    buffer_load_dwordx4 v242, s[16:19], s37 offen lds
    s_waitcnt vmcnt(13) lgkmcnt(0)
    s_barrier
    s_mov_b32 s46, s36
    s_lshl_b32 s36, s46, 11
    s_add_u32 s36, s36, 106720
    v_lshrrev_b32 v251, 3, v250
    v_lshlrev_b32 v200, 10, v251
    v_and_b32 v251, 7, v250
    v_lshl_add_u32 v200, v251, 4, v200
    v_lshrrev_b32 v251, 2, v250
    v_lshlrev_b32 v201, 7, v251
    v_and_b32 v251, 3, v250
    v_lshl_add_u32 v201, v251, 4, v201
    v_add_u32 v201, s36, v201
    v_lshlrev_b32 v202, 4, v250
    v_add_u32 v203, s36, v202
    s_mov_b32 s36, s46
    s_add_u32 m0, s55, 147456
    s_add_u32 s37, s54, 33152
    buffer_load_dwordx4 v241, s[16:19], s37 offen lds
    s_add_u32 m0, s53, 6144
    s_add_u32 s37, s52, 1572864
    buffer_load_dwordx4 v240, s[12:15], s37 offen lds
    s_add_u32 m0, s53, 14368
    s_add_u32 s37, s52, 1581056
    buffer_load_dwordx4 v240, s[12:15], s37 offen lds
    s_add_u32 m0, s53, 7168
    s_add_u32 s37, s52, 1835008
    buffer_load_dwordx4 v240, s[12:15], s37 offen lds
    s_add_u32 m0, s53, 15392
    s_add_u32 s37, s52, 1843200
    buffer_load_dwordx4 v240, s[12:15], s37 offen lds
    s_lshr_b32 s44, s31, 2
    s_add_u32 s44, s44, s32
    s_and_b32 s44, s44, 3
    s_lshl_b32 s38, s32, 2
    s_add_u32 s44, s44, s38
    s_lshl_b32 s44, s44, 2
    s_and_b32 s38, s31, 3
    s_add_u32 s44, s44, s38
    s_lshl_b32 s44, s44, 15
    s_lshl_b32 s45, s30, 4
    s_add_u32 s45, s45, s31
    s_mul_i32 s45, s45, 266240
    s_lshl_b32 s38, s32, 15
    s_add_u32 s45, s45, s38
    s_lshl_b32 s38, s36, 13
    s_add_u32 s45, s45, s38
    s_add_u32 s45, s45, 41943040
    s_lshl_b32 s38, s36, 8
    s_add_u32 s44, s44, s38
    s_add_u32 s46, s45, 4096
    buffer_load_dwordx4 v[0:3], v200, s[24:27], s44 offen nt
    buffer_load_dwordx4 v[16:19], v200, s[24:27], s44 offen offset:128 nt
    s_add_u32 s44, s44, 8192
    s_waitcnt vmcnt(13) lgkmcnt(0)
    s_barrier
    s_add_u32 m0, s55, 65760
    s_add_u32 s37, s54, 512
    buffer_load_dwordx4 v241, s[16:19], s37 offen lds
    s_add_u32 m0, s55, 66784
    s_add_u32 s37, s54, 8704
    buffer_load_dwordx4 v242, s[16:19], s37 offen lds
    s_add_u32 m0, s55, 67808
    s_add_u32 s37, s54, 16896
    buffer_load_dwordx4 v241, s[16:19], s37 offen lds
    s_add_u32 m0, s55, 68832
    s_add_u32 s37, s54, 25088
    buffer_load_dwordx4 v242, s[16:19], s37 offen lds
    s_add_u32 m0, s55, 69856
    s_add_u32 s37, s54, 33280
    buffer_load_dwordx4 v241, s[16:19], s37 offen lds
    buffer_load_dwordx4 v[4:7], v200, s[24:27], s44 offen nt
    buffer_load_dwordx4 v[20:23], v200, s[24:27], s44 offen offset:128 nt
    s_add_u32 s44, s44, 8192
    s_waitcnt vmcnt(18) lgkmcnt(0)
    s_barrier
    s_add_u32 m0, s53, 0
    s_add_u32 s37, s52, 2097152
    buffer_load_dwordx4 v240, s[12:15], s37 offen lds
    s_add_u32 m0, s53, 8224
    s_add_u32 s37, s52, 2105344
    buffer_load_dwordx4 v240, s[12:15], s37 offen lds
    s_add_u32 m0, s53, 1024
    s_add_u32 s37, s52, 2359296
    buffer_load_dwordx4 v240, s[12:15], s37 offen lds
    s_add_u32 m0, s53, 9248
    s_add_u32 s37, s52, 2367488
    buffer_load_dwordx4 v240, s[12:15], s37 offen lds
    s_add_u32 m0, s55, 86240
    s_add_u32 s37, s54, 640
    buffer_load_dwordx4 v241, s[16:19], s37 offen lds
    buffer_load_dwordx4 v[8:11], v200, s[24:27], s44 offen nt
    buffer_load_dwordx4 v[24:27], v200, s[24:27], s44 offen offset:128 nt
    s_add_u32 s44, s44, 8192
    s_waitcnt vmcnt(18) lgkmcnt(0)
    s_barrier
    s_add_u32 m0, s55, 87264
    s_add_u32 s37, s54, 8832
    buffer_load_dwordx4 v242, s[16:19], s37 offen lds
    s_add_u32 m0, s55, 88288
    s_add_u32 s37, s54, 17024
    buffer_load_dwordx4 v241, s[16:19], s37 offen lds
    s_add_u32 m0, s55, 89312
    s_add_u32 s37, s54, 25216
    buffer_load_dwordx4 v242, s[16:19], s37 offen lds
    s_add_u32 m0, s55, 90336
    s_add_u32 s37, s54, 33408
    buffer_load_dwordx4 v241, s[16:19], s37 offen lds
    s_add_u32 m0, s53, 2048
    s_add_u32 s37, s52, 2621440
    buffer_load_dwordx4 v240, s[12:15], s37 offen lds
    buffer_load_dwordx4 v[12:15], v200, s[24:27], s44 offen nt
    buffer_load_dwordx4 v[28:31], v200, s[24:27], s44 offen offset:128 nt
    s_add_u32 s44, s44, 8192
    s_waitcnt vmcnt(14) lgkmcnt(0)
    s_barrier
    s_add_u32 m0, s53, 10272
    s_add_u32 s37, s52, 2629632
    buffer_load_dwordx4 v240, s[12:15], s37 offen lds
    s_add_u32 m0, s53, 3072
    s_add_u32 s37, s52, 2883584
    buffer_load_dwordx4 v240, s[12:15], s37 offen lds
    s_add_u32 m0, s53, 11296
    s_add_u32 s37, s52, 2891776
    buffer_load_dwordx4 v240, s[12:15], s37 offen lds
    s_add_u32 m0, s55, 122880
    s_add_u32 s37, s54, 768
    buffer_load_dwordx4 v241, s[16:19], s37 offen lds
    s_add_u32 m0, s55, 123904
    s_add_u32 s37, s54, 8960
    buffer_load_dwordx4 v242, s[16:19], s37 offen lds
    ds_write_b128 v203, v[0:3] offset:0
    ds_write_b128 v203, v[4:7] offset:1024
    ds_read_b64_tr_b16 v[32:33], v201 offset:0
    ds_read_b64_tr_b16 v[36:37], v201 offset:8
    ds_read_b64_tr_b16 v[40:41], v201 offset:64
    ds_read_b64_tr_b16 v[44:45], v201 offset:72
    s_waitcnt vmcnt(5) lgkmcnt(0)
    s_barrier
    s_add_u32 m0, s55, 124928
    s_add_u32 s37, s54, 17152
    buffer_load_dwordx4 v241, s[16:19], s37 offen lds
    s_add_u32 m0, s55, 125952
    s_add_u32 s37, s54, 25344
    buffer_load_dwordx4 v242, s[16:19], s37 offen lds
    s_add_u32 m0, s55, 126976
    s_add_u32 s37, s54, 33536
    buffer_load_dwordx4 v241, s[16:19], s37 offen lds
    s_add_u32 m0, s53, 4096
    s_add_u32 s37, s52, 3145728
    buffer_load_dwordx4 v240, s[12:15], s37 offen lds
    s_add_u32 m0, s53, 12320
    s_add_u32 s37, s52, 3153920
    buffer_load_dwordx4 v240, s[12:15], s37 offen lds
    ds_write_b128 v203, v[8:11] offset:0
    ds_write_b128 v203, v[12:15] offset:1024
    ds_read_b64_tr_b16 v[34:35], v201 offset:0
    ds_read_b64_tr_b16 v[38:39], v201 offset:8
    ds_read_b64_tr_b16 v[42:43], v201 offset:64
    ds_read_b64_tr_b16 v[46:47], v201 offset:72
    s_waitcnt vmcnt(10) lgkmcnt(0)
    s_barrier
    s_add_u32 m0, s53, 5120
    s_add_u32 s37, s52, 3407872
    buffer_load_dwordx4 v240, s[12:15], s37 offen lds
    s_add_u32 m0, s53, 13344
    s_add_u32 s37, s52, 3416064
    buffer_load_dwordx4 v240, s[12:15], s37 offen lds
    s_add_u32 m0, s55, 143360
    s_add_u32 s37, s54, 896
    buffer_load_dwordx4 v241, s[16:19], s37 offen lds
    s_add_u32 m0, s55, 144384
    s_add_u32 s37, s54, 9088
    buffer_load_dwordx4 v242, s[16:19], s37 offen lds
    s_add_u32 m0, s55, 145408
    s_add_u32 s37, s54, 17280
    buffer_load_dwordx4 v241, s[16:19], s37 offen lds
    buffer_store_dwordx4 v[32:35], v202, s[20:23], s45 offen sc1
    buffer_store_dwordx4 v[36:39], v202, s[20:23], s45 offen offset:1024 sc1
    ds_write_b128 v203, v[16:19] offset:0
    ds_write_b128 v203, v[20:23] offset:1024
    ds_read_b64_tr_b16 v[48:49], v201 offset:0
    ds_read_b64_tr_b16 v[52:53], v201 offset:8
    ds_read_b64_tr_b16 v[56:57], v201 offset:64
    ds_read_b64_tr_b16 v[60:61], v201 offset:72
    s_waitcnt vmcnt(16) lgkmcnt(0)
    s_barrier
    s_add_u32 m0, s55, 146432
    s_add_u32 s37, s54, 25472
    buffer_load_dwordx4 v242, s[16:19], s37 offen lds
    s_add_u32 m0, s55, 147456
    s_add_u32 s37, s54, 33664
    buffer_load_dwordx4 v241, s[16:19], s37 offen lds
    s_add_u32 m0, s53, 6144
    s_add_u32 s37, s52, 3670016
    buffer_load_dwordx4 v240, s[12:15], s37 offen lds
    s_add_u32 m0, s53, 14368
    s_add_u32 s37, s52, 3678208
    buffer_load_dwordx4 v240, s[12:15], s37 offen lds
    s_add_u32 m0, s53, 7168
    s_add_u32 s37, s52, 3932160
    buffer_load_dwordx4 v240, s[12:15], s37 offen lds
    buffer_store_dwordx4 v[40:43], v202, s[20:23], s45 offen offset:2048 sc1
    buffer_store_dwordx4 v[44:47], v202, s[20:23], s45 offen offset:3072 sc1
    ds_write_b128 v203, v[24:27] offset:0
    ds_write_b128 v203, v[28:31] offset:1024
    ds_read_b64_tr_b16 v[50:51], v201 offset:0
    ds_read_b64_tr_b16 v[54:55], v201 offset:8
    ds_read_b64_tr_b16 v[58:59], v201 offset:64
    ds_read_b64_tr_b16 v[62:63], v201 offset:72
    s_lshl_b32 s38, s30, 4
    s_add_u32 s38, s38, s31
    s_lshl_b32 s38, s38, 13
    s_lshl_b32 s39, s32, 6
    s_add_u32 s38, s38, s39
    s_lshl_b32 s39, s36, 11
    s_add_u32 s38, s38, s39
    s_add_u32 s38, s38, 54525952
    v_lshlrev_b32 v251, 9, v250
    v_mov_b32 v252, 0
    s_mov_b64 exec, 15
    buffer_store_dword v252, v251, s[20:23], s38 offen sc1
    s_mov_b64 exec, -1
    s_waitcnt vmcnt(22) lgkmcnt(0)
    s_barrier
    s_add_u32 m0, s53, 15392
    s_add_u32 s37, s52, 3940352
    buffer_load_dwordx4 v240, s[12:15], s37 offen lds
    buffer_store_dwordx4 v[48:51], v202, s[20:23], s46 offen sc1
    buffer_store_dwordx4 v[52:55], v202, s[20:23], s46 offen offset:1024 sc1
    buffer_store_dwordx4 v[56:59], v202, s[20:23], s46 offen offset:2048 sc1
    buffer_store_dwordx4 v[60:63], v202, s[20:23], s46 offen offset:3072 sc1
    s_cmp_ge_u32 s34, 6
    s_cbranch_scc1 L_P7
L_P3:
    s_setprio 0
    s_lshl_b32 s36, s35, 7
    s_add_u32 s36, s36, 65760
    v_bfe_u32 v251, v250, 2, 3
    v_mul_u32_u24 v235, 3136, v251
    v_lshrrev_b32 v252, 5, v250
    v_lshl_add_u32 v235, v252, 9, v235
    v_and_b32 v252, 3, v250
    v_lshl_add_u32 v235, v252, 4, v235
    s_nop 0
    v_and_b32 v251, 0, v251
    v_lshl_add_u32 v235, v251, 3, v235
    v_add_u32 v235, s36, v235
    v_and_b32 v251, 15, v250
    v_lshrrev_b32 v252, 4, v250
    v_lshrrev_b32 v253, 1, v251
    v_xor_b32 v253, v252, v253
    v_lshlrev_b32 v253, 4, v253
    v_lshl_add_u32 v236, v251, 7, v253
    v_xor_b32 v237, 64, v236
    v_add_u32 v236, 90848, v236
    v_add_u32 v237, 90848, v237
    v_mov_b32 v232, v235
    v_mov_b32 v233, v236
    v_mov_b32 v234, v237
    v_lshlrev_b32 v239, 4, v250
    s_lshl_b32 s36, s35, 11
    s_add_u32 s36, s36, 122880
    v_add_u32 v238, s36, v239
    s_mov_b32 s56, 0x3e0293ee
    s_mov_b32 s64, 0
    s_mov_b32 s50, 1
    s_lshl_b32 s78, s32, 10
    s_lshl_b32 s36, s35, 16
    s_add_u32 s78, s78, s36
    s_mul_i32 s79, s31, 163840
    s_mul_i32 s36, s35, 40960
    s_add_u32 s79, s79, s36
    s_mul_i32 s67, s35, 12544
    s_add_u32 s67, s67, 65760
    s_mul_i32 s68, s35, 5120
    s_add_u32 s68, s68, 90848
    s_mov_b32 s80, 16
    s_mov_b32 s63, 0
    s_lshl_b32 s58, s31, 5
    s_lshl_b32 s36, s32, 2
    s_add_u32 s58, s58, s36
    s_lshl_b32 s58, s58, 17

    s_mov_b32 s47, s29
    s_and_b32 s36, s34, 1
    s_lshl_b32 s59, s36, 12
    s_mov_b32 s60, 0
    s_mul_i32 s36, s35, 12288
    s_add_u32 s36, s36, 122880
    v_add_u32 v245, s36, v239
    s_and_b32 s81, s80, 15
    s_lshr_b32 s82, s80, 4
    s_lshl_b32 s65, s81, 18
    s_add_u32 s82, s82, s32
    s_and_b32 s82, s82, 3
    s_lshl_b32 s82, s82, 8
    s_add_u32 s65, s65, s82
    s_add_u32 s65, s65, s78
    s_lshr_b32 s66, s81, 1
    s_lshl_b32 s66, s66, 7
    s_add_u32 s66, s66, s79
    s_and_b32 s82, s80, 1
    s_mul_i32 s82, s82, 81920
    s_add_u32 s66, s66, s82
    s_cmp_ge_u32 s80, 64
    s_cselect_b32 s65, 0x400000, s65
    s_cselect_b32 s66, 0x400000, s66
    s_lshl_b32 s81, s63, 10
    s_add_u32 s81, s81, s67
    s_mul_i32 s82, s63, 10240
    s_add_u32 s82, s82, s68
    s_add_u32 s63, s63, 1
    s_cmp_eq_u32 s63, 3
    s_cselect_b32 s63, 0, s63
    s_add_u32 s80, s80, 1
    s_lshr_b32 s61, s60, 4
    s_add_u32 s61, s61, s32
    s_and_b32 s61, s61, 3
    s_lshl_b32 s61, s61, 17
    s_add_u32 s62, s60, s47
    s_and_b32 s62, s62, 15
    s_lshl_b32 s62, s62, 13
    s_add_u32 s61, s61, s62
    s_add_u32 s61, s61, s58
    s_and_b32 s62, s60, 3
    s_lshl_b32 s62, s62, 10
    s_add_u32 s71, s62, s59
    s_cmp_ge_i32 s60, 64
    s_cselect_b32 s61, 0x4000000, s61
    s_cselect_b32 s71, 0x30000, s71
    s_add_u32 s62, s61, 4096
    s_add_u32 s60, s60, 1
    s_waitcnt vmcnt(20) lgkmcnt(0)
    s_barrier
    s_add_u32 m0, s81, 0
    s_nop 0
    buffer_load_dwordx4 v240, s[12:15], s65 offen lds
    s_add_u32 m0, s81, 3136
    s_add_u32 s65, s65, 8192
    buffer_load_dwordx4 v240, s[12:15], s65 offen lds
    s_add_u32 m0, s81, 6272
    s_add_u32 s65, s65, 8192
    buffer_load_dwordx4 v240, s[12:15], s65 offen lds
    s_add_u32 m0, s81, 9408
    s_add_u32 s65, s65, 8192
    buffer_load_dwordx4 v240, s[12:15], s65 offen lds
    s_mov_b32 m0, s82
    s_nop 0
    buffer_load_dwordx4 v241, s[16:19], s66 offen lds
    s_add_u32 s66, s66, 7168
    buffer_load_dwordx4 v242, s[16:19], s66 offen offset:1024 lds
    s_add_u32 s66, s66, 7168
    buffer_load_dwordx4 v241, s[16:19], s66 offen offset:2048 lds
    s_add_u32 s66, s66, 7168
    buffer_load_dwordx4 v242, s[16:19], s66 offen offset:3072 lds
    s_add_u32 m0, s82, 4096
    s_add_u32 s66, s66, 11264
    buffer_load_dwordx4 v241, s[16:19], s66 offen lds
    s_and_b32 s81, s80, 15
    s_lshr_b32 s82, s80, 4
    s_lshl_b32 s65, s81, 18
    s_add_u32 s82, s82, s32
    s_and_b32 s82, s82, 3
    s_lshl_b32 s82, s82, 8
    s_add_u32 s65, s65, s82
    s_add_u32 s65, s65, s78
    s_lshr_b32 s66, s81, 1
    s_lshl_b32 s66, s66, 7
    s_add_u32 s66, s66, s79
    s_and_b32 s82, s80, 1
    s_mul_i32 s82, s82, 81920
    s_add_u32 s66, s66, s82
    s_cmp_ge_u32 s80, 64
    s_cselect_b32 s65, 0x400000, s65
    s_cselect_b32 s66, 0x400000, s66
    s_lshl_b32 s81, s63, 10
    s_add_u32 s81, s81, s67
    s_mul_i32 s82, s63, 10240
    s_add_u32 s82, s82, s68
    s_add_u32 s63, s63, 1
    s_cmp_eq_u32 s63, 3
    s_cselect_b32 s63, 0, s63
    s_add_u32 s80, s80, 1
    s_waitcnt vmcnt(27) lgkmcnt(0)
    s_barrier
    s_add_u32 m0, s81, 0
    s_nop 0
    buffer_load_dwordx4 v240, s[12:15], s65 offen lds
    s_add_u32 m0, s81, 3136
    s_add_u32 s65, s65, 8192
    buffer_load_dwordx4 v240, s[12:15], s65 offen lds
    s_add_u32 m0, s81, 6272
    s_add_u32 s65, s65, 8192
    buffer_load_dwordx4 v240, s[12:15], s65 offen lds
    s_add_u32 m0, s81, 9408
    s_add_u32 s65, s65, 8192
    buffer_load_dwordx4 v240, s[12:15], s65 offen lds
    s_mov_b32 m0, s82
    s_nop 0
    buffer_load_dwordx4 v241, s[16:19], s66 offen lds
    s_add_u32 s66, s66, 7168
    buffer_load_dwordx4 v242, s[16:19], s66 offen offset:1024 lds
    s_add_u32 s66, s66, 7168
    buffer_load_dwordx4 v241, s[16:19], s66 offen offset:2048 lds
    s_add_u32 s66, s66, 7168
    buffer_load_dwordx4 v242, s[16:19], s66 offen offset:3072 lds
    s_add_u32 m0, s82, 4096
    s_add_u32 s66, s66, 11264
    buffer_load_dwordx4 v241, s[16:19], s66 offen lds
    s_and_b32 s81, s80, 15
    s_lshr_b32 s82, s80, 4
    s_lshl_b32 s65, s81, 18
    s_add_u32 s82, s82, s32
    s_and_b32 s82, s82, 3
    s_lshl_b32 s82, s82, 8
    s_add_u32 s65, s65, s82
    s_add_u32 s65, s65, s78
    s_lshr_b32 s66, s81, 1
    s_lshl_b32 s66, s66, 7
    s_add_u32 s66, s66, s79
    s_and_b32 s82, s80, 1
    s_mul_i32 s82, s82, 81920
    s_add_u32 s66, s66, s82
    s_cmp_ge_u32 s80, 64
    s_cselect_b32 s65, 0x400000, s65
    s_cselect_b32 s66, 0x400000, s66
    s_lshl_b32 s81, s63, 10
    s_add_u32 s81, s81, s67
    s_mul_i32 s82, s63, 10240
    s_add_u32 s82, s82, s68
    s_add_u32 s63, s63, 1
    s_cmp_eq_u32 s63, 3
    s_cselect_b32 s63, 0, s63
    s_add_u32 s80, s80, 1
    s_waitcnt vmcnt(27)
    s_cmp_lg_u32 s35, 0
    s_cbranch_scc1 L_P3_s13
    s_add_u32 m0, s71, 0
    s_nop 0
    buffer_load_dwordx4 v239, s[8:11], s61 offen nt lds
    s_add_u32 m0, s71, 7200
    s_nop 0
    buffer_load_dwordx4 v239, s[8:11], s61 offen offset:1024 nt lds
    s_add_u32 m0, s71, 14400
    s_nop 0
    buffer_load_dwordx4 v239, s[8:11], s61 offen offset:2048 nt lds
    s_add_u32 m0, s71, 21600
    s_nop 0
    buffer_load_dwordx4 v239, s[8:11], s61 offen offset:3072 nt lds
    s_add_u32 m0, s71, 32896
    s_nop 0
    buffer_load_dwordx4 v239, s[8:11], s62 offen nt lds
    s_add_u32 m0, s71, 40096
    s_nop 0
    buffer_load_dwordx4 v239, s[8:11], s62 offen offset:1024 nt lds
    s_add_u32 m0, s71, 47296
    s_nop 0
    buffer_load_dwordx4 v239, s[8:11], s62 offen offset:2048 nt lds
    s_add_u32 m0, s71, 54496
    s_nop 0
    buffer_load_dwordx4 v239, s[8:11], s62 offen offset:3072 nt lds
    s_lshr_b32 s61, s60, 4
    s_add_u32 s61, s61, s32
    s_and_b32 s61, s61, 3
    s_lshl_b32 s61, s61, 17
    s_add_u32 s62, s60, s47
    s_and_b32 s62, s62, 15
    s_lshl_b32 s62, s62, 13
    s_add_u32 s61, s61, s62
    s_add_u32 s61, s61, s58
    s_and_b32 s62, s60, 3
    s_lshl_b32 s62, s62, 10
    s_add_u32 s71, s62, s59
    s_cmp_ge_i32 s60, 64
    s_cselect_b32 s61, 0x4000000, s61
    s_cselect_b32 s71, 0x30000, s71
    s_add_u32 s62, s61, 4096
    s_add_u32 s60, s60, 1
L_P3_s13:
    s_waitcnt lgkmcnt(0)
    s_barrier
    s_add_u32 m0, s81, 0
    s_nop 0
    buffer_load_dwordx4 v240, s[12:15], s65 offen lds
    s_add_u32 m0, s81, 3136
    s_add_u32 s65, s65, 8192
    buffer_load_dwordx4 v240, s[12:15], s65 offen lds
    s_add_u32 m0, s81, 6272
    s_add_u32 s65, s65, 8192
    buffer_load_dwordx4 v240, s[12:15], s65 offen lds
    s_add_u32 m0, s81, 9408
    s_add_u32 s65, s65, 8192
    buffer_load_dwordx4 v240, s[12:15], s65 offen lds
    s_mov_b32 m0, s82
    s_nop 0
    buffer_load_dwordx4 v241, s[16:19], s66 offen lds
    s_add_u32 s66, s66, 7168
    buffer_load_dwordx4 v242, s[16:19], s66 offen offset:1024 lds
    s_add_u32 s66, s66, 7168
    buffer_load_dwordx4 v241, s[16:19], s66 offen offset:2048 lds
    s_add_u32 s66, s66, 7168
    buffer_load_dwordx4 v242, s[16:19], s66 offen offset:3072 lds
    s_add_u32 m0, s82, 4096
    s_add_u32 s66, s66, 11264
    buffer_load_dwordx4 v241, s[16:19], s66 offen lds
    s_add_u32 m0, s71, 0
    s_and_b32 s81, s80, 15
    s_lshr_b32 s82, s80, 4
    s_lshl_b32 s65, s81, 18
    s_add_u32 s82, s82, s32
    buffer_load_dwordx4 v239, s[8:11], s61 offen nt lds
    s_add_u32 m0, s71, 7200
    s_and_b32 s82, s82, 3
    s_lshl_b32 s82, s82, 8
    s_add_u32 s65, s65, s82
    s_add_u32 s65, s65, s78
    buffer_load_dwordx4 v239, s[8:11], s61 offen offset:1024 nt lds
    s_add_u32 m0, s71, 14400
    s_lshr_b32 s66, s81, 1
    s_lshl_b32 s66, s66, 7
    s_add_u32 s66, s66, s79
    buffer_load_dwordx4 v239, s[8:11], s61 offen offset:2048 nt lds
    s_add_u32 m0, s71, 21600
    s_and_b32 s82, s80, 1
    s_mul_i32 s82, s82, 81920
    s_add_u32 s66, s66, s82
    buffer_load_dwordx4 v239, s[8:11], s61 offen offset:3072 nt lds
    s_add_u32 m0, s71, 32896
    s_cmp_ge_u32 s80, 64
    s_cselect_b32 s65, 0x400000, s65
    s_cselect_b32 s66, 0x400000, s66
    buffer_load_dwordx4 v239, s[8:11], s62 offen nt lds
    s_add_u32 m0, s71, 40096
    s_lshl_b32 s81, s63, 10
    s_add_u32 s81, s81, s67
    s_mul_i32 s82, s63, 10240
    s_add_u32 s82, s82, s68
    buffer_load_dwordx4 v239, s[8:11], s62 offen offset:1024 nt lds
    s_add_u32 m0, s71, 47296
    s_add_u32 s63, s63, 1
    s_cmp_eq_u32 s63, 3
    s_cselect_b32 s63, 0, s63
    s_add_u32 s80, s80, 1
    buffer_load_dwordx4 v239, s[8:11], s62 offen offset:2048 nt lds
    s_add_u32 m0, s71, 54496
    s_nop 0
    buffer_load_dwordx4 v239, s[8:11], s62 offen offset:3072 nt lds
    s_lshr_b32 s61, s60, 4
    s_add_u32 s61, s61, s32
    s_and_b32 s61, s61, 3
    s_lshl_b32 s61, s61, 17
    s_add_u32 s62, s60, s47
    s_and_b32 s62, s62, 15
    s_lshl_b32 s62, s62, 13
    s_add_u32 s61, s61, s62
    s_add_u32 s61, s61, s58
    s_and_b32 s62, s60, 3
    s_lshl_b32 s62, s62, 10
    s_add_u32 s71, s62, s59
    s_cmp_ge_i32 s60, 64
    s_cselect_b32 s61, 0x4000000, s61
    s_cselect_b32 s71, 0x30000, s71
    s_add_u32 s62, s61, 4096
    s_add_u32 s60, s60, 1
    s_waitcnt vmcnt(26) lgkmcnt(0)
    s_barrier
    ds_read_b128 v[168:171], v233 offset:8192
    ds_read_b128 v[184:187], v234 offset:8192
    ds_read_b64_tr_b16 v[112:113], v232 offset:0
    ds_read_b64_tr_b16 v[114:115], v232 offset:256
    s_add_u32 m0, s71, 0
    s_nop 0
    buffer_load_dwordx4 v239, s[8:11], s61 offen nt lds
    s_add_u32 m0, s71, 7200
    s_nop 0
    buffer_load_dwordx4 v239, s[8:11], s61 offen offset:1024 nt lds
    s_add_u32 m0, s71, 14400
    s_nop 0
    buffer_load_dwordx4 v239, s[8:11], s61 offen offset:2048 nt lds
    s_add_u32 m0, s71, 21600
    s_nop 0
    buffer_load_dwordx4 v239, s[8:11], s61 offen offset:3072 nt lds
    s_add_u32 m0, s71, 32896
    s_nop 0
    buffer_load_dwordx4 v239, s[8:11], s62 offen nt lds
    s_add_u32 m0, s71, 40096
    s_nop 0
    buffer_load_dwordx4 v239, s[8:11], s62 offen offset:1024 nt lds
    s_add_u32 m0, s71, 47296
    s_nop 0
    buffer_load_dwordx4 v239, s[8:11], s62 offen offset:2048 nt lds
    s_add_u32 m0, s71, 54496
    s_nop 0
    buffer_load_dwordx4 v239, s[8:11], s62 offen offset:3072 nt lds
    s_lshr_b32 s61, s60, 4
    s_add_u32 s61, s61, s32
    s_and_b32 s61, s61, 3
    s_lshl_b32 s61, s61, 17
    s_add_u32 s62, s60, s47
    s_and_b32 s62, s62, 15
    s_lshl_b32 s62, s62, 13
    s_add_u32 s61, s61, s62
    s_add_u32 s61, s61, s58
    s_and_b32 s62, s60, 3
    s_lshl_b32 s62, s62, 10
    s_add_u32 s71, s62, s59
    s_cmp_ge_i32 s60, 64
    s_cselect_b32 s61, 0x4000000, s61
    s_cselect_b32 s71, 0x30000, s71
    s_add_u32 s62, s61, 4096
    s_add_u32 s60, s60, 1
    ds_read_b64_tr_b16 v[116:117], v232 offset:8
    ds_read_b64_tr_b16 v[118:119], v232 offset:264
    ds_read_b64_tr_b16 v[120:121], v232 offset:64
    ds_read_b64_tr_b16 v[122:123], v232 offset:320
    ds_read_b64_tr_b16 v[124:125], v232 offset:72
    ds_read_b64_tr_b16 v[126:127], v232 offset:328
    s_add_u32 s64, s64, 1
    s_cmp_eq_u32 s64, 3
    s_cselect_b32 s64, 0, s64
    s_lshl_b32 s69, s64, 10
    s_mul_i32 s70, s64, 10240
    v_add_u32 v232, s69, v235
    v_add_u32 v233, s70, v236
    v_add_u32 v234, s70, v237
    s_waitcnt vmcnt(25) lgkmcnt(0)
    s_barrier
    ds_read_b128 v[144:147], v233 offset:6144
    ds_read_b128 v[148:151], v233 offset:8192
    ds_read_b64_tr_b16 v[128:129], v232 offset:0
    ds_read_b64_tr_b16 v[130:131], v232 offset:256
    s_add_u32 m0, s81, 0
    s_nop 0
    buffer_load_dwordx4 v240, s[12:15], s65 offen lds
    s_add_u32 m0, s81, 3136
    s_add_u32 s65, s65, 8192
    buffer_load_dwordx4 v240, s[12:15], s65 offen lds
    s_add_u32 m0, s81, 6272
    s_add_u32 s65, s65, 8192
    buffer_load_dwordx4 v240, s[12:15], s65 offen lds
    s_add_u32 m0, s81, 9408
    s_add_u32 s65, s65, 8192
    buffer_load_dwordx4 v240, s[12:15], s65 offen lds
    s_mov_b32 m0, s82
    s_nop 0
    buffer_load_dwordx4 v241, s[16:19], s66 offen lds
    s_add_u32 s66, s66, 7168
    buffer_load_dwordx4 v242, s[16:19], s66 offen offset:1024 lds
    s_add_u32 s66, s66, 7168
    buffer_load_dwordx4 v241, s[16:19], s66 offen offset:2048 lds
    s_add_u32 s66, s66, 7168
    buffer_load_dwordx4 v242, s[16:19], s66 offen offset:3072 lds
    s_add_u32 m0, s82, 4096
    s_add_u32 s66, s66, 11264
    buffer_load_dwordx4 v241, s[16:19], s66 offen lds
    s_add_u32 m0, s71, 0
    s_and_b32 s81, s80, 15
    s_lshr_b32 s82, s80, 4
    s_lshl_b32 s65, s81, 18
    s_add_u32 s82, s82, s32
    buffer_load_dwordx4 v239, s[8:11], s61 offen nt lds
    s_add_u32 m0, s71, 7200
    s_and_b32 s82, s82, 3
    s_lshl_b32 s82, s82, 8
    s_add_u32 s65, s65, s82
    s_add_u32 s65, s65, s78
    buffer_load_dwordx4 v239, s[8:11], s61 offen offset:1024 nt lds
    s_add_u32 m0, s71, 14400
    s_lshr_b32 s66, s81, 1
    s_lshl_b32 s66, s66, 7
    s_add_u32 s66, s66, s79
    buffer_load_dwordx4 v239, s[8:11], s61 offen offset:2048 nt lds
    s_add_u32 m0, s71, 21600
    s_and_b32 s82, s80, 1
    s_mul_i32 s82, s82, 81920
    s_add_u32 s66, s66, s82
    buffer_load_dwordx4 v239, s[8:11], s61 offen offset:3072 nt lds
    s_add_u32 m0, s71, 32896
    s_cmp_ge_u32 s80, 64
    s_cselect_b32 s65, 0x400000, s65
    s_cselect_b32 s66, 0x400000, s66
    buffer_load_dwordx4 v239, s[8:11], s62 offen nt lds
    s_add_u32 m0, s71, 40096
    s_lshl_b32 s81, s63, 10
    s_add_u32 s81, s81, s67
    s_mul_i32 s82, s63, 10240
    s_add_u32 s82, s82, s68
    buffer_load_dwordx4 v239, s[8:11], s62 offen offset:1024 nt lds
    s_add_u32 m0, s71, 47296
    s_add_u32 s63, s63, 1
    s_cmp_eq_u32 s63, 3
    s_cselect_b32 s63, 0, s63
    s_add_u32 s80, s80, 1
    buffer_load_dwordx4 v239, s[8:11], s62 offen offset:2048 nt lds
    s_add_u32 m0, s71, 54496
    s_nop 0
    buffer_load_dwordx4 v239, s[8:11], s62 offen offset:3072 nt lds
    s_lshr_b32 s61, s60, 4
    s_add_u32 s61, s61, s32
    s_and_b32 s61, s61, 3
    s_lshl_b32 s61, s61, 17
    s_add_u32 s62, s60, s47
    s_and_b32 s62, s62, 15
    s_lshl_b32 s62, s62, 13
    s_add_u32 s61, s61, s62
    s_add_u32 s61, s61, s58
    s_and_b32 s62, s60, 3
    s_lshl_b32 s62, s62, 10
    s_add_u32 s71, s62, s59
    s_cmp_ge_i32 s60, 64
    s_cselect_b32 s61, 0x4000000, s61
    s_cselect_b32 s71, 0x30000, s71
    s_add_u32 s62, s61, 4096
    s_add_u32 s60, s60, 1
    ds_read_b64_tr_b16 v[132:133], v232 offset:8
    ds_read_b64_tr_b16 v[134:135], v232 offset:264
    ds_read_b64_tr_b16 v[136:137], v232 offset:64
    ds_read_b64_tr_b16 v[138:139], v232 offset:320
    ds_read_b64_tr_b16 v[140:141], v232 offset:72
    ds_read_b64_tr_b16 v[142:143], v232 offset:328
    ds_read_b128 v[156:159], v234 offset:6144
    ds_read_b128 v[160:163], v234 offset:8192
    v_mov_b32 v200, v184
    v_mov_b32 v201, v185
    v_mov_b32 v202, v186
    v_mov_b32 v203, v187
    s_add_u32 s64, s64, 1
    s_cmp_eq_u32 s64, 3
    s_cselect_b32 s64, 0, s64
    s_lshl_b32 s69, s64, 10
    s_mul_i32 s70, s64, 10240
    v_add_u32 v232, s69, v235
    v_add_u32 v233, s70, v236
    v_add_u32 v234, s70, v237
    s_waitcnt vmcnt(33) lgkmcnt(0)
    s_barrier
L_P3_r2:
    s_mov_b32 s51, 0
    s_add_u32 m0, s81, 0
    s_nop 0
    buffer_load_dwordx4 v240, s[12:15], s65 offen lds
    s_add_u32 m0, s81, 3136
    s_add_u32 s65, s65, 8192
    buffer_load_dwordx4 v240, s[12:15], s65 offen lds
    v_mfma_f32_16x16x32_bf16 v[0:3], v[112:115], v[168:171], 0
    s_add_u32 m0, s81, 6272
    s_add_u32 s65, s65, 8192
    buffer_load_dwordx4 v240, s[12:15], s65 offen lds
    s_add_u32 s64, s64, 1
    s_cmp_eq_u32 s64, 3
    s_cselect_b32 s64, 0, s64
    s_lshl_b32 s69, s64, 10
    s_mul_i32 s70, s64, 10240
    v_mfma_f32_16x16x32_bf16 v[4:7], v[116:119], v[168:171], 0
    s_add_u32 m0, s81, 9408
    s_add_u32 s65, s65, 8192
    buffer_load_dwordx4 v240, s[12:15], s65 offen lds
    v_mfma_f32_16x16x32_bf16 v[8:11], v[120:123], v[168:171], 0
    s_mov_b32 m0, s82
    s_nop 0
    buffer_load_dwordx4 v241, s[16:19], s66 offen lds
    v_mfma_f32_16x16x32_bf16 v[12:15], v[124:127], v[168:171], 0
    ds_read_b128 v[168:171], v233 offset:8192
    ds_read_b128 v[184:187], v234 offset:8192
    s_add_u32 s66, s66, 7168
    buffer_load_dwordx4 v242, s[16:19], s66 offen offset:1024 lds
    s_add_u32 s66, s66, 7168
    buffer_load_dwordx4 v241, s[16:19], s66 offen offset:2048 lds
    v_mfma_f32_16x16x32_bf16 v[64:67], v[112:115], v[144:147], 0
    s_add_u32 s66, s66, 7168
    buffer_load_dwordx4 v242, s[16:19], s66 offen offset:3072 lds
    v_mfma_f32_16x16x32_bf16 v[80:83], v[112:115], v[148:151], 0
    s_add_u32 m0, s82, 4096
    s_add_u32 s66, s66, 11264
    buffer_load_dwordx4 v241, s[16:19], s66 offen lds
    ds_read_b64_tr_b16 v[112:113], v232 offset:0
    ds_read_b64_tr_b16 v[114:115], v232 offset:256
    v_mfma_f32_16x16x32_bf16 v[68:71], v[116:119], v[144:147], 0
    s_and_b32 s81, s80, 15
    s_lshr_b32 s82, s80, 4
    s_lshl_b32 s65, s81, 18
    s_add_u32 s82, s82, s32
    s_and_b32 s82, s82, 3
    s_lshl_b32 s82, s82, 8
    s_add_u32 s65, s65, s82
    s_add_u32 s65, s65, s78
    s_lshr_b32 s66, s81, 1
    s_lshl_b32 s66, s66, 7
    s_add_u32 s66, s66, s79
    s_and_b32 s82, s80, 1
    s_mul_i32 s82, s82, 81920
    s_add_u32 s66, s66, s82
    s_cmp_ge_u32 s80, 64
    s_cselect_b32 s65, 0x400000, s65
    s_cselect_b32 s66, 0x400000, s66
    s_lshl_b32 s81, s63, 10
    s_add_u32 s81, s81, s67
    s_mul_i32 s82, s63, 10240
    s_add_u32 s82, s82, s68
    s_add_u32 s63, s63, 1
    s_cmp_eq_u32 s63, 3
    s_cselect_b32 s63, 0, s63
    s_add_u32 s80, s80, 1
    v_mfma_f32_16x16x32_bf16 v[84:87], v[116:119], v[148:151], 0
    ds_read_b64_tr_b16 v[116:117], v232 offset:8
    ds_read_b64_tr_b16 v[118:119], v232 offset:264
    v_mfma_f32_16x16x32_bf16 v[72:75], v[120:123], v[144:147], 0
    v_mfma_f32_16x16x32_bf16 v[88:91], v[120:123], v[148:151], 0
    ds_read_b64_tr_b16 v[120:121], v232 offset:64
    ds_read_b64_tr_b16 v[122:123], v232 offset:320
    v_mfma_f32_16x16x32_bf16 v[76:79], v[124:127], v[144:147], 0
    v_mfma_f32_16x16x32_bf16 v[92:95], v[124:127], v[148:151], 0
    ds_read_b64_tr_b16 v[124:125], v232 offset:72
    ds_read_b64_tr_b16 v[126:127], v232 offset:328
    v_mfma_f32_16x16x32_bf16 v[0:3], v[128:131], v[200:203], v[0:3]
    v_add_u32 v232, s69, v235
    v_add_u32 v233, s70, v236
    v_add_u32 v234, s70, v237
    v_mfma_f32_16x16x32_bf16 v[4:7], v[132:135], v[200:203], v[4:7]
    v_mfma_f32_16x16x32_bf16 v[8:11], v[136:139], v[200:203], v[8:11]
    v_mfma_f32_16x16x32_bf16 v[12:15], v[140:143], v[200:203], v[12:15]
    s_waitcnt vmcnt(11) lgkmcnt(0)
    s_barrier
    ds_read_b128 v[144:147], v233 offset:6144
    ds_read_b128 v[148:151], v233 offset:8192
    s_add_u32 m0, s81, 0
    s_nop 0
    buffer_load_dwordx4 v240, s[12:15], s65 offen lds
    s_add_u32 m0, s81, 3136
    s_add_u32 s65, s65, 8192
    buffer_load_dwordx4 v240, s[12:15], s65 offen lds
    s_add_u32 m0, s81, 6272
    s_add_u32 s65, s65, 8192
    buffer_load_dwordx4 v240, s[12:15], s65 offen lds
    v_mfma_f32_16x16x32_bf16 v[64:67], v[128:131], v[156:159], v[64:67]
    s_add_u32 m0, s81, 9408
    s_add_u32 s65, s65, 8192
    buffer_load_dwordx4 v240, s[12:15], s65 offen lds
    s_mov_b32 m0, s82
    s_nop 0
    buffer_load_dwordx4 v241, s[16:19], s66 offen lds
    v_mov_b32 v200, v184
    s_add_u32 s64, s64, 1
    s_cmp_eq_u32 s64, 3
    s_cselect_b32 s64, 0, s64
    s_lshl_b32 s69, s64, 10
    s_mul_i32 s70, s64, 10240
    v_mfma_f32_16x16x32_bf16 v[80:83], v[128:131], v[160:163], v[80:83]
    s_add_u32 s66, s66, 7168
    buffer_load_dwordx4 v242, s[16:19], s66 offen offset:1024 lds
    s_add_u32 s66, s66, 7168
    buffer_load_dwordx4 v241, s[16:19], s66 offen offset:2048 lds
    ds_read_b64_tr_b16 v[128:129], v232 offset:0
    ds_read_b64_tr_b16 v[130:131], v232 offset:256
    v_mfma_f32_16x16x32_bf16 v[68:71], v[132:135], v[156:159], v[68:71]
    s_add_u32 s66, s66, 7168
    buffer_load_dwordx4 v242, s[16:19], s66 offen offset:3072 lds
    s_add_u32 m0, s82, 4096
    s_add_u32 s66, s66, 11264
    buffer_load_dwordx4 v241, s[16:19], s66 offen lds
    v_mfma_f32_16x16x32_bf16 v[84:87], v[132:135], v[160:163], v[84:87]
    s_add_u32 m0, s71, 0
    s_and_b32 s81, s80, 15
    s_lshr_b32 s82, s80, 4
    s_lshl_b32 s65, s81, 18
    s_add_u32 s82, s82, s32
    buffer_load_dwordx4 v239, s[8:11], s61 offen nt lds
    s_add_u32 m0, s71, 7200
    s_and_b32 s82, s82, 3
    s_lshl_b32 s82, s82, 8
    s_add_u32 s65, s65, s82
    s_add_u32 s65, s65, s78
    buffer_load_dwordx4 v239, s[8:11], s61 offen offset:1024 nt lds
    s_lshr_b32 s66, s81, 1
    s_lshl_b32 s66, s66, 7
    s_add_u32 s66, s66, s79
    ds_read_b64_tr_b16 v[132:133], v232 offset:8
    ds_read_b64_tr_b16 v[134:135], v232 offset:264
    v_mov_b32 v201, v185
    v_mfma_f32_16x16x32_bf16 v[72:75], v[136:139], v[156:159], v[72:75]
    s_and_b32 s82, s80, 1
    s_mul_i32 s82, s82, 81920
    s_add_u32 s66, s66, s82
    s_cmp_ge_u32 s80, 64
    s_cselect_b32 s65, 0x400000, s65
    s_cselect_b32 s66, 0x400000, s66
    v_mfma_f32_16x16x32_bf16 v[88:91], v[136:139], v[160:163], v[88:91]
    s_lshl_b32 s81, s63, 10
    s_add_u32 s81, s81, s67
    s_mul_i32 s82, s63, 10240
    s_add_u32 s82, s82, s68
    s_add_u32 s63, s63, 1
    s_cmp_eq_u32 s63, 3
    s_cselect_b32 s63, 0, s63
    s_add_u32 s80, s80, 1
    ds_read_b64_tr_b16 v[136:137], v232 offset:64
    ds_read_b64_tr_b16 v[138:139], v232 offset:320
    v_mfma_f32_16x16x32_bf16 v[76:79], v[140:143], v[156:159], v[76:79]
    s_lshr_b32 s61, s60, 4
    s_add_u32 s61, s61, s32
    s_and_b32 s61, s61, 3
    s_lshl_b32 s61, s61, 17
    s_add_u32 s62, s60, s47
    s_and_b32 s62, s62, 15
    s_lshl_b32 s62, s62, 13
    s_add_u32 s61, s61, s62
    s_add_u32 s61, s61, s58
    s_and_b32 s62, s60, 3
    s_lshl_b32 s62, s62, 10
    s_add_u32 s71, s62, s59
    s_cmp_ge_i32 s60, 64
    s_cselect_b32 s61, 0x4000000, s61
    s_cselect_b32 s71, 0x30000, s71
    s_add_u32 s62, s61, 4096
    s_add_u32 s60, s60, 1
    v_mov_b32 v202, v186
    v_mfma_f32_16x16x32_bf16 v[92:95], v[140:143], v[160:163], v[92:95]
    ds_read_b64_tr_b16 v[140:141], v232 offset:72
    ds_read_b64_tr_b16 v[142:143], v232 offset:328
    ds_read_b128 v[156:159], v234 offset:6144
    ds_read_b128 v[160:163], v234 offset:8192
    v_mfma_f32_16x16x32_bf16 v[0:3], v[112:115], v[168:171], v[0:3]
    v_add_u32 v232, s69, v235
    v_add_u32 v233, s70, v236
    v_add_u32 v234, s70, v237
    v_mfma_f32_16x16x32_bf16 v[4:7], v[116:119], v[168:171], v[4:7]
    v_mov_b32 v203, v187
    v_mfma_f32_16x16x32_bf16 v[8:11], v[120:123], v[168:171], v[8:11]
    v_mfma_f32_16x16x32_bf16 v[12:15], v[124:127], v[168:171], v[12:15]
    s_waitcnt vmcnt(11) lgkmcnt(0)
    s_barrier
    s_cmp_lg_u32 s50, 2
    s_cbranch_scc1 L_P3_pk0
    ds_read_b128 v[16:19], v245 offset:0
    ds_read_b128 v[20:23], v245 offset:1024
    ds_read_b128 v[24:27], v245 offset:2048
    ds_read_b128 v[28:31], v245 offset:3072
    ds_read_b128 v[32:35], v245 offset:4096
    ds_read_b128 v[36:39], v245 offset:5120
    ds_read_b128 v[40:43], v245 offset:6144
    ds_read_b128 v[44:47], v245 offset:7168
    ds_read_b128 v[48:51], v245 offset:8192
    ds_read_b128 v[52:55], v245 offset:9216
    ds_read_b128 v[56:59], v245 offset:10240
    ds_read_b128 v[60:63], v245 offset:11264
L_P3_pk0:
    s_cmp_lg_u32 s50, 3
    s_cbranch_scc1 L_P3_pk1
    ds_read_b128 v[96:99], v245 offset:0
    ds_read_b128 v[100:103], v245 offset:1024
    ds_read_b128 v[104:107], v245 offset:2048
    ds_read_b128 v[108:111], v245 offset:3072
    ds_read_b128 v[172:175], v245 offset:4096
    ds_read_b128 v[176:179], v245 offset:5120
    ds_read_b128 v[180:183], v245 offset:6144
    ds_read_b128 v[188:191], v245 offset:7168
    ds_read_b128 v[192:195], v245 offset:8192
    ds_read_b128 v[196:199], v245 offset:9216
    ds_read_b128 v[204:207], v245 offset:10240
    ds_read_b128 v[208:211], v245 offset:11264
L_P3_pk1:
L_P3_loop:
    ds_read_b128 v[168:171], v233 offset:8192
    ds_read_b128 v[184:187], v234 offset:8192
    s_add_u32 m0, s81, 0
    s_nop 0
    buffer_load_dwordx4 v240, s[12:15], s65 offen lds
    s_add_u32 m0, s81, 3136
    s_add_u32 s65, s65, 8192
    buffer_load_dwordx4 v240, s[12:15], s65 offen lds
    s_add_u32 m0, s81, 6272
    s_add_u32 s65, s65, 8192
    buffer_load_dwordx4 v240, s[12:15], s65 offen lds
    v_mfma_f32_16x16x32_bf16 v[64:67], v[112:115], v[144:147], v[64:67]
    s_add_u32 m0, s81, 9408
    s_add_u32 s65, s65, 8192
    buffer_load_dwordx4 v240, s[12:15], s65 offen lds
    s_mov_b32 m0, s82
    s_nop 0
    buffer_load_dwordx4 v241, s[16:19], s66 offen lds
    s_add_u32 s64, s64, 1
    s_cmp_eq_u32 s64, 3
    s_cselect_b32 s64, 0, s64
    s_lshl_b32 s69, s64, 10
    s_mul_i32 s70, s64, 10240
    v_mfma_f32_16x16x32_bf16 v[80:83], v[112:115], v[148:151], v[80:83]
    s_add_u32 s66, s66, 7168
    buffer_load_dwordx4 v242, s[16:19], s66 offen offset:1024 lds
    s_add_u32 s66, s66, 7168
    buffer_load_dwordx4 v241, s[16:19], s66 offen offset:2048 lds
    ds_read_b64_tr_b16 v[112:113], v232 offset:0
    ds_read_b64_tr_b16 v[114:115], v232 offset:256
    v_mfma_f32_16x16x32_bf16 v[68:71], v[116:119], v[144:147], v[68:71]
    s_add_u32 s66, s66, 7168
    buffer_load_dwordx4 v242, s[16:19], s66 offen offset:3072 lds
    s_add_u32 m0, s82, 4096
    s_add_u32 s66, s66, 11264
    buffer_load_dwordx4 v241, s[16:19], s66 offen lds
    v_mfma_f32_16x16x32_bf16 v[84:87], v[116:119], v[148:151], v[84:87]
    s_add_u32 m0, s71, 0
    s_and_b32 s81, s80, 15
    s_lshr_b32 s82, s80, 4
    s_lshl_b32 s65, s81, 18
    s_add_u32 s82, s82, s32
    buffer_load_dwordx4 v239, s[8:11], s61 offen nt lds
    s_add_u32 m0, s71, 7200
    s_and_b32 s82, s82, 3
    s_lshl_b32 s82, s82, 8
    s_add_u32 s65, s65, s82
    s_add_u32 s65, s65, s78
    buffer_load_dwordx4 v239, s[8:11], s61 offen offset:1024 nt lds
    s_lshr_b32 s66, s81, 1
    s_lshl_b32 s66, s66, 7
    s_add_u32 s66, s66, s79
    ds_read_b64_tr_b16 v[116:117], v232 offset:8
    ds_read_b64_tr_b16 v[118:119], v232 offset:264
    v_mfma_f32_16x16x32_bf16 v[72:75], v[120:123], v[144:147], v[72:75]
    s_and_b32 s82, s80, 1
    s_mul_i32 s82, s82, 81920
    s_add_u32 s66, s66, s82
    s_cmp_ge_u32 s80, 64
    s_cselect_b32 s65, 0x400000, s65
    s_cselect_b32 s66, 0x400000, s66
    v_mfma_f32_16x16x32_bf16 v[88:91], v[120:123], v[148:151], v[88:91]
    s_lshl_b32 s81, s63, 10
    s_add_u32 s81, s81, s67
    s_mul_i32 s82, s63, 10240
    s_add_u32 s82, s82, s68
    s_add_u32 s63, s63, 1
    s_cmp_eq_u32 s63, 3
    s_cselect_b32 s63, 0, s63
    s_add_u32 s80, s80, 1
    ds_read_b64_tr_b16 v[120:121], v232 offset:64
    ds_read_b64_tr_b16 v[122:123], v232 offset:320
    v_mfma_f32_16x16x32_bf16 v[76:79], v[124:127], v[144:147], v[76:79]
    s_lshr_b32 s61, s60, 4
    s_add_u32 s61, s61, s32
    s_and_b32 s61, s61, 3
    s_lshl_b32 s61, s61, 17
    s_add_u32 s62, s60, s47
    s_and_b32 s62, s62, 15
    s_lshl_b32 s62, s62, 13
    s_add_u32 s61, s61, s62
    s_add_u32 s61, s61, s58
    s_and_b32 s62, s60, 3
    s_lshl_b32 s62, s62, 10
    s_add_u32 s71, s62, s59
    s_cmp_ge_i32 s60, 64
    s_cselect_b32 s61, 0x4000000, s61
    s_cselect_b32 s71, 0x30000, s71
    s_add_u32 s62, s61, 4096
    s_add_u32 s60, s60, 1
    v_mfma_f32_16x16x32_bf16 v[92:95], v[124:127], v[148:151], v[92:95]
    ds_read_b64_tr_b16 v[124:125], v232 offset:72
    ds_read_b64_tr_b16 v[126:127], v232 offset:328
    v_mfma_f32_16x16x32_bf16 v[0:3], v[128:131], v[200:203], v[0:3]
    v_add_u32 v232, s69, v235
    v_add_u32 v233, s70, v236
    v_add_u32 v234, s70, v237
    v_mfma_f32_16x16x32_bf16 v[4:7], v[132:135], v[200:203], v[4:7]
    v_mfma_f32_16x16x32_bf16 v[8:11], v[136:139], v[200:203], v[8:11]
    v_mfma_f32_16x16x32_bf16 v[12:15], v[140:143], v[200:203], v[12:15]
    s_waitcnt vmcnt(13) lgkmcnt(0)
    s_barrier
    ds_read_b128 v[144:147], v233 offset:6144
    ds_read_b128 v[148:151], v233 offset:8192
    s_add_u32 m0, s81, 0
    s_nop 0
    buffer_load_dwordx4 v240, s[12:15], s65 offen lds
    s_add_u32 m0, s81, 3136
    s_add_u32 s65, s65, 8192
    buffer_load_dwordx4 v240, s[12:15], s65 offen lds
    s_add_u32 m0, s81, 6272
    s_add_u32 s65, s65, 8192
    buffer_load_dwordx4 v240, s[12:15], s65 offen lds
    v_mfma_f32_16x16x32_bf16 v[64:67], v[128:131], v[156:159], v[64:67]
    s_add_u32 m0, s81, 9408
    s_add_u32 s65, s65, 8192
    buffer_load_dwordx4 v240, s[12:15], s65 offen lds
    s_mov_b32 m0, s82
    s_nop 0
    buffer_load_dwordx4 v241, s[16:19], s66 offen lds
    v_mov_b32 v200, v184
    s_add_u32 s64, s64, 1
    s_cmp_eq_u32 s64, 3
    s_cselect_b32 s64, 0, s64
    s_lshl_b32 s69, s64, 10
    s_mul_i32 s70, s64, 10240
    v_mfma_f32_16x16x32_bf16 v[80:83], v[128:131], v[160:163], v[80:83]
    s_add_u32 s66, s66, 7168
    buffer_load_dwordx4 v242, s[16:19], s66 offen offset:1024 lds
    s_add_u32 s66, s66, 7168
    buffer_load_dwordx4 v241, s[16:19], s66 offen offset:2048 lds
    ds_read_b64_tr_b16 v[128:129], v232 offset:0
    ds_read_b64_tr_b16 v[130:131], v232 offset:256
    v_mfma_f32_16x16x32_bf16 v[68:71], v[132:135], v[156:159], v[68:71]
    s_add_u32 s66, s66, 7168
    buffer_load_dwordx4 v242, s[16:19], s66 offen offset:3072 lds
    s_add_u32 m0, s82, 4096
    s_add_u32 s66, s66, 11264
    buffer_load_dwordx4 v241, s[16:19], s66 offen lds
    v_mfma_f32_16x16x32_bf16 v[84:87], v[132:135], v[160:163], v[84:87]
    s_add_u32 m0, s71, 0
    s_and_b32 s81, s80, 15
    s_lshr_b32 s82, s80, 4
    s_lshl_b32 s65, s81, 18
    s_add_u32 s82, s82, s32
    buffer_load_dwordx4 v239, s[8:11], s61 offen nt lds
    s_add_u32 m0, s71, 7200
    s_and_b32 s82, s82, 3
    s_lshl_b32 s82, s82, 8
    s_add_u32 s65, s65, s82
    s_add_u32 s65, s65, s78
    buffer_load_dwordx4 v239, s[8:11], s61 offen offset:1024 nt lds
    s_lshr_b32 s66, s81, 1
    s_lshl_b32 s66, s66, 7
    s_add_u32 s66, s66, s79
    ds_read_b64_tr_b16 v[132:133], v232 offset:8
    ds_read_b64_tr_b16 v[134:135], v232 offset:264
    v_mov_b32 v201, v185
    v_mfma_f32_16x16x32_bf16 v[72:75], v[136:139], v[156:159], v[72:75]
    s_and_b32 s82, s80, 1
    s_mul_i32 s82, s82, 81920
    s_add_u32 s66, s66, s82
    s_cmp_ge_u32 s80, 64
    s_cselect_b32 s65, 0x400000, s65
    s_cselect_b32 s66, 0x400000, s66
    v_mfma_f32_16x16x32_bf16 v[88:91], v[136:139], v[160:163], v[88:91]
    s_lshl_b32 s81, s63, 10
    s_add_u32 s81, s81, s67
    s_mul_i32 s82, s63, 10240
    s_add_u32 s82, s82, s68
    s_add_u32 s63, s63, 1
    s_cmp_eq_u32 s63, 3
    s_cselect_b32 s63, 0, s63
    s_add_u32 s80, s80, 1
    ds_read_b64_tr_b16 v[136:137], v232 offset:64
    ds_read_b64_tr_b16 v[138:139], v232 offset:320
    v_mfma_f32_16x16x32_bf16 v[76:79], v[140:143], v[156:159], v[76:79]
    s_lshr_b32 s61, s60, 4
    s_add_u32 s61, s61, s32
    s_and_b32 s61, s61, 3
    s_lshl_b32 s61, s61, 17
    s_add_u32 s62, s60, s47
    s_and_b32 s62, s62, 15
    s_lshl_b32 s62, s62, 13
    s_add_u32 s61, s61, s62
    s_add_u32 s61, s61, s58
    s_and_b32 s62, s60, 3
    s_lshl_b32 s62, s62, 10
    s_add_u32 s71, s62, s59
    s_cmp_ge_i32 s60, 64
    s_cselect_b32 s61, 0x4000000, s61
    s_cselect_b32 s71, 0x30000, s71
    s_add_u32 s62, s61, 4096
    s_add_u32 s60, s60, 1
    v_mov_b32 v202, v186
    v_mfma_f32_16x16x32_bf16 v[92:95], v[140:143], v[160:163], v[92:95]
    ds_read_b64_tr_b16 v[140:141], v232 offset:72
    ds_read_b64_tr_b16 v[142:143], v232 offset:328
    ds_read_b128 v[156:159], v234 offset:6144
    ds_read_b128 v[160:163], v234 offset:8192
    v_mfma_f32_16x16x32_bf16 v[0:3], v[112:115], v[168:171], v[0:3]
    v_add_u32 v232, s69, v235
    v_add_u32 v233, s70, v236
    v_add_u32 v234, s70, v237
    v_mfma_f32_16x16x32_bf16 v[4:7], v[116:119], v[168:171], v[4:7]
    v_mov_b32 v203, v187
    v_mfma_f32_16x16x32_bf16 v[8:11], v[120:123], v[168:171], v[8:11]
    v_mfma_f32_16x16x32_bf16 v[12:15], v[124:127], v[168:171], v[12:15]
    s_waitcnt vmcnt(13) lgkmcnt(0)
    s_barrier
    s_add_u32 s51, s51, 1
    s_cmp_lt_u32 s51, 6
    s_cbranch_scc1 L_P3_loop
    s_add_u32 m0, s81, 0
    s_nop 0
    buffer_load_dwordx4 v240, s[12:15], s65 offen lds
    s_add_u32 m0, s81, 3136
    s_add_u32 s65, s65, 8192
    buffer_load_dwordx4 v240, s[12:15], s65 offen lds
    s_add_u32 m0, s81, 6272
    s_add_u32 s65, s65, 8192
    buffer_load_dwordx4 v240, s[12:15], s65 offen lds
    v_mfma_f32_16x16x32_bf16 v[0:3], v[128:131], v[200:203], v[0:3]
    s_add_u32 m0, s81, 9408
    s_add_u32 s65, s65, 8192
    buffer_load_dwordx4 v240, s[12:15], s65 offen lds
    s_mov_b32 m0, s82
    s_nop 0
    buffer_load_dwordx4 v241, s[16:19], s66 offen lds
    v_mfma_f32_16x16x32_bf16 v[4:7], v[132:135], v[200:203], v[4:7]
    s_add_u32 s66, s66, 7168
    buffer_load_dwordx4 v242, s[16:19], s66 offen offset:1024 lds
    s_add_u32 s66, s66, 7168
    buffer_load_dwordx4 v241, s[16:19], s66 offen offset:2048 lds
    v_mfma_f32_16x16x32_bf16 v[8:11], v[136:139], v[200:203], v[8:11]
    s_add_u32 s66, s66, 7168
    buffer_load_dwordx4 v242, s[16:19], s66 offen offset:3072 lds
    s_add_u32 m0, s82, 4096
    s_add_u32 s66, s66, 11264
    buffer_load_dwordx4 v241, s[16:19], s66 offen lds
    v_mfma_f32_16x16x32_bf16 v[12:15], v[140:143], v[200:203], v[12:15]
    s_add_u32 m0, s71, 0
    s_and_b32 s81, s80, 15
    s_lshr_b32 s82, s80, 4
    s_lshl_b32 s65, s81, 18
    s_add_u32 s82, s82, s32
    buffer_load_dwordx4 v239, s[8:11], s61 offen nt lds
    s_add_u32 m0, s71, 7200
    s_and_b32 s82, s82, 3
    s_lshl_b32 s82, s82, 8
    s_add_u32 s65, s65, s82
    s_add_u32 s65, s65, s78
    buffer_load_dwordx4 v239, s[8:11], s61 offen offset:1024 nt lds
    s_lshr_b32 s66, s81, 1
    s_lshl_b32 s66, s66, 7
    s_add_u32 s66, s66, s79
    v_mfma_f32_16x16x32_bf16 v[64:67], v[112:115], v[144:147], v[64:67]
    s_and_b32 s82, s80, 1
    s_mul_i32 s82, s82, 81920
    s_add_u32 s66, s66, s82
    s_cmp_ge_u32 s80, 64
    s_cselect_b32 s65, 0x400000, s65
    s_cselect_b32 s66, 0x400000, s66
    v_mfma_f32_16x16x32_bf16 v[80:83], v[112:115], v[148:151], v[80:83]
    s_lshl_b32 s81, s63, 10
    s_add_u32 s81, s81, s67
    s_mul_i32 s82, s63, 10240
    s_add_u32 s82, s82, s68
    s_add_u32 s63, s63, 1
    s_cmp_eq_u32 s63, 3
    s_cselect_b32 s63, 0, s63
    s_add_u32 s80, s80, 1
    v_mul_f32 v0, s56, v0
    v_mul_f32 v1, s56, v1
    v_mfma_f32_16x16x32_bf16 v[68:71], v[116:119], v[144:147], v[68:71]
    s_lshr_b32 s61, s60, 4
    s_add_u32 s61, s61, s32
    s_and_b32 s61, s61, 3
    s_lshl_b32 s61, s61, 17
    s_add_u32 s62, s60, s47
    s_and_b32 s62, s62, 15
    s_lshl_b32 s62, s62, 13
    s_add_u32 s61, s61, s62
    s_add_u32 s61, s61, s58
    s_and_b32 s62, s60, 3
    s_lshl_b32 s62, s62, 10
    s_add_u32 s71, s62, s59
    s_cmp_ge_i32 s60, 64
    s_cselect_b32 s61, 0x4000000, s61
    s_cselect_b32 s71, 0x30000, s71
    s_add_u32 s62, s61, 4096
    s_add_u32 s60, s60, 1
    v_mul_f32 v2, s56, v2
    v_mul_f32 v3, s56, v3
    v_mfma_f32_16x16x32_bf16 v[84:87], v[116:119], v[148:151], v[84:87]
    v_mul_f32 v4, s56, v4
    v_mul_f32 v5, s56, v5
    v_mfma_f32_16x16x32_bf16 v[72:75], v[120:123], v[144:147], v[72:75]
    v_mul_f32 v6, s56, v6
    v_mul_f32 v7, s56, v7
    v_mfma_f32_16x16x32_bf16 v[88:91], v[120:123], v[148:151], v[88:91]
    v_cvt_pk_bf16_f32 v216, v0, v1
    v_cvt_pk_bf16_f32 v217, v2, v3
    v_mfma_f32_16x16x32_bf16 v[76:79], v[124:127], v[144:147], v[76:79]
    v_cvt_pk_bf16_f32 v218, v4, v5
    v_cvt_pk_bf16_f32 v219, v6, v7
    v_mfma_f32_16x16x32_bf16 v[92:95], v[124:127], v[148:151], v[92:95]
    ds_write_b128 v238, v[216:219] offset:16384
    s_waitcnt vmcnt(22) lgkmcnt(0)
    s_barrier
    s_cmp_eq_u32 s50, 3
    s_cbranch_scc1 L_P3_fin
    s_add_u32 s50, s50, 1
    ds_read_b128 v[168:171], v233 offset:8192
    ds_read_b128 v[184:187], v234 offset:8192
    ds_read_b64_tr_b16 v[112:113], v232 offset:0
    ds_read_b64_tr_b16 v[114:115], v232 offset:256
    s_add_u32 m0, s71, 0
    s_nop 0
    buffer_load_dwordx4 v239, s[8:11], s61 offen nt lds
    s_add_u32 m0, s71, 7200
    s_nop 0
    buffer_load_dwordx4 v239, s[8:11], s61 offen offset:1024 nt lds
    ds_read_b64_tr_b16 v[116:117], v232 offset:8
    v_mul_f32 v8, s56, v8
    v_mul_f32 v9, s56, v9
    v_mfma_f32_16x16x32_bf16 v[64:67], v[128:131], v[156:159], v[64:67]
    ds_read_b64_tr_b16 v[118:119], v232 offset:264
    v_mul_f32 v10, s56, v10
    s_add_u32 s64, s64, 1
    s_cmp_eq_u32 s64, 3
    s_cselect_b32 s64, 0, s64
    s_lshl_b32 s69, s64, 10
    s_mul_i32 s70, s64, 10240
    v_mfma_f32_16x16x32_bf16 v[68:71], v[132:135], v[156:159], v[68:71]
    ds_read_b64_tr_b16 v[120:121], v232 offset:64
    v_mul_f32 v11, s56, v11
    v_mul_f32 v12, s56, v12
    v_mfma_f32_16x16x32_bf16 v[72:75], v[136:139], v[156:159], v[72:75]
    v_mul_f32 v13, s56, v13
    v_mfma_f32_16x16x32_bf16 v[76:79], v[140:143], v[156:159], v[76:79]
    ds_read_b64_tr_b16 v[122:123], v232 offset:320
    v_mul_f32 v14, s56, v14
    v_mul_f32 v15, s56, v15
    v_mfma_f32_16x16x32_bf16 v[80:83], v[128:131], v[160:163], v[80:83]
    ds_read_b64_tr_b16 v[124:125], v232 offset:72
    v_cvt_pk_bf16_f32 v220, v8, v9
    v_mfma_f32_16x16x32_bf16 v[84:87], v[132:135], v[160:163], v[84:87]
    ds_read_b64_tr_b16 v[126:127], v232 offset:328
    v_cvt_pk_bf16_f32 v221, v10, v11
    v_cvt_pk_bf16_f32 v222, v12, v13
    v_mfma_f32_16x16x32_bf16 v[88:91], v[136:139], v[160:163], v[88:91]
    s_lshr_b32 s61, s60, 4
    s_add_u32 s61, s61, s32
    s_and_b32 s61, s61, 3
    s_lshl_b32 s61, s61, 17
    s_add_u32 s62, s60, s47
    s_and_b32 s62, s62, 15
    s_lshl_b32 s62, s62, 13
    s_add_u32 s61, s61, s62
    s_add_u32 s61, s61, s58
    s_and_b32 s62, s60, 3
    s_lshl_b32 s62, s62, 10
    s_add_u32 s71, s62, s59
    s_cmp_ge_i32 s60, 64
    s_cselect_b32 s61, 0x4000000, s61
    s_cselect_b32 s71, 0x30000, s71
    s_add_u32 s62, s61, 4096
    s_add_u32 s60, s60, 1
    v_cvt_pk_bf16_f32 v223, v14, v15
    v_mfma_f32_16x16x32_bf16 v[92:95], v[140:143], v[160:163], v[92:95]
    ds_write_b128 v238, v[220:223] offset:17408
    v_mul_f32 v64, s56, v64
    v_mul_f32 v65, s56, v65
    v_mul_f32 v66, s56, v66
    v_mul_f32 v67, s56, v67
    v_mul_f32 v68, s56, v68
    v_mul_f32 v69, s56, v69
    v_mul_f32 v70, s56, v70
    v_mul_f32 v71, s56, v71
    v_cvt_pk_bf16_f32 v224, v64, v65
    v_cvt_pk_bf16_f32 v225, v66, v67
    v_cvt_pk_bf16_f32 v226, v68, v69
    v_cvt_pk_bf16_f32 v227, v70, v71
    ds_write_b128 v238, v[224:227] offset:32768
    v_mul_f32 v72, s56, v72
    v_mul_f32 v73, s56, v73
    v_mul_f32 v74, s56, v74
    v_mul_f32 v75, s56, v75
    v_mul_f32 v76, s56, v76
    v_mul_f32 v77, s56, v77
    v_mul_f32 v78, s56, v78
    v_mul_f32 v79, s56, v79
    v_cvt_pk_bf16_f32 v228, v72, v73
    v_cvt_pk_bf16_f32 v229, v74, v75
    v_cvt_pk_bf16_f32 v230, v76, v77
    v_cvt_pk_bf16_f32 v231, v78, v79
    ds_write_b128 v238, v[228:231] offset:33792
    v_add_u32 v232, s69, v235
    v_add_u32 v233, s70, v236
    v_add_u32 v234, s70, v237
    s_waitcnt vmcnt(13) lgkmcnt(0)
    s_barrier
    ds_read_b128 v[144:147], v233 offset:6144
    ds_read_b128 v[148:151], v233 offset:8192
    ds_read_b64_tr_b16 v[128:129], v232 offset:0
    ds_read_b64_tr_b16 v[130:131], v232 offset:256
    s_add_u32 m0, s81, 0
    s_nop 0
    buffer_load_dwordx4 v240, s[12:15], s65 offen lds
    s_add_u32 m0, s81, 3136
    s_add_u32 s65, s65, 8192
    buffer_load_dwordx4 v240, s[12:15], s65 offen lds
    s_add_u32 m0, s81, 6272
    s_add_u32 s65, s65, 8192
    buffer_load_dwordx4 v240, s[12:15], s65 offen lds
    s_add_u32 m0, s81, 9408
    s_add_u32 s65, s65, 8192
    buffer_load_dwordx4 v240, s[12:15], s65 offen lds
    s_mov_b32 m0, s82
    s_nop 0
    buffer_load_dwordx4 v241, s[16:19], s66 offen lds
    s_add_u32 s66, s66, 7168
    buffer_load_dwordx4 v242, s[16:19], s66 offen offset:1024 lds
    s_add_u32 s66, s66, 7168
    buffer_load_dwordx4 v241, s[16:19], s66 offen offset:2048 lds
    s_add_u32 s66, s66, 7168
    buffer_load_dwordx4 v242, s[16:19], s66 offen offset:3072 lds
    s_add_u32 m0, s82, 4096
    s_add_u32 s66, s66, 11264
    buffer_load_dwordx4 v241, s[16:19], s66 offen lds
    s_add_u32 m0, s71, 0
    s_and_b32 s81, s80, 15
    s_lshr_b32 s82, s80, 4
    s_lshl_b32 s65, s81, 18
    s_add_u32 s82, s82, s32
    buffer_load_dwordx4 v239, s[8:11], s61 offen nt lds
    s_add_u32 m0, s71, 7200
    s_and_b32 s82, s82, 3
    s_lshl_b32 s82, s82, 8
    s_add_u32 s65, s65, s82
    s_add_u32 s65, s65, s78
    buffer_load_dwordx4 v239, s[8:11], s61 offen offset:1024 nt lds
    s_lshr_b32 s66, s81, 1
    s_lshl_b32 s66, s66, 7
    s_add_u32 s66, s66, s79
    s_and_b32 s82, s80, 1
    s_mul_i32 s82, s82, 81920
    s_add_u32 s66, s66, s82
    s_cmp_ge_u32 s80, 64
    s_cselect_b32 s65, 0x400000, s65
    s_cselect_b32 s66, 0x400000, s66
    s_lshl_b32 s81, s63, 10
    s_add_u32 s81, s81, s67
    s_mul_i32 s82, s63, 10240
    s_add_u32 s82, s82, s68
    s_add_u32 s63, s63, 1
    s_cmp_eq_u32 s63, 3
    s_cselect_b32 s63, 0, s63
    s_add_u32 s80, s80, 1
    s_lshr_b32 s61, s60, 4
    s_add_u32 s61, s61, s32
    s_and_b32 s61, s61, 3
    s_lshl_b32 s61, s61, 17
    s_add_u32 s62, s60, s47
    s_and_b32 s62, s62, 15
    s_lshl_b32 s62, s62, 13
    s_add_u32 s61, s61, s62
    s_add_u32 s61, s61, s58
    s_and_b32 s62, s60, 3
    s_lshl_b32 s62, s62, 10
    s_add_u32 s71, s62, s59
    s_cmp_ge_i32 s60, 64
    s_cselect_b32 s61, 0x4000000, s61
    s_cselect_b32 s71, 0x30000, s71
    s_add_u32 s62, s61, 4096
    s_add_u32 s60, s60, 1
    ds_read_b64_tr_b16 v[132:133], v232 offset:8
    ds_read_b64_tr_b16 v[134:135], v232 offset:264
    ds_read_b64_tr_b16 v[136:137], v232 offset:64
    ds_read_b64_tr_b16 v[138:139], v232 offset:320
    ds_read_b64_tr_b16 v[140:141], v232 offset:72
    ds_read_b64_tr_b16 v[142:143], v232 offset:328
    ds_read_b128 v[156:159], v234 offset:6144
    ds_read_b128 v[160:163], v234 offset:8192
    v_mul_f32 v80, s56, v80
    v_mul_f32 v81, s56, v81
    v_mul_f32 v82, s56, v82
    v_mul_f32 v83, s56, v83
    v_mul_f32 v84, s56, v84
    v_mul_f32 v85, s56, v85
    v_mul_f32 v86, s56, v86
    v_mul_f32 v87, s56, v87
    v_cvt_pk_bf16_f32 v216, v80, v81
    v_cvt_pk_bf16_f32 v217, v82, v83
    v_cvt_pk_bf16_f32 v218, v84, v85
    v_cvt_pk_bf16_f32 v219, v86, v87
    ds_write_b128 v238, v[216:219] offset:36864
    v_mul_f32 v88, s56, v88
    v_mul_f32 v89, s56, v89
    v_mul_f32 v90, s56, v90
    v_mul_f32 v91, s56, v91
    v_mul_f32 v92, s56, v92
    v_mul_f32 v93, s56, v93
    v_mul_f32 v94, s56, v94
    v_mul_f32 v95, s56, v95
    v_cvt_pk_bf16_f32 v220, v88, v89
    v_cvt_pk_bf16_f32 v221, v90, v91
    v_cvt_pk_bf16_f32 v222, v92, v93
    v_cvt_pk_bf16_f32 v223, v94, v95
    ds_write_b128 v238, v[220:223] offset:37888
    v_mov_b32 v200, v184
    v_mov_b32 v201, v185
    v_mov_b32 v202, v186
    v_mov_b32 v203, v187
    s_add_u32 s64, s64, 1
    s_cmp_eq_u32 s64, 3
    s_cselect_b32 s64, 0, s64
    s_lshl_b32 s69, s64, 10
    s_mul_i32 s70, s64, 10240
    v_add_u32 v232, s69, v235
    v_add_u32 v233, s70, v236
    v_add_u32 v234, s70, v237
    s_waitcnt vmcnt(15) lgkmcnt(0)
    s_barrier
    s_branch L_P3_r2
L_P3_fin:
    s_add_u32 m0, s71, 0
    s_nop 0
    buffer_load_dwordx4 v239, s[8:11], s61 offen nt lds
    s_add_u32 m0, s71, 7200
    s_nop 0
    buffer_load_dwordx4 v239, s[8:11], s61 offen offset:1024 nt lds
    v_mul_f32 v8, s56, v8
    v_mul_f32 v9, s56, v9
    v_mfma_f32_16x16x32_bf16 v[64:67], v[128:131], v[156:159], v[64:67]
    v_mul_f32 v10, s56, v10
    v_mfma_f32_16x16x32_bf16 v[68:71], v[132:135], v[156:159], v[68:71]
    v_mul_f32 v11, s56, v11
    v_mul_f32 v12, s56, v12
    v_mfma_f32_16x16x32_bf16 v[72:75], v[136:139], v[156:159], v[72:75]
    v_mul_f32 v13, s56, v13
    v_mfma_f32_16x16x32_bf16 v[76:79], v[140:143], v[156:159], v[76:79]
    v_mul_f32 v14, s56, v14
    v_mul_f32 v15, s56, v15
    v_mfma_f32_16x16x32_bf16 v[80:83], v[128:131], v[160:163], v[80:83]
    v_cvt_pk_bf16_f32 v220, v8, v9
    v_mfma_f32_16x16x32_bf16 v[84:87], v[132:135], v[160:163], v[84:87]
    v_cvt_pk_bf16_f32 v221, v10, v11
    v_cvt_pk_bf16_f32 v222, v12, v13
    v_mfma_f32_16x16x32_bf16 v[88:91], v[136:139], v[160:163], v[88:91]
    s_lshr_b32 s61, s60, 4
    s_add_u32 s61, s61, s32
    s_and_b32 s61, s61, 3
    s_lshl_b32 s61, s61, 17
    s_add_u32 s62, s60, s47
    s_and_b32 s62, s62, 15
    s_lshl_b32 s62, s62, 13
    s_add_u32 s61, s61, s62
    s_add_u32 s61, s61, s58
    s_and_b32 s62, s60, 3
    s_lshl_b32 s62, s62, 10
    s_add_u32 s71, s62, s59
    s_cmp_ge_i32 s60, 64
    s_cselect_b32 s61, 0x4000000, s61
    s_cselect_b32 s71, 0x30000, s71
    s_add_u32 s62, s61, 4096
    s_add_u32 s60, s60, 1
    v_cvt_pk_bf16_f32 v223, v14, v15
    v_mfma_f32_16x16x32_bf16 v[92:95], v[140:143], v[160:163], v[92:95]
    ds_write_b128 v238, v[220:223] offset:17408
    v_mul_f32 v64, s56, v64
    v_mul_f32 v65, s56, v65
    v_mul_f32 v66, s56, v66
    v_mul_f32 v67, s56, v67
    v_mul_f32 v68, s56, v68
    v_mul_f32 v69, s56, v69
    v_mul_f32 v70, s56, v70
    v_mul_f32 v71, s56, v71
    v_cvt_pk_bf16_f32 v224, v64, v65
    v_cvt_pk_bf16_f32 v225, v66, v67
    v_cvt_pk_bf16_f32 v226, v68, v69
    v_cvt_pk_bf16_f32 v227, v70, v71
    ds_write_b128 v238, v[224:227] offset:32768
    v_mul_f32 v72, s56, v72
    v_mul_f32 v73, s56, v73
    v_mul_f32 v74, s56, v74
    v_mul_f32 v75, s56, v75
    v_mul_f32 v76, s56, v76
    v_mul_f32 v77, s56, v77
    v_mul_f32 v78, s56, v78
    v_mul_f32 v79, s56, v79
    v_cvt_pk_bf16_f32 v228, v72, v73
    v_cvt_pk_bf16_f32 v229, v74, v75
    v_cvt_pk_bf16_f32 v230, v76, v77
    v_cvt_pk_bf16_f32 v231, v78, v79
    ds_write_b128 v238, v[228:231] offset:33792
    s_waitcnt vmcnt(13) lgkmcnt(0)
    s_barrier
    s_add_u32 m0, s71, 0
    s_nop 0
    buffer_load_dwordx4 v239, s[8:11], s61 offen nt lds
    s_add_u32 m0, s71, 7200
    s_nop 0
    buffer_load_dwordx4 v239, s[8:11], s61 offen offset:1024 nt lds
    s_lshr_b32 s61, s60, 4
    s_add_u32 s61, s61, s32
    s_and_b32 s61, s61, 3
    s_lshl_b32 s61, s61, 17
    s_add_u32 s62, s60, s47
    s_and_b32 s62, s62, 15
    s_lshl_b32 s62, s62, 13
    s_add_u32 s61, s61, s62
    s_add_u32 s61, s61, s58
    s_and_b32 s62, s60, 3
    s_lshl_b32 s62, s62, 10
    s_add_u32 s71, s62, s59
    s_cmp_ge_i32 s60, 64
    s_cselect_b32 s61, 0x4000000, s61
    s_cselect_b32 s71, 0x30000, s71
    s_add_u32 s62, s61, 4096
    s_add_u32 s60, s60, 1
    v_mul_f32 v80, s56, v80
    v_mul_f32 v81, s56, v81
    v_mul_f32 v82, s56, v82
    v_mul_f32 v83, s56, v83
    v_mul_f32 v84, s56, v84
    v_mul_f32 v85, s56, v85
    v_mul_f32 v86, s56, v86
    v_mul_f32 v87, s56, v87
    v_cvt_pk_bf16_f32 v216, v80, v81
    v_cvt_pk_bf16_f32 v217, v82, v83
    v_cvt_pk_bf16_f32 v218, v84, v85
    v_cvt_pk_bf16_f32 v219, v86, v87
    ds_write_b128 v238, v[216:219] offset:36864
    v_mul_f32 v88, s56, v88
    v_mul_f32 v89, s56, v89
    v_mul_f32 v90, s56, v90
    v_mul_f32 v91, s56, v91
    v_mul_f32 v92, s56, v92
    v_mul_f32 v93, s56, v93
    v_mul_f32 v94, s56, v94
    v_mul_f32 v95, s56, v95
    v_cvt_pk_bf16_f32 v220, v88, v89
    v_cvt_pk_bf16_f32 v221, v90, v91
    v_cvt_pk_bf16_f32 v222, v92, v93
    v_cvt_pk_bf16_f32 v223, v94, v95
    ds_write_b128 v238, v[220:223] offset:37888
    s_waitcnt vmcnt(4) lgkmcnt(0)
    s_barrier
    v_subrev_u32 v245, 40960, v245
    s_nop 4
    ds_write_b128 v245, v[96:99] offset:0
    ds_write_b128 v245, v[100:103] offset:1024
    ds_write_b128 v245, v[104:107] offset:2048
    ds_write_b128 v245, v[108:111] offset:3072
    ds_write_b128 v245, v[172:175] offset:4096
    ds_write_b128 v245, v[176:179] offset:5120
    ds_write_b128 v245, v[180:183] offset:6144
    ds_write_b128 v245, v[188:191] offset:7168
    ds_write_b128 v245, v[192:195] offset:8192
    ds_write_b128 v245, v[196:199] offset:9216
    ds_write_b128 v245, v[204:207] offset:10240
    ds_write_b128 v245, v[208:211] offset:11264
    s_waitcnt lgkmcnt(0)
    v_mov_b32 v176, v16
    v_mov_b32 v177, v17
    v_mov_b32 v178, v18
    v_mov_b32 v179, v19
    v_mov_b32 v180, v20
    v_mov_b32 v181, v21
    v_mov_b32 v182, v22
    v_mov_b32 v183, v23
    v_mov_b32 v184, v24
    v_mov_b32 v185, v25
    v_mov_b32 v186, v26
    v_mov_b32 v187, v27
    v_mov_b32 v188, v28
    v_mov_b32 v189, v29
    v_mov_b32 v190, v30
    v_mov_b32 v191, v31
    v_mov_b32 v192, v32
    v_mov_b32 v193, v33
    v_mov_b32 v194, v34
    v_mov_b32 v195, v35
    v_mov_b32 v196, v36
    v_mov_b32 v197, v37
    v_mov_b32 v198, v38
    v_mov_b32 v199, v39
    v_mov_b32 v200, v40
    v_mov_b32 v201, v41
    v_mov_b32 v202, v42
    v_mov_b32 v203, v43
    v_mov_b32 v204, v44
    v_mov_b32 v205, v45
    v_mov_b32 v206, v46
    v_mov_b32 v207, v47
    v_mov_b32 v208, v48
    v_mov_b32 v209, v49
    v_mov_b32 v210, v50
    v_mov_b32 v211, v51
    v_mov_b32 v212, v52
    v_mov_b32 v213, v53
    v_mov_b32 v214, v54
    v_mov_b32 v215, v55
    v_mov_b32 v216, v56
    v_mov_b32 v217, v57
    v_mov_b32 v218, v58
    v_mov_b32 v219, v59
    v_mov_b32 v220, v60
    v_mov_b32 v221, v61
    v_mov_b32 v222, v62
    v_mov_b32 v223, v63
    s_waitcnt vmcnt(4) lgkmcnt(0)
    s_barrier
    v_mbcnt_lo_u32_b32 v248, -1, 0
    v_mbcnt_hi_u32_b32 v248, -1, v248
    v_lshlrev_b32 v248, 4, v248
    s_mul_i32 s68, s30, 4259840
    s_lshl_b32 s67, s32, 15
    s_add_u32 s68, s68, s67
    s_lshl_b32 s67, s34, 11
    s_add_u32 s68, s68, s67
    s_add_u32 s68, s68, 41943040
    s_lshl_b32 s40, s30, 4
    s_add_u32 s40, s40, s31
    s_lshl_b32 s69, s40, 3
    s_add_u32 s69, s69, s32
    s_lshl_b32 s69, s69, 4
    s_add_u32 s69, s69, s34
    s_mul_i32 s69, s69, 10240

    s_lshl_b32 s41, s40, 13
    s_add_u32 s41, s41, 54525952
    s_lshl_b32 s70, s34, 9
    s_add_u32 s70, s70, s41
    s_lshl_b32 s67, s32, 6
    s_add_u32 s70, s70, s67
    v_add_u32 v249, 0x10000, v248
    v_add_u32 v253, 122880, v248
    s_add_u32 s67, s68, 2129920
    buffer_load_dwordx4 v[160:163], v248, s[20:23], s67 offen sc1
    buffer_load_dwordx4 v[164:167], v248, s[20:23], s67 offen offset:1024 sc1
    s_add_u32 m0, s71, 0
    s_nop 0
    buffer_load_dwordx4 v248, s[8:11], s61 offen nt lds
    s_add_u32 m0, s71, 7200
    s_nop 0
    buffer_load_dwordx4 v248, s[8:11], s61 offen offset:1024 nt lds
    s_lshr_b32 s61, s60, 4
    s_add_u32 s61, s61, s32
    s_and_b32 s61, s61, 3
    s_lshl_b32 s61, s61, 17
    s_add_u32 s62, s60, s47
    s_and_b32 s62, s62, 15
    s_lshl_b32 s62, s62, 13
    s_add_u32 s61, s61, s62
    s_add_u32 s61, s61, s58
    s_and_b32 s62, s60, 3
    s_lshl_b32 s62, s62, 10
    s_add_u32 s71, s62, s59
    s_cmp_ge_i32 s60, 64
    s_cselect_b32 s61, 0x4000000, s61
    s_cselect_b32 s71, 0x30000, s71
    s_add_u32 s62, s61, 4096
    s_add_u32 s60, s60, 1
    s_waitcnt vmcnt(6) lgkmcnt(0)
    s_barrier
    s_waitcnt vmcnt(2)
    s_add_u32 s67, s68, 2138112
    buffer_load_dwordx4 v[168:171], v248, s[20:23], s67 offen sc1
    buffer_load_dwordx4 v[172:175], v248, s[20:23], s67 offen offset:1024 sc1
    ds_read_b128 v[224:227], v253 offset:0
    ds_read_b128 v[228:231], v253 offset:4096
    ds_read_b128 v[232:235], v253 offset:8192
    s_add_u32 m0, s71, 0
    s_nop 0
    buffer_load_dwordx4 v248, s[8:11], s61 offen nt lds
    ds_read_b128 v[236:239], v253 offset:12288
    ds_read_b128 v[240:243], v253 offset:16384
    s_waitcnt lgkmcnt(4)
    v_mfma_f32_16x16x32_bf16 v[0:3], v[160:163], v[224:227], 0
    ds_read_b128 v[244:247], v253 offset:20480
    v_mfma_f32_16x16x32_bf16 v[4:7], v[164:167], v[224:227], 0
    s_waitcnt lgkmcnt(4)
    v_mfma_f32_16x16x32_bf16 v[16:19], v[160:163], v[228:231], 0
    s_add_u32 m0, s71, 7200
    s_nop 0
    buffer_load_dwordx4 v248, s[8:11], s61 offen offset:1024 nt lds
    ds_read_b128 v[224:227], v253 offset:24576
    v_mfma_f32_16x16x32_bf16 v[20:23], v[164:167], v[228:231], 0
    s_waitcnt lgkmcnt(4)
    v_mfma_f32_16x16x32_bf16 v[32:35], v[160:163], v[232:235], 0
    ds_read_b128 v[228:231], v253 offset:28672
    v_mfma_f32_16x16x32_bf16 v[36:39], v[164:167], v[232:235], 0
    s_waitcnt lgkmcnt(4)
    v_mfma_f32_16x16x32_bf16 v[48:51], v[160:163], v[236:239], 0
    s_lshr_b32 s61, s60, 4
    s_add_u32 s61, s61, s32
    s_and_b32 s61, s61, 3
    s_lshl_b32 s61, s61, 17
    s_add_u32 s62, s60, s47
    s_and_b32 s62, s62, 15
    s_lshl_b32 s62, s62, 13
    s_add_u32 s61, s61, s62
    s_add_u32 s61, s61, s58
    s_and_b32 s62, s60, 3
    s_lshl_b32 s62, s62, 10
    s_add_u32 s71, s62, s59
    s_cmp_ge_i32 s60, 64
    s_cselect_b32 s61, 0x4000000, s61
    s_cselect_b32 s71, 0x30000, s71
    s_add_u32 s62, s61, 4096
    s_add_u32 s60, s60, 1
    ds_read_b128 v[232:235], v253 offset:32768
    v_mfma_f32_16x16x32_bf16 v[52:55], v[164:167], v[236:239], 0
    s_waitcnt lgkmcnt(4)
    v_mfma_f32_16x16x32_bf16 v[64:67], v[160:163], v[240:243], 0
    ds_read_b128 v[236:239], v253 offset:36864
    v_mfma_f32_16x16x32_bf16 v[68:71], v[164:167], v[240:243], 0
    s_waitcnt lgkmcnt(4)
    v_mfma_f32_16x16x32_bf16 v[80:83], v[160:163], v[244:247], 0
    v_mfma_f32_16x16x32_bf16 v[84:87], v[164:167], v[244:247], 0
    s_waitcnt lgkmcnt(3)
    v_mfma_f32_16x16x32_bf16 v[96:99], v[160:163], v[224:227], 0
    v_mfma_f32_16x16x32_bf16 v[100:103], v[164:167], v[224:227], 0
    s_waitcnt lgkmcnt(2)
    v_mfma_f32_16x16x32_bf16 v[112:115], v[160:163], v[228:231], 0
    v_mfma_f32_16x16x32_bf16 v[116:119], v[164:167], v[228:231], 0
    s_waitcnt lgkmcnt(1)
    v_mfma_f32_16x16x32_bf16 v[128:131], v[160:163], v[232:235], 0
    v_mfma_f32_16x16x32_bf16 v[132:135], v[164:167], v[232:235], 0
    s_waitcnt lgkmcnt(0)
    v_mfma_f32_16x16x32_bf16 v[144:147], v[160:163], v[236:239], 0
    v_mfma_f32_16x16x32_bf16 v[148:151], v[164:167], v[236:239], 0
    s_waitcnt vmcnt(8) lgkmcnt(0)
    s_barrier
    s_waitcnt vmcnt(2)
    s_add_u32 s67, s68, 2396160
    buffer_load_dwordx4 v[160:163], v248, s[20:23], s67 offen sc1
    buffer_load_dwordx4 v[164:167], v248, s[20:23], s67 offen offset:1024 sc1
    ds_read_b128 v[224:227], v253 offset:0
    ds_read_b128 v[228:231], v253 offset:4096
    ds_read_b128 v[232:235], v253 offset:8192
    s_add_u32 m0, s71, 0
    s_nop 0
    buffer_load_dwordx4 v248, s[8:11], s61 offen nt lds
    ds_read_b128 v[236:239], v253 offset:12288
    ds_read_b128 v[240:243], v253 offset:16384
    s_waitcnt lgkmcnt(4)
    v_mfma_f32_16x16x32_bf16 v[8:11], v[168:171], v[224:227], 0
    ds_read_b128 v[244:247], v253 offset:20480
    v_mfma_f32_16x16x32_bf16 v[12:15], v[172:175], v[224:227], 0
    s_waitcnt lgkmcnt(4)
    v_mfma_f32_16x16x32_bf16 v[24:27], v[168:171], v[228:231], 0
    s_add_u32 m0, s71, 7200
    s_nop 0
    buffer_load_dwordx4 v248, s[8:11], s61 offen offset:1024 nt lds
    ds_read_b128 v[224:227], v253 offset:24576
    v_mfma_f32_16x16x32_bf16 v[28:31], v[172:175], v[228:231], 0
    s_waitcnt lgkmcnt(4)
    v_mfma_f32_16x16x32_bf16 v[40:43], v[168:171], v[232:235], 0
    ds_read_b128 v[228:231], v253 offset:28672
    v_mfma_f32_16x16x32_bf16 v[44:47], v[172:175], v[232:235], 0
    s_waitcnt lgkmcnt(4)
    v_mfma_f32_16x16x32_bf16 v[56:59], v[168:171], v[236:239], 0
    s_lshr_b32 s61, s60, 4
    s_add_u32 s61, s61, s32
    s_and_b32 s61, s61, 3
    s_lshl_b32 s61, s61, 17
    s_add_u32 s62, s60, s47
    s_and_b32 s62, s62, 15
    s_lshl_b32 s62, s62, 13
    s_add_u32 s61, s61, s62
    s_add_u32 s61, s61, s58
    s_and_b32 s62, s60, 3
    s_lshl_b32 s62, s62, 10
    s_add_u32 s71, s62, s59
    s_cmp_ge_i32 s60, 64
    s_cselect_b32 s61, 0x4000000, s61
    s_cselect_b32 s71, 0x30000, s71
    s_add_u32 s62, s61, 4096
    s_add_u32 s60, s60, 1
    ds_read_b128 v[232:235], v253 offset:32768
    v_mfma_f32_16x16x32_bf16 v[60:63], v[172:175], v[236:239], 0
    s_waitcnt lgkmcnt(4)
    v_mfma_f32_16x16x32_bf16 v[72:75], v[168:171], v[240:243], 0
    ds_read_b128 v[236:239], v253 offset:36864
    v_mfma_f32_16x16x32_bf16 v[76:79], v[172:175], v[240:243], 0
    s_waitcnt lgkmcnt(4)
    v_mfma_f32_16x16x32_bf16 v[88:91], v[168:171], v[244:247], 0
    v_mfma_f32_16x16x32_bf16 v[92:95], v[172:175], v[244:247], 0
    s_waitcnt lgkmcnt(3)
    v_mfma_f32_16x16x32_bf16 v[104:107], v[168:171], v[224:227], 0
    v_mfma_f32_16x16x32_bf16 v[108:111], v[172:175], v[224:227], 0
    s_waitcnt lgkmcnt(2)
    v_mfma_f32_16x16x32_bf16 v[120:123], v[168:171], v[228:231], 0
    v_mfma_f32_16x16x32_bf16 v[124:127], v[172:175], v[228:231], 0
    s_waitcnt lgkmcnt(1)
    v_mfma_f32_16x16x32_bf16 v[136:139], v[168:171], v[232:235], 0
    v_mfma_f32_16x16x32_bf16 v[140:143], v[172:175], v[232:235], 0
    s_waitcnt lgkmcnt(0)
    v_mfma_f32_16x16x32_bf16 v[152:155], v[168:171], v[236:239], 0
    v_mfma_f32_16x16x32_bf16 v[156:159], v[172:175], v[236:239], 0
    s_waitcnt vmcnt(8) lgkmcnt(0)
    s_barrier
    s_waitcnt vmcnt(2)
    s_add_u32 s67, s68, 2404352
    buffer_load_dwordx4 v[168:171], v248, s[20:23], s67 offen sc1
    buffer_load_dwordx4 v[172:175], v248, s[20:23], s67 offen offset:1024 sc1
    ds_read_b128 v[224:227], v253 offset:1024
    ds_read_b128 v[228:231], v253 offset:5120
    ds_read_b128 v[232:235], v253 offset:9216
    s_add_u32 m0, s71, 0
    s_nop 0
    buffer_load_dwordx4 v248, s[8:11], s61 offen nt lds
    ds_read_b128 v[236:239], v253 offset:13312
    ds_read_b128 v[240:243], v253 offset:17408
    s_waitcnt lgkmcnt(4)
    v_mfma_f32_16x16x32_bf16 v[0:3], v[160:163], v[224:227], v[0:3]
    ds_read_b128 v[244:247], v253 offset:21504
    v_mfma_f32_16x16x32_bf16 v[4:7], v[164:167], v[224:227], v[4:7]
    s_waitcnt lgkmcnt(4)
    v_mfma_f32_16x16x32_bf16 v[16:19], v[160:163], v[228:231], v[16:19]
    s_add_u32 m0, s71, 7200
    s_nop 0
    buffer_load_dwordx4 v248, s[8:11], s61 offen offset:1024 nt lds
    ds_read_b128 v[224:227], v253 offset:25600
    v_mfma_f32_16x16x32_bf16 v[20:23], v[164:167], v[228:231], v[20:23]
    s_waitcnt lgkmcnt(4)
    v_mfma_f32_16x16x32_bf16 v[32:35], v[160:163], v[232:235], v[32:35]
    ds_read_b128 v[228:231], v253 offset:29696
    v_mfma_f32_16x16x32_bf16 v[36:39], v[164:167], v[232:235], v[36:39]
    s_waitcnt lgkmcnt(4)
    v_mfma_f32_16x16x32_bf16 v[48:51], v[160:163], v[236:239], v[48:51]
    s_lshr_b32 s61, s60, 4
    s_add_u32 s61, s61, s32
    s_and_b32 s61, s61, 3
    s_lshl_b32 s61, s61, 17
    s_add_u32 s62, s60, s47
    s_and_b32 s62, s62, 15
    s_lshl_b32 s62, s62, 13
    s_add_u32 s61, s61, s62
    s_add_u32 s61, s61, s58
    s_and_b32 s62, s60, 3
    s_lshl_b32 s62, s62, 10
    s_add_u32 s71, s62, s59
    s_cmp_ge_i32 s60, 64
    s_cselect_b32 s61, 0x4000000, s61
    s_cselect_b32 s71, 0x30000, s71
    s_add_u32 s62, s61, 4096
    s_add_u32 s60, s60, 1
    ds_read_b128 v[232:235], v253 offset:33792
    v_mfma_f32_16x16x32_bf16 v[52:55], v[164:167], v[236:239], v[52:55]
    s_waitcnt lgkmcnt(4)
    v_mfma_f32_16x16x32_bf16 v[64:67], v[160:163], v[240:243], v[64:67]
    ds_read_b128 v[236:239], v253 offset:37888
    v_mfma_f32_16x16x32_bf16 v[68:71], v[164:167], v[240:243], v[68:71]
    s_waitcnt lgkmcnt(4)
    v_mfma_f32_16x16x32_bf16 v[80:83], v[160:163], v[244:247], v[80:83]
    v_mfma_f32_16x16x32_bf16 v[84:87], v[164:167], v[244:247], v[84:87]
    s_waitcnt lgkmcnt(3)
    v_mfma_f32_16x16x32_bf16 v[96:99], v[160:163], v[224:227], v[96:99]
    v_mfma_f32_16x16x32_bf16 v[100:103], v[164:167], v[224:227], v[100:103]
    s_waitcnt lgkmcnt(2)
    v_mfma_f32_16x16x32_bf16 v[112:115], v[160:163], v[228:231], v[112:115]
    v_mfma_f32_16x16x32_bf16 v[116:119], v[164:167], v[228:231], v[116:119]
    s_waitcnt lgkmcnt(1)
    v_mfma_f32_16x16x32_bf16 v[128:131], v[160:163], v[232:235], v[128:131]
    v_mfma_f32_16x16x32_bf16 v[132:135], v[164:167], v[232:235], v[132:135]
    s_waitcnt lgkmcnt(0)
    v_mfma_f32_16x16x32_bf16 v[144:147], v[160:163], v[236:239], v[144:147]
    v_mfma_f32_16x16x32_bf16 v[148:151], v[164:167], v[236:239], v[148:151]
    s_waitcnt vmcnt(8) lgkmcnt(0)
    s_barrier
    s_waitcnt vmcnt(2)
    s_add_u32 s67, s68, 2662400
    buffer_load_dwordx4 v[160:163], v248, s[20:23], s67 offen sc1
    buffer_load_dwordx4 v[164:167], v248, s[20:23], s67 offen offset:1024 sc1
    ds_read_b128 v[224:227], v253 offset:1024
    ds_read_b128 v[228:231], v253 offset:5120
    ds_read_b128 v[232:235], v253 offset:9216
    s_add_u32 m0, s71, 0
    s_nop 0
    buffer_load_dwordx4 v248, s[8:11], s61 offen nt lds
    ds_read_b128 v[236:239], v253 offset:13312
    ds_read_b128 v[240:243], v253 offset:17408
    s_waitcnt lgkmcnt(4)
    v_mfma_f32_16x16x32_bf16 v[8:11], v[168:171], v[224:227], v[8:11]
    ds_read_b128 v[244:247], v253 offset:21504
    v_mfma_f32_16x16x32_bf16 v[12:15], v[172:175], v[224:227], v[12:15]
    s_waitcnt lgkmcnt(4)
    v_mfma_f32_16x16x32_bf16 v[24:27], v[168:171], v[228:231], v[24:27]
    s_add_u32 m0, s71, 7200
    s_nop 0
    buffer_load_dwordx4 v248, s[8:11], s61 offen offset:1024 nt lds
    ds_read_b128 v[224:227], v253 offset:25600
    v_mfma_f32_16x16x32_bf16 v[28:31], v[172:175], v[228:231], v[28:31]
    s_waitcnt lgkmcnt(4)
    v_mfma_f32_16x16x32_bf16 v[40:43], v[168:171], v[232:235], v[40:43]
    ds_read_b128 v[228:231], v253 offset:29696
    v_mfma_f32_16x16x32_bf16 v[44:47], v[172:175], v[232:235], v[44:47]
    s_waitcnt lgkmcnt(4)
    v_mfma_f32_16x16x32_bf16 v[56:59], v[168:171], v[236:239], v[56:59]
    s_lshr_b32 s61, s60, 4
    s_add_u32 s61, s61, s32
    s_and_b32 s61, s61, 3
    s_lshl_b32 s61, s61, 17
    s_add_u32 s62, s60, s47
    s_and_b32 s62, s62, 15
    s_lshl_b32 s62, s62, 13
    s_add_u32 s61, s61, s62
    s_add_u32 s61, s61, s58
    s_and_b32 s62, s60, 3
    s_lshl_b32 s62, s62, 10
    s_add_u32 s71, s62, s59
    s_cmp_ge_i32 s60, 64
    s_cselect_b32 s61, 0x4000000, s61
    s_cselect_b32 s71, 0x30000, s71
    s_add_u32 s62, s61, 4096
    s_add_u32 s60, s60, 1
    ds_read_b128 v[232:235], v253 offset:33792
    v_mfma_f32_16x16x32_bf16 v[60:63], v[172:175], v[236:239], v[60:63]
    s_waitcnt lgkmcnt(4)
    v_mfma_f32_16x16x32_bf16 v[72:75], v[168:171], v[240:243], v[72:75]
    ds_read_b128 v[236:239], v253 offset:37888
    v_mfma_f32_16x16x32_bf16 v[76:79], v[172:175], v[240:243], v[76:79]
    s_waitcnt lgkmcnt(4)
    v_mfma_f32_16x16x32_bf16 v[88:91], v[168:171], v[244:247], v[88:91]
    v_mfma_f32_16x16x32_bf16 v[92:95], v[172:175], v[244:247], v[92:95]
    s_waitcnt lgkmcnt(3)
    v_mfma_f32_16x16x32_bf16 v[104:107], v[168:171], v[224:227], v[104:107]
    v_mfma_f32_16x16x32_bf16 v[108:111], v[172:175], v[224:227], v[108:111]
    s_waitcnt lgkmcnt(2)
    v_mfma_f32_16x16x32_bf16 v[120:123], v[168:171], v[228:231], v[120:123]
    v_mfma_f32_16x16x32_bf16 v[124:127], v[172:175], v[228:231], v[124:127]
    s_waitcnt lgkmcnt(1)
    v_mfma_f32_16x16x32_bf16 v[136:139], v[168:171], v[232:235], v[136:139]
    v_mfma_f32_16x16x32_bf16 v[140:143], v[172:175], v[232:235], v[140:143]
    s_waitcnt lgkmcnt(0)
    v_mfma_f32_16x16x32_bf16 v[152:155], v[168:171], v[236:239], v[152:155]
    v_mfma_f32_16x16x32_bf16 v[156:159], v[172:175], v[236:239], v[156:159]
    s_waitcnt vmcnt(8) lgkmcnt(0)
    s_barrier
    s_waitcnt vmcnt(2)
    s_add_u32 s67, s68, 2670592
    buffer_load_dwordx4 v[168:171], v248, s[20:23], s67 offen sc1
    buffer_load_dwordx4 v[172:175], v248, s[20:23], s67 offen offset:1024 sc1
    ds_read_b128 v[224:227], v253 offset:2048
    ds_read_b128 v[228:231], v253 offset:6144
    ds_read_b128 v[232:235], v253 offset:10240
    s_add_u32 m0, s71, 0
    s_nop 0
    buffer_load_dwordx4 v248, s[8:11], s61 offen nt lds
    ds_read_b128 v[236:239], v253 offset:14336
    ds_read_b128 v[240:243], v253 offset:18432
    s_waitcnt lgkmcnt(4)
    v_mfma_f32_16x16x32_bf16 v[0:3], v[160:163], v[224:227], v[0:3]
    ds_read_b128 v[244:247], v253 offset:22528
    v_mfma_f32_16x16x32_bf16 v[4:7], v[164:167], v[224:227], v[4:7]
    s_waitcnt lgkmcnt(4)
    v_mfma_f32_16x16x32_bf16 v[16:19], v[160:163], v[228:231], v[16:19]
    s_add_u32 m0, s71, 7200
    s_nop 0
    buffer_load_dwordx4 v248, s[8:11], s61 offen offset:1024 nt lds
    ds_read_b128 v[224:227], v253 offset:26624
    v_mfma_f32_16x16x32_bf16 v[20:23], v[164:167], v[228:231], v[20:23]
    s_waitcnt lgkmcnt(4)
    v_mfma_f32_16x16x32_bf16 v[32:35], v[160:163], v[232:235], v[32:35]
    ds_read_b128 v[228:231], v253 offset:30720
    v_mfma_f32_16x16x32_bf16 v[36:39], v[164:167], v[232:235], v[36:39]
    s_waitcnt lgkmcnt(4)
    v_mfma_f32_16x16x32_bf16 v[48:51], v[160:163], v[236:239], v[48:51]
    s_lshr_b32 s61, s60, 4
    s_add_u32 s61, s61, s32
    s_and_b32 s61, s61, 3
    s_lshl_b32 s61, s61, 17
    s_add_u32 s62, s60, s47
    s_and_b32 s62, s62, 15
    s_lshl_b32 s62, s62, 13
    s_add_u32 s61, s61, s62
    s_add_u32 s61, s61, s58
    s_and_b32 s62, s60, 3
    s_lshl_b32 s62, s62, 10
    s_add_u32 s71, s62, s59
    s_cmp_ge_i32 s60, 64
    s_cselect_b32 s61, 0x4000000, s61
    s_cselect_b32 s71, 0x30000, s71
    s_add_u32 s62, s61, 4096
    s_add_u32 s60, s60, 1
    ds_read_b128 v[232:235], v253 offset:34816
    v_mfma_f32_16x16x32_bf16 v[52:55], v[164:167], v[236:239], v[52:55]
    s_waitcnt lgkmcnt(4)
    v_mfma_f32_16x16x32_bf16 v[64:67], v[160:163], v[240:243], v[64:67]
    ds_read_b128 v[236:239], v253 offset:38912
    v_mfma_f32_16x16x32_bf16 v[68:71], v[164:167], v[240:243], v[68:71]
    s_waitcnt lgkmcnt(4)
    v_mfma_f32_16x16x32_bf16 v[80:83], v[160:163], v[244:247], v[80:83]
    v_mfma_f32_16x16x32_bf16 v[84:87], v[164:167], v[244:247], v[84:87]
    s_waitcnt lgkmcnt(3)
    v_mfma_f32_16x16x32_bf16 v[96:99], v[160:163], v[224:227], v[96:99]
    v_mfma_f32_16x16x32_bf16 v[100:103], v[164:167], v[224:227], v[100:103]
    s_waitcnt lgkmcnt(2)
    v_mfma_f32_16x16x32_bf16 v[112:115], v[160:163], v[228:231], v[112:115]
    v_mfma_f32_16x16x32_bf16 v[116:119], v[164:167], v[228:231], v[116:119]
    s_waitcnt lgkmcnt(1)
    v_mfma_f32_16x16x32_bf16 v[128:131], v[160:163], v[232:235], v[128:131]
    v_mfma_f32_16x16x32_bf16 v[132:135], v[164:167], v[232:235], v[132:135]
    s_waitcnt lgkmcnt(0)
    v_mfma_f32_16x16x32_bf16 v[144:147], v[160:163], v[236:239], v[144:147]
    v_mfma_f32_16x16x32_bf16 v[148:151], v[164:167], v[236:239], v[148:151]
    s_waitcnt vmcnt(8) lgkmcnt(0)
    s_barrier
    s_waitcnt vmcnt(2)
    s_add_u32 s67, s68, 2928640
    buffer_load_dwordx4 v[160:163], v248, s[20:23], s67 offen sc1
    buffer_load_dwordx4 v[164:167], v248, s[20:23], s67 offen offset:1024 sc1
    ds_read_b128 v[224:227], v253 offset:2048
    ds_read_b128 v[228:231], v253 offset:6144
    ds_read_b128 v[232:235], v253 offset:10240
    s_add_u32 m0, s71, 0
    s_nop 0
    buffer_load_dwordx4 v248, s[8:11], s61 offen nt lds
    ds_read_b128 v[236:239], v253 offset:14336
    ds_read_b128 v[240:243], v253 offset:18432
    s_waitcnt lgkmcnt(4)
    v_mfma_f32_16x16x32_bf16 v[8:11], v[168:171], v[224:227], v[8:11]
    ds_read_b128 v[244:247], v253 offset:22528
    v_mfma_f32_16x16x32_bf16 v[12:15], v[172:175], v[224:227], v[12:15]
    s_waitcnt lgkmcnt(4)
    v_mfma_f32_16x16x32_bf16 v[24:27], v[168:171], v[228:231], v[24:27]
    s_add_u32 m0, s71, 7200
    s_nop 0
    buffer_load_dwordx4 v248, s[8:11], s61 offen offset:1024 nt lds
    ds_read_b128 v[224:227], v253 offset:26624
    v_mfma_f32_16x16x32_bf16 v[28:31], v[172:175], v[228:231], v[28:31]
    s_waitcnt lgkmcnt(4)
    v_mfma_f32_16x16x32_bf16 v[40:43], v[168:171], v[232:235], v[40:43]
    ds_read_b128 v[228:231], v253 offset:30720
    v_mfma_f32_16x16x32_bf16 v[44:47], v[172:175], v[232:235], v[44:47]
    s_waitcnt lgkmcnt(4)
    v_mfma_f32_16x16x32_bf16 v[56:59], v[168:171], v[236:239], v[56:59]
    s_lshr_b32 s61, s60, 4
    s_add_u32 s61, s61, s32
    s_and_b32 s61, s61, 3
    s_lshl_b32 s61, s61, 17
    s_add_u32 s62, s60, s47
    s_and_b32 s62, s62, 15
    s_lshl_b32 s62, s62, 13
    s_add_u32 s61, s61, s62
    s_add_u32 s61, s61, s58
    s_and_b32 s62, s60, 3
    s_lshl_b32 s62, s62, 10
    s_add_u32 s71, s62, s59
    s_cmp_ge_i32 s60, 64
    s_cselect_b32 s61, 0x4000000, s61
    s_cselect_b32 s71, 0x30000, s71
    s_add_u32 s62, s61, 4096
    s_add_u32 s60, s60, 1
    ds_read_b128 v[232:235], v253 offset:34816
    v_mfma_f32_16x16x32_bf16 v[60:63], v[172:175], v[236:239], v[60:63]
    s_waitcnt lgkmcnt(4)
    v_mfma_f32_16x16x32_bf16 v[72:75], v[168:171], v[240:243], v[72:75]
    ds_read_b128 v[236:239], v253 offset:38912
    v_mfma_f32_16x16x32_bf16 v[76:79], v[172:175], v[240:243], v[76:79]
    s_waitcnt lgkmcnt(4)
    v_mfma_f32_16x16x32_bf16 v[88:91], v[168:171], v[244:247], v[88:91]
    v_mfma_f32_16x16x32_bf16 v[92:95], v[172:175], v[244:247], v[92:95]
    s_waitcnt lgkmcnt(3)
    v_mfma_f32_16x16x32_bf16 v[104:107], v[168:171], v[224:227], v[104:107]
    v_mfma_f32_16x16x32_bf16 v[108:111], v[172:175], v[224:227], v[108:111]
    s_waitcnt lgkmcnt(2)
    v_mfma_f32_16x16x32_bf16 v[120:123], v[168:171], v[228:231], v[120:123]
    v_mfma_f32_16x16x32_bf16 v[124:127], v[172:175], v[228:231], v[124:127]
    s_waitcnt lgkmcnt(1)
    v_mfma_f32_16x16x32_bf16 v[136:139], v[168:171], v[232:235], v[136:139]
    v_mfma_f32_16x16x32_bf16 v[140:143], v[172:175], v[232:235], v[140:143]
    s_waitcnt lgkmcnt(0)
    v_mfma_f32_16x16x32_bf16 v[152:155], v[168:171], v[236:239], v[152:155]
    v_mfma_f32_16x16x32_bf16 v[156:159], v[172:175], v[236:239], v[156:159]
    s_waitcnt vmcnt(8) lgkmcnt(0)
    s_barrier
    s_waitcnt vmcnt(2)
    s_add_u32 s67, s68, 2936832
    buffer_load_dwordx4 v[168:171], v248, s[20:23], s67 offen sc1
    buffer_load_dwordx4 v[172:175], v248, s[20:23], s67 offen offset:1024 sc1
    ds_read_b128 v[224:227], v253 offset:3072
    ds_read_b128 v[228:231], v253 offset:7168
    ds_read_b128 v[232:235], v253 offset:11264
    s_add_u32 m0, s71, 0
    s_nop 0
    buffer_load_dwordx4 v248, s[8:11], s61 offen nt lds
    ds_read_b128 v[236:239], v253 offset:15360
    ds_read_b128 v[240:243], v253 offset:19456
    s_waitcnt lgkmcnt(4)
    v_mfma_f32_16x16x32_bf16 v[0:3], v[160:163], v[224:227], v[0:3]
    ds_read_b128 v[244:247], v253 offset:23552
    v_mfma_f32_16x16x32_bf16 v[4:7], v[164:167], v[224:227], v[4:7]
    s_waitcnt lgkmcnt(4)
    v_mfma_f32_16x16x32_bf16 v[16:19], v[160:163], v[228:231], v[16:19]
    s_add_u32 m0, s71, 7200
    s_nop 0
    buffer_load_dwordx4 v248, s[8:11], s61 offen offset:1024 nt lds
    ds_read_b128 v[224:227], v253 offset:27648
    v_mfma_f32_16x16x32_bf16 v[20:23], v[164:167], v[228:231], v[20:23]
    s_waitcnt lgkmcnt(4)
    v_mfma_f32_16x16x32_bf16 v[32:35], v[160:163], v[232:235], v[32:35]
    ds_read_b128 v[228:231], v253 offset:31744
    v_mfma_f32_16x16x32_bf16 v[36:39], v[164:167], v[232:235], v[36:39]
    s_waitcnt lgkmcnt(4)
    v_mfma_f32_16x16x32_bf16 v[48:51], v[160:163], v[236:239], v[48:51]
    s_lshr_b32 s61, s60, 4
    s_add_u32 s61, s61, s32
    s_and_b32 s61, s61, 3
    s_lshl_b32 s61, s61, 17
    s_add_u32 s62, s60, s47
    s_and_b32 s62, s62, 15
    s_lshl_b32 s62, s62, 13
    s_add_u32 s61, s61, s62
    s_add_u32 s61, s61, s58
    s_and_b32 s62, s60, 3
    s_lshl_b32 s62, s62, 10
    s_add_u32 s71, s62, s59
    s_cmp_ge_i32 s60, 64
    s_cselect_b32 s61, 0x4000000, s61
    s_cselect_b32 s71, 0x30000, s71
    s_add_u32 s62, s61, 4096
    s_add_u32 s60, s60, 1
    ds_read_b128 v[232:235], v253 offset:35840
    v_mfma_f32_16x16x32_bf16 v[52:55], v[164:167], v[236:239], v[52:55]
    s_waitcnt lgkmcnt(4)
    v_mfma_f32_16x16x32_bf16 v[64:67], v[160:163], v[240:243], v[64:67]
    ds_read_b128 v[236:239], v253 offset:39936
    v_mfma_f32_16x16x32_bf16 v[68:71], v[164:167], v[240:243], v[68:71]
    s_waitcnt lgkmcnt(4)
    v_mfma_f32_16x16x32_bf16 v[80:83], v[160:163], v[244:247], v[80:83]
    v_mfma_f32_16x16x32_bf16 v[84:87], v[164:167], v[244:247], v[84:87]
    s_waitcnt lgkmcnt(3)
    v_mfma_f32_16x16x32_bf16 v[96:99], v[160:163], v[224:227], v[96:99]
    v_mfma_f32_16x16x32_bf16 v[100:103], v[164:167], v[224:227], v[100:103]
    s_waitcnt lgkmcnt(2)
    v_mfma_f32_16x16x32_bf16 v[112:115], v[160:163], v[228:231], v[112:115]
    v_mfma_f32_16x16x32_bf16 v[116:119], v[164:167], v[228:231], v[116:119]
    s_waitcnt lgkmcnt(1)
    v_mfma_f32_16x16x32_bf16 v[128:131], v[160:163], v[232:235], v[128:131]
    v_mfma_f32_16x16x32_bf16 v[132:135], v[164:167], v[232:235], v[132:135]
    s_waitcnt lgkmcnt(0)
    v_mfma_f32_16x16x32_bf16 v[144:147], v[160:163], v[236:239], v[144:147]
    v_mfma_f32_16x16x32_bf16 v[148:151], v[164:167], v[236:239], v[148:151]
    s_waitcnt vmcnt(8) lgkmcnt(0)
    s_barrier
    s_waitcnt vmcnt(2)
    s_add_u32 s67, s68, 1064960
    buffer_load_dwordx4 v[160:163], v248, s[20:23], s67 offen sc1
    buffer_load_dwordx4 v[164:167], v248, s[20:23], s67 offen offset:1024 sc1
    ds_read_b128 v[224:227], v253 offset:3072
    ds_read_b128 v[228:231], v253 offset:7168
    ds_read_b128 v[232:235], v253 offset:11264
    s_add_u32 m0, s71, 0
    s_nop 0
    buffer_load_dwordx4 v248, s[8:11], s61 offen nt lds
    ds_read_b128 v[236:239], v253 offset:15360
    ds_read_b128 v[240:243], v253 offset:19456
    s_waitcnt lgkmcnt(4)
    v_mfma_f32_16x16x32_bf16 v[8:11], v[168:171], v[224:227], v[8:11]
    ds_read_b128 v[244:247], v253 offset:23552
    v_mfma_f32_16x16x32_bf16 v[12:15], v[172:175], v[224:227], v[12:15]
    s_waitcnt lgkmcnt(4)
    v_mfma_f32_16x16x32_bf16 v[24:27], v[168:171], v[228:231], v[24:27]
    s_add_u32 m0, s71, 7200
    s_nop 0
    buffer_load_dwordx4 v248, s[8:11], s61 offen offset:1024 nt lds
    ds_read_b128 v[224:227], v253 offset:27648
    v_mfma_f32_16x16x32_bf16 v[28:31], v[172:175], v[228:231], v[28:31]
    s_waitcnt lgkmcnt(4)
    v_mfma_f32_16x16x32_bf16 v[40:43], v[168:171], v[232:235], v[40:43]
    ds_read_b128 v[228:231], v253 offset:31744
    v_mfma_f32_16x16x32_bf16 v[44:47], v[172:175], v[232:235], v[44:47]
    s_waitcnt lgkmcnt(4)
    v_mfma_f32_16x16x32_bf16 v[56:59], v[168:171], v[236:239], v[56:59]
    s_lshr_b32 s61, s60, 4
    s_add_u32 s61, s61, s32
    s_and_b32 s61, s61, 3
    s_lshl_b32 s61, s61, 17
    s_add_u32 s62, s60, s47
    s_and_b32 s62, s62, 15
    s_lshl_b32 s62, s62, 13
    s_add_u32 s61, s61, s62
    s_add_u32 s61, s61, s58
    s_and_b32 s62, s60, 3
    s_lshl_b32 s62, s62, 10
    s_add_u32 s71, s62, s59
    s_cmp_ge_i32 s60, 64
    s_cselect_b32 s61, 0x4000000, s61
    s_cselect_b32 s71, 0x30000, s71
    s_add_u32 s62, s61, 4096
    s_add_u32 s60, s60, 1
    ds_read_b128 v[232:235], v253 offset:35840
    v_mfma_f32_16x16x32_bf16 v[60:63], v[172:175], v[236:239], v[60:63]
    s_waitcnt lgkmcnt(4)
    v_mfma_f32_16x16x32_bf16 v[72:75], v[168:171], v[240:243], v[72:75]
    ds_read_b128 v[236:239], v253 offset:39936
    v_mfma_f32_16x16x32_bf16 v[76:79], v[172:175], v[240:243], v[76:79]
    s_waitcnt lgkmcnt(4)
    v_mfma_f32_16x16x32_bf16 v[88:91], v[168:171], v[244:247], v[88:91]
    v_mfma_f32_16x16x32_bf16 v[92:95], v[172:175], v[244:247], v[92:95]
    s_waitcnt lgkmcnt(3)
    v_mfma_f32_16x16x32_bf16 v[104:107], v[168:171], v[224:227], v[104:107]
    v_mfma_f32_16x16x32_bf16 v[108:111], v[172:175], v[224:227], v[108:111]
    s_waitcnt lgkmcnt(2)
    v_mfma_f32_16x16x32_bf16 v[120:123], v[168:171], v[228:231], v[120:123]
    v_mfma_f32_16x16x32_bf16 v[124:127], v[172:175], v[228:231], v[124:127]
    s_waitcnt lgkmcnt(1)
    v_mfma_f32_16x16x32_bf16 v[136:139], v[168:171], v[232:235], v[136:139]
    v_mfma_f32_16x16x32_bf16 v[140:143], v[172:175], v[232:235], v[140:143]
    s_waitcnt lgkmcnt(0)
    v_mfma_f32_16x16x32_bf16 v[152:155], v[168:171], v[236:239], v[152:155]
    v_mfma_f32_16x16x32_bf16 v[156:159], v[172:175], v[236:239], v[156:159]
    s_waitcnt vmcnt(8) lgkmcnt(0)
    s_barrier
    s_waitcnt vmcnt(2)
    s_add_u32 s67, s68, 1073152
    buffer_load_dwordx4 v[168:171], v248, s[20:23], s67 offen sc1
    buffer_load_dwordx4 v[172:175], v248, s[20:23], s67 offen offset:1024 sc1
    ds_read_b128 v[224:227], v249 offset:16384
    ds_read_b128 v[228:231], v249 offset:20480
    ds_read_b128 v[232:235], v249 offset:24576
    s_add_u32 m0, s71, 0
    s_nop 0
    buffer_load_dwordx4 v248, s[8:11], s61 offen nt lds
    ds_read_b128 v[236:239], v249 offset:28672
    ds_read_b128 v[240:243], v249 offset:32768
    s_waitcnt lgkmcnt(4)
    v_mfma_f32_16x16x32_bf16 v[0:3], v[160:163], v[224:227], v[0:3]
    ds_read_b128 v[244:247], v249 offset:36864
    v_mfma_f32_16x16x32_bf16 v[4:7], v[164:167], v[224:227], v[4:7]
    s_waitcnt lgkmcnt(4)
    v_mfma_f32_16x16x32_bf16 v[16:19], v[160:163], v[228:231], v[16:19]
    s_add_u32 m0, s71, 7200
    s_nop 0
    buffer_load_dwordx4 v248, s[8:11], s61 offen offset:1024 nt lds
    ds_read_b128 v[224:227], v249 offset:40960
    v_mfma_f32_16x16x32_bf16 v[20:23], v[164:167], v[228:231], v[20:23]
    s_waitcnt lgkmcnt(4)
    v_mfma_f32_16x16x32_bf16 v[32:35], v[160:163], v[232:235], v[32:35]
    ds_read_b128 v[228:231], v249 offset:45056
    v_mfma_f32_16x16x32_bf16 v[36:39], v[164:167], v[232:235], v[36:39]
    s_waitcnt lgkmcnt(4)
    v_mfma_f32_16x16x32_bf16 v[48:51], v[160:163], v[236:239], v[48:51]
    s_lshr_b32 s61, s60, 4
    s_add_u32 s61, s61, s32
    s_and_b32 s61, s61, 3
    s_lshl_b32 s61, s61, 17
    s_add_u32 s62, s60, s47
    s_and_b32 s62, s62, 15
    s_lshl_b32 s62, s62, 13
    s_add_u32 s61, s61, s62
    s_add_u32 s61, s61, s58
    s_and_b32 s62, s60, 3
    s_lshl_b32 s62, s62, 10
    s_add_u32 s71, s62, s59
    s_cmp_ge_i32 s60, 64
    s_cselect_b32 s61, 0x4000000, s61
    s_cselect_b32 s71, 0x30000, s71
    s_add_u32 s62, s61, 4096
    s_add_u32 s60, s60, 1
    ds_read_b128 v[232:235], v249 offset:49152
    v_mfma_f32_16x16x32_bf16 v[52:55], v[164:167], v[236:239], v[52:55]
    s_waitcnt lgkmcnt(4)
    v_mfma_f32_16x16x32_bf16 v[64:67], v[160:163], v[240:243], v[64:67]
    ds_read_b128 v[236:239], v249 offset:53248
    v_mfma_f32_16x16x32_bf16 v[68:71], v[164:167], v[240:243], v[68:71]
    s_waitcnt lgkmcnt(4)
    v_mfma_f32_16x16x32_bf16 v[80:83], v[160:163], v[244:247], v[80:83]
    v_mfma_f32_16x16x32_bf16 v[84:87], v[164:167], v[244:247], v[84:87]
    s_waitcnt lgkmcnt(3)
    v_mfma_f32_16x16x32_bf16 v[96:99], v[160:163], v[224:227], v[96:99]
    v_mfma_f32_16x16x32_bf16 v[100:103], v[164:167], v[224:227], v[100:103]
    s_waitcnt lgkmcnt(2)
    v_mfma_f32_16x16x32_bf16 v[112:115], v[160:163], v[228:231], v[112:115]
    v_mfma_f32_16x16x32_bf16 v[116:119], v[164:167], v[228:231], v[116:119]
    s_waitcnt lgkmcnt(1)
    v_mfma_f32_16x16x32_bf16 v[128:131], v[160:163], v[232:235], v[128:131]
    v_mfma_f32_16x16x32_bf16 v[132:135], v[164:167], v[232:235], v[132:135]
    s_waitcnt lgkmcnt(0)
    v_mfma_f32_16x16x32_bf16 v[144:147], v[160:163], v[236:239], v[144:147]
    v_mfma_f32_16x16x32_bf16 v[148:151], v[164:167], v[236:239], v[148:151]
    s_waitcnt vmcnt(8) lgkmcnt(0)
    s_barrier
    s_waitcnt vmcnt(2)
    s_add_u32 s67, s68, 1331200
    buffer_load_dwordx4 v[160:163], v248, s[20:23], s67 offen sc1
    buffer_load_dwordx4 v[164:167], v248, s[20:23], s67 offen offset:1024 sc1
    ds_read_b128 v[224:227], v249 offset:16384
    ds_read_b128 v[228:231], v249 offset:20480
    ds_read_b128 v[232:235], v249 offset:24576
    s_add_u32 m0, s71, 0
    s_nop 0
    buffer_load_dwordx4 v248, s[8:11], s61 offen nt lds
    ds_read_b128 v[236:239], v249 offset:28672
    ds_read_b128 v[240:243], v249 offset:32768
    s_waitcnt lgkmcnt(4)
    v_mfma_f32_16x16x32_bf16 v[8:11], v[168:171], v[224:227], v[8:11]
    ds_read_b128 v[244:247], v249 offset:36864
    v_mfma_f32_16x16x32_bf16 v[12:15], v[172:175], v[224:227], v[12:15]
    s_waitcnt lgkmcnt(4)
    v_mfma_f32_16x16x32_bf16 v[24:27], v[168:171], v[228:231], v[24:27]
    s_add_u32 m0, s71, 7200
    s_nop 0
    buffer_load_dwordx4 v248, s[8:11], s61 offen offset:1024 nt lds
    ds_read_b128 v[224:227], v249 offset:40960
    v_mfma_f32_16x16x32_bf16 v[28:31], v[172:175], v[228:231], v[28:31]
    s_waitcnt lgkmcnt(4)
    v_mfma_f32_16x16x32_bf16 v[40:43], v[168:171], v[232:235], v[40:43]
    ds_read_b128 v[228:231], v249 offset:45056
    v_mfma_f32_16x16x32_bf16 v[44:47], v[172:175], v[232:235], v[44:47]
    s_waitcnt lgkmcnt(4)
    v_mfma_f32_16x16x32_bf16 v[56:59], v[168:171], v[236:239], v[56:59]
    s_lshr_b32 s61, s60, 4
    s_add_u32 s61, s61, s32
    s_and_b32 s61, s61, 3
    s_lshl_b32 s61, s61, 17
    s_add_u32 s62, s60, s47
    s_and_b32 s62, s62, 15
    s_lshl_b32 s62, s62, 13
    s_add_u32 s61, s61, s62
    s_add_u32 s61, s61, s58
    s_and_b32 s62, s60, 3
    s_lshl_b32 s62, s62, 10
    s_add_u32 s71, s62, s59
    s_cmp_ge_i32 s60, 64
    s_cselect_b32 s61, 0x4000000, s61
    s_cselect_b32 s71, 0x30000, s71
    s_add_u32 s62, s61, 4096
    s_add_u32 s60, s60, 1
    ds_read_b128 v[232:235], v249 offset:49152
    v_mfma_f32_16x16x32_bf16 v[60:63], v[172:175], v[236:239], v[60:63]
    s_waitcnt lgkmcnt(4)
    v_mfma_f32_16x16x32_bf16 v[72:75], v[168:171], v[240:243], v[72:75]
    ds_read_b128 v[236:239], v249 offset:53248
    v_mfma_f32_16x16x32_bf16 v[76:79], v[172:175], v[240:243], v[76:79]
    s_waitcnt lgkmcnt(4)
    v_mfma_f32_16x16x32_bf16 v[88:91], v[168:171], v[244:247], v[88:91]
    v_mfma_f32_16x16x32_bf16 v[92:95], v[172:175], v[244:247], v[92:95]
    s_waitcnt lgkmcnt(3)
    v_mfma_f32_16x16x32_bf16 v[104:107], v[168:171], v[224:227], v[104:107]
    v_mfma_f32_16x16x32_bf16 v[108:111], v[172:175], v[224:227], v[108:111]
    s_waitcnt lgkmcnt(2)
    v_mfma_f32_16x16x32_bf16 v[120:123], v[168:171], v[228:231], v[120:123]
    v_mfma_f32_16x16x32_bf16 v[124:127], v[172:175], v[228:231], v[124:127]
    s_waitcnt lgkmcnt(1)
    v_mfma_f32_16x16x32_bf16 v[136:139], v[168:171], v[232:235], v[136:139]
    v_mfma_f32_16x16x32_bf16 v[140:143], v[172:175], v[232:235], v[140:143]
    s_waitcnt lgkmcnt(0)
    v_mfma_f32_16x16x32_bf16 v[152:155], v[168:171], v[236:239], v[152:155]
    v_mfma_f32_16x16x32_bf16 v[156:159], v[172:175], v[236:239], v[156:159]
    s_waitcnt vmcnt(8) lgkmcnt(0)
    s_barrier
    s_waitcnt vmcnt(2)
    s_add_u32 s67, s68, 1339392
    buffer_load_dwordx4 v[168:171], v248, s[20:23], s67 offen sc1
    buffer_load_dwordx4 v[172:175], v248, s[20:23], s67 offen offset:1024 sc1
    ds_read_b128 v[224:227], v249 offset:17408
    ds_read_b128 v[228:231], v249 offset:21504
    ds_read_b128 v[232:235], v249 offset:25600
    s_add_u32 m0, s71, 0
    s_nop 0
    buffer_load_dwordx4 v248, s[8:11], s61 offen nt lds
    ds_read_b128 v[236:239], v249 offset:29696
    ds_read_b128 v[240:243], v249 offset:33792
    s_waitcnt lgkmcnt(4)
    v_mfma_f32_16x16x32_bf16 v[0:3], v[160:163], v[224:227], v[0:3]
    ds_read_b128 v[244:247], v249 offset:37888
    v_mfma_f32_16x16x32_bf16 v[4:7], v[164:167], v[224:227], v[4:7]
    s_waitcnt lgkmcnt(4)
    v_mfma_f32_16x16x32_bf16 v[16:19], v[160:163], v[228:231], v[16:19]
    s_add_u32 m0, s71, 7200
    s_nop 0
    buffer_load_dwordx4 v248, s[8:11], s61 offen offset:1024 nt lds
    ds_read_b128 v[224:227], v249 offset:41984
    v_mfma_f32_16x16x32_bf16 v[20:23], v[164:167], v[228:231], v[20:23]
    s_waitcnt lgkmcnt(4)
    v_mfma_f32_16x16x32_bf16 v[32:35], v[160:163], v[232:235], v[32:35]
    ds_read_b128 v[228:231], v249 offset:46080
    v_mfma_f32_16x16x32_bf16 v[36:39], v[164:167], v[232:235], v[36:39]
    s_waitcnt lgkmcnt(4)
    v_mfma_f32_16x16x32_bf16 v[48:51], v[160:163], v[236:239], v[48:51]
    s_lshr_b32 s61, s60, 4
    s_add_u32 s61, s61, s32
    s_and_b32 s61, s61, 3
    s_lshl_b32 s61, s61, 17
    s_add_u32 s62, s60, s47
    s_and_b32 s62, s62, 15
    s_lshl_b32 s62, s62, 13
    s_add_u32 s61, s61, s62
    s_add_u32 s61, s61, s58
    s_and_b32 s62, s60, 3
    s_lshl_b32 s62, s62, 10
    s_add_u32 s71, s62, s59
    s_cmp_ge_i32 s60, 64
    s_cselect_b32 s61, 0x4000000, s61
    s_cselect_b32 s71, 0x30000, s71
    s_add_u32 s62, s61, 4096
    s_add_u32 s60, s60, 1
    ds_read_b128 v[232:235], v249 offset:50176
    v_mfma_f32_16x16x32_bf16 v[52:55], v[164:167], v[236:239], v[52:55]
    s_waitcnt lgkmcnt(4)
    v_mfma_f32_16x16x32_bf16 v[64:67], v[160:163], v[240:243], v[64:67]
    ds_read_b128 v[236:239], v249 offset:54272
    v_mfma_f32_16x16x32_bf16 v[68:71], v[164:167], v[240:243], v[68:71]
    s_waitcnt lgkmcnt(4)
    v_mfma_f32_16x16x32_bf16 v[80:83], v[160:163], v[244:247], v[80:83]
    v_mfma_f32_16x16x32_bf16 v[84:87], v[164:167], v[244:247], v[84:87]
    s_waitcnt lgkmcnt(3)
    v_mfma_f32_16x16x32_bf16 v[96:99], v[160:163], v[224:227], v[96:99]
    v_mfma_f32_16x16x32_bf16 v[100:103], v[164:167], v[224:227], v[100:103]
    s_waitcnt lgkmcnt(2)
    v_mfma_f32_16x16x32_bf16 v[112:115], v[160:163], v[228:231], v[112:115]
    v_mfma_f32_16x16x32_bf16 v[116:119], v[164:167], v[228:231], v[116:119]
    s_waitcnt lgkmcnt(1)
    v_mfma_f32_16x16x32_bf16 v[128:131], v[160:163], v[232:235], v[128:131]
    v_mfma_f32_16x16x32_bf16 v[132:135], v[164:167], v[232:235], v[132:135]
    s_waitcnt lgkmcnt(0)
    v_mfma_f32_16x16x32_bf16 v[144:147], v[160:163], v[236:239], v[144:147]
    v_mfma_f32_16x16x32_bf16 v[148:151], v[164:167], v[236:239], v[148:151]
    s_waitcnt vmcnt(8) lgkmcnt(0)
    s_barrier
    s_waitcnt vmcnt(2)
    s_add_u32 s67, s68, 1597440
    buffer_load_dwordx4 v[160:163], v248, s[20:23], s67 offen sc1
    buffer_load_dwordx4 v[164:167], v248, s[20:23], s67 offen offset:1024 sc1
    ds_read_b128 v[224:227], v249 offset:17408
    ds_read_b128 v[228:231], v249 offset:21504
    ds_read_b128 v[232:235], v249 offset:25600
    s_add_u32 m0, s71, 0
    s_nop 0
    buffer_load_dwordx4 v248, s[8:11], s61 offen nt lds
    ds_read_b128 v[236:239], v249 offset:29696
    ds_read_b128 v[240:243], v249 offset:33792
    s_waitcnt lgkmcnt(4)
    v_mfma_f32_16x16x32_bf16 v[8:11], v[168:171], v[224:227], v[8:11]
    ds_read_b128 v[244:247], v249 offset:37888
    v_mfma_f32_16x16x32_bf16 v[12:15], v[172:175], v[224:227], v[12:15]
    s_waitcnt lgkmcnt(4)
    v_mfma_f32_16x16x32_bf16 v[24:27], v[168:171], v[228:231], v[24:27]
    s_add_u32 m0, s71, 7200
    s_nop 0
    buffer_load_dwordx4 v248, s[8:11], s61 offen offset:1024 nt lds
    ds_read_b128 v[224:227], v249 offset:41984
    v_mfma_f32_16x16x32_bf16 v[28:31], v[172:175], v[228:231], v[28:31]
    s_waitcnt lgkmcnt(4)
    v_mfma_f32_16x16x32_bf16 v[40:43], v[168:171], v[232:235], v[40:43]
    ds_read_b128 v[228:231], v249 offset:46080
    v_mfma_f32_16x16x32_bf16 v[44:47], v[172:175], v[232:235], v[44:47]
    s_waitcnt lgkmcnt(4)
    v_mfma_f32_16x16x32_bf16 v[56:59], v[168:171], v[236:239], v[56:59]
    s_lshr_b32 s61, s60, 4
    s_add_u32 s61, s61, s32
    s_and_b32 s61, s61, 3
    s_lshl_b32 s61, s61, 17
    s_add_u32 s62, s60, s47
    s_and_b32 s62, s62, 15
    s_lshl_b32 s62, s62, 13
    s_add_u32 s61, s61, s62
    s_add_u32 s61, s61, s58
    s_and_b32 s62, s60, 3
    s_lshl_b32 s62, s62, 10
    s_add_u32 s71, s62, s59
    s_cmp_ge_i32 s60, 64
    s_cselect_b32 s61, 0x4000000, s61
    s_cselect_b32 s71, 0x30000, s71
    s_add_u32 s62, s61, 4096
    s_add_u32 s60, s60, 1
    ds_read_b128 v[232:235], v249 offset:50176
    v_mfma_f32_16x16x32_bf16 v[60:63], v[172:175], v[236:239], v[60:63]
    s_waitcnt lgkmcnt(4)
    v_mfma_f32_16x16x32_bf16 v[72:75], v[168:171], v[240:243], v[72:75]
    ds_read_b128 v[236:239], v249 offset:54272
    v_mfma_f32_16x16x32_bf16 v[76:79], v[172:175], v[240:243], v[76:79]
    s_waitcnt lgkmcnt(4)
    v_mfma_f32_16x16x32_bf16 v[88:91], v[168:171], v[244:247], v[88:91]
    v_mfma_f32_16x16x32_bf16 v[92:95], v[172:175], v[244:247], v[92:95]
    s_waitcnt lgkmcnt(3)
    v_mfma_f32_16x16x32_bf16 v[104:107], v[168:171], v[224:227], v[104:107]
    v_mfma_f32_16x16x32_bf16 v[108:111], v[172:175], v[224:227], v[108:111]
    s_waitcnt lgkmcnt(2)
    v_mfma_f32_16x16x32_bf16 v[120:123], v[168:171], v[228:231], v[120:123]
    v_mfma_f32_16x16x32_bf16 v[124:127], v[172:175], v[228:231], v[124:127]
    s_waitcnt lgkmcnt(1)
    v_mfma_f32_16x16x32_bf16 v[136:139], v[168:171], v[232:235], v[136:139]
    v_mfma_f32_16x16x32_bf16 v[140:143], v[172:175], v[232:235], v[140:143]
    s_waitcnt lgkmcnt(0)
    v_mfma_f32_16x16x32_bf16 v[152:155], v[168:171], v[236:239], v[152:155]
    v_mfma_f32_16x16x32_bf16 v[156:159], v[172:175], v[236:239], v[156:159]
    s_waitcnt vmcnt(8) lgkmcnt(0)
    s_barrier
    s_waitcnt vmcnt(2)
    s_add_u32 s67, s68, 1605632
    buffer_load_dwordx4 v[168:171], v248, s[20:23], s67 offen sc1
    buffer_load_dwordx4 v[172:175], v248, s[20:23], s67 offen offset:1024 sc1
    ds_read_b128 v[224:227], v249 offset:18432
    ds_read_b128 v[228:231], v249 offset:22528
    ds_read_b128 v[232:235], v249 offset:26624
    ds_read_b128 v[236:239], v249 offset:30720
    ds_read_b128 v[240:243], v249 offset:34816
    s_waitcnt lgkmcnt(4)
    v_mfma_f32_16x16x32_bf16 v[0:3], v[160:163], v[224:227], v[0:3]
    ds_read_b128 v[244:247], v249 offset:38912
    v_mfma_f32_16x16x32_bf16 v[4:7], v[164:167], v[224:227], v[4:7]
    s_waitcnt lgkmcnt(4)
    v_mfma_f32_16x16x32_bf16 v[16:19], v[160:163], v[228:231], v[16:19]
    ds_read_b128 v[224:227], v249 offset:43008
    v_mfma_f32_16x16x32_bf16 v[20:23], v[164:167], v[228:231], v[20:23]
    s_waitcnt lgkmcnt(4)
    v_mfma_f32_16x16x32_bf16 v[32:35], v[160:163], v[232:235], v[32:35]
    ds_read_b128 v[228:231], v249 offset:47104
    v_mfma_f32_16x16x32_bf16 v[36:39], v[164:167], v[232:235], v[36:39]
    s_waitcnt lgkmcnt(4)
    v_mfma_f32_16x16x32_bf16 v[48:51], v[160:163], v[236:239], v[48:51]
    ds_read_b128 v[232:235], v249 offset:51200
    v_mfma_f32_16x16x32_bf16 v[52:55], v[164:167], v[236:239], v[52:55]
    s_waitcnt lgkmcnt(4)
    v_mfma_f32_16x16x32_bf16 v[64:67], v[160:163], v[240:243], v[64:67]
    ds_read_b128 v[236:239], v249 offset:55296
    v_mfma_f32_16x16x32_bf16 v[68:71], v[164:167], v[240:243], v[68:71]
    s_waitcnt lgkmcnt(4)
    v_mfma_f32_16x16x32_bf16 v[80:83], v[160:163], v[244:247], v[80:83]
    v_mfma_f32_16x16x32_bf16 v[84:87], v[164:167], v[244:247], v[84:87]
    s_waitcnt lgkmcnt(3)
    v_mfma_f32_16x16x32_bf16 v[96:99], v[160:163], v[224:227], v[96:99]
    v_mfma_f32_16x16x32_bf16 v[100:103], v[164:167], v[224:227], v[100:103]
    s_waitcnt lgkmcnt(2)
    v_mfma_f32_16x16x32_bf16 v[112:115], v[160:163], v[228:231], v[112:115]
    v_mfma_f32_16x16x32_bf16 v[116:119], v[164:167], v[228:231], v[116:119]
    s_waitcnt lgkmcnt(1)
    v_mfma_f32_16x16x32_bf16 v[128:131], v[160:163], v[232:235], v[128:131]
    v_mfma_f32_16x16x32_bf16 v[132:135], v[164:167], v[232:235], v[132:135]
    s_waitcnt lgkmcnt(0)
    v_mfma_f32_16x16x32_bf16 v[144:147], v[160:163], v[236:239], v[144:147]
    v_mfma_f32_16x16x32_bf16 v[148:151], v[164:167], v[236:239], v[148:151]
    s_waitcnt vmcnt(6) lgkmcnt(0)
    s_barrier
    s_waitcnt vmcnt(0)
    s_add_u32 s67, s68, 1863680
    buffer_load_dwordx4 v[160:163], v248, s[20:23], s67 offen sc1
    buffer_load_dwordx4 v[164:167], v248, s[20:23], s67 offen offset:1024 sc1
    ds_read_b128 v[224:227], v249 offset:18432
    ds_read_b128 v[228:231], v249 offset:22528
    ds_read_b128 v[232:235], v249 offset:26624
    ds_read_b128 v[236:239], v249 offset:30720
    ds_read_b128 v[240:243], v249 offset:34816
    s_waitcnt lgkmcnt(4)
    v_mfma_f32_16x16x32_bf16 v[8:11], v[168:171], v[224:227], v[8:11]
    ds_read_b128 v[244:247], v249 offset:38912
    v_mfma_f32_16x16x32_bf16 v[12:15], v[172:175], v[224:227], v[12:15]
    s_waitcnt lgkmcnt(4)
    v_mfma_f32_16x16x32_bf16 v[24:27], v[168:171], v[228:231], v[24:27]
    ds_read_b128 v[224:227], v249 offset:43008
    v_mfma_f32_16x16x32_bf16 v[28:31], v[172:175], v[228:231], v[28:31]
    s_waitcnt lgkmcnt(4)
    v_mfma_f32_16x16x32_bf16 v[40:43], v[168:171], v[232:235], v[40:43]
    ds_read_b128 v[228:231], v249 offset:47104
    v_mfma_f32_16x16x32_bf16 v[44:47], v[172:175], v[232:235], v[44:47]
    s_waitcnt lgkmcnt(4)
    v_mfma_f32_16x16x32_bf16 v[56:59], v[168:171], v[236:239], v[56:59]
    ds_read_b128 v[232:235], v249 offset:51200
    v_mfma_f32_16x16x32_bf16 v[60:63], v[172:175], v[236:239], v[60:63]
    s_waitcnt lgkmcnt(4)
    v_mfma_f32_16x16x32_bf16 v[72:75], v[168:171], v[240:243], v[72:75]
    ds_read_b128 v[236:239], v249 offset:55296
    v_mfma_f32_16x16x32_bf16 v[76:79], v[172:175], v[240:243], v[76:79]
    s_waitcnt lgkmcnt(4)
    v_mfma_f32_16x16x32_bf16 v[88:91], v[168:171], v[244:247], v[88:91]
    v_mfma_f32_16x16x32_bf16 v[92:95], v[172:175], v[244:247], v[92:95]
    s_waitcnt lgkmcnt(3)
    v_mfma_f32_16x16x32_bf16 v[104:107], v[168:171], v[224:227], v[104:107]
    v_mfma_f32_16x16x32_bf16 v[108:111], v[172:175], v[224:227], v[108:111]
    s_waitcnt lgkmcnt(2)
    v_mfma_f32_16x16x32_bf16 v[120:123], v[168:171], v[228:231], v[120:123]
    v_mfma_f32_16x16x32_bf16 v[124:127], v[172:175], v[228:231], v[124:127]
    s_waitcnt lgkmcnt(1)
    v_mfma_f32_16x16x32_bf16 v[136:139], v[168:171], v[232:235], v[136:139]
    v_mfma_f32_16x16x32_bf16 v[140:143], v[172:175], v[232:235], v[140:143]
    s_waitcnt lgkmcnt(0)
    v_mfma_f32_16x16x32_bf16 v[152:155], v[168:171], v[236:239], v[152:155]
    v_mfma_f32_16x16x32_bf16 v[156:159], v[172:175], v[236:239], v[156:159]
    s_waitcnt vmcnt(4) lgkmcnt(0)
    s_barrier
    s_add_u32 s67, s68, 1871872
    buffer_load_dwordx4 v[168:171], v248, s[20:23], s67 offen sc1
    buffer_load_dwordx4 v[172:175], v248, s[20:23], s67 offen offset:1024 sc1
    s_mul_i32 s36, s35, 24576
    v_add_u32 v252, s36, v248
    ds_write_b128 v252, v[176:179] offset:3072
    ds_write_b128 v252, v[180:183] offset:4096
    ds_write_b128 v252, v[184:187] offset:5120
    ds_write_b128 v252, v[188:191] offset:6144
    ds_write_b128 v252, v[192:195] offset:11264
    ds_write_b128 v252, v[196:199] offset:12288
    ds_write_b128 v252, v[200:203] offset:13312
    ds_write_b128 v252, v[204:207] offset:14336
    ds_write_b128 v252, v[208:211] offset:19456
    ds_write_b128 v252, v[212:215] offset:20480
    ds_write_b128 v252, v[216:219] offset:21504
    ds_write_b128 v252, v[220:223] offset:22528
    s_waitcnt lgkmcnt(0)
    s_add_u32 s67, s68, 0
    buffer_load_dwordx4 v[176:179], v248, s[20:23], s67 offen sc1
    buffer_load_dwordx4 v[180:183], v248, s[20:23], s67 offen offset:1024 sc1
    s_add_u32 s67, s68, 266240
    buffer_load_dwordx4 v[184:187], v248, s[20:23], s67 offen sc1
    buffer_load_dwordx4 v[188:191], v248, s[20:23], s67 offen offset:1024 sc1
    s_add_u32 s67, s68, 532480
    buffer_load_dwordx4 v[192:195], v248, s[20:23], s67 offen sc1
    buffer_load_dwordx4 v[196:199], v248, s[20:23], s67 offen offset:1024 sc1
    s_add_u32 s67, s68, 798720
    buffer_load_dwordx4 v[200:203], v248, s[20:23], s67 offen sc1
    buffer_load_dwordx4 v[204:207], v248, s[20:23], s67 offen offset:1024 sc1
    s_add_u32 s67, s68, 3194880
    buffer_load_dwordx4 v[208:211], v248, s[20:23], s67 offen sc1
    buffer_load_dwordx4 v[212:215], v248, s[20:23], s67 offen offset:1024 sc1
    s_add_u32 s67, s68, 3461120
    buffer_load_dwordx4 v[216:219], v248, s[20:23], s67 offen sc1
    buffer_load_dwordx4 v[220:223], v248, s[20:23], s67 offen offset:1024 sc1
    s_barrier
    v_mov_b32 v251, 0
    ds_read_b128 v[224:227], v251 offset:8192
    s_waitcnt lgkmcnt(0)
    v_or_b32 v224, v224, v225
    v_or_b32 v226, v226, v227
    v_or_b32 v224, v224, v226
    s_nop 0
    v_readfirstlane_b32 s86, v224
    s_barrier
    s_waitcnt vmcnt(14)
    ds_read_b128 v[224:227], v249 offset:19456
    ds_read_b128 v[228:231], v249 offset:23552
    ds_read_b128 v[232:235], v249 offset:27648
    ds_read_b128 v[236:239], v249 offset:31744
    ds_read_b128 v[240:243], v249 offset:35840
    s_waitcnt lgkmcnt(4)
    v_mfma_f32_16x16x32_bf16 v[0:3], v[160:163], v[224:227], v[0:3]
    ds_read_b128 v[244:247], v249 offset:39936
    v_mfma_f32_16x16x32_bf16 v[4:7], v[164:167], v[224:227], v[4:7]
    s_waitcnt lgkmcnt(4)
    v_mfma_f32_16x16x32_bf16 v[16:19], v[160:163], v[228:231], v[16:19]
    ds_read_b128 v[224:227], v249 offset:44032
    v_mfma_f32_16x16x32_bf16 v[20:23], v[164:167], v[228:231], v[20:23]
    s_waitcnt lgkmcnt(4)
    v_mfma_f32_16x16x32_bf16 v[32:35], v[160:163], v[232:235], v[32:35]
    ds_read_b128 v[228:231], v249 offset:48128
    v_mfma_f32_16x16x32_bf16 v[36:39], v[164:167], v[232:235], v[36:39]
    s_waitcnt lgkmcnt(4)
    v_mfma_f32_16x16x32_bf16 v[48:51], v[160:163], v[236:239], v[48:51]
    ds_read_b128 v[232:235], v249 offset:52224
    v_mfma_f32_16x16x32_bf16 v[52:55], v[164:167], v[236:239], v[52:55]
    s_waitcnt lgkmcnt(4)
    v_mfma_f32_16x16x32_bf16 v[64:67], v[160:163], v[240:243], v[64:67]
    ds_read_b128 v[236:239], v249 offset:56320
    v_mfma_f32_16x16x32_bf16 v[68:71], v[164:167], v[240:243], v[68:71]
    s_waitcnt lgkmcnt(4)
    v_mfma_f32_16x16x32_bf16 v[80:83], v[160:163], v[244:247], v[80:83]
    v_mfma_f32_16x16x32_bf16 v[84:87], v[164:167], v[244:247], v[84:87]
    s_waitcnt lgkmcnt(3)
    v_mfma_f32_16x16x32_bf16 v[96:99], v[160:163], v[224:227], v[96:99]
    v_mfma_f32_16x16x32_bf16 v[100:103], v[164:167], v[224:227], v[100:103]
    s_waitcnt lgkmcnt(2)
    v_mfma_f32_16x16x32_bf16 v[112:115], v[160:163], v[228:231], v[112:115]
    v_mfma_f32_16x16x32_bf16 v[116:119], v[164:167], v[228:231], v[116:119]
    s_waitcnt lgkmcnt(1)
    v_mfma_f32_16x16x32_bf16 v[128:131], v[160:163], v[232:235], v[128:131]
    v_mfma_f32_16x16x32_bf16 v[132:135], v[164:167], v[232:235], v[132:135]
    s_waitcnt lgkmcnt(0)
    v_mfma_f32_16x16x32_bf16 v[144:147], v[160:163], v[236:239], v[144:147]
    v_mfma_f32_16x16x32_bf16 v[148:151], v[164:167], v[236:239], v[148:151]
    s_add_u32 s67, s68, 3727360
    buffer_load_dwordx4 v[160:163], v248, s[20:23], s67 offen sc1
    buffer_load_dwordx4 v[164:167], v248, s[20:23], s67 offen offset:1024 sc1
    s_waitcnt lgkmcnt(0)
    s_barrier
    s_waitcnt vmcnt(14)
    ds_read_b128 v[224:227], v249 offset:19456
    ds_read_b128 v[228:231], v249 offset:23552
    ds_read_b128 v[232:235], v249 offset:27648
    ds_read_b128 v[236:239], v249 offset:31744
    ds_read_b128 v[240:243], v249 offset:35840
    s_waitcnt lgkmcnt(4)
    v_mfma_f32_16x16x32_bf16 v[8:11], v[168:171], v[224:227], v[8:11]
    ds_read_b128 v[244:247], v249 offset:39936
    v_mfma_f32_16x16x32_bf16 v[12:15], v[172:175], v[224:227], v[12:15]
    s_waitcnt lgkmcnt(4)
    v_mfma_f32_16x16x32_bf16 v[24:27], v[168:171], v[228:231], v[24:27]
    ds_read_b128 v[224:227], v249 offset:44032
    v_mfma_f32_16x16x32_bf16 v[28:31], v[172:175], v[228:231], v[28:31]
    s_waitcnt lgkmcnt(4)
    v_mfma_f32_16x16x32_bf16 v[40:43], v[168:171], v[232:235], v[40:43]
    ds_read_b128 v[228:231], v249 offset:48128
    v_mfma_f32_16x16x32_bf16 v[44:47], v[172:175], v[232:235], v[44:47]
    s_waitcnt lgkmcnt(4)
    v_mfma_f32_16x16x32_bf16 v[56:59], v[168:171], v[236:239], v[56:59]
    ds_read_b128 v[232:235], v249 offset:52224
    v_mfma_f32_16x16x32_bf16 v[60:63], v[172:175], v[236:239], v[60:63]
    s_waitcnt lgkmcnt(4)
    v_mfma_f32_16x16x32_bf16 v[72:75], v[168:171], v[240:243], v[72:75]
    ds_read_b128 v[236:239], v249 offset:56320
    v_mfma_f32_16x16x32_bf16 v[76:79], v[172:175], v[240:243], v[76:79]
    s_waitcnt lgkmcnt(4)
    v_mfma_f32_16x16x32_bf16 v[88:91], v[168:171], v[244:247], v[88:91]
    v_mfma_f32_16x16x32_bf16 v[92:95], v[172:175], v[244:247], v[92:95]
    s_waitcnt lgkmcnt(3)
    v_mfma_f32_16x16x32_bf16 v[104:107], v[168:171], v[224:227], v[104:107]
    v_mfma_f32_16x16x32_bf16 v[108:111], v[172:175], v[224:227], v[108:111]
    s_waitcnt lgkmcnt(2)
    v_mfma_f32_16x16x32_bf16 v[120:123], v[168:171], v[228:231], v[120:123]
    v_mfma_f32_16x16x32_bf16 v[124:127], v[172:175], v[228:231], v[124:127]
    s_waitcnt lgkmcnt(1)
    v_mfma_f32_16x16x32_bf16 v[136:139], v[168:171], v[232:235], v[136:139]
    v_mfma_f32_16x16x32_bf16 v[140:143], v[172:175], v[232:235], v[140:143]
    s_waitcnt lgkmcnt(0)
    v_mfma_f32_16x16x32_bf16 v[152:155], v[168:171], v[236:239], v[152:155]
    v_mfma_f32_16x16x32_bf16 v[156:159], v[172:175], v[236:239], v[156:159]
    s_add_u32 s67, s68, 3993600
    buffer_load_dwordx4 v[168:171], v248, s[20:23], s67 offen sc1
    buffer_load_dwordx4 v[172:175], v248, s[20:23], s67 offen offset:1024 sc1
    s_branch L_tail
L_P7:
    s_setprio 0
    s_lshl_b32 s36, s35, 7
    s_add_u32 s36, s36, 65760
    v_bfe_u32 v251, v250, 2, 3
    v_mul_u32_u24 v235, 3136, v251
    v_lshrrev_b32 v252, 5, v250
    v_lshl_add_u32 v235, v252, 9, v235
    v_and_b32 v252, 3, v250
    v_lshl_add_u32 v235, v252, 4, v235
    s_nop 0
    v_and_b32 v251, 0, v251
    v_lshl_add_u32 v235, v251, 3, v235
    v_add_u32 v235, s36, v235
    v_and_b32 v251, 15, v250
    v_lshrrev_b32 v252, 4, v250
    v_lshrrev_b32 v253, 1, v251
    v_xor_b32 v253, v252, v253
    v_lshlrev_b32 v253, 4, v253
    v_lshl_add_u32 v236, v251, 7, v253
    v_xor_b32 v237, 64, v236
    v_add_u32 v236, 90848, v236
    v_add_u32 v237, 90848, v237
    v_mov_b32 v232, v235
    v_mov_b32 v233, v236
    v_mov_b32 v234, v237
    v_lshlrev_b32 v239, 4, v250
    s_lshl_b32 s36, s35, 11
    s_add_u32 s36, s36, 122880
    v_add_u32 v238, s36, v239
    s_mov_b32 s56, 0x3e0293ee
    s_mov_b32 s64, 0
    s_mov_b32 s50, 1
    v_lshrrev_b32 v251, 1, v250
    v_lshlrev_b32 v243, 16, v251
    v_and_b32 v251, 1, v250
    v_lshl_add_u32 v243, v251, 7, v243
    s_lshr_b32 s84, s29, 2
    s_lshl_b32 s84, s84, 13
    s_lshl_b32 s36, s35, 21
    s_add_u32 s84, s84, s36
    s_lshl_b32 s36, s32, 10
    s_add_u32 s84, s84, s36
    s_mul_i32 s85, s29, 3
    s_lshr_b32 s85, s85, 2
    s_add_u32 s85, s85, 2
    s_cmp_lg_u32 s35, 0
    s_cselect_b32 s85, 0, s85
    s_waitcnt vmcnt(20) lgkmcnt(0)
    s_barrier
    s_waitcnt vmcnt(18) lgkmcnt(0)
    s_barrier
    s_waitcnt vmcnt(9) lgkmcnt(0)
    s_barrier
    s_waitcnt vmcnt(4) lgkmcnt(0)
    s_barrier
    ds_read_b128 v[168:171], v233 offset:0
    ds_read_b128 v[172:175], v233 offset:2048
    ds_read_b128 v[176:179], v233 offset:4096
    ds_read_b128 v[180:183], v233 offset:6144
    ds_read_b128 v[184:187], v234 offset:0
    ds_read_b128 v[188:191], v234 offset:2048
    ds_read_b128 v[192:195], v234 offset:4096
    ds_read_b128 v[196:199], v234 offset:6144
    ds_read_b64_tr_b16 v[112:113], v232 offset:0
    ds_read_b64_tr_b16 v[114:115], v232 offset:256
    ds_read_b64_tr_b16 v[116:117], v232 offset:8
    ds_read_b64_tr_b16 v[118:119], v232 offset:264
    ds_read_b64_tr_b16 v[120:121], v232 offset:64
    ds_read_b64_tr_b16 v[122:123], v232 offset:320
    ds_read_b64_tr_b16 v[124:125], v232 offset:72
    ds_read_b64_tr_b16 v[126:127], v232 offset:328
    s_add_u32 s64, s64, 1
    s_cmp_eq_u32 s64, 3
    s_cselect_b32 s64, 0, s64
    s_lshl_b32 s69, s64, 10
    s_mul_i32 s70, s64, 10240
    v_add_u32 v232, s69, v235
    v_add_u32 v233, s70, v236
    v_add_u32 v234, s70, v237
    s_waitcnt vmcnt(0) lgkmcnt(0)
    s_barrier
    ds_read_b128 v[144:147], v233 offset:0
    ds_read_b128 v[148:151], v233 offset:2048
    ds_read_b128 v[152:155], v233 offset:4096
    ds_read_b64_tr_b16 v[128:129], v232 offset:0
    ds_read_b64_tr_b16 v[130:131], v232 offset:256
    ds_read_b64_tr_b16 v[132:133], v232 offset:8
    ds_read_b64_tr_b16 v[134:135], v232 offset:264
    ds_read_b64_tr_b16 v[136:137], v232 offset:64
    ds_read_b64_tr_b16 v[138:139], v232 offset:320
    ds_read_b64_tr_b16 v[140:141], v232 offset:72
    ds_read_b64_tr_b16 v[142:143], v232 offset:328
    ds_read_b128 v[156:159], v234 offset:0
    ds_read_b128 v[160:163], v234 offset:2048
    ds_read_b128 v[164:167], v234 offset:4096
    v_mov_b32 v200, v184
    v_mov_b32 v201, v185
    v_mov_b32 v202, v186
    v_mov_b32 v203, v187
    v_mov_b32 v204, v188
    v_mov_b32 v205, v189
    v_mov_b32 v206, v190
    v_mov_b32 v207, v191
    v_mov_b32 v208, v192
    v_mov_b32 v209, v193
    v_mov_b32 v210, v194
    v_mov_b32 v211, v195
    v_mov_b32 v212, v196
    v_mov_b32 v213, v197
    v_mov_b32 v214, v198
    v_mov_b32 v215, v199
    s_add_u32 s64, s64, 1
    s_cmp_eq_u32 s64, 3
    s_cselect_b32 s64, 0, s64
    s_lshl_b32 s69, s64, 10
    s_mul_i32 s70, s64, 10240
    v_add_u32 v232, s69, v235
    v_add_u32 v233, s70, v236
    v_add_u32 v234, s70, v237
    s_waitcnt lgkmcnt(0)
    s_barrier
L_P7_r2:
    s_mov_b32 s51, 0
    v_mfma_f32_16x16x32_bf16 v[0:3], v[112:115], v[168:171], 0
    s_add_u32 s64, s64, 1
    s_cmp_eq_u32 s64, 3
    s_cselect_b32 s64, 0, s64
    s_lshl_b32 s69, s64, 10
    s_mul_i32 s70, s64, 10240
    v_mfma_f32_16x16x32_bf16 v[16:19], v[112:115], v[172:175], 0
    v_mfma_f32_16x16x32_bf16 v[32:35], v[112:115], v[176:179], 0
    v_mfma_f32_16x16x32_bf16 v[48:51], v[112:115], v[180:183], 0
    v_mfma_f32_16x16x32_bf16 v[4:7], v[116:119], v[168:171], 0
    v_mfma_f32_16x16x32_bf16 v[20:23], v[116:119], v[172:175], 0
    v_mfma_f32_16x16x32_bf16 v[36:39], v[116:119], v[176:179], 0
    v_mfma_f32_16x16x32_bf16 v[52:55], v[116:119], v[180:183], 0
    v_mfma_f32_16x16x32_bf16 v[8:11], v[120:123], v[168:171], 0
    v_mfma_f32_16x16x32_bf16 v[24:27], v[120:123], v[172:175], 0
    v_mfma_f32_16x16x32_bf16 v[40:43], v[120:123], v[176:179], 0
    v_mfma_f32_16x16x32_bf16 v[56:59], v[120:123], v[180:183], 0
    v_mfma_f32_16x16x32_bf16 v[12:15], v[124:127], v[168:171], 0
    v_mfma_f32_16x16x32_bf16 v[28:31], v[124:127], v[172:175], 0
    v_mfma_f32_16x16x32_bf16 v[44:47], v[124:127], v[176:179], 0
    v_mfma_f32_16x16x32_bf16 v[60:63], v[124:127], v[180:183], 0
    ds_read_b128 v[168:171], v233 offset:0
    ds_read_b128 v[172:175], v233 offset:2048
    ds_read_b128 v[176:179], v233 offset:4096
    ds_read_b128 v[180:183], v233 offset:6144
    ds_read_b128 v[184:187], v234 offset:0
    v_mfma_f32_16x16x32_bf16 v[64:67], v[112:115], v[144:147], 0
    v_mfma_f32_16x16x32_bf16 v[80:83], v[112:115], v[148:151], 0
    v_mfma_f32_16x16x32_bf16 v[96:99], v[112:115], v[152:155], 0
    ds_read_b128 v[188:191], v234 offset:2048
    ds_read_b64_tr_b16 v[112:113], v232 offset:0
    ds_read_b64_tr_b16 v[114:115], v232 offset:256
    v_mfma_f32_16x16x32_bf16 v[68:71], v[116:119], v[144:147], 0
    v_mfma_f32_16x16x32_bf16 v[84:87], v[116:119], v[148:151], 0
    v_mfma_f32_16x16x32_bf16 v[100:103], v[116:119], v[152:155], 0
    ds_read_b128 v[192:195], v234 offset:4096
    ds_read_b64_tr_b16 v[116:117], v232 offset:8
    ds_read_b64_tr_b16 v[118:119], v232 offset:264
    s_add_u32 s83, s50, s32
    s_add_u32 s83, s83, 1
    s_and_b32 s83, s83, 3
    s_lshl_b32 s83, s83, 8
    s_add_u32 s83, s83, s84
    s_cmp_ge_u32 s50, 3
    s_cselect_b32 s83, 0x400000, s83
    buffer_load_dword v246, v243, s[12:15], s83 offen
    v_mfma_f32_16x16x32_bf16 v[72:75], v[120:123], v[144:147], 0
    v_mfma_f32_16x16x32_bf16 v[88:91], v[120:123], v[148:151], 0
    v_mfma_f32_16x16x32_bf16 v[104:107], v[120:123], v[152:155], 0
    ds_read_b128 v[196:199], v234 offset:6144
    ds_read_b64_tr_b16 v[120:121], v232 offset:64
    ds_read_b64_tr_b16 v[122:123], v232 offset:320
    v_mfma_f32_16x16x32_bf16 v[76:79], v[124:127], v[144:147], 0
    v_mfma_f32_16x16x32_bf16 v[92:95], v[124:127], v[148:151], 0
    v_mfma_f32_16x16x32_bf16 v[108:111], v[124:127], v[152:155], 0
    ds_read_b64_tr_b16 v[124:125], v232 offset:72
    ds_read_b64_tr_b16 v[126:127], v232 offset:328
    v_mfma_f32_16x16x32_bf16 v[0:3], v[128:131], v[200:203], v[0:3]
    v_add_u32 v232, s69, v235
    v_add_u32 v233, s70, v236
    v_add_u32 v234, s70, v237
    v_mfma_f32_16x16x32_bf16 v[16:19], v[128:131], v[204:207], v[16:19]
    v_mfma_f32_16x16x32_bf16 v[32:35], v[128:131], v[208:211], v[32:35]
    v_mfma_f32_16x16x32_bf16 v[48:51], v[128:131], v[212:215], v[48:51]
    v_mfma_f32_16x16x32_bf16 v[4:7], v[132:135], v[200:203], v[4:7]
    v_mfma_f32_16x16x32_bf16 v[20:23], v[132:135], v[204:207], v[20:23]
    v_mfma_f32_16x16x32_bf16 v[36:39], v[132:135], v[208:211], v[36:39]
    v_mfma_f32_16x16x32_bf16 v[52:55], v[132:135], v[212:215], v[52:55]
    v_mfma_f32_16x16x32_bf16 v[8:11], v[136:139], v[200:203], v[8:11]
    v_mfma_f32_16x16x32_bf16 v[24:27], v[136:139], v[204:207], v[24:27]
    v_mfma_f32_16x16x32_bf16 v[40:43], v[136:139], v[208:211], v[40:43]
    v_mfma_f32_16x16x32_bf16 v[56:59], v[136:139], v[212:215], v[56:59]
    v_mfma_f32_16x16x32_bf16 v[12:15], v[140:143], v[200:203], v[12:15]
    v_mfma_f32_16x16x32_bf16 v[28:31], v[140:143], v[204:207], v[28:31]
    v_mfma_f32_16x16x32_bf16 v[44:47], v[140:143], v[208:211], v[44:47]
    v_mfma_f32_16x16x32_bf16 v[60:63], v[140:143], v[212:215], v[60:63]
    s_waitcnt lgkmcnt(0)
    s_barrier
    s_nop 3
    v_mfma_f32_16x16x32_bf16 v[64:67], v[128:131], v[156:159], v[64:67]
    v_mov_b32 v200, v184
    s_add_u32 s64, s64, 1
    s_cmp_eq_u32 s64, 3
    s_cselect_b32 s64, 0, s64
    s_lshl_b32 s69, s64, 10
    s_mul_i32 s70, s64, 10240
    v_mfma_f32_16x16x32_bf16 v[80:83], v[128:131], v[160:163], v[80:83]
    v_mov_b32 v201, v185
    v_mfma_f32_16x16x32_bf16 v[96:99], v[128:131], v[164:167], v[96:99]
    ds_read_b64_tr_b16 v[128:129], v232 offset:0
    ds_read_b64_tr_b16 v[130:131], v232 offset:256
    v_mfma_f32_16x16x32_bf16 v[68:71], v[132:135], v[156:159], v[68:71]
    v_mov_b32 v202, v186
    v_mfma_f32_16x16x32_bf16 v[84:87], v[132:135], v[160:163], v[84:87]
    v_mfma_f32_16x16x32_bf16 v[100:103], v[132:135], v[164:167], v[100:103]
    v_mov_b32 v203, v187
    v_mfma_f32_16x16x32_bf16 v[72:75], v[136:139], v[156:159], v[72:75]
    ds_read_b128 v[144:147], v233 offset:0
    ds_read_b128 v[148:151], v233 offset:2048
    ds_read_b128 v[152:155], v233 offset:4096
    v_mfma_f32_16x16x32_bf16 v[88:91], v[136:139], v[160:163], v[88:91]
    v_mov_b32 v204, v188
    v_mfma_f32_16x16x32_bf16 v[104:107], v[136:139], v[164:167], v[104:107]
    v_mov_b32 v205, v189
    v_mfma_f32_16x16x32_bf16 v[76:79], v[140:143], v[156:159], v[76:79]
    v_mfma_f32_16x16x32_bf16 v[92:95], v[140:143], v[160:163], v[92:95]
    v_mov_b32 v206, v190
    v_mfma_f32_16x16x32_bf16 v[108:111], v[140:143], v[164:167], v[108:111]
    ds_read_b64_tr_b16 v[140:141], v232 offset:72
    ds_read_b64_tr_b16 v[142:143], v232 offset:328
    v_mfma_f32_16x16x32_bf16 v[0:3], v[112:115], v[168:171], v[0:3]
    v_mov_b32 v207, v191
    v_mfma_f32_16x16x32_bf16 v[16:19], v[112:115], v[172:175], v[16:19]
    v_mfma_f32_16x16x32_bf16 v[32:35], v[112:115], v[176:179], v[32:35]
    ds_read_b64_tr_b16 v[136:137], v232 offset:64
    ds_read_b64_tr_b16 v[138:139], v232 offset:320
    v_mov_b32 v208, v192
    v_mfma_f32_16x16x32_bf16 v[48:51], v[112:115], v[180:183], v[48:51]
    v_mov_b32 v209, v193
    v_mfma_f32_16x16x32_bf16 v[4:7], v[116:119], v[168:171], v[4:7]
    ds_read_b64_tr_b16 v[132:133], v232 offset:8
    ds_read_b64_tr_b16 v[134:135], v232 offset:264
    v_mfma_f32_16x16x32_bf16 v[20:23], v[116:119], v[172:175], v[20:23]
    v_mov_b32 v210, v194
    v_mfma_f32_16x16x32_bf16 v[36:39], v[116:119], v[176:179], v[36:39]
    v_mfma_f32_16x16x32_bf16 v[52:55], v[116:119], v[180:183], v[52:55]
    v_mov_b32 v211, v195
    v_mfma_f32_16x16x32_bf16 v[8:11], v[120:123], v[168:171], v[8:11]
    v_mfma_f32_16x16x32_bf16 v[24:27], v[120:123], v[172:175], v[24:27]
    v_mov_b32 v212, v196
    v_mfma_f32_16x16x32_bf16 v[40:43], v[120:123], v[176:179], v[40:43]
    ds_read_b128 v[156:159], v234 offset:0
    ds_read_b128 v[160:163], v234 offset:2048
    ds_read_b128 v[164:167], v234 offset:4096
    v_mov_b32 v213, v197
    v_mfma_f32_16x16x32_bf16 v[56:59], v[120:123], v[180:183], v[56:59]
    v_add_u32 v232, s69, v235
    v_add_u32 v233, s70, v236
    v_add_u32 v234, s70, v237
    v_mfma_f32_16x16x32_bf16 v[12:15], v[124:127], v[168:171], v[12:15]
    v_mov_b32 v214, v198
    v_mfma_f32_16x16x32_bf16 v[28:31], v[124:127], v[172:175], v[28:31]
    v_mfma_f32_16x16x32_bf16 v[44:47], v[124:127], v[176:179], v[44:47]
    v_mov_b32 v215, v199
    v_mfma_f32_16x16x32_bf16 v[60:63], v[124:127], v[180:183], v[60:63]
    s_waitcnt lgkmcnt(0)
    s_barrier
L_P7_loop:
    s_sub_u32 s85, s85, 1
    s_cmp_lg_u32 s85, 0
    s_cbranch_scc1 L_P7_nf0
    s_lshl_b32 s39, s30, 3
    s_add_u32 s39, s39, s32
    s_lshl_b32 s39, s39, 4
    s_add_u32 s39, s39, s31
    v_mov_b32 v216, 3
    v_mov_b32 v217, 0
    s_mov_b64 exec, 1
    buffer_store_byte v216, v217, s[4:7], s39 offen sc1
    s_mov_b64 exec, -1
L_P7_nf0:
    s_nop 3
    v_mfma_f32_16x16x32_bf16 v[64:67], v[112:115], v[144:147], v[64:67]
    s_add_u32 s64, s64, 1
    s_cmp_eq_u32 s64, 3
    s_cselect_b32 s64, 0, s64
    s_lshl_b32 s69, s64, 10
    s_mul_i32 s70, s64, 10240
    v_mfma_f32_16x16x32_bf16 v[80:83], v[112:115], v[148:151], v[80:83]
    v_mfma_f32_16x16x32_bf16 v[96:99], v[112:115], v[152:155], v[96:99]
    ds_read_b64_tr_b16 v[112:113], v232 offset:0
    ds_read_b64_tr_b16 v[114:115], v232 offset:256
    v_mfma_f32_16x16x32_bf16 v[68:71], v[116:119], v[144:147], v[68:71]
    v_mfma_f32_16x16x32_bf16 v[84:87], v[116:119], v[148:151], v[84:87]
    v_mfma_f32_16x16x32_bf16 v[100:103], v[116:119], v[152:155], v[100:103]
    v_mfma_f32_16x16x32_bf16 v[72:75], v[120:123], v[144:147], v[72:75]
    ds_read_b128 v[168:171], v233 offset:0
    ds_read_b128 v[172:175], v233 offset:2048
    ds_read_b128 v[176:179], v233 offset:4096
    ds_read_b128 v[180:183], v233 offset:6144
    v_mfma_f32_16x16x32_bf16 v[88:91], v[120:123], v[148:151], v[88:91]
    v_mfma_f32_16x16x32_bf16 v[104:107], v[120:123], v[152:155], v[104:107]
    ds_read_b128 v[184:187], v234 offset:0
    v_mfma_f32_16x16x32_bf16 v[76:79], v[124:127], v[144:147], v[76:79]
    v_mfma_f32_16x16x32_bf16 v[92:95], v[124:127], v[148:151], v[92:95]
    v_mfma_f32_16x16x32_bf16 v[108:111], v[124:127], v[152:155], v[108:111]
    ds_read_b128 v[188:191], v234 offset:2048
    ds_read_b64_tr_b16 v[124:125], v232 offset:72
    ds_read_b64_tr_b16 v[126:127], v232 offset:328
    v_mfma_f32_16x16x32_bf16 v[0:3], v[128:131], v[200:203], v[0:3]
    v_mfma_f32_16x16x32_bf16 v[16:19], v[128:131], v[204:207], v[16:19]
    v_mfma_f32_16x16x32_bf16 v[32:35], v[128:131], v[208:211], v[32:35]
    ds_read_b128 v[192:195], v234 offset:4096
    ds_read_b64_tr_b16 v[120:121], v232 offset:64
    ds_read_b64_tr_b16 v[122:123], v232 offset:320
    v_mfma_f32_16x16x32_bf16 v[48:51], v[128:131], v[212:215], v[48:51]
    v_mfma_f32_16x16x32_bf16 v[4:7], v[132:135], v[200:203], v[4:7]
    ds_read_b64_tr_b16 v[116:117], v232 offset:8
    ds_read_b64_tr_b16 v[118:119], v232 offset:264
    v_mfma_f32_16x16x32_bf16 v[20:23], v[132:135], v[204:207], v[20:23]
    ds_read_b128 v[196:199], v234 offset:6144
    v_mfma_f32_16x16x32_bf16 v[36:39], v[132:135], v[208:211], v[36:39]
    v_mfma_f32_16x16x32_bf16 v[52:55], v[132:135], v[212:215], v[52:55]
    v_mfma_f32_16x16x32_bf16 v[8:11], v[136:139], v[200:203], v[8:11]
    v_mfma_f32_16x16x32_bf16 v[24:27], v[136:139], v[204:207], v[24:27]
    v_mfma_f32_16x16x32_bf16 v[40:43], v[136:139], v[208:211], v[40:43]
    v_mfma_f32_16x16x32_bf16 v[56:59], v[136:139], v[212:215], v[56:59]
    v_add_u32 v232, s69, v235
    v_add_u32 v233, s70, v236
    v_add_u32 v234, s70, v237
    v_mfma_f32_16x16x32_bf16 v[12:15], v[140:143], v[200:203], v[12:15]
    v_mfma_f32_16x16x32_bf16 v[28:31], v[140:143], v[204:207], v[28:31]
    v_mfma_f32_16x16x32_bf16 v[44:47], v[140:143], v[208:211], v[44:47]
    v_mfma_f32_16x16x32_bf16 v[60:63], v[140:143], v[212:215], v[60:63]
    s_waitcnt lgkmcnt(0)
    s_barrier
    s_sub_u32 s85, s85, 1
    s_cmp_lg_u32 s85, 0
    s_cbranch_scc1 L_P7_nf1
    s_lshl_b32 s39, s30, 3
    s_add_u32 s39, s39, s32
    s_lshl_b32 s39, s39, 4
    s_add_u32 s39, s39, s31
    v_mov_b32 v216, 3
    v_mov_b32 v217, 0
    s_mov_b64 exec, 1
    buffer_store_byte v216, v217, s[4:7], s39 offen sc1
    s_mov_b64 exec, -1
L_P7_nf1:
    s_nop 3
    v_mfma_f32_16x16x32_bf16 v[64:67], v[128:131], v[156:159], v[64:67]
    v_mov_b32 v200, v184
    s_add_u32 s64, s64, 1
    s_cmp_eq_u32 s64, 3
    s_cselect_b32 s64, 0, s64
    s_lshl_b32 s69, s64, 10
    s_mul_i32 s70, s64, 10240
    v_mfma_f32_16x16x32_bf16 v[80:83], v[128:131], v[160:163], v[80:83]
    v_mov_b32 v201, v185
    v_mfma_f32_16x16x32_bf16 v[96:99], v[128:131], v[164:167], v[96:99]
    ds_read_b64_tr_b16 v[128:129], v232 offset:0
    ds_read_b64_tr_b16 v[130:131], v232 offset:256
    v_mfma_f32_16x16x32_bf16 v[68:71], v[132:135], v[156:159], v[68:71]
    v_mov_b32 v202, v186
    v_mfma_f32_16x16x32_bf16 v[84:87], v[132:135], v[160:163], v[84:87]
    v_mfma_f32_16x16x32_bf16 v[100:103], v[132:135], v[164:167], v[100:103]
    v_mov_b32 v203, v187
    v_mfma_f32_16x16x32_bf16 v[72:75], v[136:139], v[156:159], v[72:75]
    ds_read_b128 v[144:147], v233 offset:0
    ds_read_b128 v[148:151], v233 offset:2048
    ds_read_b128 v[152:155], v233 offset:4096
    v_mfma_f32_16x16x32_bf16 v[88:91], v[136:139], v[160:163], v[88:91]
    v_mov_b32 v204, v188
    v_mfma_f32_16x16x32_bf16 v[104:107], v[136:139], v[164:167], v[104:107]
    v_mov_b32 v205, v189
    v_mfma_f32_16x16x32_bf16 v[76:79], v[140:143], v[156:159], v[76:79]
    v_mfma_f32_16x16x32_bf16 v[92:95], v[140:143], v[160:163], v[92:95]
    v_mov_b32 v206, v190
    v_mfma_f32_16x16x32_bf16 v[108:111], v[140:143], v[164:167], v[108:111]
    ds_read_b64_tr_b16 v[140:141], v232 offset:72
    ds_read_b64_tr_b16 v[142:143], v232 offset:328
    v_mfma_f32_16x16x32_bf16 v[0:3], v[112:115], v[168:171], v[0:3]
    v_mov_b32 v207, v191
    v_mfma_f32_16x16x32_bf16 v[16:19], v[112:115], v[172:175], v[16:19]
    v_mfma_f32_16x16x32_bf16 v[32:35], v[112:115], v[176:179], v[32:35]
    ds_read_b64_tr_b16 v[136:137], v232 offset:64
    ds_read_b64_tr_b16 v[138:139], v232 offset:320
    v_mov_b32 v208, v192
    v_mfma_f32_16x16x32_bf16 v[48:51], v[112:115], v[180:183], v[48:51]
    v_mov_b32 v209, v193
    v_mfma_f32_16x16x32_bf16 v[4:7], v[116:119], v[168:171], v[4:7]
    ds_read_b64_tr_b16 v[132:133], v232 offset:8
    ds_read_b64_tr_b16 v[134:135], v232 offset:264
    v_mfma_f32_16x16x32_bf16 v[20:23], v[116:119], v[172:175], v[20:23]
    v_mov_b32 v210, v194
    v_mfma_f32_16x16x32_bf16 v[36:39], v[116:119], v[176:179], v[36:39]
    v_mfma_f32_16x16x32_bf16 v[52:55], v[116:119], v[180:183], v[52:55]
    v_mov_b32 v211, v195
    v_mfma_f32_16x16x32_bf16 v[8:11], v[120:123], v[168:171], v[8:11]
    v_mfma_f32_16x16x32_bf16 v[24:27], v[120:123], v[172:175], v[24:27]
    v_mov_b32 v212, v196
    v_mfma_f32_16x16x32_bf16 v[40:43], v[120:123], v[176:179], v[40:43]
    ds_read_b128 v[156:159], v234 offset:0
    ds_read_b128 v[160:163], v234 offset:2048
    ds_read_b128 v[164:167], v234 offset:4096
    v_mov_b32 v213, v197
    v_mfma_f32_16x16x32_bf16 v[56:59], v[120:123], v[180:183], v[56:59]
    v_add_u32 v232, s69, v235
    v_add_u32 v233, s70, v236
    v_add_u32 v234, s70, v237
    v_mfma_f32_16x16x32_bf16 v[12:15], v[124:127], v[168:171], v[12:15]
    v_mov_b32 v214, v198
    v_mfma_f32_16x16x32_bf16 v[28:31], v[124:127], v[172:175], v[28:31]
    v_mfma_f32_16x16x32_bf16 v[44:47], v[124:127], v[176:179], v[44:47]
    v_mov_b32 v215, v199
    v_mfma_f32_16x16x32_bf16 v[60:63], v[124:127], v[180:183], v[60:63]
    s_waitcnt lgkmcnt(0)
    s_barrier
    s_add_u32 s51, s51, 1
    s_cmp_lt_u32 s51, 6
    s_cbranch_scc1 L_P7_loop
    s_nop 3
    v_mfma_f32_16x16x32_bf16 v[0:3], v[128:131], v[200:203], v[0:3]
    v_mfma_f32_16x16x32_bf16 v[4:7], v[132:135], v[200:203], v[4:7]
    v_mfma_f32_16x16x32_bf16 v[8:11], v[136:139], v[200:203], v[8:11]
    v_mfma_f32_16x16x32_bf16 v[12:15], v[140:143], v[200:203], v[12:15]
    v_mfma_f32_16x16x32_bf16 v[16:19], v[128:131], v[204:207], v[16:19]
    v_mfma_f32_16x16x32_bf16 v[20:23], v[132:135], v[204:207], v[20:23]
    v_mfma_f32_16x16x32_bf16 v[24:27], v[136:139], v[204:207], v[24:27]
    v_mfma_f32_16x16x32_bf16 v[28:31], v[140:143], v[204:207], v[28:31]
    v_mfma_f32_16x16x32_bf16 v[32:35], v[128:131], v[208:211], v[32:35]
    v_mfma_f32_16x16x32_bf16 v[36:39], v[132:135], v[208:211], v[36:39]
    v_mul_f32 v0, s56, v0
    v_mul_f32 v1, s56, v1
    v_mul_f32 v2, s56, v2
    v_mfma_f32_16x16x32_bf16 v[40:43], v[136:139], v[208:211], v[40:43]
    v_mul_f32 v3, s56, v3
    v_mul_f32 v4, s56, v4
    v_mfma_f32_16x16x32_bf16 v[44:47], v[140:143], v[208:211], v[44:47]
    v_mul_f32 v5, s56, v5
    v_mul_f32 v6, s56, v6
    v_mfma_f32_16x16x32_bf16 v[48:51], v[128:131], v[212:215], v[48:51]
    v_mul_f32 v7, s56, v7
    v_cvt_pk_bf16_f32 v216, v0, v1
    v_mfma_f32_16x16x32_bf16 v[52:55], v[132:135], v[212:215], v[52:55]
    v_cvt_pk_bf16_f32 v217, v2, v3
    v_cvt_pk_bf16_f32 v218, v4, v5
    v_mfma_f32_16x16x32_bf16 v[56:59], v[136:139], v[212:215], v[56:59]
    v_cvt_pk_bf16_f32 v219, v6, v7
    ds_write_b128 v238, v[216:219] offset:0
    v_mfma_f32_16x16x32_bf16 v[60:63], v[140:143], v[212:215], v[60:63]
    v_mul_f32 v8, s56, v8
    v_mul_f32 v9, s56, v9
    v_mfma_f32_16x16x32_bf16 v[64:67], v[112:115], v[144:147], v[64:67]
    v_mul_f32 v10, s56, v10
    v_mul_f32 v11, s56, v11
    v_mfma_f32_16x16x32_bf16 v[80:83], v[112:115], v[148:151], v[80:83]
    v_mul_f32 v12, s56, v12
    v_mul_f32 v13, s56, v13
    v_mfma_f32_16x16x32_bf16 v[96:99], v[112:115], v[152:155], v[96:99]
    v_mul_f32 v14, s56, v14
    v_mul_f32 v15, s56, v15
    v_mfma_f32_16x16x32_bf16 v[68:71], v[116:119], v[144:147], v[68:71]
    v_cvt_pk_bf16_f32 v220, v8, v9
    v_cvt_pk_bf16_f32 v221, v10, v11
    v_mfma_f32_16x16x32_bf16 v[84:87], v[116:119], v[148:151], v[84:87]
    v_cvt_pk_bf16_f32 v222, v12, v13
    v_cvt_pk_bf16_f32 v223, v14, v15
    v_mfma_f32_16x16x32_bf16 v[100:103], v[116:119], v[152:155], v[100:103]
    ds_write_b128 v238, v[220:223] offset:1024
    v_mul_f32 v16, s56, v16
    v_mfma_f32_16x16x32_bf16 v[72:75], v[120:123], v[144:147], v[72:75]
    v_mul_f32 v17, s56, v17
    v_mul_f32 v18, s56, v18
    v_mfma_f32_16x16x32_bf16 v[88:91], v[120:123], v[148:151], v[88:91]
    v_mul_f32 v19, s56, v19
    v_mul_f32 v20, s56, v20
    v_mfma_f32_16x16x32_bf16 v[104:107], v[120:123], v[152:155], v[104:107]
    v_mul_f32 v21, s56, v21
    v_mul_f32 v22, s56, v22
    v_mfma_f32_16x16x32_bf16 v[76:79], v[124:127], v[144:147], v[76:79]
    v_mul_f32 v23, s56, v23
    v_cvt_pk_bf16_f32 v224, v16, v17
    v_mfma_f32_16x16x32_bf16 v[92:95], v[124:127], v[148:151], v[92:95]
    v_cvt_pk_bf16_f32 v225, v18, v19
    v_cvt_pk_bf16_f32 v226, v20, v21
    v_mfma_f32_16x16x32_bf16 v[108:111], v[124:127], v[152:155], v[108:111]
    v_cvt_pk_bf16_f32 v227, v22, v23
    ds_write_b128 v238, v[224:227] offset:4096
    s_waitcnt lgkmcnt(0)
    s_barrier
    s_cmp_eq_u32 s50, 3
    s_cbranch_scc1 L_P7_fin
    s_add_u32 s50, s50, 1
    ds_read_b128 v[168:171], v233 offset:0
    ds_read_b128 v[172:175], v233 offset:2048
    ds_read_b128 v[176:179], v233 offset:4096
    ds_read_b128 v[180:183], v233 offset:6144
    ds_read_b128 v[184:187], v234 offset:0
    s_nop 0
    v_mul_f32 v24, s56, v24
    v_mul_f32 v25, s56, v25
    v_mul_f32 v26, s56, v26
    v_mul_f32 v27, s56, v27
    v_mul_f32 v28, s56, v28
    v_mfma_f32_16x16x32_bf16 v[64:67], v[128:131], v[156:159], v[64:67]
    ds_read_b128 v[188:191], v234 offset:2048
    v_mul_f32 v29, s56, v29
    v_mul_f32 v30, s56, v30
    v_mul_f32 v31, s56, v31
    v_cvt_pk_bf16_f32 v228, v24, v25
    v_cvt_pk_bf16_f32 v229, v26, v27
    s_add_u32 s64, s64, 1
    s_cmp_eq_u32 s64, 3
    s_cselect_b32 s64, 0, s64
    s_lshl_b32 s69, s64, 10
    s_mul_i32 s70, s64, 10240
    v_mfma_f32_16x16x32_bf16 v[68:71], v[132:135], v[156:159], v[68:71]
    ds_read_b128 v[192:195], v234 offset:4096
    v_cvt_pk_bf16_f32 v230, v28, v29
    v_cvt_pk_bf16_f32 v231, v30, v31
    ds_write_b128 v238, v[228:231] offset:5120
    v_mul_f32 v32, s56, v32
    v_mul_f32 v33, s56, v33
    v_mfma_f32_16x16x32_bf16 v[72:75], v[136:139], v[156:159], v[72:75]
    ds_read_b128 v[196:199], v234 offset:6144
    v_mul_f32 v34, s56, v34
    v_mul_f32 v35, s56, v35
    v_mul_f32 v36, s56, v36
    v_mul_f32 v37, s56, v37
    v_mul_f32 v38, s56, v38
    v_mfma_f32_16x16x32_bf16 v[76:79], v[140:143], v[156:159], v[76:79]
    ds_read_b64_tr_b16 v[112:113], v232 offset:0
    v_mul_f32 v39, s56, v39
    v_cvt_pk_bf16_f32 v216, v32, v33
    v_cvt_pk_bf16_f32 v217, v34, v35
    v_cvt_pk_bf16_f32 v218, v36, v37
    v_cvt_pk_bf16_f32 v219, v38, v39
    v_mfma_f32_16x16x32_bf16 v[80:83], v[128:131], v[160:163], v[80:83]
    ds_read_b64_tr_b16 v[114:115], v232 offset:256
    ds_write_b128 v238, v[216:219] offset:8192
    v_mul_f32 v40, s56, v40
    v_mul_f32 v41, s56, v41
    v_mul_f32 v42, s56, v42
    v_mul_f32 v43, s56, v43
    v_mfma_f32_16x16x32_bf16 v[84:87], v[132:135], v[160:163], v[84:87]
    ds_read_b64_tr_b16 v[116:117], v232 offset:8
    v_mul_f32 v44, s56, v44
    v_mul_f32 v45, s56, v45
    v_mul_f32 v46, s56, v46
    v_mul_f32 v47, s56, v47
    v_cvt_pk_bf16_f32 v220, v40, v41
    v_mfma_f32_16x16x32_bf16 v[88:91], v[136:139], v[160:163], v[88:91]
    ds_read_b64_tr_b16 v[118:119], v232 offset:264
    v_cvt_pk_bf16_f32 v221, v42, v43
    v_cvt_pk_bf16_f32 v222, v44, v45
    v_cvt_pk_bf16_f32 v223, v46, v47
    ds_write_b128 v238, v[220:223] offset:9216
    v_mul_f32 v48, s56, v48
    v_mfma_f32_16x16x32_bf16 v[92:95], v[140:143], v[160:163], v[92:95]
    ds_read_b64_tr_b16 v[120:121], v232 offset:64
    v_mul_f32 v49, s56, v49
    v_mul_f32 v50, s56, v50
    v_mul_f32 v51, s56, v51
    v_mul_f32 v52, s56, v52
    v_mul_f32 v53, s56, v53
    v_mfma_f32_16x16x32_bf16 v[96:99], v[128:131], v[164:167], v[96:99]
    ds_read_b64_tr_b16 v[122:123], v232 offset:320
    v_mul_f32 v54, s56, v54
    v_mul_f32 v55, s56, v55
    v_cvt_pk_bf16_f32 v224, v48, v49
    v_cvt_pk_bf16_f32 v225, v50, v51
    v_cvt_pk_bf16_f32 v226, v52, v53
    v_mfma_f32_16x16x32_bf16 v[100:103], v[132:135], v[164:167], v[100:103]
    ds_read_b64_tr_b16 v[124:125], v232 offset:72
    v_cvt_pk_bf16_f32 v227, v54, v55
    ds_write_b128 v238, v[224:227] offset:12288
    v_mul_f32 v56, s56, v56
    v_mul_f32 v57, s56, v57
    v_mul_f32 v58, s56, v58
    v_mfma_f32_16x16x32_bf16 v[104:107], v[136:139], v[164:167], v[104:107]
    ds_read_b64_tr_b16 v[126:127], v232 offset:328
    v_mul_f32 v59, s56, v59
    v_mul_f32 v60, s56, v60
    v_mul_f32 v61, s56, v61
    v_mul_f32 v62, s56, v62
    v_mul_f32 v63, s56, v63
    v_mfma_f32_16x16x32_bf16 v[108:111], v[140:143], v[164:167], v[108:111]
    v_cvt_pk_bf16_f32 v228, v56, v57
    v_cvt_pk_bf16_f32 v229, v58, v59
    v_cvt_pk_bf16_f32 v230, v60, v61
    v_cvt_pk_bf16_f32 v231, v62, v63
    ds_write_b128 v238, v[228:231] offset:13312
    v_mul_f32 v64, s56, v64
    v_mul_f32 v65, s56, v65
    v_mul_f32 v66, s56, v66
    v_mul_f32 v67, s56, v67
    v_mul_f32 v68, s56, v68
    v_mul_f32 v69, s56, v69
    v_mul_f32 v70, s56, v70
    v_mul_f32 v71, s56, v71
    v_cvt_pk_bf16_f32 v216, v64, v65
    v_cvt_pk_bf16_f32 v217, v66, v67
    v_cvt_pk_bf16_f32 v218, v68, v69
    v_cvt_pk_bf16_f32 v219, v70, v71
    ds_write_b128 v238, v[216:219] offset:20480
    v_add_u32 v232, s69, v235
    v_add_u32 v233, s70, v236
    v_add_u32 v234, s70, v237
    s_waitcnt lgkmcnt(0)
    s_barrier
    ds_read_b128 v[144:147], v233 offset:0
    ds_read_b128 v[148:151], v233 offset:2048
    ds_read_b128 v[152:155], v233 offset:4096
    ds_read_b64_tr_b16 v[128:129], v232 offset:0
    ds_read_b64_tr_b16 v[130:131], v232 offset:256
    ds_read_b64_tr_b16 v[132:133], v232 offset:8
    ds_read_b64_tr_b16 v[134:135], v232 offset:264
    ds_read_b64_tr_b16 v[136:137], v232 offset:64
    ds_read_b64_tr_b16 v[138:139], v232 offset:320
    ds_read_b64_tr_b16 v[140:141], v232 offset:72
    ds_read_b64_tr_b16 v[142:143], v232 offset:328
    ds_read_b128 v[156:159], v234 offset:0
    ds_read_b128 v[160:163], v234 offset:2048
    ds_read_b128 v[164:167], v234 offset:4096
    v_mul_f32 v72, s56, v72
    v_mul_f32 v73, s56, v73
    v_mul_f32 v74, s56, v74
    v_mul_f32 v75, s56, v75
    v_mul_f32 v76, s56, v76
    v_mul_f32 v77, s56, v77
    v_mul_f32 v78, s56, v78
    v_mul_f32 v79, s56, v79
    v_cvt_pk_bf16_f32 v220, v72, v73
    v_cvt_pk_bf16_f32 v221, v74, v75
    v_cvt_pk_bf16_f32 v222, v76, v77
    v_cvt_pk_bf16_f32 v223, v78, v79
    ds_write_b128 v238, v[220:223] offset:21504
    v_mul_f32 v80, s56, v80
    v_mul_f32 v81, s56, v81
    v_mul_f32 v82, s56, v82
    v_mul_f32 v83, s56, v83
    v_mul_f32 v84, s56, v84
    v_mul_f32 v85, s56, v85
    v_mul_f32 v86, s56, v86
    v_mul_f32 v87, s56, v87
    v_cvt_pk_bf16_f32 v224, v80, v81
    v_cvt_pk_bf16_f32 v225, v82, v83
    v_cvt_pk_bf16_f32 v226, v84, v85
    v_cvt_pk_bf16_f32 v227, v86, v87
    ds_write_b128 v238, v[224:227] offset:24576
    v_mul_f32 v88, s56, v88
    v_mul_f32 v89, s56, v89
    v_mul_f32 v90, s56, v90
    v_mul_f32 v91, s56, v91
    v_mul_f32 v92, s56, v92
    v_mul_f32 v93, s56, v93
    v_mul_f32 v94, s56, v94
    v_mul_f32 v95, s56, v95
    v_cvt_pk_bf16_f32 v228, v88, v89
    v_cvt_pk_bf16_f32 v229, v90, v91
    v_cvt_pk_bf16_f32 v230, v92, v93
    v_cvt_pk_bf16_f32 v231, v94, v95
    ds_write_b128 v238, v[228:231] offset:25600
    v_mul_f32 v96, s56, v96
    v_mul_f32 v97, s56, v97
    v_mul_f32 v98, s56, v98
    v_mul_f32 v99, s56, v99
    v_mul_f32 v100, s56, v100
    v_mul_f32 v101, s56, v101
    v_mul_f32 v102, s56, v102
    v_mul_f32 v103, s56, v103
    v_cvt_pk_bf16_f32 v216, v96, v97
    v_cvt_pk_bf16_f32 v217, v98, v99
    v_cvt_pk_bf16_f32 v218, v100, v101
    v_cvt_pk_bf16_f32 v219, v102, v103
    ds_write_b128 v238, v[216:219] offset:28672
    v_mul_f32 v104, s56, v104
    v_mul_f32 v105, s56, v105
    v_mul_f32 v106, s56, v106
    v_mul_f32 v107, s56, v107
    v_mul_f32 v108, s56, v108
    v_mul_f32 v109, s56, v109
    v_mul_f32 v110, s56, v110
    v_mul_f32 v111, s56, v111
    v_cvt_pk_bf16_f32 v220, v104, v105
    v_cvt_pk_bf16_f32 v221, v106, v107
    v_cvt_pk_bf16_f32 v222, v108, v109
    v_cvt_pk_bf16_f32 v223, v110, v111
    ds_write_b128 v238, v[220:223] offset:29696
    v_mov_b32 v200, v184
    v_mov_b32 v201, v185
    v_mov_b32 v202, v186
    v_mov_b32 v203, v187
    v_mov_b32 v204, v188
    v_mov_b32 v205, v189
    v_mov_b32 v206, v190
    v_mov_b32 v207, v191
    v_mov_b32 v208, v192
    v_mov_b32 v209, v193
    v_mov_b32 v210, v194
    v_mov_b32 v211, v195
    v_mov_b32 v212, v196
    v_mov_b32 v213, v197
    v_mov_b32 v214, v198
    v_mov_b32 v215, v199
    s_add_u32 s64, s64, 1
    s_cmp_eq_u32 s64, 3
    s_cselect_b32 s64, 0, s64
    s_lshl_b32 s69, s64, 10
    s_mul_i32 s70, s64, 10240
    v_add_u32 v232, s69, v235
    v_add_u32 v233, s70, v236
    v_add_u32 v234, s70, v237
    s_waitcnt lgkmcnt(0)
    s_barrier
    s_branch L_P7_r2
L_P7_fin:
    s_nop 5
    v_mul_f32 v24, s56, v24
    v_mul_f32 v25, s56, v25
    v_mul_f32 v26, s56, v26
    v_mul_f32 v27, s56, v27
    v_mul_f32 v28, s56, v28
    v_mfma_f32_16x16x32_bf16 v[64:67], v[128:131], v[156:159], v[64:67]
    v_mul_f32 v29, s56, v29
    v_mul_f32 v30, s56, v30
    v_mul_f32 v31, s56, v31
    v_cvt_pk_bf16_f32 v228, v24, v25
    v_cvt_pk_bf16_f32 v229, v26, v27
    v_mfma_f32_16x16x32_bf16 v[68:71], v[132:135], v[156:159], v[68:71]
    v_cvt_pk_bf16_f32 v230, v28, v29
    v_cvt_pk_bf16_f32 v231, v30, v31
    ds_write_b128 v238, v[228:231] offset:5120
    v_mul_f32 v32, s56, v32
    v_mul_f32 v33, s56, v33
    v_mfma_f32_16x16x32_bf16 v[72:75], v[136:139], v[156:159], v[72:75]
    v_mul_f32 v34, s56, v34
    v_mul_f32 v35, s56, v35
    v_mul_f32 v36, s56, v36
    v_mul_f32 v37, s56, v37
    v_mul_f32 v38, s56, v38
    v_mfma_f32_16x16x32_bf16 v[76:79], v[140:143], v[156:159], v[76:79]
    v_mul_f32 v39, s56, v39
    v_cvt_pk_bf16_f32 v216, v32, v33
    v_cvt_pk_bf16_f32 v217, v34, v35
    v_cvt_pk_bf16_f32 v218, v36, v37
    v_cvt_pk_bf16_f32 v219, v38, v39
    v_mfma_f32_16x16x32_bf16 v[80:83], v[128:131], v[160:163], v[80:83]
    ds_write_b128 v238, v[216:219] offset:8192
    v_mul_f32 v40, s56, v40
    v_mul_f32 v41, s56, v41
    v_mul_f32 v42, s56, v42
    v_mul_f32 v43, s56, v43
    v_mfma_f32_16x16x32_bf16 v[84:87], v[132:135], v[160:163], v[84:87]
    v_mul_f32 v44, s56, v44
    v_mul_f32 v45, s56, v45
    v_mul_f32 v46, s56, v46
    v_mul_f32 v47, s56, v47
    v_cvt_pk_bf16_f32 v220, v40, v41
    v_mfma_f32_16x16x32_bf16 v[88:91], v[136:139], v[160:163], v[88:91]
    v_cvt_pk_bf16_f32 v221, v42, v43
    v_cvt_pk_bf16_f32 v222, v44, v45
    v_cvt_pk_bf16_f32 v223, v46, v47
    ds_write_b128 v238, v[220:223] offset:9216
    v_mul_f32 v48, s56, v48
    v_mfma_f32_16x16x32_bf16 v[92:95], v[140:143], v[160:163], v[92:95]
    v_mul_f32 v49, s56, v49
    v_mul_f32 v50, s56, v50
    v_mul_f32 v51, s56, v51
    v_mul_f32 v52, s56, v52
    v_mul_f32 v53, s56, v53
    v_mfma_f32_16x16x32_bf16 v[96:99], v[128:131], v[164:167], v[96:99]
    v_mul_f32 v54, s56, v54
    v_mul_f32 v55, s56, v55
    v_cvt_pk_bf16_f32 v224, v48, v49
    v_cvt_pk_bf16_f32 v225, v50, v51
    v_cvt_pk_bf16_f32 v226, v52, v53
    v_mfma_f32_16x16x32_bf16 v[100:103], v[132:135], v[164:167], v[100:103]
    v_cvt_pk_bf16_f32 v227, v54, v55
    ds_write_b128 v238, v[224:227] offset:12288
    v_mul_f32 v56, s56, v56
    v_mul_f32 v57, s56, v57
    v_mul_f32 v58, s56, v58
    v_mfma_f32_16x16x32_bf16 v[104:107], v[136:139], v[164:167], v[104:107]
    v_mul_f32 v59, s56, v59
    v_mul_f32 v60, s56, v60
    v_mul_f32 v61, s56, v61
    v_mul_f32 v62, s56, v62
    v_mul_f32 v63, s56, v63
    v_mfma_f32_16x16x32_bf16 v[108:111], v[140:143], v[164:167], v[108:111]
    v_cvt_pk_bf16_f32 v228, v56, v57
    v_cvt_pk_bf16_f32 v229, v58, v59
    v_cvt_pk_bf16_f32 v230, v60, v61
    v_cvt_pk_bf16_f32 v231, v62, v63
    ds_write_b128 v238, v[228:231] offset:13312
    v_mul_f32 v64, s56, v64
    v_mul_f32 v65, s56, v65
    v_mul_f32 v66, s56, v66
    v_mul_f32 v67, s56, v67
    v_mul_f32 v68, s56, v68
    v_mul_f32 v69, s56, v69
    v_mul_f32 v70, s56, v70
    v_mul_f32 v71, s56, v71
    v_cvt_pk_bf16_f32 v216, v64, v65
    v_cvt_pk_bf16_f32 v217, v66, v67
    v_cvt_pk_bf16_f32 v218, v68, v69
    v_cvt_pk_bf16_f32 v219, v70, v71
    ds_write_b128 v238, v[216:219] offset:20480
    s_waitcnt lgkmcnt(0)
    s_barrier
    s_nop 5
    v_mul_f32 v72, s56, v72
    v_mul_f32 v73, s56, v73
    v_mul_f32 v74, s56, v74
    v_mul_f32 v75, s56, v75
    v_mul_f32 v76, s56, v76
    v_mul_f32 v77, s56, v77
    v_mul_f32 v78, s56, v78
    v_mul_f32 v79, s56, v79
    v_cvt_pk_bf16_f32 v220, v72, v73
    v_cvt_pk_bf16_f32 v221, v74, v75
    v_cvt_pk_bf16_f32 v222, v76, v77
    v_cvt_pk_bf16_f32 v223, v78, v79
    ds_write_b128 v238, v[220:223] offset:21504
    v_mul_f32 v80, s56, v80
    v_mul_f32 v81, s56, v81
    v_mul_f32 v82, s56, v82
    v_mul_f32 v83, s56, v83
    v_mul_f32 v84, s56, v84
    v_mul_f32 v85, s56, v85
    v_mul_f32 v86, s56, v86
    v_mul_f32 v87, s56, v87
    v_cvt_pk_bf16_f32 v224, v80, v81
    v_cvt_pk_bf16_f32 v225, v82, v83
    v_cvt_pk_bf16_f32 v226, v84, v85
    v_cvt_pk_bf16_f32 v227, v86, v87
    ds_write_b128 v238, v[224:227] offset:24576
    v_mul_f32 v88, s56, v88
    v_mul_f32 v89, s56, v89
    v_mul_f32 v90, s56, v90
    v_mul_f32 v91, s56, v91
    v_mul_f32 v92, s56, v92
    v_mul_f32 v93, s56, v93
    v_mul_f32 v94, s56, v94
    v_mul_f32 v95, s56, v95
    v_cvt_pk_bf16_f32 v228, v88, v89
    v_cvt_pk_bf16_f32 v229, v90, v91
    v_cvt_pk_bf16_f32 v230, v92, v93
    v_cvt_pk_bf16_f32 v231, v94, v95
    ds_write_b128 v238, v[228:231] offset:25600
    v_mul_f32 v96, s56, v96
    v_mul_f32 v97, s56, v97
    v_mul_f32 v98, s56, v98
    v_mul_f32 v99, s56, v99
    v_mul_f32 v100, s56, v100
    v_mul_f32 v101, s56, v101
    v_mul_f32 v102, s56, v102
    v_mul_f32 v103, s56, v103
    v_cvt_pk_bf16_f32 v216, v96, v97
    v_cvt_pk_bf16_f32 v217, v98, v99
    v_cvt_pk_bf16_f32 v218, v100, v101
    v_cvt_pk_bf16_f32 v219, v102, v103
    ds_write_b128 v238, v[216:219] offset:28672
    v_mul_f32 v104, s56, v104
    v_mul_f32 v105, s56, v105
    v_mul_f32 v106, s56, v106
    v_mul_f32 v107, s56, v107
    v_mul_f32 v108, s56, v108
    v_mul_f32 v109, s56, v109
    v_mul_f32 v110, s56, v110
    v_mul_f32 v111, s56, v111
    v_cvt_pk_bf16_f32 v220, v104, v105
    v_cvt_pk_bf16_f32 v221, v106, v107
    v_cvt_pk_bf16_f32 v222, v108, v109
    v_cvt_pk_bf16_f32 v223, v110, v111
    ds_write_b128 v238, v[220:223] offset:29696
    s_waitcnt lgkmcnt(0)
    s_barrier
    s_lshl_b32 s39, s30, 3
    s_add_u32 s39, s39, s32
    s_lshl_b32 s39, s39, 4
    v_mov_b32 v164, 0
    buffer_load_dwordx4 v[160:163], v164, s[4:7], s39 offen sc1
    s_waitcnt vmcnt(0)
    v_and_b32 v160, v160, v161
    v_and_b32 v162, v162, v163
    v_and_b32 v160, v160, v162
    v_and_b32 v160, 0x01010101, v160
    s_nop 0
    v_readfirstlane_b32 s39, v160
    s_nop 3
    s_cmp_eq_u32 s39, 0x01010101
    s_cbranch_scc1 L_fb_done
    v_mbcnt_lo_u32_b32 v250, -1, 0
    v_mbcnt_hi_u32_b32 v250, -1, v250
    s_lshl_b32 s36, s35, 12
    s_add_u32 s36, s36, 65760
    v_lshrrev_b32 v251, 3, v250
    v_lshlrev_b32 v200, 10, v251
    v_and_b32 v251, 7, v250
    v_lshl_add_u32 v200, v251, 4, v200
    v_lshrrev_b32 v251, 2, v250
    v_lshlrev_b32 v201, 7, v251
    v_and_b32 v251, 3, v250
    v_lshl_add_u32 v201, v251, 4, v201
    v_add_u32 v201, s36, v201
    v_lshlrev_b32 v202, 4, v250
    s_mov_b32 m0, s36
    s_lshl_b32 s51, s35, 6
    s_add_u32 s52, s51, 64
L_fb_loop:
    s_lshr_b32 s37, s51, 5
    s_add_u32 s37, s37, s32
    s_and_b32 s37, s37, 3
    s_lshl_b32 s38, s32, 2
    s_add_u32 s37, s37, s38
    s_lshl_b32 s37, s37, 2
    s_bfe_u32 s38, s51, 0x20003
    s_add_u32 s37, s37, s38
    s_lshl_b32 s37, s37, 15
    s_lshl_b32 s38, s30, 4
    s_lshr_b32 s39, s51, 3
    s_add_u32 s38, s38, s39
    s_mul_i32 s38, s38, 266240
    s_lshl_b32 s39, s32, 15
    s_add_u32 s38, s38, s39
    s_and_b32 s40, s51, 7
    s_lshl_b32 s39, s40, 12
    s_add_u32 s38, s38, s39
    s_add_u32 s38, s38, 41943040
    s_lshl_b32 s39, s40, 7
    s_add_u32 s39, s37, s39
    buffer_load_dwordx4 v200, s[24:27], s39 offen lds
    s_add_u32 s39, s39, 7168
    buffer_load_dwordx4 v200, s[24:27], s39 offen offset:1024 lds
    s_add_u32 s39, s39, 7168
    buffer_load_dwordx4 v200, s[24:27], s39 offen offset:2048 lds
    s_add_u32 s39, s39, 7168
    buffer_load_dwordx4 v200, s[24:27], s39 offen offset:3072 lds
    s_add_u32 s39, s39, 7168
    s_waitcnt vmcnt(0)
    ds_read_b64_tr_b16 v[160:161], v201 offset:0
    ds_read_b64_tr_b16 v[162:163], v201 offset:2048
    ds_read_b64_tr_b16 v[164:165], v201 offset:8
    ds_read_b64_tr_b16 v[166:167], v201 offset:2056
    ds_read_b64_tr_b16 v[168:169], v201 offset:64
    ds_read_b64_tr_b16 v[170:171], v201 offset:2112
    ds_read_b64_tr_b16 v[172:173], v201 offset:72
    ds_read_b64_tr_b16 v[174:175], v201 offset:2120
    s_waitcnt lgkmcnt(0)
    buffer_store_dwordx4 v[160:163], v202, s[20:23], s38 offen sc1
    buffer_store_dwordx4 v[164:167], v202, s[20:23], s38 offen offset:1024 sc1
    buffer_store_dwordx4 v[168:171], v202, s[20:23], s38 offen offset:2048 sc1
    buffer_store_dwordx4 v[172:175], v202, s[20:23], s38 offen offset:3072 sc1
    s_add_u32 s51, s51, 1
    s_cmp_lt_u32 s51, s52
    s_cbranch_scc1 L_fb_loop
    s_waitcnt vmcnt(0)
L_fb_done:
    s_waitcnt lgkmcnt(0)
    s_barrier
    v_mbcnt_lo_u32_b32 v248, -1, 0
    v_mbcnt_hi_u32_b32 v248, -1, v248
    v_lshlrev_b32 v248, 4, v248
    s_mul_i32 s68, s30, 4259840
    s_lshl_b32 s67, s32, 15
    s_add_u32 s68, s68, s67
    s_lshl_b32 s67, s34, 11
    s_add_u32 s68, s68, s67
    s_add_u32 s68, s68, 41943040
    s_lshl_b32 s40, s30, 4
    s_add_u32 s40, s40, s31
    s_lshl_b32 s69, s40, 3
    s_add_u32 s69, s69, s32
    s_lshl_b32 s69, s69, 4
    s_add_u32 s69, s69, s34
    s_mul_i32 s69, s69, 10240

    s_lshl_b32 s41, s40, 13
    s_add_u32 s41, s41, 54525952
    s_lshl_b32 s70, s34, 9
    s_add_u32 s70, s70, s41
    s_lshl_b32 s67, s32, 6
    s_add_u32 s70, s70, s67
    v_add_u32 v249, 0x10000, v248
    v_add_u32 v253, 122880, v248
    s_add_u32 s67, s68, 2129920
    buffer_load_dwordx4 v[160:163], v248, s[20:23], s67 offen sc1
    buffer_load_dwordx4 v[164:167], v248, s[20:23], s67 offen offset:1024 sc1
    s_waitcnt lgkmcnt(0)
    s_barrier
    s_waitcnt vmcnt(0)
    s_add_u32 s67, s68, 2138112
    buffer_load_dwordx4 v[168:171], v248, s[20:23], s67 offen sc1
    buffer_load_dwordx4 v[172:175], v248, s[20:23], s67 offen offset:1024 sc1
    ds_read_b128 v[224:227], v253 offset:0
    ds_read_b128 v[228:231], v253 offset:4096
    ds_read_b128 v[232:235], v253 offset:8192
    ds_read_b128 v[236:239], v253 offset:12288
    ds_read_b128 v[240:243], v253 offset:16384
    s_waitcnt lgkmcnt(4)
    v_mfma_f32_16x16x32_bf16 v[0:3], v[160:163], v[224:227], 0
    ds_read_b128 v[244:247], v253 offset:20480
    v_mfma_f32_16x16x32_bf16 v[4:7], v[164:167], v[224:227], 0
    s_waitcnt lgkmcnt(4)
    v_mfma_f32_16x16x32_bf16 v[16:19], v[160:163], v[228:231], 0
    ds_read_b128 v[224:227], v253 offset:24576
    v_mfma_f32_16x16x32_bf16 v[20:23], v[164:167], v[228:231], 0
    s_waitcnt lgkmcnt(4)
    v_mfma_f32_16x16x32_bf16 v[32:35], v[160:163], v[232:235], 0
    ds_read_b128 v[228:231], v253 offset:28672
    v_mfma_f32_16x16x32_bf16 v[36:39], v[164:167], v[232:235], 0
    s_waitcnt lgkmcnt(4)
    v_mfma_f32_16x16x32_bf16 v[48:51], v[160:163], v[236:239], 0
    ds_read_b128 v[232:235], v253 offset:32768
    v_mfma_f32_16x16x32_bf16 v[52:55], v[164:167], v[236:239], 0
    s_waitcnt lgkmcnt(4)
    v_mfma_f32_16x16x32_bf16 v[64:67], v[160:163], v[240:243], 0
    ds_read_b128 v[236:239], v253 offset:36864
    v_mfma_f32_16x16x32_bf16 v[68:71], v[164:167], v[240:243], 0
    s_waitcnt lgkmcnt(4)
    v_mfma_f32_16x16x32_bf16 v[80:83], v[160:163], v[244:247], 0
    v_mfma_f32_16x16x32_bf16 v[84:87], v[164:167], v[244:247], 0
    s_waitcnt lgkmcnt(3)
    v_mfma_f32_16x16x32_bf16 v[96:99], v[160:163], v[224:227], 0
    v_mfma_f32_16x16x32_bf16 v[100:103], v[164:167], v[224:227], 0
    s_waitcnt lgkmcnt(2)
    v_mfma_f32_16x16x32_bf16 v[112:115], v[160:163], v[228:231], 0
    v_mfma_f32_16x16x32_bf16 v[116:119], v[164:167], v[228:231], 0
    s_waitcnt lgkmcnt(1)
    v_mfma_f32_16x16x32_bf16 v[128:131], v[160:163], v[232:235], 0
    v_mfma_f32_16x16x32_bf16 v[132:135], v[164:167], v[232:235], 0
    s_waitcnt lgkmcnt(0)
    v_mfma_f32_16x16x32_bf16 v[144:147], v[160:163], v[236:239], 0
    v_mfma_f32_16x16x32_bf16 v[148:151], v[164:167], v[236:239], 0
    s_waitcnt lgkmcnt(0)
    s_barrier
    s_waitcnt vmcnt(0)
    s_add_u32 s67, s68, 2396160
    buffer_load_dwordx4 v[160:163], v248, s[20:23], s67 offen sc1
    buffer_load_dwordx4 v[164:167], v248, s[20:23], s67 offen offset:1024 sc1
    ds_read_b128 v[224:227], v253 offset:0
    ds_read_b128 v[228:231], v253 offset:4096
    ds_read_b128 v[232:235], v253 offset:8192
    ds_read_b128 v[236:239], v253 offset:12288
    ds_read_b128 v[240:243], v253 offset:16384
    s_waitcnt lgkmcnt(4)
    v_mfma_f32_16x16x32_bf16 v[8:11], v[168:171], v[224:227], 0
    ds_read_b128 v[244:247], v253 offset:20480
    v_mfma_f32_16x16x32_bf16 v[12:15], v[172:175], v[224:227], 0
    s_waitcnt lgkmcnt(4)
    v_mfma_f32_16x16x32_bf16 v[24:27], v[168:171], v[228:231], 0
    ds_read_b128 v[224:227], v253 offset:24576
    v_mfma_f32_16x16x32_bf16 v[28:31], v[172:175], v[228:231], 0
    s_waitcnt lgkmcnt(4)
    v_mfma_f32_16x16x32_bf16 v[40:43], v[168:171], v[232:235], 0
    ds_read_b128 v[228:231], v253 offset:28672
    v_mfma_f32_16x16x32_bf16 v[44:47], v[172:175], v[232:235], 0
    s_waitcnt lgkmcnt(4)
    v_mfma_f32_16x16x32_bf16 v[56:59], v[168:171], v[236:239], 0
    ds_read_b128 v[232:235], v253 offset:32768
    v_mfma_f32_16x16x32_bf16 v[60:63], v[172:175], v[236:239], 0
    s_waitcnt lgkmcnt(4)
    v_mfma_f32_16x16x32_bf16 v[72:75], v[168:171], v[240:243], 0
    ds_read_b128 v[236:239], v253 offset:36864
    v_mfma_f32_16x16x32_bf16 v[76:79], v[172:175], v[240:243], 0
    s_waitcnt lgkmcnt(4)
    v_mfma_f32_16x16x32_bf16 v[88:91], v[168:171], v[244:247], 0
    v_mfma_f32_16x16x32_bf16 v[92:95], v[172:175], v[244:247], 0
    s_waitcnt lgkmcnt(3)
    v_mfma_f32_16x16x32_bf16 v[104:107], v[168:171], v[224:227], 0
    v_mfma_f32_16x16x32_bf16 v[108:111], v[172:175], v[224:227], 0
    s_waitcnt lgkmcnt(2)
    v_mfma_f32_16x16x32_bf16 v[120:123], v[168:171], v[228:231], 0
    v_mfma_f32_16x16x32_bf16 v[124:127], v[172:175], v[228:231], 0
    s_waitcnt lgkmcnt(1)
    v_mfma_f32_16x16x32_bf16 v[136:139], v[168:171], v[232:235], 0
    v_mfma_f32_16x16x32_bf16 v[140:143], v[172:175], v[232:235], 0
    s_waitcnt lgkmcnt(0)
    v_mfma_f32_16x16x32_bf16 v[152:155], v[168:171], v[236:239], 0
    v_mfma_f32_16x16x32_bf16 v[156:159], v[172:175], v[236:239], 0
    s_waitcnt lgkmcnt(0)
    s_barrier
    s_waitcnt vmcnt(0)
    s_add_u32 s67, s68, 2404352
    buffer_load_dwordx4 v[168:171], v248, s[20:23], s67 offen sc1
    buffer_load_dwordx4 v[172:175], v248, s[20:23], s67 offen offset:1024 sc1
    ds_read_b128 v[224:227], v253 offset:1024
    ds_read_b128 v[228:231], v253 offset:5120
    ds_read_b128 v[232:235], v253 offset:9216
    ds_read_b128 v[236:239], v253 offset:13312
    ds_read_b128 v[240:243], v253 offset:17408
    s_waitcnt lgkmcnt(4)
    v_mfma_f32_16x16x32_bf16 v[0:3], v[160:163], v[224:227], v[0:3]
    ds_read_b128 v[244:247], v253 offset:21504
    v_mfma_f32_16x16x32_bf16 v[4:7], v[164:167], v[224:227], v[4:7]
    s_waitcnt lgkmcnt(4)
    v_mfma_f32_16x16x32_bf16 v[16:19], v[160:163], v[228:231], v[16:19]
    ds_read_b128 v[224:227], v253 offset:25600
    v_mfma_f32_16x16x32_bf16 v[20:23], v[164:167], v[228:231], v[20:23]
    s_waitcnt lgkmcnt(4)
    v_mfma_f32_16x16x32_bf16 v[32:35], v[160:163], v[232:235], v[32:35]
    ds_read_b128 v[228:231], v253 offset:29696
    v_mfma_f32_16x16x32_bf16 v[36:39], v[164:167], v[232:235], v[36:39]
    s_waitcnt lgkmcnt(4)
    v_mfma_f32_16x16x32_bf16 v[48:51], v[160:163], v[236:239], v[48:51]
    ds_read_b128 v[232:235], v253 offset:33792
    v_mfma_f32_16x16x32_bf16 v[52:55], v[164:167], v[236:239], v[52:55]
    s_waitcnt lgkmcnt(4)
    v_mfma_f32_16x16x32_bf16 v[64:67], v[160:163], v[240:243], v[64:67]
    ds_read_b128 v[236:239], v253 offset:37888
    v_mfma_f32_16x16x32_bf16 v[68:71], v[164:167], v[240:243], v[68:71]
    s_waitcnt lgkmcnt(4)
    v_mfma_f32_16x16x32_bf16 v[80:83], v[160:163], v[244:247], v[80:83]
    v_mfma_f32_16x16x32_bf16 v[84:87], v[164:167], v[244:247], v[84:87]
    s_waitcnt lgkmcnt(3)
    v_mfma_f32_16x16x32_bf16 v[96:99], v[160:163], v[224:227], v[96:99]
    v_mfma_f32_16x16x32_bf16 v[100:103], v[164:167], v[224:227], v[100:103]
    s_waitcnt lgkmcnt(2)
    v_mfma_f32_16x16x32_bf16 v[112:115], v[160:163], v[228:231], v[112:115]
    v_mfma_f32_16x16x32_bf16 v[116:119], v[164:167], v[228:231], v[116:119]
    s_waitcnt lgkmcnt(1)
    v_mfma_f32_16x16x32_bf16 v[128:131], v[160:163], v[232:235], v[128:131]
    v_mfma_f32_16x16x32_bf16 v[132:135], v[164:167], v[232:235], v[132:135]
    s_waitcnt lgkmcnt(0)
    v_mfma_f32_16x16x32_bf16 v[144:147], v[160:163], v[236:239], v[144:147]
    v_mfma_f32_16x16x32_bf16 v[148:151], v[164:167], v[236:239], v[148:151]
    s_waitcnt lgkmcnt(0)
    s_barrier
    s_waitcnt vmcnt(0)
    s_add_u32 s67, s68, 2662400
    buffer_load_dwordx4 v[160:163], v248, s[20:23], s67 offen sc1
    buffer_load_dwordx4 v[164:167], v248, s[20:23], s67 offen offset:1024 sc1
    ds_read_b128 v[224:227], v253 offset:1024
    ds_read_b128 v[228:231], v253 offset:5120
    ds_read_b128 v[232:235], v253 offset:9216
    ds_read_b128 v[236:239], v253 offset:13312
    ds_read_b128 v[240:243], v253 offset:17408
    s_waitcnt lgkmcnt(4)
    v_mfma_f32_16x16x32_bf16 v[8:11], v[168:171], v[224:227], v[8:11]
    ds_read_b128 v[244:247], v253 offset:21504
    v_mfma_f32_16x16x32_bf16 v[12:15], v[172:175], v[224:227], v[12:15]
    s_waitcnt lgkmcnt(4)
    v_mfma_f32_16x16x32_bf16 v[24:27], v[168:171], v[228:231], v[24:27]
    ds_read_b128 v[224:227], v253 offset:25600
    v_mfma_f32_16x16x32_bf16 v[28:31], v[172:175], v[228:231], v[28:31]
    s_waitcnt lgkmcnt(4)
    v_mfma_f32_16x16x32_bf16 v[40:43], v[168:171], v[232:235], v[40:43]
    ds_read_b128 v[228:231], v253 offset:29696
    v_mfma_f32_16x16x32_bf16 v[44:47], v[172:175], v[232:235], v[44:47]
    s_waitcnt lgkmcnt(4)
    v_mfma_f32_16x16x32_bf16 v[56:59], v[168:171], v[236:239], v[56:59]
    ds_read_b128 v[232:235], v253 offset:33792
    v_mfma_f32_16x16x32_bf16 v[60:63], v[172:175], v[236:239], v[60:63]
    s_waitcnt lgkmcnt(4)
    v_mfma_f32_16x16x32_bf16 v[72:75], v[168:171], v[240:243], v[72:75]
    ds_read_b128 v[236:239], v253 offset:37888
    v_mfma_f32_16x16x32_bf16 v[76:79], v[172:175], v[240:243], v[76:79]
    s_waitcnt lgkmcnt(4)
    v_mfma_f32_16x16x32_bf16 v[88:91], v[168:171], v[244:247], v[88:91]
    v_mfma_f32_16x16x32_bf16 v[92:95], v[172:175], v[244:247], v[92:95]
    s_waitcnt lgkmcnt(3)
    v_mfma_f32_16x16x32_bf16 v[104:107], v[168:171], v[224:227], v[104:107]
    v_mfma_f32_16x16x32_bf16 v[108:111], v[172:175], v[224:227], v[108:111]
    s_waitcnt lgkmcnt(2)
    v_mfma_f32_16x16x32_bf16 v[120:123], v[168:171], v[228:231], v[120:123]
    v_mfma_f32_16x16x32_bf16 v[124:127], v[172:175], v[228:231], v[124:127]
    s_waitcnt lgkmcnt(1)
    v_mfma_f32_16x16x32_bf16 v[136:139], v[168:171], v[232:235], v[136:139]
    v_mfma_f32_16x16x32_bf16 v[140:143], v[172:175], v[232:235], v[140:143]
    s_waitcnt lgkmcnt(0)
    v_mfma_f32_16x16x32_bf16 v[152:155], v[168:171], v[236:239], v[152:155]
    v_mfma_f32_16x16x32_bf16 v[156:159], v[172:175], v[236:239], v[156:159]
    s_waitcnt lgkmcnt(0)
    s_barrier
    s_waitcnt vmcnt(0)
    s_add_u32 s67, s68, 2670592
    buffer_load_dwordx4 v[168:171], v248, s[20:23], s67 offen sc1
    buffer_load_dwordx4 v[172:175], v248, s[20:23], s67 offen offset:1024 sc1
    ds_read_b128 v[224:227], v253 offset:2048
    ds_read_b128 v[228:231], v253 offset:6144
    ds_read_b128 v[232:235], v253 offset:10240
    ds_read_b128 v[236:239], v253 offset:14336
    ds_read_b128 v[240:243], v253 offset:18432
    s_waitcnt lgkmcnt(4)
    v_mfma_f32_16x16x32_bf16 v[0:3], v[160:163], v[224:227], v[0:3]
    ds_read_b128 v[244:247], v253 offset:22528
    v_mfma_f32_16x16x32_bf16 v[4:7], v[164:167], v[224:227], v[4:7]
    s_waitcnt lgkmcnt(4)
    v_mfma_f32_16x16x32_bf16 v[16:19], v[160:163], v[228:231], v[16:19]
    ds_read_b128 v[224:227], v253 offset:26624
    v_mfma_f32_16x16x32_bf16 v[20:23], v[164:167], v[228:231], v[20:23]
    s_waitcnt lgkmcnt(4)
    v_mfma_f32_16x16x32_bf16 v[32:35], v[160:163], v[232:235], v[32:35]
    ds_read_b128 v[228:231], v253 offset:30720
    v_mfma_f32_16x16x32_bf16 v[36:39], v[164:167], v[232:235], v[36:39]
    s_waitcnt lgkmcnt(4)
    v_mfma_f32_16x16x32_bf16 v[48:51], v[160:163], v[236:239], v[48:51]
    ds_read_b128 v[232:235], v253 offset:34816
    v_mfma_f32_16x16x32_bf16 v[52:55], v[164:167], v[236:239], v[52:55]
    s_waitcnt lgkmcnt(4)
    v_mfma_f32_16x16x32_bf16 v[64:67], v[160:163], v[240:243], v[64:67]
    ds_read_b128 v[236:239], v253 offset:38912
    v_mfma_f32_16x16x32_bf16 v[68:71], v[164:167], v[240:243], v[68:71]
    s_waitcnt lgkmcnt(4)
    v_mfma_f32_16x16x32_bf16 v[80:83], v[160:163], v[244:247], v[80:83]
    v_mfma_f32_16x16x32_bf16 v[84:87], v[164:167], v[244:247], v[84:87]
    s_waitcnt lgkmcnt(3)
    v_mfma_f32_16x16x32_bf16 v[96:99], v[160:163], v[224:227], v[96:99]
    v_mfma_f32_16x16x32_bf16 v[100:103], v[164:167], v[224:227], v[100:103]
    s_waitcnt lgkmcnt(2)
    v_mfma_f32_16x16x32_bf16 v[112:115], v[160:163], v[228:231], v[112:115]
    v_mfma_f32_16x16x32_bf16 v[116:119], v[164:167], v[228:231], v[116:119]
    s_waitcnt lgkmcnt(1)
    v_mfma_f32_16x16x32_bf16 v[128:131], v[160:163], v[232:235], v[128:131]
    v_mfma_f32_16x16x32_bf16 v[132:135], v[164:167], v[232:235], v[132:135]
    s_waitcnt lgkmcnt(0)
    v_mfma_f32_16x16x32_bf16 v[144:147], v[160:163], v[236:239], v[144:147]
    v_mfma_f32_16x16x32_bf16 v[148:151], v[164:167], v[236:239], v[148:151]
    s_waitcnt lgkmcnt(0)
    s_barrier
    s_waitcnt vmcnt(0)
    s_add_u32 s67, s68, 2928640
    buffer_load_dwordx4 v[160:163], v248, s[20:23], s67 offen sc1
    buffer_load_dwordx4 v[164:167], v248, s[20:23], s67 offen offset:1024 sc1
    ds_read_b128 v[224:227], v253 offset:2048
    ds_read_b128 v[228:231], v253 offset:6144
    ds_read_b128 v[232:235], v253 offset:10240
    ds_read_b128 v[236:239], v253 offset:14336
    ds_read_b128 v[240:243], v253 offset:18432
    s_waitcnt lgkmcnt(4)
    v_mfma_f32_16x16x32_bf16 v[8:11], v[168:171], v[224:227], v[8:11]
    ds_read_b128 v[244:247], v253 offset:22528
    v_mfma_f32_16x16x32_bf16 v[12:15], v[172:175], v[224:227], v[12:15]
    s_waitcnt lgkmcnt(4)
    v_mfma_f32_16x16x32_bf16 v[24:27], v[168:171], v[228:231], v[24:27]
    ds_read_b128 v[224:227], v253 offset:26624
    v_mfma_f32_16x16x32_bf16 v[28:31], v[172:175], v[228:231], v[28:31]
    s_waitcnt lgkmcnt(4)
    v_mfma_f32_16x16x32_bf16 v[40:43], v[168:171], v[232:235], v[40:43]
    ds_read_b128 v[228:231], v253 offset:30720
    v_mfma_f32_16x16x32_bf16 v[44:47], v[172:175], v[232:235], v[44:47]
    s_waitcnt lgkmcnt(4)
    v_mfma_f32_16x16x32_bf16 v[56:59], v[168:171], v[236:239], v[56:59]
    ds_read_b128 v[232:235], v253 offset:34816
    v_mfma_f32_16x16x32_bf16 v[60:63], v[172:175], v[236:239], v[60:63]
    s_waitcnt lgkmcnt(4)
    v_mfma_f32_16x16x32_bf16 v[72:75], v[168:171], v[240:243], v[72:75]
    ds_read_b128 v[236:239], v253 offset:38912
    v_mfma_f32_16x16x32_bf16 v[76:79], v[172:175], v[240:243], v[76:79]
    s_waitcnt lgkmcnt(4)
    v_mfma_f32_16x16x32_bf16 v[88:91], v[168:171], v[244:247], v[88:91]
    v_mfma_f32_16x16x32_bf16 v[92:95], v[172:175], v[244:247], v[92:95]
    s_waitcnt lgkmcnt(3)
    v_mfma_f32_16x16x32_bf16 v[104:107], v[168:171], v[224:227], v[104:107]
    v_mfma_f32_16x16x32_bf16 v[108:111], v[172:175], v[224:227], v[108:111]
    s_waitcnt lgkmcnt(2)
    v_mfma_f32_16x16x32_bf16 v[120:123], v[168:171], v[228:231], v[120:123]
    v_mfma_f32_16x16x32_bf16 v[124:127], v[172:175], v[228:231], v[124:127]
    s_waitcnt lgkmcnt(1)
    v_mfma_f32_16x16x32_bf16 v[136:139], v[168:171], v[232:235], v[136:139]
    v_mfma_f32_16x16x32_bf16 v[140:143], v[172:175], v[232:235], v[140:143]
    s_waitcnt lgkmcnt(0)
    v_mfma_f32_16x16x32_bf16 v[152:155], v[168:171], v[236:239], v[152:155]
    v_mfma_f32_16x16x32_bf16 v[156:159], v[172:175], v[236:239], v[156:159]
    s_waitcnt lgkmcnt(0)
    s_barrier
    s_waitcnt vmcnt(0)
    s_add_u32 s67, s68, 2936832
    buffer_load_dwordx4 v[168:171], v248, s[20:23], s67 offen sc1
    buffer_load_dwordx4 v[172:175], v248, s[20:23], s67 offen offset:1024 sc1
    ds_read_b128 v[224:227], v253 offset:3072
    ds_read_b128 v[228:231], v253 offset:7168
    ds_read_b128 v[232:235], v253 offset:11264
    ds_read_b128 v[236:239], v253 offset:15360
    ds_read_b128 v[240:243], v253 offset:19456
    s_waitcnt lgkmcnt(4)
    v_mfma_f32_16x16x32_bf16 v[0:3], v[160:163], v[224:227], v[0:3]
    ds_read_b128 v[244:247], v253 offset:23552
    v_mfma_f32_16x16x32_bf16 v[4:7], v[164:167], v[224:227], v[4:7]
    s_waitcnt lgkmcnt(4)
    v_mfma_f32_16x16x32_bf16 v[16:19], v[160:163], v[228:231], v[16:19]
    ds_read_b128 v[224:227], v253 offset:27648
    v_mfma_f32_16x16x32_bf16 v[20:23], v[164:167], v[228:231], v[20:23]
    s_waitcnt lgkmcnt(4)
    v_mfma_f32_16x16x32_bf16 v[32:35], v[160:163], v[232:235], v[32:35]
    ds_read_b128 v[228:231], v253 offset:31744
    v_mfma_f32_16x16x32_bf16 v[36:39], v[164:167], v[232:235], v[36:39]
    s_waitcnt lgkmcnt(4)
    v_mfma_f32_16x16x32_bf16 v[48:51], v[160:163], v[236:239], v[48:51]
    ds_read_b128 v[232:235], v253 offset:35840
    v_mfma_f32_16x16x32_bf16 v[52:55], v[164:167], v[236:239], v[52:55]
    s_waitcnt lgkmcnt(4)
    v_mfma_f32_16x16x32_bf16 v[64:67], v[160:163], v[240:243], v[64:67]
    ds_read_b128 v[236:239], v253 offset:39936
    v_mfma_f32_16x16x32_bf16 v[68:71], v[164:167], v[240:243], v[68:71]
    s_waitcnt lgkmcnt(4)
    v_mfma_f32_16x16x32_bf16 v[80:83], v[160:163], v[244:247], v[80:83]
    v_mfma_f32_16x16x32_bf16 v[84:87], v[164:167], v[244:247], v[84:87]
    s_waitcnt lgkmcnt(3)
    v_mfma_f32_16x16x32_bf16 v[96:99], v[160:163], v[224:227], v[96:99]
    v_mfma_f32_16x16x32_bf16 v[100:103], v[164:167], v[224:227], v[100:103]
    s_waitcnt lgkmcnt(2)
    v_mfma_f32_16x16x32_bf16 v[112:115], v[160:163], v[228:231], v[112:115]
    v_mfma_f32_16x16x32_bf16 v[116:119], v[164:167], v[228:231], v[116:119]
    s_waitcnt lgkmcnt(1)
    v_mfma_f32_16x16x32_bf16 v[128:131], v[160:163], v[232:235], v[128:131]
    v_mfma_f32_16x16x32_bf16 v[132:135], v[164:167], v[232:235], v[132:135]
    s_waitcnt lgkmcnt(0)
    v_mfma_f32_16x16x32_bf16 v[144:147], v[160:163], v[236:239], v[144:147]
    v_mfma_f32_16x16x32_bf16 v[148:151], v[164:167], v[236:239], v[148:151]
    s_waitcnt lgkmcnt(0)
    s_barrier
    s_waitcnt vmcnt(0)
    s_add_u32 s67, s68, 1064960
    buffer_load_dwordx4 v[160:163], v248, s[20:23], s67 offen sc1
    buffer_load_dwordx4 v[164:167], v248, s[20:23], s67 offen offset:1024 sc1
    ds_read_b128 v[224:227], v253 offset:3072
    ds_read_b128 v[228:231], v253 offset:7168
    ds_read_b128 v[232:235], v253 offset:11264
    ds_read_b128 v[236:239], v253 offset:15360
    ds_read_b128 v[240:243], v253 offset:19456
    s_waitcnt lgkmcnt(4)
    v_mfma_f32_16x16x32_bf16 v[8:11], v[168:171], v[224:227], v[8:11]
    ds_read_b128 v[244:247], v253 offset:23552
    v_mfma_f32_16x16x32_bf16 v[12:15], v[172:175], v[224:227], v[12:15]
    s_waitcnt lgkmcnt(4)
    v_mfma_f32_16x16x32_bf16 v[24:27], v[168:171], v[228:231], v[24:27]
    ds_read_b128 v[224:227], v253 offset:27648
    v_mfma_f32_16x16x32_bf16 v[28:31], v[172:175], v[228:231], v[28:31]
    s_waitcnt lgkmcnt(4)
    v_mfma_f32_16x16x32_bf16 v[40:43], v[168:171], v[232:235], v[40:43]
    ds_read_b128 v[228:231], v253 offset:31744
    v_mfma_f32_16x16x32_bf16 v[44:47], v[172:175], v[232:235], v[44:47]
    s_waitcnt lgkmcnt(4)
    v_mfma_f32_16x16x32_bf16 v[56:59], v[168:171], v[236:239], v[56:59]
    ds_read_b128 v[232:235], v253 offset:35840
    v_mfma_f32_16x16x32_bf16 v[60:63], v[172:175], v[236:239], v[60:63]
    s_waitcnt lgkmcnt(4)
    v_mfma_f32_16x16x32_bf16 v[72:75], v[168:171], v[240:243], v[72:75]
    ds_read_b128 v[236:239], v253 offset:39936
    v_mfma_f32_16x16x32_bf16 v[76:79], v[172:175], v[240:243], v[76:79]
    s_waitcnt lgkmcnt(4)
    v_mfma_f32_16x16x32_bf16 v[88:91], v[168:171], v[244:247], v[88:91]
    v_mfma_f32_16x16x32_bf16 v[92:95], v[172:175], v[244:247], v[92:95]
    s_waitcnt lgkmcnt(3)
    v_mfma_f32_16x16x32_bf16 v[104:107], v[168:171], v[224:227], v[104:107]
    v_mfma_f32_16x16x32_bf16 v[108:111], v[172:175], v[224:227], v[108:111]
    s_waitcnt lgkmcnt(2)
    v_mfma_f32_16x16x32_bf16 v[120:123], v[168:171], v[228:231], v[120:123]
    v_mfma_f32_16x16x32_bf16 v[124:127], v[172:175], v[228:231], v[124:127]
    s_waitcnt lgkmcnt(1)
    v_mfma_f32_16x16x32_bf16 v[136:139], v[168:171], v[232:235], v[136:139]
    v_mfma_f32_16x16x32_bf16 v[140:143], v[172:175], v[232:235], v[140:143]
    s_waitcnt lgkmcnt(0)
    v_mfma_f32_16x16x32_bf16 v[152:155], v[168:171], v[236:239], v[152:155]
    v_mfma_f32_16x16x32_bf16 v[156:159], v[172:175], v[236:239], v[156:159]
    s_waitcnt lgkmcnt(0)
    s_barrier
    s_waitcnt vmcnt(0)
    s_add_u32 s67, s68, 1073152
    buffer_load_dwordx4 v[168:171], v248, s[20:23], s67 offen sc1
    buffer_load_dwordx4 v[172:175], v248, s[20:23], s67 offen offset:1024 sc1
    ds_read_b128 v[224:227], v249 offset:16384
    ds_read_b128 v[228:231], v249 offset:20480
    ds_read_b128 v[232:235], v249 offset:24576
    ds_read_b128 v[236:239], v249 offset:28672
    ds_read_b128 v[240:243], v249 offset:32768
    s_waitcnt lgkmcnt(4)
    v_mfma_f32_16x16x32_bf16 v[0:3], v[160:163], v[224:227], v[0:3]
    ds_read_b128 v[244:247], v249 offset:36864
    v_mfma_f32_16x16x32_bf16 v[4:7], v[164:167], v[224:227], v[4:7]
    s_waitcnt lgkmcnt(4)
    v_mfma_f32_16x16x32_bf16 v[16:19], v[160:163], v[228:231], v[16:19]
    ds_read_b128 v[224:227], v249 offset:40960
    v_mfma_f32_16x16x32_bf16 v[20:23], v[164:167], v[228:231], v[20:23]
    s_waitcnt lgkmcnt(4)
    v_mfma_f32_16x16x32_bf16 v[32:35], v[160:163], v[232:235], v[32:35]
    ds_read_b128 v[228:231], v249 offset:45056
    v_mfma_f32_16x16x32_bf16 v[36:39], v[164:167], v[232:235], v[36:39]
    s_waitcnt lgkmcnt(4)
    v_mfma_f32_16x16x32_bf16 v[48:51], v[160:163], v[236:239], v[48:51]
    ds_read_b128 v[232:235], v249 offset:49152
    v_mfma_f32_16x16x32_bf16 v[52:55], v[164:167], v[236:239], v[52:55]
    s_waitcnt lgkmcnt(4)
    v_mfma_f32_16x16x32_bf16 v[64:67], v[160:163], v[240:243], v[64:67]
    ds_read_b128 v[236:239], v249 offset:53248
    v_mfma_f32_16x16x32_bf16 v[68:71], v[164:167], v[240:243], v[68:71]
    s_waitcnt lgkmcnt(4)
    v_mfma_f32_16x16x32_bf16 v[80:83], v[160:163], v[244:247], v[80:83]
    v_mfma_f32_16x16x32_bf16 v[84:87], v[164:167], v[244:247], v[84:87]
    s_waitcnt lgkmcnt(3)
    v_mfma_f32_16x16x32_bf16 v[96:99], v[160:163], v[224:227], v[96:99]
    v_mfma_f32_16x16x32_bf16 v[100:103], v[164:167], v[224:227], v[100:103]
    s_waitcnt lgkmcnt(2)
    v_mfma_f32_16x16x32_bf16 v[112:115], v[160:163], v[228:231], v[112:115]
    v_mfma_f32_16x16x32_bf16 v[116:119], v[164:167], v[228:231], v[116:119]
    s_waitcnt lgkmcnt(1)
    v_mfma_f32_16x16x32_bf16 v[128:131], v[160:163], v[232:235], v[128:131]
    v_mfma_f32_16x16x32_bf16 v[132:135], v[164:167], v[232:235], v[132:135]
    s_waitcnt lgkmcnt(0)
    v_mfma_f32_16x16x32_bf16 v[144:147], v[160:163], v[236:239], v[144:147]
    v_mfma_f32_16x16x32_bf16 v[148:151], v[164:167], v[236:239], v[148:151]
    s_waitcnt lgkmcnt(0)
    s_barrier
    s_waitcnt vmcnt(0)
    s_add_u32 s67, s68, 1331200
    buffer_load_dwordx4 v[160:163], v248, s[20:23], s67 offen sc1
    buffer_load_dwordx4 v[164:167], v248, s[20:23], s67 offen offset:1024 sc1
    ds_read_b128 v[224:227], v249 offset:16384
    ds_read_b128 v[228:231], v249 offset:20480
    ds_read_b128 v[232:235], v249 offset:24576
    ds_read_b128 v[236:239], v249 offset:28672
    ds_read_b128 v[240:243], v249 offset:32768
    s_waitcnt lgkmcnt(4)
    v_mfma_f32_16x16x32_bf16 v[8:11], v[168:171], v[224:227], v[8:11]
    ds_read_b128 v[244:247], v249 offset:36864
    v_mfma_f32_16x16x32_bf16 v[12:15], v[172:175], v[224:227], v[12:15]
    s_waitcnt lgkmcnt(4)
    v_mfma_f32_16x16x32_bf16 v[24:27], v[168:171], v[228:231], v[24:27]
    ds_read_b128 v[224:227], v249 offset:40960
    v_mfma_f32_16x16x32_bf16 v[28:31], v[172:175], v[228:231], v[28:31]
    s_waitcnt lgkmcnt(4)
    v_mfma_f32_16x16x32_bf16 v[40:43], v[168:171], v[232:235], v[40:43]
    ds_read_b128 v[228:231], v249 offset:45056
    v_mfma_f32_16x16x32_bf16 v[44:47], v[172:175], v[232:235], v[44:47]
    s_waitcnt lgkmcnt(4)
    v_mfma_f32_16x16x32_bf16 v[56:59], v[168:171], v[236:239], v[56:59]
    ds_read_b128 v[232:235], v249 offset:49152
    v_mfma_f32_16x16x32_bf16 v[60:63], v[172:175], v[236:239], v[60:63]
    s_waitcnt lgkmcnt(4)
    v_mfma_f32_16x16x32_bf16 v[72:75], v[168:171], v[240:243], v[72:75]
    ds_read_b128 v[236:239], v249 offset:53248
    v_mfma_f32_16x16x32_bf16 v[76:79], v[172:175], v[240:243], v[76:79]
    s_waitcnt lgkmcnt(4)
    v_mfma_f32_16x16x32_bf16 v[88:91], v[168:171], v[244:247], v[88:91]
    v_mfma_f32_16x16x32_bf16 v[92:95], v[172:175], v[244:247], v[92:95]
    s_waitcnt lgkmcnt(3)
    v_mfma_f32_16x16x32_bf16 v[104:107], v[168:171], v[224:227], v[104:107]
    v_mfma_f32_16x16x32_bf16 v[108:111], v[172:175], v[224:227], v[108:111]
    s_waitcnt lgkmcnt(2)
    v_mfma_f32_16x16x32_bf16 v[120:123], v[168:171], v[228:231], v[120:123]
    v_mfma_f32_16x16x32_bf16 v[124:127], v[172:175], v[228:231], v[124:127]
    s_waitcnt lgkmcnt(1)
    v_mfma_f32_16x16x32_bf16 v[136:139], v[168:171], v[232:235], v[136:139]
    v_mfma_f32_16x16x32_bf16 v[140:143], v[172:175], v[232:235], v[140:143]
    s_waitcnt lgkmcnt(0)
    v_mfma_f32_16x16x32_bf16 v[152:155], v[168:171], v[236:239], v[152:155]
    v_mfma_f32_16x16x32_bf16 v[156:159], v[172:175], v[236:239], v[156:159]
    s_waitcnt lgkmcnt(0)
    s_barrier
    s_waitcnt vmcnt(0)
    s_add_u32 s67, s68, 1339392
    buffer_load_dwordx4 v[168:171], v248, s[20:23], s67 offen sc1
    buffer_load_dwordx4 v[172:175], v248, s[20:23], s67 offen offset:1024 sc1
    ds_read_b128 v[224:227], v249 offset:17408
    ds_read_b128 v[228:231], v249 offset:21504
    ds_read_b128 v[232:235], v249 offset:25600
    ds_read_b128 v[236:239], v249 offset:29696
    ds_read_b128 v[240:243], v249 offset:33792
    s_waitcnt lgkmcnt(4)
    v_mfma_f32_16x16x32_bf16 v[0:3], v[160:163], v[224:227], v[0:3]
    ds_read_b128 v[244:247], v249 offset:37888
    v_mfma_f32_16x16x32_bf16 v[4:7], v[164:167], v[224:227], v[4:7]
    s_waitcnt lgkmcnt(4)
    v_mfma_f32_16x16x32_bf16 v[16:19], v[160:163], v[228:231], v[16:19]
    ds_read_b128 v[224:227], v249 offset:41984
    v_mfma_f32_16x16x32_bf16 v[20:23], v[164:167], v[228:231], v[20:23]
    s_waitcnt lgkmcnt(4)
    v_mfma_f32_16x16x32_bf16 v[32:35], v[160:163], v[232:235], v[32:35]
    ds_read_b128 v[228:231], v249 offset:46080
    v_mfma_f32_16x16x32_bf16 v[36:39], v[164:167], v[232:235], v[36:39]
    s_waitcnt lgkmcnt(4)
    v_mfma_f32_16x16x32_bf16 v[48:51], v[160:163], v[236:239], v[48:51]
    ds_read_b128 v[232:235], v249 offset:50176
    v_mfma_f32_16x16x32_bf16 v[52:55], v[164:167], v[236:239], v[52:55]
    s_waitcnt lgkmcnt(4)
    v_mfma_f32_16x16x32_bf16 v[64:67], v[160:163], v[240:243], v[64:67]
    ds_read_b128 v[236:239], v249 offset:54272
    v_mfma_f32_16x16x32_bf16 v[68:71], v[164:167], v[240:243], v[68:71]
    s_waitcnt lgkmcnt(4)
    v_mfma_f32_16x16x32_bf16 v[80:83], v[160:163], v[244:247], v[80:83]
    v_mfma_f32_16x16x32_bf16 v[84:87], v[164:167], v[244:247], v[84:87]
    s_waitcnt lgkmcnt(3)
    v_mfma_f32_16x16x32_bf16 v[96:99], v[160:163], v[224:227], v[96:99]
    v_mfma_f32_16x16x32_bf16 v[100:103], v[164:167], v[224:227], v[100:103]
    s_waitcnt lgkmcnt(2)
    v_mfma_f32_16x16x32_bf16 v[112:115], v[160:163], v[228:231], v[112:115]
    v_mfma_f32_16x16x32_bf16 v[116:119], v[164:167], v[228:231], v[116:119]
    s_waitcnt lgkmcnt(1)
    v_mfma_f32_16x16x32_bf16 v[128:131], v[160:163], v[232:235], v[128:131]
    v_mfma_f32_16x16x32_bf16 v[132:135], v[164:167], v[232:235], v[132:135]
    s_waitcnt lgkmcnt(0)
    v_mfma_f32_16x16x32_bf16 v[144:147], v[160:163], v[236:239], v[144:147]
    v_mfma_f32_16x16x32_bf16 v[148:151], v[164:167], v[236:239], v[148:151]
    s_waitcnt lgkmcnt(0)
    s_barrier
    s_waitcnt vmcnt(0)
    s_add_u32 s67, s68, 1597440
    buffer_load_dwordx4 v[160:163], v248, s[20:23], s67 offen sc1
    buffer_load_dwordx4 v[164:167], v248, s[20:23], s67 offen offset:1024 sc1
    ds_read_b128 v[224:227], v249 offset:17408
    ds_read_b128 v[228:231], v249 offset:21504
    ds_read_b128 v[232:235], v249 offset:25600
    ds_read_b128 v[236:239], v249 offset:29696
    ds_read_b128 v[240:243], v249 offset:33792
    s_waitcnt lgkmcnt(4)
    v_mfma_f32_16x16x32_bf16 v[8:11], v[168:171], v[224:227], v[8:11]
    ds_read_b128 v[244:247], v249 offset:37888
    v_mfma_f32_16x16x32_bf16 v[12:15], v[172:175], v[224:227], v[12:15]
    s_waitcnt lgkmcnt(4)
    v_mfma_f32_16x16x32_bf16 v[24:27], v[168:171], v[228:231], v[24:27]
    ds_read_b128 v[224:227], v249 offset:41984
    v_mfma_f32_16x16x32_bf16 v[28:31], v[172:175], v[228:231], v[28:31]
    s_waitcnt lgkmcnt(4)
    v_mfma_f32_16x16x32_bf16 v[40:43], v[168:171], v[232:235], v[40:43]
    ds_read_b128 v[228:231], v249 offset:46080
    v_mfma_f32_16x16x32_bf16 v[44:47], v[172:175], v[232:235], v[44:47]
    s_waitcnt lgkmcnt(4)
    v_mfma_f32_16x16x32_bf16 v[56:59], v[168:171], v[236:239], v[56:59]
    ds_read_b128 v[232:235], v249 offset:50176
    v_mfma_f32_16x16x32_bf16 v[60:63], v[172:175], v[236:239], v[60:63]
    s_waitcnt lgkmcnt(4)
    v_mfma_f32_16x16x32_bf16 v[72:75], v[168:171], v[240:243], v[72:75]
    ds_read_b128 v[236:239], v249 offset:54272
    v_mfma_f32_16x16x32_bf16 v[76:79], v[172:175], v[240:243], v[76:79]
    s_waitcnt lgkmcnt(4)
    v_mfma_f32_16x16x32_bf16 v[88:91], v[168:171], v[244:247], v[88:91]
    v_mfma_f32_16x16x32_bf16 v[92:95], v[172:175], v[244:247], v[92:95]
    s_waitcnt lgkmcnt(3)
    v_mfma_f32_16x16x32_bf16 v[104:107], v[168:171], v[224:227], v[104:107]
    v_mfma_f32_16x16x32_bf16 v[108:111], v[172:175], v[224:227], v[108:111]
    s_waitcnt lgkmcnt(2)
    v_mfma_f32_16x16x32_bf16 v[120:123], v[168:171], v[228:231], v[120:123]
    v_mfma_f32_16x16x32_bf16 v[124:127], v[172:175], v[228:231], v[124:127]
    s_waitcnt lgkmcnt(1)
    v_mfma_f32_16x16x32_bf16 v[136:139], v[168:171], v[232:235], v[136:139]
    v_mfma_f32_16x16x32_bf16 v[140:143], v[172:175], v[232:235], v[140:143]
    s_waitcnt lgkmcnt(0)
    v_mfma_f32_16x16x32_bf16 v[152:155], v[168:171], v[236:239], v[152:155]
    v_mfma_f32_16x16x32_bf16 v[156:159], v[172:175], v[236:239], v[156:159]
    s_waitcnt lgkmcnt(0)
    s_barrier
    s_waitcnt vmcnt(0)
    s_add_u32 s67, s68, 1605632
    buffer_load_dwordx4 v[168:171], v248, s[20:23], s67 offen sc1
    buffer_load_dwordx4 v[172:175], v248, s[20:23], s67 offen offset:1024 sc1
    ds_read_b128 v[224:227], v249 offset:18432
    ds_read_b128 v[228:231], v249 offset:22528
    ds_read_b128 v[232:235], v249 offset:26624
    ds_read_b128 v[236:239], v249 offset:30720
    ds_read_b128 v[240:243], v249 offset:34816
    s_waitcnt lgkmcnt(4)
    v_mfma_f32_16x16x32_bf16 v[0:3], v[160:163], v[224:227], v[0:3]
    ds_read_b128 v[244:247], v249 offset:38912
    v_mfma_f32_16x16x32_bf16 v[4:7], v[164:167], v[224:227], v[4:7]
    s_waitcnt lgkmcnt(4)
    v_mfma_f32_16x16x32_bf16 v[16:19], v[160:163], v[228:231], v[16:19]
    ds_read_b128 v[224:227], v249 offset:43008
    v_mfma_f32_16x16x32_bf16 v[20:23], v[164:167], v[228:231], v[20:23]
    s_waitcnt lgkmcnt(4)
    v_mfma_f32_16x16x32_bf16 v[32:35], v[160:163], v[232:235], v[32:35]
    ds_read_b128 v[228:231], v249 offset:47104
    v_mfma_f32_16x16x32_bf16 v[36:39], v[164:167], v[232:235], v[36:39]
    s_waitcnt lgkmcnt(4)
    v_mfma_f32_16x16x32_bf16 v[48:51], v[160:163], v[236:239], v[48:51]
    ds_read_b128 v[232:235], v249 offset:51200
    v_mfma_f32_16x16x32_bf16 v[52:55], v[164:167], v[236:239], v[52:55]
    s_waitcnt lgkmcnt(4)
    v_mfma_f32_16x16x32_bf16 v[64:67], v[160:163], v[240:243], v[64:67]
    ds_read_b128 v[236:239], v249 offset:55296
    v_mfma_f32_16x16x32_bf16 v[68:71], v[164:167], v[240:243], v[68:71]
    s_waitcnt lgkmcnt(4)
    v_mfma_f32_16x16x32_bf16 v[80:83], v[160:163], v[244:247], v[80:83]
    v_mfma_f32_16x16x32_bf16 v[84:87], v[164:167], v[244:247], v[84:87]
    s_waitcnt lgkmcnt(3)
    v_mfma_f32_16x16x32_bf16 v[96:99], v[160:163], v[224:227], v[96:99]
    v_mfma_f32_16x16x32_bf16 v[100:103], v[164:167], v[224:227], v[100:103]
    s_waitcnt lgkmcnt(2)
    v_mfma_f32_16x16x32_bf16 v[112:115], v[160:163], v[228:231], v[112:115]
    v_mfma_f32_16x16x32_bf16 v[116:119], v[164:167], v[228:231], v[116:119]
    s_waitcnt lgkmcnt(1)
    v_mfma_f32_16x16x32_bf16 v[128:131], v[160:163], v[232:235], v[128:131]
    v_mfma_f32_16x16x32_bf16 v[132:135], v[164:167], v[232:235], v[132:135]
    s_waitcnt lgkmcnt(0)
    v_mfma_f32_16x16x32_bf16 v[144:147], v[160:163], v[236:239], v[144:147]
    v_mfma_f32_16x16x32_bf16 v[148:151], v[164:167], v[236:239], v[148:151]
    s_waitcnt lgkmcnt(0)
    s_barrier
    s_waitcnt vmcnt(0)
    s_add_u32 s67, s68, 1863680
    buffer_load_dwordx4 v[160:163], v248, s[20:23], s67 offen sc1
    buffer_load_dwordx4 v[164:167], v248, s[20:23], s67 offen offset:1024 sc1
    ds_read_b128 v[224:227], v249 offset:18432
    ds_read_b128 v[228:231], v249 offset:22528
    ds_read_b128 v[232:235], v249 offset:26624
    ds_read_b128 v[236:239], v249 offset:30720
    ds_read_b128 v[240:243], v249 offset:34816
    s_waitcnt lgkmcnt(4)
    v_mfma_f32_16x16x32_bf16 v[8:11], v[168:171], v[224:227], v[8:11]
    ds_read_b128 v[244:247], v249 offset:38912
    v_mfma_f32_16x16x32_bf16 v[12:15], v[172:175], v[224:227], v[12:15]
    s_waitcnt lgkmcnt(4)
    v_mfma_f32_16x16x32_bf16 v[24:27], v[168:171], v[228:231], v[24:27]
    ds_read_b128 v[224:227], v249 offset:43008
    v_mfma_f32_16x16x32_bf16 v[28:31], v[172:175], v[228:231], v[28:31]
    s_waitcnt lgkmcnt(4)
    v_mfma_f32_16x16x32_bf16 v[40:43], v[168:171], v[232:235], v[40:43]
    ds_read_b128 v[228:231], v249 offset:47104
    v_mfma_f32_16x16x32_bf16 v[44:47], v[172:175], v[232:235], v[44:47]
    s_waitcnt lgkmcnt(4)
    v_mfma_f32_16x16x32_bf16 v[56:59], v[168:171], v[236:239], v[56:59]
    ds_read_b128 v[232:235], v249 offset:51200
    v_mfma_f32_16x16x32_bf16 v[60:63], v[172:175], v[236:239], v[60:63]
    s_waitcnt lgkmcnt(4)
    v_mfma_f32_16x16x32_bf16 v[72:75], v[168:171], v[240:243], v[72:75]
    ds_read_b128 v[236:239], v249 offset:55296
    v_mfma_f32_16x16x32_bf16 v[76:79], v[172:175], v[240:243], v[76:79]
    s_waitcnt lgkmcnt(4)
    v_mfma_f32_16x16x32_bf16 v[88:91], v[168:171], v[244:247], v[88:91]
    v_mfma_f32_16x16x32_bf16 v[92:95], v[172:175], v[244:247], v[92:95]
    s_waitcnt lgkmcnt(3)
    v_mfma_f32_16x16x32_bf16 v[104:107], v[168:171], v[224:227], v[104:107]
    v_mfma_f32_16x16x32_bf16 v[108:111], v[172:175], v[224:227], v[108:111]
    s_waitcnt lgkmcnt(2)
    v_mfma_f32_16x16x32_bf16 v[120:123], v[168:171], v[228:231], v[120:123]
    v_mfma_f32_16x16x32_bf16 v[124:127], v[172:175], v[228:231], v[124:127]
    s_waitcnt lgkmcnt(1)
    v_mfma_f32_16x16x32_bf16 v[136:139], v[168:171], v[232:235], v[136:139]
    v_mfma_f32_16x16x32_bf16 v[140:143], v[172:175], v[232:235], v[140:143]
    s_waitcnt lgkmcnt(0)
    v_mfma_f32_16x16x32_bf16 v[152:155], v[168:171], v[236:239], v[152:155]
    v_mfma_f32_16x16x32_bf16 v[156:159], v[172:175], v[236:239], v[156:159]
    s_waitcnt lgkmcnt(0)
    s_barrier
    s_add_u32 s67, s68, 1871872
    buffer_load_dwordx4 v[168:171], v248, s[20:23], s67 offen sc1
    buffer_load_dwordx4 v[172:175], v248, s[20:23], s67 offen offset:1024 sc1
    s_add_u32 s67, s68, 0
    buffer_load_dwordx4 v[176:179], v248, s[20:23], s67 offen sc1
    buffer_load_dwordx4 v[180:183], v248, s[20:23], s67 offen offset:1024 sc1
    s_add_u32 s67, s68, 266240
    buffer_load_dwordx4 v[184:187], v248, s[20:23], s67 offen sc1
    buffer_load_dwordx4 v[188:191], v248, s[20:23], s67 offen offset:1024 sc1
    s_add_u32 s67, s68, 532480
    buffer_load_dwordx4 v[192:195], v248, s[20:23], s67 offen sc1
    buffer_load_dwordx4 v[196:199], v248, s[20:23], s67 offen offset:1024 sc1
    s_add_u32 s67, s68, 798720
    buffer_load_dwordx4 v[200:203], v248, s[20:23], s67 offen sc1
    buffer_load_dwordx4 v[204:207], v248, s[20:23], s67 offen offset:1024 sc1
    s_add_u32 s67, s68, 3194880
    buffer_load_dwordx4 v[208:211], v248, s[20:23], s67 offen sc1
    buffer_load_dwordx4 v[212:215], v248, s[20:23], s67 offen offset:1024 sc1
    s_add_u32 s67, s68, 3461120
    buffer_load_dwordx4 v[216:219], v248, s[20:23], s67 offen sc1
    buffer_load_dwordx4 v[220:223], v248, s[20:23], s67 offen offset:1024 sc1
    s_waitcnt vmcnt(14)
    ds_read_b128 v[224:227], v249 offset:19456
    ds_read_b128 v[228:231], v249 offset:23552
    ds_read_b128 v[232:235], v249 offset:27648
    ds_read_b128 v[236:239], v249 offset:31744
    ds_read_b128 v[240:243], v249 offset:35840
    s_waitcnt lgkmcnt(4)
    v_mfma_f32_16x16x32_bf16 v[0:3], v[160:163], v[224:227], v[0:3]
    ds_read_b128 v[244:247], v249 offset:39936
    v_mfma_f32_16x16x32_bf16 v[4:7], v[164:167], v[224:227], v[4:7]
    s_waitcnt lgkmcnt(4)
    v_mfma_f32_16x16x32_bf16 v[16:19], v[160:163], v[228:231], v[16:19]
    ds_read_b128 v[224:227], v249 offset:44032
    v_mfma_f32_16x16x32_bf16 v[20:23], v[164:167], v[228:231], v[20:23]
    s_waitcnt lgkmcnt(4)
    v_mfma_f32_16x16x32_bf16 v[32:35], v[160:163], v[232:235], v[32:35]
    ds_read_b128 v[228:231], v249 offset:48128
    v_mfma_f32_16x16x32_bf16 v[36:39], v[164:167], v[232:235], v[36:39]
    s_waitcnt lgkmcnt(4)
    v_mfma_f32_16x16x32_bf16 v[48:51], v[160:163], v[236:239], v[48:51]
    ds_read_b128 v[232:235], v249 offset:52224
    v_mfma_f32_16x16x32_bf16 v[52:55], v[164:167], v[236:239], v[52:55]
    s_waitcnt lgkmcnt(4)
    v_mfma_f32_16x16x32_bf16 v[64:67], v[160:163], v[240:243], v[64:67]
    ds_read_b128 v[236:239], v249 offset:56320
    v_mfma_f32_16x16x32_bf16 v[68:71], v[164:167], v[240:243], v[68:71]
    s_waitcnt lgkmcnt(4)
    v_mfma_f32_16x16x32_bf16 v[80:83], v[160:163], v[244:247], v[80:83]
    v_mfma_f32_16x16x32_bf16 v[84:87], v[164:167], v[244:247], v[84:87]
    s_waitcnt lgkmcnt(3)
    v_mfma_f32_16x16x32_bf16 v[96:99], v[160:163], v[224:227], v[96:99]
    v_mfma_f32_16x16x32_bf16 v[100:103], v[164:167], v[224:227], v[100:103]
    s_waitcnt lgkmcnt(2)
    v_mfma_f32_16x16x32_bf16 v[112:115], v[160:163], v[228:231], v[112:115]
    v_mfma_f32_16x16x32_bf16 v[116:119], v[164:167], v[228:231], v[116:119]
    s_waitcnt lgkmcnt(1)
    v_mfma_f32_16x16x32_bf16 v[128:131], v[160:163], v[232:235], v[128:131]
    v_mfma_f32_16x16x32_bf16 v[132:135], v[164:167], v[232:235], v[132:135]
    s_waitcnt lgkmcnt(0)
    v_mfma_f32_16x16x32_bf16 v[144:147], v[160:163], v[236:239], v[144:147]
    v_mfma_f32_16x16x32_bf16 v[148:151], v[164:167], v[236:239], v[148:151]
    s_barrier
    v_mov_b32 v251, 0
    ds_read_b128 v[224:227], v251 offset:8192
    s_waitcnt lgkmcnt(0)
    v_or_b32 v224, v224, v225
    v_or_b32 v226, v226, v227
    v_or_b32 v224, v224, v226
    s_nop 0
    v_readfirstlane_b32 s86, v224
    s_add_u32 s67, s68, 3727360
    buffer_load_dwordx4 v[160:163], v248, s[20:23], s67 offen sc1
    buffer_load_dwordx4 v[164:167], v248, s[20:23], s67 offen offset:1024 sc1
    s_waitcnt vmcnt(14)
    ds_read_b128 v[224:227], v249 offset:19456
    ds_read_b128 v[228:231], v249 offset:23552
    ds_read_b128 v[232:235], v249 offset:27648
    ds_read_b128 v[236:239], v249 offset:31744
    ds_read_b128 v[240:243], v249 offset:35840
    s_waitcnt lgkmcnt(4)
    v_mfma_f32_16x16x32_bf16 v[8:11], v[168:171], v[224:227], v[8:11]
    ds_read_b128 v[244:247], v249 offset:39936
    v_mfma_f32_16x16x32_bf16 v[12:15], v[172:175], v[224:227], v[12:15]
    s_waitcnt lgkmcnt(4)
    v_mfma_f32_16x16x32_bf16 v[24:27], v[168:171], v[228:231], v[24:27]
    ds_read_b128 v[224:227], v249 offset:44032
    v_mfma_f32_16x16x32_bf16 v[28:31], v[172:175], v[228:231], v[28:31]
    s_waitcnt lgkmcnt(4)
    v_mfma_f32_16x16x32_bf16 v[40:43], v[168:171], v[232:235], v[40:43]
    ds_read_b128 v[228:231], v249 offset:48128
    v_mfma_f32_16x16x32_bf16 v[44:47], v[172:175], v[232:235], v[44:47]
    s_waitcnt lgkmcnt(4)
    v_mfma_f32_16x16x32_bf16 v[56:59], v[168:171], v[236:239], v[56:59]
    ds_read_b128 v[232:235], v249 offset:52224
    v_mfma_f32_16x16x32_bf16 v[60:63], v[172:175], v[236:239], v[60:63]
    s_waitcnt lgkmcnt(4)
    v_mfma_f32_16x16x32_bf16 v[72:75], v[168:171], v[240:243], v[72:75]
    ds_read_b128 v[236:239], v249 offset:56320
    v_mfma_f32_16x16x32_bf16 v[76:79], v[172:175], v[240:243], v[76:79]
    s_waitcnt lgkmcnt(4)
    v_mfma_f32_16x16x32_bf16 v[88:91], v[168:171], v[244:247], v[88:91]
    v_mfma_f32_16x16x32_bf16 v[92:95], v[172:175], v[244:247], v[92:95]
    s_waitcnt lgkmcnt(3)
    v_mfma_f32_16x16x32_bf16 v[104:107], v[168:171], v[224:227], v[104:107]
    v_mfma_f32_16x16x32_bf16 v[108:111], v[172:175], v[224:227], v[108:111]
    s_waitcnt lgkmcnt(2)
    v_mfma_f32_16x16x32_bf16 v[120:123], v[168:171], v[228:231], v[120:123]
    v_mfma_f32_16x16x32_bf16 v[124:127], v[172:175], v[228:231], v[124:127]
    s_waitcnt lgkmcnt(1)
    v_mfma_f32_16x16x32_bf16 v[136:139], v[168:171], v[232:235], v[136:139]
    v_mfma_f32_16x16x32_bf16 v[140:143], v[172:175], v[232:235], v[140:143]
    s_waitcnt lgkmcnt(0)
    v_mfma_f32_16x16x32_bf16 v[152:155], v[168:171], v[236:239], v[152:155]
    v_mfma_f32_16x16x32_bf16 v[156:159], v[172:175], v[236:239], v[156:159]
    s_add_u32 s67, s68, 3993600
    buffer_load_dwordx4 v[168:171], v248, s[20:23], s67 offen sc1
    buffer_load_dwordx4 v[172:175], v248, s[20:23], s67 offen offset:1024 sc1
    s_barrier
    s_waitcnt lgkmcnt(0)
    s_barrier
    s_branch L_tail
L_A3:
    s_setprio 0
    v_mbcnt_lo_u32_b32 v250, -1, 0
    v_mbcnt_hi_u32_b32 v250, -1, v250
    s_mul_i32 s41, s31, 163840
    s_and_b32 s42, s29, 3
    s_mul_i32 s42, s42, 40960
    s_add_u32 s41, s41, s42
    s_lshl_b32 s42, s34, 7
    s_add_u32 s41, s41, s42
    v_lshlrev_b32 v251, 10, v250
    v_mov_b32 v252, 0x400000
    v_cmp_gt_u32 vcc, 40, v250
    s_nop 1
    v_cndmask_b32 v251, v252, v251, vcc
    buffer_load_dword v249, v251, s[16:19], s41 offen offset:256
    buffer_load_dword v249, v251, s[16:19], s41 offen offset:768
    s_mul_i32 s35, s34, 3
    v_bfe_u32 v251, v250, 2, 3
    v_mul_u32_u24 v233, 8224, v251
    v_lshrrev_b32 v252, 5, v250
    v_lshl_add_u32 v233, v252, 9, v233
    v_and_b32 v252, 3, v250
    v_lshl_add_u32 v233, v252, 4, v233
    s_nop 0
    v_and_b32 v251, 0, v251
    v_lshl_add_u32 v233, v251, 3, v233
    v_add_u32 v233, 0, v233
    s_lshl_b32 s36, s35, 11
    s_add_u32 s36, s36, 65760
    v_and_b32 v251, 15, v250
    v_lshrrev_b32 v252, 4, v250
    v_lshrrev_b32 v253, 1, v251
    v_xor_b32 v253, v252, v253
    v_lshlrev_b32 v253, 4, v253
    v_lshl_add_u32 v240, v251, 7, v253
    v_xor_b32 v241, 64, v240
    v_add_u32 v240, s36, v240
    v_add_u32 v241, s36, v241
    v_mov_b32 v232, v233
    v_mov_b32 v234, v240
    v_and_b32 v251, 7, v250
    v_mul_u32_u24 v236, 8224, v251
    v_bfe_u32 v251, v250, 3, 1
    v_lshl_add_u32 v236, v251, 8, v236
    v_lshrrev_b32 v252, 4, v250
    v_lshl_add_u32 v236, v252, 4, v236
    v_bfe_u32 v251, v250, 2, 3
    v_mul_u32_u24 v237, 8224, v251
    v_lshrrev_b32 v251, 5, v250
    v_lshl_add_u32 v237, v251, 8, v237
    v_and_b32 v251, 3, v250
    v_lshl_add_u32 v237, v251, 3, v237
    v_add_u32 v237, 4096, v237
    v_lshlrev_b32 v238, 4, v250
    s_lshl_b32 s36, s35, 12
    s_add_u32 s36, s36, 122880
    v_add_u32 v239, s36, v238
    s_lshl_b32 s36, s35, 13
    v_add_u32 v238, s36, v238
    s_mov_b32 s56, 0x5f800000
    s_mov_b32 s57, 0x3e0293ee
    s_mov_b64 s[48:49], 0
    s_mov_b32 s50, 0
    s_mov_b32 s51, 0
    s_mov_b32 s52, 0
    s_waitcnt lgkmcnt(0)
    s_barrier
    ds_read_b128 v[176:179], v234 offset:0
    ds_read_b128 v[180:183], v234 offset:2048
    ds_read_b128 v[184:187], v234 offset:4096
    ds_read_b64_tr_b16 v[144:145], v232 offset:0
    ds_read_b64_tr_b16 v[146:147], v232 offset:256
    ds_read_b64_tr_b16 v[148:149], v232 offset:8
    ds_read_b64_tr_b16 v[150:151], v232 offset:264
    ds_read_b64_tr_b16 v[152:153], v232 offset:64
    ds_read_b64_tr_b16 v[154:155], v232 offset:320
    ds_read_b64_tr_b16 v[156:157], v232 offset:72
    ds_read_b64_tr_b16 v[158:159], v232 offset:328
    ds_read_b64_tr_b16 v[160:161], v232 offset:128
    ds_read_b64_tr_b16 v[162:163], v232 offset:384
    ds_read_b64_tr_b16 v[164:165], v232 offset:136
    ds_read_b64_tr_b16 v[166:167], v232 offset:392
    ds_read_b64_tr_b16 v[168:169], v232 offset:192
    ds_read_b64_tr_b16 v[170:171], v232 offset:448
    ds_read_b64_tr_b16 v[172:173], v232 offset:200
    ds_read_b64_tr_b16 v[174:175], v232 offset:456
    s_add_u32 s52, s52, 1
    s_and_b32 s53, s52, 7
    s_lshl_b32 s53, s53, 10
    s_bfe_u32 s54, s52, 0x20001
    s_mul_i32 s55, s54, 20480
    s_cmp_ge_u32 s54, 2
    s_cselect_b32 s54, 16160, 0
    s_add_u32 s55, s55, s54
    v_add_u32 v232, s53, v233
    v_add_u32 v234, s55, v241
    s_waitcnt lgkmcnt(0)
    s_barrier
    ds_read_b128 v[220:223], v234 offset:0
    ds_read_b128 v[224:227], v234 offset:2048
    v_mfma_f32_16x16x32_bf16 v[0:3], v[144:147], v[176:179], 0
    ds_read_b128 v[228:231], v234 offset:4096
    s_add_u32 s52, s52, 1
    s_and_b32 s53, s52, 7
    s_lshl_b32 s53, s53, 10
    s_bfe_u32 s54, s52, 0x20001
    s_mul_i32 s55, s54, 20480
    s_cmp_ge_u32 s54, 2
    s_cselect_b32 s54, 16160, 0
    s_add_u32 s55, s55, s54
    v_mfma_f32_16x16x32_bf16 v[32:35], v[144:147], v[180:183], 0
    ds_read_b64_tr_b16 v[188:189], v232 offset:0
    v_mfma_f32_16x16x32_bf16 v[64:67], v[144:147], v[184:187], 0
    ds_read_b64_tr_b16 v[190:191], v232 offset:256
    v_mfma_f32_16x16x32_bf16 v[4:7], v[148:151], v[176:179], 0
    ds_read_b64_tr_b16 v[192:193], v232 offset:8
    v_mfma_f32_16x16x32_bf16 v[36:39], v[148:151], v[180:183], 0
    ds_read_b64_tr_b16 v[194:195], v232 offset:264
    v_mfma_f32_16x16x32_bf16 v[68:71], v[148:151], v[184:187], 0
    ds_read_b64_tr_b16 v[196:197], v232 offset:64
    v_mfma_f32_16x16x32_bf16 v[8:11], v[152:155], v[176:179], 0
    ds_read_b64_tr_b16 v[198:199], v232 offset:320
    v_mfma_f32_16x16x32_bf16 v[40:43], v[152:155], v[180:183], 0
    ds_read_b64_tr_b16 v[200:201], v232 offset:72
    ds_read_b64_tr_b16 v[202:203], v232 offset:328
    v_mfma_f32_16x16x32_bf16 v[72:75], v[152:155], v[184:187], 0
    ds_read_b64_tr_b16 v[204:205], v232 offset:128
    v_mfma_f32_16x16x32_bf16 v[12:15], v[156:159], v[176:179], 0
    ds_read_b64_tr_b16 v[206:207], v232 offset:384
    v_mfma_f32_16x16x32_bf16 v[44:47], v[156:159], v[180:183], 0
    ds_read_b64_tr_b16 v[208:209], v232 offset:136
    v_mfma_f32_16x16x32_bf16 v[76:79], v[156:159], v[184:187], 0
    ds_read_b64_tr_b16 v[210:211], v232 offset:392
    v_mfma_f32_16x16x32_bf16 v[16:19], v[160:163], v[176:179], 0
    ds_read_b64_tr_b16 v[212:213], v232 offset:192
    v_mfma_f32_16x16x32_bf16 v[48:51], v[160:163], v[180:183], 0
    ds_read_b64_tr_b16 v[214:215], v232 offset:448
    v_mfma_f32_16x16x32_bf16 v[80:83], v[160:163], v[184:187], 0
    ds_read_b64_tr_b16 v[216:217], v232 offset:200
    v_mfma_f32_16x16x32_bf16 v[20:23], v[164:167], v[176:179], 0
    ds_read_b64_tr_b16 v[218:219], v232 offset:456
    v_mfma_f32_16x16x32_bf16 v[52:55], v[164:167], v[180:183], 0
    v_mfma_f32_16x16x32_bf16 v[84:87], v[164:167], v[184:187], 0
    v_mfma_f32_16x16x32_bf16 v[24:27], v[168:171], v[176:179], 0
    v_mfma_f32_16x16x32_bf16 v[56:59], v[168:171], v[180:183], 0
    v_mfma_f32_16x16x32_bf16 v[88:91], v[168:171], v[184:187], 0
    v_mfma_f32_16x16x32_bf16 v[28:31], v[172:175], v[176:179], 0
    v_mfma_f32_16x16x32_bf16 v[60:63], v[172:175], v[180:183], 0
    v_mfma_f32_16x16x32_bf16 v[92:95], v[172:175], v[184:187], 0
    v_add_u32 v232, s53, v233
    v_add_u32 v234, s55, v240
    s_waitcnt lgkmcnt(0)
    s_barrier
L_A3_pg:
    ds_read_b128 v[176:179], v234 offset:0
    ds_read_b128 v[180:183], v234 offset:2048
    v_mfma_f32_16x16x32_bf16 v[0:3], v[188:191], v[220:223], v[0:3]
    ds_read_b128 v[184:187], v234 offset:4096
    s_add_u32 s52, s52, 1
    s_and_b32 s53, s52, 7
    s_lshl_b32 s53, s53, 10
    s_bfe_u32 s54, s52, 0x20001
    s_mul_i32 s55, s54, 20480
    s_cmp_ge_u32 s54, 2
    s_cselect_b32 s54, 16160, 0
    s_add_u32 s55, s55, s54
    v_mfma_f32_16x16x32_bf16 v[32:35], v[188:191], v[224:227], v[32:35]
    ds_read_b64_tr_b16 v[144:145], v232 offset:0
    v_mfma_f32_16x16x32_bf16 v[64:67], v[188:191], v[228:231], v[64:67]
    ds_read_b64_tr_b16 v[146:147], v232 offset:256
    v_mfma_f32_16x16x32_bf16 v[4:7], v[192:195], v[220:223], v[4:7]
    ds_read_b64_tr_b16 v[148:149], v232 offset:8
    v_mfma_f32_16x16x32_bf16 v[36:39], v[192:195], v[224:227], v[36:39]
    ds_read_b64_tr_b16 v[150:151], v232 offset:264
    v_mfma_f32_16x16x32_bf16 v[68:71], v[192:195], v[228:231], v[68:71]
    ds_read_b64_tr_b16 v[152:153], v232 offset:64
    v_mfma_f32_16x16x32_bf16 v[8:11], v[196:199], v[220:223], v[8:11]
    ds_read_b64_tr_b16 v[154:155], v232 offset:320
    v_mfma_f32_16x16x32_bf16 v[40:43], v[196:199], v[224:227], v[40:43]
    ds_read_b64_tr_b16 v[156:157], v232 offset:72
    ds_read_b64_tr_b16 v[158:159], v232 offset:328
    v_mfma_f32_16x16x32_bf16 v[72:75], v[196:199], v[228:231], v[72:75]
    ds_read_b64_tr_b16 v[160:161], v232 offset:128
    v_mfma_f32_16x16x32_bf16 v[12:15], v[200:203], v[220:223], v[12:15]
    ds_read_b64_tr_b16 v[162:163], v232 offset:384
    v_mfma_f32_16x16x32_bf16 v[44:47], v[200:203], v[224:227], v[44:47]
    ds_read_b64_tr_b16 v[164:165], v232 offset:136
    v_mfma_f32_16x16x32_bf16 v[76:79], v[200:203], v[228:231], v[76:79]
    ds_read_b64_tr_b16 v[166:167], v232 offset:392
    v_mfma_f32_16x16x32_bf16 v[16:19], v[204:207], v[220:223], v[16:19]
    ds_read_b64_tr_b16 v[168:169], v232 offset:192
    v_mfma_f32_16x16x32_bf16 v[48:51], v[204:207], v[224:227], v[48:51]
    ds_read_b64_tr_b16 v[170:171], v232 offset:448
    v_mfma_f32_16x16x32_bf16 v[80:83], v[204:207], v[228:231], v[80:83]
    ds_read_b64_tr_b16 v[172:173], v232 offset:200
    v_mfma_f32_16x16x32_bf16 v[20:23], v[208:211], v[220:223], v[20:23]
    ds_read_b64_tr_b16 v[174:175], v232 offset:456
    v_mfma_f32_16x16x32_bf16 v[52:55], v[208:211], v[224:227], v[52:55]
    v_mfma_f32_16x16x32_bf16 v[84:87], v[208:211], v[228:231], v[84:87]
    v_mfma_f32_16x16x32_bf16 v[24:27], v[212:215], v[220:223], v[24:27]
    v_mfma_f32_16x16x32_bf16 v[56:59], v[212:215], v[224:227], v[56:59]
    v_mfma_f32_16x16x32_bf16 v[88:91], v[212:215], v[228:231], v[88:91]
    v_mfma_f32_16x16x32_bf16 v[28:31], v[216:219], v[220:223], v[28:31]
    v_mfma_f32_16x16x32_bf16 v[60:63], v[216:219], v[224:227], v[60:63]
    v_mfma_f32_16x16x32_bf16 v[92:95], v[216:219], v[228:231], v[92:95]
    v_add_u32 v232, s53, v233
    v_add_u32 v234, s55, v241
    s_waitcnt lgkmcnt(0)
    s_barrier
    ds_read_b128 v[220:223], v234 offset:0
    ds_read_b128 v[224:227], v234 offset:2048
    v_mfma_f32_16x16x32_bf16 v[0:3], v[144:147], v[176:179], v[0:3]
    ds_read_b128 v[228:231], v234 offset:4096
    s_add_u32 s52, s52, 1
    s_and_b32 s53, s52, 7
    s_lshl_b32 s53, s53, 10
    s_bfe_u32 s54, s52, 0x20001
    s_mul_i32 s55, s54, 20480
    s_cmp_ge_u32 s54, 2
    s_cselect_b32 s54, 16160, 0
    s_add_u32 s55, s55, s54
    v_mfma_f32_16x16x32_bf16 v[32:35], v[144:147], v[180:183], v[32:35]
    ds_read_b64_tr_b16 v[188:189], v232 offset:0
    v_mfma_f32_16x16x32_bf16 v[64:67], v[144:147], v[184:187], v[64:67]
    ds_read_b64_tr_b16 v[190:191], v232 offset:256
    v_mfma_f32_16x16x32_bf16 v[4:7], v[148:151], v[176:179], v[4:7]
    ds_read_b64_tr_b16 v[192:193], v232 offset:8
    v_mfma_f32_16x16x32_bf16 v[36:39], v[148:151], v[180:183], v[36:39]
    ds_read_b64_tr_b16 v[194:195], v232 offset:264
    v_mfma_f32_16x16x32_bf16 v[68:71], v[148:151], v[184:187], v[68:71]
    ds_read_b64_tr_b16 v[196:197], v232 offset:64
    v_mfma_f32_16x16x32_bf16 v[8:11], v[152:155], v[176:179], v[8:11]
    ds_read_b64_tr_b16 v[198:199], v232 offset:320
    v_mfma_f32_16x16x32_bf16 v[40:43], v[152:155], v[180:183], v[40:43]
    ds_read_b64_tr_b16 v[200:201], v232 offset:72
    ds_read_b64_tr_b16 v[202:203], v232 offset:328
    v_mfma_f32_16x16x32_bf16 v[72:75], v[152:155], v[184:187], v[72:75]
    ds_read_b64_tr_b16 v[204:205], v232 offset:128
    v_mfma_f32_16x16x32_bf16 v[12:15], v[156:159], v[176:179], v[12:15]
    ds_read_b64_tr_b16 v[206:207], v232 offset:384
    v_mfma_f32_16x16x32_bf16 v[44:47], v[156:159], v[180:183], v[44:47]
    ds_read_b64_tr_b16 v[208:209], v232 offset:136
    v_mfma_f32_16x16x32_bf16 v[76:79], v[156:159], v[184:187], v[76:79]
    ds_read_b64_tr_b16 v[210:211], v232 offset:392
    v_mfma_f32_16x16x32_bf16 v[16:19], v[160:163], v[176:179], v[16:19]
    ds_read_b64_tr_b16 v[212:213], v232 offset:192
    v_mfma_f32_16x16x32_bf16 v[48:51], v[160:163], v[180:183], v[48:51]
    ds_read_b64_tr_b16 v[214:215], v232 offset:448
    v_mfma_f32_16x16x32_bf16 v[80:83], v[160:163], v[184:187], v[80:83]
    ds_read_b64_tr_b16 v[216:217], v232 offset:200
    v_mfma_f32_16x16x32_bf16 v[20:23], v[164:167], v[176:179], v[20:23]
    ds_read_b64_tr_b16 v[218:219], v232 offset:456
    v_mfma_f32_16x16x32_bf16 v[52:55], v[164:167], v[180:183], v[52:55]
    v_mfma_f32_16x16x32_bf16 v[84:87], v[164:167], v[184:187], v[84:87]
    v_mfma_f32_16x16x32_bf16 v[24:27], v[168:171], v[176:179], v[24:27]
    v_mfma_f32_16x16x32_bf16 v[56:59], v[168:171], v[180:183], v[56:59]
    v_mfma_f32_16x16x32_bf16 v[88:91], v[168:171], v[184:187], v[88:91]
    v_mfma_f32_16x16x32_bf16 v[28:31], v[172:175], v[176:179], v[28:31]
    v_mfma_f32_16x16x32_bf16 v[60:63], v[172:175], v[180:183], v[60:63]
    v_mfma_f32_16x16x32_bf16 v[92:95], v[172:175], v[184:187], v[92:95]
    v_add_u32 v232, s53, v233
    v_add_u32 v234, s55, v240
    s_waitcnt lgkmcnt(0)
    s_barrier
    s_cmp_lt_u32 s52, 16
    s_cbranch_scc1 L_A3_pg
    v_mfma_f32_16x16x32_bf16 v[0:3], v[188:191], v[220:223], v[0:3]
    v_mfma_f32_16x16x32_bf16 v[4:7], v[192:195], v[220:223], v[4:7]
    v_mfma_f32_16x16x32_bf16 v[8:11], v[196:199], v[220:223], v[8:11]
    v_mfma_f32_16x16x32_bf16 v[12:15], v[200:203], v[220:223], v[12:15]
    v_mfma_f32_16x16x32_bf16 v[16:19], v[204:207], v[220:223], v[16:19]
    v_mfma_f32_16x16x32_bf16 v[20:23], v[208:211], v[220:223], v[20:23]
    v_mfma_f32_16x16x32_bf16 v[24:27], v[212:215], v[220:223], v[24:27]
    v_mfma_f32_16x16x32_bf16 v[28:31], v[216:219], v[220:223], v[28:31]
    v_mfma_f32_16x16x32_bf16 v[32:35], v[188:191], v[224:227], v[32:35]
    v_mfma_f32_16x16x32_bf16 v[36:39], v[192:195], v[224:227], v[36:39]
    v_mul_f32 v0, s57, v0
    v_mul_f32 v1, s57, v1
    v_mul_f32 v2, s57, v2
    v_mul_f32 v3, s57, v3
    v_mul_f32 v4, s57, v4
    v_mul_f32 v5, s57, v5
    v_mfma_f32_16x16x32_bf16 v[40:43], v[196:199], v[224:227], v[40:43]
    v_mul_f32 v6, s57, v6
    v_mul_f32 v7, s57, v7
    v_cvt_pk_bf16_f32 v96, v0, v1
    v_cvt_pk_bf16_f32 v97, v2, v3
    v_cvt_pk_bf16_f32 v98, v4, v5
    v_cvt_pk_bf16_f32 v99, v6, v7
    v_mfma_f32_16x16x32_bf16 v[44:47], v[200:203], v[224:227], v[44:47]
    v_mul_f32 v8, s57, v8
    v_mul_f32 v9, s57, v9
    v_mul_f32 v10, s57, v10
    v_mul_f32 v11, s57, v11
    v_mul_f32 v12, s57, v12
    v_mul_f32 v13, s57, v13
    v_mfma_f32_16x16x32_bf16 v[48:51], v[204:207], v[224:227], v[48:51]
    v_mul_f32 v14, s57, v14
    v_mul_f32 v15, s57, v15
    v_cvt_pk_bf16_f32 v100, v8, v9
    v_cvt_pk_bf16_f32 v101, v10, v11
    v_cvt_pk_bf16_f32 v102, v12, v13
    v_cvt_pk_bf16_f32 v103, v14, v15
    v_mfma_f32_16x16x32_bf16 v[52:55], v[208:211], v[224:227], v[52:55]
    v_mul_f32 v16, s57, v16
    v_mul_f32 v17, s57, v17
    v_mul_f32 v18, s57, v18
    v_mul_f32 v19, s57, v19
    v_mul_f32 v20, s57, v20
    v_mul_f32 v21, s57, v21
    v_mfma_f32_16x16x32_bf16 v[56:59], v[212:215], v[224:227], v[56:59]
    v_mul_f32 v22, s57, v22
    v_mul_f32 v23, s57, v23
    v_cvt_pk_bf16_f32 v104, v16, v17
    v_cvt_pk_bf16_f32 v105, v18, v19
    v_cvt_pk_bf16_f32 v106, v20, v21
    v_cvt_pk_bf16_f32 v107, v22, v23
    v_mfma_f32_16x16x32_bf16 v[60:63], v[216:219], v[224:227], v[60:63]
    v_mul_f32 v24, s57, v24
    v_mul_f32 v25, s57, v25
    v_mul_f32 v26, s57, v26
    v_mul_f32 v27, s57, v27
    v_mul_f32 v28, s57, v28
    v_mul_f32 v29, s57, v29
    v_mfma_f32_16x16x32_bf16 v[64:67], v[188:191], v[228:231], v[64:67]
    v_mul_f32 v30, s57, v30
    v_mul_f32 v31, s57, v31
    v_cvt_pk_bf16_f32 v108, v24, v25
    v_cvt_pk_bf16_f32 v109, v26, v27
    v_cvt_pk_bf16_f32 v110, v28, v29
    v_cvt_pk_bf16_f32 v111, v30, v31
    v_mfma_f32_16x16x32_bf16 v[68:71], v[192:195], v[228:231], v[68:71]
    v_mul_f32 v32, s57, v32
    v_mul_f32 v33, s57, v33
    v_mul_f32 v34, s57, v34
    v_mul_f32 v35, s57, v35
    v_mul_f32 v36, s57, v36
    v_mul_f32 v37, s57, v37
    v_mul_f32 v38, s57, v38
    v_mfma_f32_16x16x32_bf16 v[72:75], v[196:199], v[228:231], v[72:75]
    v_mul_f32 v39, s57, v39
    v_cvt_pk_bf16_f32 v112, v32, v33
    v_cvt_pk_bf16_f32 v113, v34, v35
    v_cvt_pk_bf16_f32 v114, v36, v37
    v_cvt_pk_bf16_f32 v115, v38, v39
    v_mul_f32 v40, s57, v40
    v_mul_f32 v41, s57, v41
    v_mfma_f32_16x16x32_bf16 v[76:79], v[200:203], v[228:231], v[76:79]
    v_mul_f32 v42, s57, v42
    v_mul_f32 v43, s57, v43
    v_mul_f32 v44, s57, v44
    v_mul_f32 v45, s57, v45
    v_mul_f32 v46, s57, v46
    v_mul_f32 v47, s57, v47
    v_cvt_pk_bf16_f32 v116, v40, v41
    v_mfma_f32_16x16x32_bf16 v[80:83], v[204:207], v[228:231], v[80:83]
    v_cvt_pk_bf16_f32 v117, v42, v43
    v_cvt_pk_bf16_f32 v118, v44, v45
    v_cvt_pk_bf16_f32 v119, v46, v47
    v_mul_f32 v48, s57, v48
    v_mul_f32 v49, s57, v49
    v_mul_f32 v50, s57, v50
    v_mul_f32 v51, s57, v51
    v_mfma_f32_16x16x32_bf16 v[84:87], v[208:211], v[228:231], v[84:87]
    v_mul_f32 v52, s57, v52
    v_mul_f32 v53, s57, v53
    v_mul_f32 v54, s57, v54
    v_mul_f32 v55, s57, v55
    v_cvt_pk_bf16_f32 v120, v48, v49
    v_cvt_pk_bf16_f32 v121, v50, v51
    v_cvt_pk_bf16_f32 v122, v52, v53
    v_mfma_f32_16x16x32_bf16 v[88:91], v[212:215], v[228:231], v[88:91]
    v_cvt_pk_bf16_f32 v123, v54, v55
    v_mul_f32 v56, s57, v56
    v_mul_f32 v57, s57, v57
    v_mul_f32 v58, s57, v58
    v_mul_f32 v59, s57, v59
    v_mul_f32 v60, s57, v60
    v_mul_f32 v61, s57, v61
    v_mfma_f32_16x16x32_bf16 v[92:95], v[216:219], v[228:231], v[92:95]
    v_mul_f32 v62, s57, v62
    v_mul_f32 v63, s57, v63
    v_cvt_pk_bf16_f32 v124, v56, v57
    v_cvt_pk_bf16_f32 v125, v58, v59
    v_cvt_pk_bf16_f32 v126, v60, v61
    v_cvt_pk_bf16_f32 v127, v62, v63
    v_mul_f32 v64, s57, v64
    v_mul_f32 v65, s57, v65
    v_mul_f32 v66, s57, v66
    v_mul_f32 v67, s57, v67
    v_mul_f32 v68, s57, v68
    v_mul_f32 v69, s57, v69
    v_mul_f32 v70, s57, v70
    v_mul_f32 v71, s57, v71
    v_cvt_pk_bf16_f32 v128, v64, v65
    v_cvt_pk_bf16_f32 v129, v66, v67
    v_cvt_pk_bf16_f32 v130, v68, v69
    v_cvt_pk_bf16_f32 v131, v70, v71
    v_mul_f32 v72, s57, v72
    v_mul_f32 v73, s57, v73
    v_mul_f32 v74, s57, v74
    v_mul_f32 v75, s57, v75
    v_mul_f32 v76, s57, v76
    v_mul_f32 v77, s57, v77
    v_mul_f32 v78, s57, v78
    v_mul_f32 v79, s57, v79
    v_cvt_pk_bf16_f32 v132, v72, v73
    v_cvt_pk_bf16_f32 v133, v74, v75
    v_cvt_pk_bf16_f32 v134, v76, v77
    v_cvt_pk_bf16_f32 v135, v78, v79
    v_mul_f32 v80, s57, v80
    v_mul_f32 v81, s57, v81
    v_mul_f32 v82, s57, v82
    v_mul_f32 v83, s57, v83
    v_mul_f32 v84, s57, v84
    v_mul_f32 v85, s57, v85
    v_mul_f32 v86, s57, v86
    v_mul_f32 v87, s57, v87
    v_cvt_pk_bf16_f32 v136, v80, v81
    v_cvt_pk_bf16_f32 v137, v82, v83
    v_cvt_pk_bf16_f32 v138, v84, v85
    v_cvt_pk_bf16_f32 v139, v86, v87
    v_mul_f32 v88, s57, v88
    v_mul_f32 v89, s57, v89
    v_mul_f32 v90, s57, v90
    v_mul_f32 v91, s57, v91
    v_mul_f32 v92, s57, v92
    v_mul_f32 v93, s57, v93
    v_mul_f32 v94, s57, v94
    v_mul_f32 v95, s57, v95
    v_cvt_pk_bf16_f32 v140, v88, v89
    v_cvt_pk_bf16_f32 v141, v90, v91
    v_cvt_pk_bf16_f32 v142, v92, v93
    v_cvt_pk_bf16_f32 v143, v94, v95
    s_waitcnt lgkmcnt(0)
    s_barrier
    s_cmp_lg_u32 s87, 0
    s_cbranch_scc1 L_A3_care
    ds_read_b128 v[204:207], v236 offset:0
    ds_read_b128 v[208:211], v236 offset:64
    ds_read_b128 v[212:215], v236 offset:128
    ds_read_b128 v[216:219], v236 offset:192
    ds_read_b128 v[220:223], v236 offset:512
    ds_read_b128 v[224:227], v236 offset:576
    ds_read_b128 v[228:231], v236 offset:640
    ds_read_b128 v[232:235], v236 offset:704
    s_waitcnt lgkmcnt(7)
    v_mfma_f32_16x16x32_bf16 v[144:147], v[204:207], v[96:99], 0
    v_mfma_f32_16x16x32_bf16 v[148:151], v[204:207], v[112:115], 0
    v_mfma_f32_16x16x32_bf16 v[152:155], v[204:207], v[128:131], 0
    s_waitcnt lgkmcnt(6)
    v_mfma_f32_16x16x32_bf16 v[144:147], v[208:211], v[100:103], v[144:147]
    v_mfma_f32_16x16x32_bf16 v[148:151], v[208:211], v[116:119], v[148:151]
    v_mfma_f32_16x16x32_bf16 v[152:155], v[208:211], v[132:135], v[152:155]
    s_waitcnt lgkmcnt(5)
    v_mfma_f32_16x16x32_bf16 v[144:147], v[212:215], v[104:107], v[144:147]
    v_mfma_f32_16x16x32_bf16 v[148:151], v[212:215], v[120:123], v[148:151]
    v_mfma_f32_16x16x32_bf16 v[152:155], v[212:215], v[136:139], v[152:155]
    s_waitcnt lgkmcnt(4)
    v_mfma_f32_16x16x32_bf16 v[144:147], v[216:219], v[108:111], v[144:147]
    v_mfma_f32_16x16x32_bf16 v[148:151], v[216:219], v[124:127], v[148:151]
    v_mfma_f32_16x16x32_bf16 v[152:155], v[216:219], v[140:143], v[152:155]
    s_nop 5
    v_max3_f32 v171, v144, v145, v146
    v_max3_f32 v175, v148, v149, v150
    v_max3_f32 v179, v152, v153, v154
    v_max_f32 v171, v171, v147
    v_max_f32 v175, v175, v151
    v_max_f32 v179, v179, v155
    v_mov_b32 v168, v171
    v_mov_b32 v172, v175
    v_mov_b32 v176, v179
    v_permlane16_swap_b32 v171, v168
    v_permlane16_swap_b32 v175, v172
    v_permlane16_swap_b32 v179, v176
    v_max_f32 v171, v171, v168
    v_max_f32 v175, v175, v172
    v_max_f32 v179, v179, v176
    v_mov_b32 v168, v171
    v_mov_b32 v172, v175
    v_mov_b32 v176, v179
    v_permlane32_swap_b32 v171, v168
    v_permlane32_swap_b32 v175, v172
    v_permlane32_swap_b32 v179, v176
    v_max_f32 v171, v171, v168
    v_max_f32 v175, v175, v172
    v_max_f32 v179, v179, v176
    v_sub_f32 v168, 0, v171
    v_sub_f32 v172, 0, v175
    v_sub_f32 v176, 0, v179
    v_sub_f32 v169, 0, v171
    v_sub_f32 v173, 0, v175
    v_sub_f32 v177, 0, v179
    v_sub_f32 v170, 0, v171
    v_sub_f32 v174, 0, v175
    v_sub_f32 v178, 0, v179
    v_sub_f32 v171, 0, v171
    v_sub_f32 v175, 0, v175
    v_sub_f32 v179, 0, v179
    s_waitcnt lgkmcnt(3)
    v_mfma_f32_16x16x32_bf16 v[156:159], v[220:223], v[96:99], v[168:171]
    v_add_f32 v144, v144, v168
    v_add_f32 v145, v145, v168
    v_add_f32 v146, v146, v168
    v_add_f32 v147, v147, v168
    v_mfma_f32_16x16x32_bf16 v[160:163], v[220:223], v[112:115], v[172:175]
    v_add_f32 v148, v148, v172
    v_add_f32 v149, v149, v172
    v_add_f32 v150, v150, v172
    v_add_f32 v151, v151, v172
    v_add_f32 v152, v152, v176
    v_mfma_f32_16x16x32_bf16 v[164:167], v[220:223], v[128:131], v[176:179]
    v_add_f32 v153, v153, v176
    v_add_f32 v154, v154, v176
    v_add_f32 v155, v155, v176
    s_waitcnt lgkmcnt(2)
    v_mfma_f32_16x16x32_bf16 v[156:159], v[224:227], v[100:103], v[156:159]
    v_exp_f32 v144, v144
    v_exp_f32 v145, v145
    v_exp_f32 v146, v146
    v_mfma_f32_16x16x32_bf16 v[160:163], v[224:227], v[116:119], v[160:163]
    v_exp_f32 v147, v147
    v_add_f32 v240, v144, v145
    v_mfma_f32_16x16x32_bf16 v[164:167], v[224:227], v[132:135], v[164:167]
    v_exp_f32 v148, v148
    v_cvt_pk_bf16_f32 v180, v144, v145
    v_exp_f32 v149, v149
    s_waitcnt lgkmcnt(1)
    v_mfma_f32_16x16x32_bf16 v[156:159], v[228:231], v[104:107], v[156:159]
    v_add_f32 v240, v240, v146
    v_exp_f32 v150, v150
    v_add_f32 v240, v240, v147
    v_mfma_f32_16x16x32_bf16 v[160:163], v[228:231], v[120:123], v[160:163]
    v_exp_f32 v151, v151
    v_cvt_pk_bf16_f32 v181, v146, v147
    v_add_f32 v241, v148, v149
    v_mfma_f32_16x16x32_bf16 v[164:167], v[228:231], v[136:139], v[164:167]
    v_exp_f32 v152, v152
    v_cvt_pk_bf16_f32 v184, v148, v149
    v_exp_f32 v153, v153
    s_waitcnt lgkmcnt(0)
    v_mfma_f32_16x16x32_bf16 v[156:159], v[232:235], v[108:111], v[156:159]
    v_add_f32 v241, v241, v150
    v_exp_f32 v154, v154
    v_add_f32 v241, v241, v151
    v_mfma_f32_16x16x32_bf16 v[160:163], v[232:235], v[124:127], v[160:163]
    v_exp_f32 v155, v155
    v_cvt_pk_bf16_f32 v185, v150, v151
    v_add_f32 v242, v152, v153
    v_mfma_f32_16x16x32_bf16 v[164:167], v[232:235], v[140:143], v[164:167]
    v_cvt_pk_bf16_f32 v188, v152, v153
    v_add_f32 v242, v242, v154
    v_add_f32 v242, v242, v155
    v_cvt_pk_bf16_f32 v189, v154, v155
    s_waitcnt lgkmcnt(0)
    s_barrier
    ds_read_b128 v[204:207], v236 offset:1024
    ds_read_b128 v[208:211], v236 offset:1088
    ds_read_b128 v[212:215], v236 offset:1152
    ds_read_b128 v[216:219], v236 offset:1216
    s_waitcnt lgkmcnt(3)
    v_mfma_f32_16x16x32_bf16 v[144:147], v[204:207], v[96:99], v[168:171]
    ds_read_b64_tr_b16 v[220:221], v237 offset:0
    ds_read_b64_tr_b16 v[222:223], v237 offset:512
    v_mfma_f32_16x16x32_bf16 v[148:151], v[204:207], v[112:115], v[172:175]
    v_exp_f32 v156, v156
    v_exp_f32 v157, v157
    v_exp_f32 v158, v158
    v_mfma_f32_16x16x32_bf16 v[152:155], v[204:207], v[128:131], v[176:179]
    ds_read_b128 v[204:207], v236 offset:1536
    ds_read_b64_tr_b16 v[224:225], v237 offset:32
    ds_read_b64_tr_b16 v[226:227], v237 offset:544
    s_waitcnt lgkmcnt(7)
    v_mfma_f32_16x16x32_bf16 v[144:147], v[208:211], v[100:103], v[144:147]
    ds_read_b64_tr_b16 v[228:229], v237 offset:64
    ds_read_b64_tr_b16 v[230:231], v237 offset:576
    v_mfma_f32_16x16x32_bf16 v[148:151], v[208:211], v[116:119], v[148:151]
    v_exp_f32 v159, v159
    v_add_f32 v240, v240, v156
    v_exp_f32 v160, v160
    v_add_f32 v240, v240, v157
    v_mfma_f32_16x16x32_bf16 v[152:155], v[208:211], v[132:135], v[152:155]
    ds_read_b128 v[208:211], v236 offset:1600
    ds_read_b64_tr_b16 v[232:233], v237 offset:96
    ds_read_b64_tr_b16 v[234:235], v237 offset:608
    s_waitcnt lgkmcnt(11)
    v_mfma_f32_16x16x32_bf16 v[144:147], v[212:215], v[104:107], v[144:147]
    v_exp_f32 v161, v161
    v_cvt_pk_bf16_f32 v182, v156, v157
    v_add_f32 v240, v240, v158
    v_exp_f32 v162, v162
    v_mfma_f32_16x16x32_bf16 v[148:151], v[212:215], v[120:123], v[148:151]
    v_add_f32 v240, v240, v159
    v_exp_f32 v163, v163
    v_cvt_pk_bf16_f32 v183, v158, v159
    v_add_f32 v241, v241, v160
    v_exp_f32 v164, v164
    v_mfma_f32_16x16x32_bf16 v[152:155], v[212:215], v[136:139], v[152:155]
    ds_read_b128 v[212:215], v236 offset:1664
    v_add_f32 v241, v241, v161
    v_exp_f32 v165, v165
    v_cvt_pk_bf16_f32 v186, v160, v161
    v_add_f32 v241, v241, v162
    s_waitcnt lgkmcnt(11)
    v_mfma_f32_16x16x32_bf16 v[144:147], v[216:219], v[108:111], v[144:147]
    v_exp_f32 v166, v166
    v_add_f32 v241, v241, v163
    v_exp_f32 v167, v167
    v_cvt_pk_bf16_f32 v187, v162, v163
    v_mfma_f32_16x16x32_bf16 v[148:151], v[216:219], v[124:127], v[148:151]
    v_add_f32 v242, v242, v164
    v_add_f32 v242, v242, v165
    v_cvt_pk_bf16_f32 v190, v164, v165
    v_add_f32 v242, v242, v166
    v_add_f32 v242, v242, v167
    v_cvt_pk_bf16_f32 v191, v166, v167
    v_mfma_f32_16x16x32_bf16 v[152:155], v[216:219], v[140:143], v[152:155]
    ds_read_b128 v[216:219], v236 offset:1728
    s_waitcnt lgkmcnt(2)
    v_mfma_f32_16x16x32_bf16 v[0:3], v[220:223], v[180:183], 0
    v_mfma_f32_16x16x32_bf16 v[32:35], v[220:223], v[184:187], 0
    v_mfma_f32_16x16x32_bf16 v[64:67], v[220:223], v[188:191], 0
    ds_read_b64_tr_b16 v[220:221], v237 offset:128
    ds_read_b64_tr_b16 v[222:223], v237 offset:640
    v_exp_f32 v144, v144
    v_mfma_f32_16x16x32_bf16 v[4:7], v[224:227], v[180:183], 0
    v_exp_f32 v145, v145
    v_mfma_f32_16x16x32_bf16 v[36:39], v[224:227], v[184:187], 0
    v_exp_f32 v146, v146
    v_mfma_f32_16x16x32_bf16 v[68:71], v[224:227], v[188:191], 0
    ds_read_b64_tr_b16 v[224:225], v237 offset:160
    ds_read_b64_tr_b16 v[226:227], v237 offset:672
    v_mfma_f32_16x16x32_bf16 v[8:11], v[228:231], v[180:183], 0
    v_exp_f32 v147, v147
    v_mfma_f32_16x16x32_bf16 v[40:43], v[228:231], v[184:187], 0
    v_add_f32 v240, v240, v144
    v_exp_f32 v148, v148
    v_mfma_f32_16x16x32_bf16 v[72:75], v[228:231], v[188:191], 0
    ds_read_b64_tr_b16 v[228:229], v237 offset:192
    ds_read_b64_tr_b16 v[230:231], v237 offset:704
    v_add_f32 v240, v240, v145
    v_mfma_f32_16x16x32_bf16 v[12:15], v[232:235], v[180:183], 0
    v_exp_f32 v149, v149
    v_mfma_f32_16x16x32_bf16 v[44:47], v[232:235], v[184:187], 0
    v_cvt_pk_bf16_f32 v192, v144, v145
    v_add_f32 v240, v240, v146
    v_mfma_f32_16x16x32_bf16 v[76:79], v[232:235], v[188:191], 0
    ds_read_b64_tr_b16 v[232:233], v237 offset:224
    ds_read_b64_tr_b16 v[234:235], v237 offset:736
    s_waitcnt lgkmcnt(8)
    v_mfma_f32_16x16x32_bf16 v[156:159], v[204:207], v[96:99], v[168:171]
    v_exp_f32 v150, v150
    v_add_f32 v240, v240, v147
    v_mfma_f32_16x16x32_bf16 v[160:163], v[204:207], v[112:115], v[172:175]
    v_exp_f32 v151, v151
    v_mfma_f32_16x16x32_bf16 v[164:167], v[204:207], v[128:131], v[176:179]
    v_cvt_pk_bf16_f32 v193, v146, v147
    v_add_f32 v241, v241, v148
    v_mfma_f32_16x16x32_bf16 v[156:159], v[208:211], v[100:103], v[156:159]
    v_exp_f32 v152, v152
    v_mfma_f32_16x16x32_bf16 v[160:163], v[208:211], v[116:119], v[160:163]
    v_add_f32 v241, v241, v149
    v_exp_f32 v153, v153
    v_mfma_f32_16x16x32_bf16 v[164:167], v[208:211], v[132:135], v[164:167]
    v_cvt_pk_bf16_f32 v196, v148, v149
    v_mfma_f32_16x16x32_bf16 v[156:159], v[212:215], v[104:107], v[156:159]
    v_add_f32 v241, v241, v150
    v_exp_f32 v154, v154
    v_mfma_f32_16x16x32_bf16 v[160:163], v[212:215], v[120:123], v[160:163]
    v_add_f32 v241, v241, v151
    v_mfma_f32_16x16x32_bf16 v[164:167], v[212:215], v[136:139], v[164:167]
    v_exp_f32 v155, v155
    v_cvt_pk_bf16_f32 v197, v150, v151
    v_mfma_f32_16x16x32_bf16 v[156:159], v[216:219], v[108:111], v[156:159]
    v_add_f32 v242, v242, v152
    v_add_f32 v242, v242, v153
    v_mfma_f32_16x16x32_bf16 v[160:163], v[216:219], v[124:127], v[160:163]
    v_cvt_pk_bf16_f32 v200, v152, v153
    v_add_f32 v242, v242, v154
    v_mfma_f32_16x16x32_bf16 v[164:167], v[216:219], v[140:143], v[164:167]
    v_add_f32 v242, v242, v155
    v_cvt_pk_bf16_f32 v201, v154, v155
    v_xor_b32 v236, 0x800, v236
    s_waitcnt lgkmcnt(0)
    s_barrier
L_A3_e1:
    s_mov_b32 s51, 0
    ds_read_b128 v[204:207], v236 offset:0
    ds_read_b128 v[208:211], v236 offset:64
    ds_read_b128 v[212:215], v236 offset:128
    v_mfma_f32_16x16x32_bf16 v[16:19], v[220:223], v[180:183], 0
    v_mfma_f32_16x16x32_bf16 v[48:51], v[220:223], v[184:187], 0
    s_nop 0
    v_exp_f32 v156, v156
    v_mfma_f32_16x16x32_bf16 v[80:83], v[220:223], v[188:191], 0
    ds_read_b128 v[216:219], v236 offset:192
    ds_read_b64_tr_b16 v[220:221], v237 offset:1024
    ds_read_b64_tr_b16 v[222:223], v237 offset:1536
    v_mfma_f32_16x16x32_bf16 v[20:23], v[224:227], v[180:183], 0
    v_exp_f32 v157, v157
    v_mfma_f32_16x16x32_bf16 v[52:55], v[224:227], v[184:187], 0
    v_exp_f32 v158, v158
    v_mfma_f32_16x16x32_bf16 v[84:87], v[224:227], v[188:191], 0
    v_exp_f32 v159, v159
    v_add_f32 v240, v240, v156
    v_mfma_f32_16x16x32_bf16 v[24:27], v[228:231], v[180:183], 0
    ds_read_b64_tr_b16 v[224:225], v237 offset:1056
    ds_read_b64_tr_b16 v[226:227], v237 offset:1568
    v_mfma_f32_16x16x32_bf16 v[56:59], v[228:231], v[184:187], 0
    v_exp_f32 v160, v160
    v_add_f32 v240, v240, v157
    v_mfma_f32_16x16x32_bf16 v[88:91], v[228:231], v[188:191], 0
    v_exp_f32 v161, v161
    v_mfma_f32_16x16x32_bf16 v[28:31], v[232:235], v[180:183], 0
    v_cvt_pk_bf16_f32 v194, v156, v157
    v_add_f32 v240, v240, v158
    v_mfma_f32_16x16x32_bf16 v[60:63], v[232:235], v[184:187], 0
    v_exp_f32 v162, v162
    v_mfma_f32_16x16x32_bf16 v[92:95], v[232:235], v[188:191], 0
    ds_read_b64_tr_b16 v[232:233], v237 offset:1120
    ds_read_b64_tr_b16 v[234:235], v237 offset:1632
    v_add_f32 v240, v240, v159
    s_waitcnt lgkmcnt(6)
    v_mfma_f32_16x16x32_bf16 v[144:147], v[204:207], v[96:99], v[168:171]
    v_exp_f32 v163, v163
    v_cvt_pk_bf16_f32 v195, v158, v159
    v_mfma_f32_16x16x32_bf16 v[148:151], v[204:207], v[112:115], v[172:175]
    ds_read_b64_tr_b16 v[228:229], v237 offset:1088
    ds_read_b64_tr_b16 v[230:231], v237 offset:1600
    v_mfma_f32_16x16x32_bf16 v[152:155], v[204:207], v[128:131], v[176:179]
    ds_read_b128 v[204:207], v236 offset:512
    v_add_f32 v241, v241, v160
    v_mfma_f32_16x16x32_bf16 v[144:147], v[208:211], v[100:103], v[144:147]
    v_exp_f32 v164, v164
    v_add_f32 v241, v241, v161
    v_mfma_f32_16x16x32_bf16 v[148:151], v[208:211], v[116:119], v[148:151]
    v_exp_f32 v165, v165
    v_mfma_f32_16x16x32_bf16 v[152:155], v[208:211], v[132:135], v[152:155]
    ds_read_b128 v[208:211], v236 offset:576
    v_cvt_pk_bf16_f32 v198, v160, v161
    v_add_f32 v241, v241, v162
    v_mfma_f32_16x16x32_bf16 v[144:147], v[212:215], v[104:107], v[144:147]
    v_exp_f32 v166, v166
    v_mfma_f32_16x16x32_bf16 v[148:151], v[212:215], v[120:123], v[148:151]
    v_add_f32 v241, v241, v163
    v_exp_f32 v167, v167
    v_mfma_f32_16x16x32_bf16 v[152:155], v[212:215], v[136:139], v[152:155]
    v_cvt_pk_bf16_f32 v199, v162, v163
    v_add_f32 v242, v242, v164
    v_add_f32 v242, v242, v165
    v_mfma_f32_16x16x32_bf16 v[144:147], v[216:219], v[108:111], v[144:147]
    v_cvt_pk_bf16_f32 v202, v164, v165
    v_add_f32 v242, v242, v166
    v_mfma_f32_16x16x32_bf16 v[148:151], v[216:219], v[124:127], v[148:151]
    v_add_f32 v242, v242, v167
    v_cvt_pk_bf16_f32 v203, v166, v167
    v_mfma_f32_16x16x32_bf16 v[152:155], v[216:219], v[140:143], v[152:155]
    ds_read_b128 v[212:215], v236 offset:640
    s_waitcnt lgkmcnt(3)
    v_mfma_f32_16x16x32_bf16 v[0:3], v[220:223], v[192:195], v[0:3]
    v_mfma_f32_16x16x32_bf16 v[32:35], v[220:223], v[196:199], v[32:35]
    v_mfma_f32_16x16x32_bf16 v[64:67], v[220:223], v[200:203], v[64:67]
    ds_read_b128 v[216:219], v236 offset:704
    v_exp_f32 v144, v144
    v_mfma_f32_16x16x32_bf16 v[4:7], v[224:227], v[192:195], v[4:7]
    v_exp_f32 v145, v145
    v_mfma_f32_16x16x32_bf16 v[36:39], v[224:227], v[196:199], v[36:39]
    v_exp_f32 v146, v146
    v_mfma_f32_16x16x32_bf16 v[68:71], v[224:227], v[200:203], v[68:71]
    ds_read_b64_tr_b16 v[224:225], v237 offset:1184
    ds_read_b64_tr_b16 v[226:227], v237 offset:1696
    v_exp_f32 v147, v147
    v_mfma_f32_16x16x32_bf16 v[8:11], v[228:231], v[192:195], v[8:11]
    ds_read_b64_tr_b16 v[220:221], v237 offset:1152
    ds_read_b64_tr_b16 v[222:223], v237 offset:1664
    v_mfma_f32_16x16x32_bf16 v[40:43], v[228:231], v[196:199], v[40:43]
    v_add_f32 v240, v240, v144
    v_mfma_f32_16x16x32_bf16 v[72:75], v[228:231], v[200:203], v[72:75]
    v_exp_f32 v148, v148
    v_add_f32 v240, v240, v145
    v_mfma_f32_16x16x32_bf16 v[12:15], v[232:235], v[192:195], v[12:15]
    v_exp_f32 v149, v149
    v_cvt_pk_bf16_f32 v180, v144, v145
    v_mfma_f32_16x16x32_bf16 v[44:47], v[232:235], v[196:199], v[44:47]
    v_add_f32 v240, v240, v146
    v_exp_f32 v150, v150
    v_mfma_f32_16x16x32_bf16 v[76:79], v[232:235], v[200:203], v[76:79]
    ds_read_b64_tr_b16 v[232:233], v237 offset:1248
    ds_read_b64_tr_b16 v[234:235], v237 offset:1760
    v_add_f32 v240, v240, v147
    s_waitcnt lgkmcnt(6)
    v_mfma_f32_16x16x32_bf16 v[156:159], v[204:207], v[96:99], v[168:171]
    v_exp_f32 v151, v151
    v_mfma_f32_16x16x32_bf16 v[160:163], v[204:207], v[112:115], v[172:175]
    v_cvt_pk_bf16_f32 v181, v146, v147
    v_add_f32 v241, v241, v148
    v_mfma_f32_16x16x32_bf16 v[164:167], v[204:207], v[128:131], v[176:179]
    ds_read_b64_tr_b16 v[228:229], v237 offset:1216
    ds_read_b64_tr_b16 v[230:231], v237 offset:1728
    v_mfma_f32_16x16x32_bf16 v[156:159], v[208:211], v[100:103], v[156:159]
    v_exp_f32 v152, v152
    v_add_f32 v241, v241, v149
    v_mfma_f32_16x16x32_bf16 v[160:163], v[208:211], v[116:119], v[160:163]
    v_exp_f32 v153, v153
    v_mfma_f32_16x16x32_bf16 v[164:167], v[208:211], v[132:135], v[164:167]
    v_cvt_pk_bf16_f32 v184, v148, v149
    v_add_f32 v241, v241, v150
    v_mfma_f32_16x16x32_bf16 v[156:159], v[212:215], v[104:107], v[156:159]
    v_exp_f32 v154, v154
    v_add_f32 v241, v241, v151
    v_mfma_f32_16x16x32_bf16 v[160:163], v[212:215], v[120:123], v[160:163]
    v_mfma_f32_16x16x32_bf16 v[164:167], v[212:215], v[136:139], v[164:167]
    v_exp_f32 v155, v155
    v_mfma_f32_16x16x32_bf16 v[156:159], v[216:219], v[108:111], v[156:159]
    v_cvt_pk_bf16_f32 v185, v150, v151
    v_add_f32 v242, v242, v152
    v_mfma_f32_16x16x32_bf16 v[160:163], v[216:219], v[124:127], v[160:163]
    v_add_f32 v242, v242, v153
    v_cvt_pk_bf16_f32 v188, v152, v153
    v_add_f32 v242, v242, v154
    v_mfma_f32_16x16x32_bf16 v[164:167], v[216:219], v[140:143], v[164:167]
    v_add_f32 v242, v242, v155
    v_cvt_pk_bf16_f32 v189, v154, v155
    v_xor_b32 v237, 0x800, v237
    s_waitcnt lgkmcnt(0)
    s_barrier
L_A3_loop:
    ds_read_b128 v[204:207], v236 offset:1024
    ds_read_b128 v[208:211], v236 offset:1088
    ds_read_b128 v[212:215], v236 offset:1152
    s_nop 0
    v_mfma_f32_16x16x32_bf16 v[16:19], v[220:223], v[192:195], v[16:19]
    v_mfma_f32_16x16x32_bf16 v[48:51], v[220:223], v[196:199], v[48:51]
    v_exp_f32 v156, v156
    v_mfma_f32_16x16x32_bf16 v[80:83], v[220:223], v[200:203], v[80:83]
    ds_read_b128 v[216:219], v236 offset:1216
    ds_read_b64_tr_b16 v[220:221], v237 offset:0
    ds_read_b64_tr_b16 v[222:223], v237 offset:512
    v_mfma_f32_16x16x32_bf16 v[20:23], v[224:227], v[192:195], v[20:23]
    v_exp_f32 v157, v157
    v_mfma_f32_16x16x32_bf16 v[52:55], v[224:227], v[196:199], v[52:55]
    v_exp_f32 v158, v158
    v_mfma_f32_16x16x32_bf16 v[84:87], v[224:227], v[200:203], v[84:87]
    v_exp_f32 v159, v159
    v_add_f32 v240, v240, v156
    v_mfma_f32_16x16x32_bf16 v[24:27], v[228:231], v[192:195], v[24:27]
    ds_read_b64_tr_b16 v[224:225], v237 offset:32
    ds_read_b64_tr_b16 v[226:227], v237 offset:544
    v_mfma_f32_16x16x32_bf16 v[56:59], v[228:231], v[196:199], v[56:59]
    v_exp_f32 v160, v160
    v_add_f32 v240, v240, v157
    v_mfma_f32_16x16x32_bf16 v[88:91], v[228:231], v[200:203], v[88:91]
    v_exp_f32 v161, v161
    v_mfma_f32_16x16x32_bf16 v[28:31], v[232:235], v[192:195], v[28:31]
    v_cvt_pk_bf16_f32 v182, v156, v157
    v_add_f32 v240, v240, v158
    v_mfma_f32_16x16x32_bf16 v[60:63], v[232:235], v[196:199], v[60:63]
    v_exp_f32 v162, v162
    v_mfma_f32_16x16x32_bf16 v[92:95], v[232:235], v[200:203], v[92:95]
    ds_read_b64_tr_b16 v[232:233], v237 offset:96
    ds_read_b64_tr_b16 v[234:235], v237 offset:608
    v_add_f32 v240, v240, v159
    s_waitcnt lgkmcnt(6)
    v_mfma_f32_16x16x32_bf16 v[144:147], v[204:207], v[96:99], v[168:171]
    v_exp_f32 v163, v163
    v_cvt_pk_bf16_f32 v183, v158, v159
    v_mfma_f32_16x16x32_bf16 v[148:151], v[204:207], v[112:115], v[172:175]
    ds_read_b64_tr_b16 v[228:229], v237 offset:64
    ds_read_b64_tr_b16 v[230:231], v237 offset:576
    v_mfma_f32_16x16x32_bf16 v[152:155], v[204:207], v[128:131], v[176:179]
    ds_read_b128 v[204:207], v236 offset:1536
    v_add_f32 v241, v241, v160
    v_mfma_f32_16x16x32_bf16 v[144:147], v[208:211], v[100:103], v[144:147]
    v_exp_f32 v164, v164
    v_add_f32 v241, v241, v161
    v_mfma_f32_16x16x32_bf16 v[148:151], v[208:211], v[116:119], v[148:151]
    v_exp_f32 v165, v165
    v_mfma_f32_16x16x32_bf16 v[152:155], v[208:211], v[132:135], v[152:155]
    ds_read_b128 v[208:211], v236 offset:1600
    v_cvt_pk_bf16_f32 v186, v160, v161
    v_add_f32 v241, v241, v162
    v_mfma_f32_16x16x32_bf16 v[144:147], v[212:215], v[104:107], v[144:147]
    v_exp_f32 v166, v166
    v_mfma_f32_16x16x32_bf16 v[148:151], v[212:215], v[120:123], v[148:151]
    v_add_f32 v241, v241, v163
    v_exp_f32 v167, v167
    v_mfma_f32_16x16x32_bf16 v[152:155], v[212:215], v[136:139], v[152:155]
    v_cvt_pk_bf16_f32 v187, v162, v163
    v_add_f32 v242, v242, v164
    v_add_f32 v242, v242, v165
    v_mfma_f32_16x16x32_bf16 v[144:147], v[216:219], v[108:111], v[144:147]
    v_cvt_pk_bf16_f32 v190, v164, v165
    v_add_f32 v242, v242, v166
    v_mfma_f32_16x16x32_bf16 v[148:151], v[216:219], v[124:127], v[148:151]
    v_add_f32 v242, v242, v167
    v_cvt_pk_bf16_f32 v191, v166, v167
    v_mfma_f32_16x16x32_bf16 v[152:155], v[216:219], v[140:143], v[152:155]
    ds_read_b128 v[212:215], v236 offset:1664
    s_waitcnt lgkmcnt(3)
    v_mfma_f32_16x16x32_bf16 v[0:3], v[220:223], v[180:183], v[0:3]
    v_mfma_f32_16x16x32_bf16 v[32:35], v[220:223], v[184:187], v[32:35]
    v_mfma_f32_16x16x32_bf16 v[64:67], v[220:223], v[188:191], v[64:67]
    ds_read_b128 v[216:219], v236 offset:1728
    v_exp_f32 v144, v144
    v_mfma_f32_16x16x32_bf16 v[4:7], v[224:227], v[180:183], v[4:7]
    v_exp_f32 v145, v145
    v_mfma_f32_16x16x32_bf16 v[36:39], v[224:227], v[184:187], v[36:39]
    v_exp_f32 v146, v146
    v_mfma_f32_16x16x32_bf16 v[68:71], v[224:227], v[188:191], v[68:71]
    ds_read_b64_tr_b16 v[224:225], v237 offset:160
    ds_read_b64_tr_b16 v[226:227], v237 offset:672
    v_exp_f32 v147, v147
    v_mfma_f32_16x16x32_bf16 v[8:11], v[228:231], v[180:183], v[8:11]
    ds_read_b64_tr_b16 v[220:221], v237 offset:128
    ds_read_b64_tr_b16 v[222:223], v237 offset:640
    v_mfma_f32_16x16x32_bf16 v[40:43], v[228:231], v[184:187], v[40:43]
    v_add_f32 v240, v240, v144
    v_mfma_f32_16x16x32_bf16 v[72:75], v[228:231], v[188:191], v[72:75]
    v_exp_f32 v148, v148
    v_add_f32 v240, v240, v145
    v_mfma_f32_16x16x32_bf16 v[12:15], v[232:235], v[180:183], v[12:15]
    v_exp_f32 v149, v149
    v_cvt_pk_bf16_f32 v192, v144, v145
    v_mfma_f32_16x16x32_bf16 v[44:47], v[232:235], v[184:187], v[44:47]
    v_add_f32 v240, v240, v146
    v_exp_f32 v150, v150
    v_mfma_f32_16x16x32_bf16 v[76:79], v[232:235], v[188:191], v[76:79]
    ds_read_b64_tr_b16 v[232:233], v237 offset:224
    ds_read_b64_tr_b16 v[234:235], v237 offset:736
    v_add_f32 v240, v240, v147
    s_waitcnt lgkmcnt(6)
    v_mfma_f32_16x16x32_bf16 v[156:159], v[204:207], v[96:99], v[168:171]
    v_exp_f32 v151, v151
    v_mfma_f32_16x16x32_bf16 v[160:163], v[204:207], v[112:115], v[172:175]
    v_cvt_pk_bf16_f32 v193, v146, v147
    v_add_f32 v241, v241, v148
    v_mfma_f32_16x16x32_bf16 v[164:167], v[204:207], v[128:131], v[176:179]
    ds_read_b64_tr_b16 v[228:229], v237 offset:192
    ds_read_b64_tr_b16 v[230:231], v237 offset:704
    v_mfma_f32_16x16x32_bf16 v[156:159], v[208:211], v[100:103], v[156:159]
    v_exp_f32 v152, v152
    v_add_f32 v241, v241, v149
    v_mfma_f32_16x16x32_bf16 v[160:163], v[208:211], v[116:119], v[160:163]
    v_exp_f32 v153, v153
    v_mfma_f32_16x16x32_bf16 v[164:167], v[208:211], v[132:135], v[164:167]
    v_cvt_pk_bf16_f32 v196, v148, v149
    v_add_f32 v241, v241, v150
    v_mfma_f32_16x16x32_bf16 v[156:159], v[212:215], v[104:107], v[156:159]
    v_exp_f32 v154, v154
    v_add_f32 v241, v241, v151
    v_mfma_f32_16x16x32_bf16 v[160:163], v[212:215], v[120:123], v[160:163]
    v_mfma_f32_16x16x32_bf16 v[164:167], v[212:215], v[136:139], v[164:167]
    v_exp_f32 v155, v155
    v_mfma_f32_16x16x32_bf16 v[156:159], v[216:219], v[108:111], v[156:159]
    v_cvt_pk_bf16_f32 v197, v150, v151
    v_add_f32 v242, v242, v152
    v_mfma_f32_16x16x32_bf16 v[160:163], v[216:219], v[124:127], v[160:163]
    v_add_f32 v242, v242, v153
    v_cvt_pk_bf16_f32 v200, v152, v153
    v_add_f32 v242, v242, v154
    v_mfma_f32_16x16x32_bf16 v[164:167], v[216:219], v[140:143], v[164:167]
    v_add_f32 v242, v242, v155
    v_cvt_pk_bf16_f32 v201, v154, v155
    v_xor_b32 v236, 0x800, v236
    s_waitcnt lgkmcnt(0)
    s_barrier
    s_cmp_eq_u32 s51, 6
    s_cbranch_scc1 L_A3_e15
    s_add_u32 s51, s51, 1
    ds_read_b128 v[204:207], v236 offset:0
    ds_read_b128 v[208:211], v236 offset:64
    ds_read_b128 v[212:215], v236 offset:128
    s_nop 0
    v_mfma_f32_16x16x32_bf16 v[16:19], v[220:223], v[180:183], v[16:19]
    v_mfma_f32_16x16x32_bf16 v[48:51], v[220:223], v[184:187], v[48:51]
    v_exp_f32 v156, v156
    v_mfma_f32_16x16x32_bf16 v[80:83], v[220:223], v[188:191], v[80:83]
    ds_read_b128 v[216:219], v236 offset:192
    ds_read_b64_tr_b16 v[220:221], v237 offset:1024
    ds_read_b64_tr_b16 v[222:223], v237 offset:1536
    v_mfma_f32_16x16x32_bf16 v[20:23], v[224:227], v[180:183], v[20:23]
    v_exp_f32 v157, v157
    v_mfma_f32_16x16x32_bf16 v[52:55], v[224:227], v[184:187], v[52:55]
    v_exp_f32 v158, v158
    v_mfma_f32_16x16x32_bf16 v[84:87], v[224:227], v[188:191], v[84:87]
    v_exp_f32 v159, v159
    v_add_f32 v240, v240, v156
    v_mfma_f32_16x16x32_bf16 v[24:27], v[228:231], v[180:183], v[24:27]
    ds_read_b64_tr_b16 v[224:225], v237 offset:1056
    ds_read_b64_tr_b16 v[226:227], v237 offset:1568
    v_mfma_f32_16x16x32_bf16 v[56:59], v[228:231], v[184:187], v[56:59]
    v_exp_f32 v160, v160
    v_add_f32 v240, v240, v157
    v_mfma_f32_16x16x32_bf16 v[88:91], v[228:231], v[188:191], v[88:91]
    v_exp_f32 v161, v161
    v_mfma_f32_16x16x32_bf16 v[28:31], v[232:235], v[180:183], v[28:31]
    v_cvt_pk_bf16_f32 v194, v156, v157
    v_add_f32 v240, v240, v158
    v_mfma_f32_16x16x32_bf16 v[60:63], v[232:235], v[184:187], v[60:63]
    v_exp_f32 v162, v162
    v_mfma_f32_16x16x32_bf16 v[92:95], v[232:235], v[188:191], v[92:95]
    ds_read_b64_tr_b16 v[232:233], v237 offset:1120
    ds_read_b64_tr_b16 v[234:235], v237 offset:1632
    v_add_f32 v240, v240, v159
    s_waitcnt lgkmcnt(6)
    v_mfma_f32_16x16x32_bf16 v[144:147], v[204:207], v[96:99], v[168:171]
    v_exp_f32 v163, v163
    v_cvt_pk_bf16_f32 v195, v158, v159
    v_mfma_f32_16x16x32_bf16 v[148:151], v[204:207], v[112:115], v[172:175]
    ds_read_b64_tr_b16 v[228:229], v237 offset:1088
    ds_read_b64_tr_b16 v[230:231], v237 offset:1600
    v_mfma_f32_16x16x32_bf16 v[152:155], v[204:207], v[128:131], v[176:179]
    ds_read_b128 v[204:207], v236 offset:512
    v_add_f32 v241, v241, v160
    v_mfma_f32_16x16x32_bf16 v[144:147], v[208:211], v[100:103], v[144:147]
    v_exp_f32 v164, v164
    v_add_f32 v241, v241, v161
    v_mfma_f32_16x16x32_bf16 v[148:151], v[208:211], v[116:119], v[148:151]
    v_exp_f32 v165, v165
    v_mfma_f32_16x16x32_bf16 v[152:155], v[208:211], v[132:135], v[152:155]
    ds_read_b128 v[208:211], v236 offset:576
    v_cvt_pk_bf16_f32 v198, v160, v161
    v_add_f32 v241, v241, v162
    v_mfma_f32_16x16x32_bf16 v[144:147], v[212:215], v[104:107], v[144:147]
    v_exp_f32 v166, v166
    v_mfma_f32_16x16x32_bf16 v[148:151], v[212:215], v[120:123], v[148:151]
    v_add_f32 v241, v241, v163
    v_exp_f32 v167, v167
    v_mfma_f32_16x16x32_bf16 v[152:155], v[212:215], v[136:139], v[152:155]
    v_cvt_pk_bf16_f32 v199, v162, v163
    v_add_f32 v242, v242, v164
    v_add_f32 v242, v242, v165
    v_mfma_f32_16x16x32_bf16 v[144:147], v[216:219], v[108:111], v[144:147]
    v_cvt_pk_bf16_f32 v202, v164, v165
    v_add_f32 v242, v242, v166
    v_mfma_f32_16x16x32_bf16 v[148:151], v[216:219], v[124:127], v[148:151]
    v_add_f32 v242, v242, v167
    v_cvt_pk_bf16_f32 v203, v166, v167
    v_mfma_f32_16x16x32_bf16 v[152:155], v[216:219], v[140:143], v[152:155]
    ds_read_b128 v[212:215], v236 offset:640
    s_waitcnt lgkmcnt(3)
    v_mfma_f32_16x16x32_bf16 v[0:3], v[220:223], v[192:195], v[0:3]
    v_mfma_f32_16x16x32_bf16 v[32:35], v[220:223], v[196:199], v[32:35]
    v_mfma_f32_16x16x32_bf16 v[64:67], v[220:223], v[200:203], v[64:67]
    ds_read_b128 v[216:219], v236 offset:704
    v_exp_f32 v144, v144
    v_mfma_f32_16x16x32_bf16 v[4:7], v[224:227], v[192:195], v[4:7]
    v_exp_f32 v145, v145
    v_mfma_f32_16x16x32_bf16 v[36:39], v[224:227], v[196:199], v[36:39]
    v_exp_f32 v146, v146
    v_mfma_f32_16x16x32_bf16 v[68:71], v[224:227], v[200:203], v[68:71]
    ds_read_b64_tr_b16 v[224:225], v237 offset:1184
    ds_read_b64_tr_b16 v[226:227], v237 offset:1696
    v_exp_f32 v147, v147
    v_mfma_f32_16x16x32_bf16 v[8:11], v[228:231], v[192:195], v[8:11]
    ds_read_b64_tr_b16 v[220:221], v237 offset:1152
    ds_read_b64_tr_b16 v[222:223], v237 offset:1664
    v_mfma_f32_16x16x32_bf16 v[40:43], v[228:231], v[196:199], v[40:43]
    v_add_f32 v240, v240, v144
    v_mfma_f32_16x16x32_bf16 v[72:75], v[228:231], v[200:203], v[72:75]
    v_exp_f32 v148, v148
    v_add_f32 v240, v240, v145
    v_mfma_f32_16x16x32_bf16 v[12:15], v[232:235], v[192:195], v[12:15]
    v_exp_f32 v149, v149
    v_cvt_pk_bf16_f32 v180, v144, v145
    v_mfma_f32_16x16x32_bf16 v[44:47], v[232:235], v[196:199], v[44:47]
    v_add_f32 v240, v240, v146
    v_exp_f32 v150, v150
    v_mfma_f32_16x16x32_bf16 v[76:79], v[232:235], v[200:203], v[76:79]
    ds_read_b64_tr_b16 v[232:233], v237 offset:1248
    ds_read_b64_tr_b16 v[234:235], v237 offset:1760
    v_add_f32 v240, v240, v147
    s_waitcnt lgkmcnt(6)
    v_mfma_f32_16x16x32_bf16 v[156:159], v[204:207], v[96:99], v[168:171]
    v_exp_f32 v151, v151
    v_mfma_f32_16x16x32_bf16 v[160:163], v[204:207], v[112:115], v[172:175]
    v_cvt_pk_bf16_f32 v181, v146, v147
    v_add_f32 v241, v241, v148
    v_mfma_f32_16x16x32_bf16 v[164:167], v[204:207], v[128:131], v[176:179]
    ds_read_b64_tr_b16 v[228:229], v237 offset:1216
    ds_read_b64_tr_b16 v[230:231], v237 offset:1728
    v_mfma_f32_16x16x32_bf16 v[156:159], v[208:211], v[100:103], v[156:159]
    v_exp_f32 v152, v152
    v_add_f32 v241, v241, v149
    v_mfma_f32_16x16x32_bf16 v[160:163], v[208:211], v[116:119], v[160:163]
    v_exp_f32 v153, v153
    v_mfma_f32_16x16x32_bf16 v[164:167], v[208:211], v[132:135], v[164:167]
    v_cvt_pk_bf16_f32 v184, v148, v149
    v_add_f32 v241, v241, v150
    v_mfma_f32_16x16x32_bf16 v[156:159], v[212:215], v[104:107], v[156:159]
    v_exp_f32 v154, v154
    v_add_f32 v241, v241, v151
    v_mfma_f32_16x16x32_bf16 v[160:163], v[212:215], v[120:123], v[160:163]
    v_mfma_f32_16x16x32_bf16 v[164:167], v[212:215], v[136:139], v[164:167]
    v_exp_f32 v155, v155
    v_mfma_f32_16x16x32_bf16 v[156:159], v[216:219], v[108:111], v[156:159]
    v_cvt_pk_bf16_f32 v185, v150, v151
    v_add_f32 v242, v242, v152
    v_mfma_f32_16x16x32_bf16 v[160:163], v[216:219], v[124:127], v[160:163]
    v_add_f32 v242, v242, v153
    v_cvt_pk_bf16_f32 v188, v152, v153
    v_add_f32 v242, v242, v154
    v_mfma_f32_16x16x32_bf16 v[164:167], v[216:219], v[140:143], v[164:167]
    v_add_f32 v242, v242, v155
    v_cvt_pk_bf16_f32 v189, v154, v155
    v_xor_b32 v237, 0x800, v237
    s_waitcnt lgkmcnt(0)
    s_barrier
    s_branch L_A3_loop
L_A3_e15:
    s_cmp_eq_u32 s50, 3
    s_cbranch_scc1 L_A3_last
    s_add_u32 s50, s50, 1
    ds_read_b64_tr_b16 v[204:205], v237 offset:1024
    ds_read_b64_tr_b16 v[206:207], v237 offset:1536
    s_nop 1
    v_mfma_f32_16x16x32_bf16 v[16:19], v[220:223], v[180:183], v[16:19]
    ds_read_b64_tr_b16 v[208:209], v237 offset:1056
    ds_read_b64_tr_b16 v[210:211], v237 offset:1568
    v_mfma_f32_16x16x32_bf16 v[48:51], v[220:223], v[184:187], v[48:51]
    ds_read_b64_tr_b16 v[212:213], v237 offset:1088
    ds_read_b64_tr_b16 v[214:215], v237 offset:1600
    v_exp_f32 v156, v156
    v_exp_f32 v157, v157
    v_mfma_f32_16x16x32_bf16 v[80:83], v[220:223], v[188:191], v[80:83]
    ds_read_b64_tr_b16 v[220:221], v237 offset:1152
    ds_read_b64_tr_b16 v[222:223], v237 offset:1664
    ds_read_b64_tr_b16 v[216:217], v237 offset:1120
    ds_read_b64_tr_b16 v[218:219], v237 offset:1632
    v_exp_f32 v158, v158
    v_mfma_f32_16x16x32_bf16 v[20:23], v[224:227], v[180:183], v[20:23]
    v_exp_f32 v159, v159
    v_add_f32 v240, v240, v156
    v_exp_f32 v160, v160
    v_mfma_f32_16x16x32_bf16 v[52:55], v[224:227], v[184:187], v[52:55]
    v_add_f32 v240, v240, v157
    v_exp_f32 v161, v161
    v_cvt_pk_bf16_f32 v194, v156, v157
    v_mfma_f32_16x16x32_bf16 v[84:87], v[224:227], v[188:191], v[84:87]
    ds_read_b64_tr_b16 v[224:225], v237 offset:1184
    ds_read_b64_tr_b16 v[226:227], v237 offset:1696
    v_add_f32 v240, v240, v158
    v_exp_f32 v162, v162
    v_mfma_f32_16x16x32_bf16 v[24:27], v[228:231], v[180:183], v[24:27]
    v_add_f32 v240, v240, v159
    v_exp_f32 v163, v163
    v_cvt_pk_bf16_f32 v195, v158, v159
    v_add_f32 v241, v241, v160
    v_mfma_f32_16x16x32_bf16 v[56:59], v[228:231], v[184:187], v[56:59]
    v_exp_f32 v164, v164
    v_add_f32 v241, v241, v161
    v_exp_f32 v165, v165
    v_cvt_pk_bf16_f32 v198, v160, v161
    v_mfma_f32_16x16x32_bf16 v[88:91], v[228:231], v[188:191], v[88:91]
    ds_read_b64_tr_b16 v[228:229], v237 offset:1216
    ds_read_b64_tr_b16 v[230:231], v237 offset:1728
    v_add_f32 v241, v241, v162
    v_exp_f32 v166, v166
    v_mfma_f32_16x16x32_bf16 v[28:31], v[232:235], v[180:183], v[28:31]
    v_add_f32 v241, v241, v163
    v_exp_f32 v167, v167
    v_cvt_pk_bf16_f32 v199, v162, v163
    v_add_f32 v242, v242, v164
    v_mfma_f32_16x16x32_bf16 v[60:63], v[232:235], v[184:187], v[60:63]
    v_add_f32 v242, v242, v165
    v_cvt_pk_bf16_f32 v202, v164, v165
    v_add_f32 v242, v242, v166
    v_add_f32 v242, v242, v167
    v_cvt_pk_bf16_f32 v203, v166, v167
    v_mfma_f32_16x16x32_bf16 v[92:95], v[232:235], v[188:191], v[92:95]
    ds_read_b64_tr_b16 v[232:233], v237 offset:1248
    ds_read_b64_tr_b16 v[234:235], v237 offset:1760
    v_mov_b32 v243, v240
    v_mov_b32 v244, v241
    v_mov_b32 v245, v242
    s_waitcnt lgkmcnt(14)
    v_mfma_f32_16x16x32_bf16 v[0:3], v[204:207], v[192:195], v[0:3]
    v_mov_b32 v246, v243
    v_mov_b32 v247, v244
    v_mov_b32 v248, v245
    v_mfma_f32_16x16x32_bf16 v[32:35], v[204:207], v[196:199], v[32:35]
    v_permlane16_swap_b32 v243, v246
    v_permlane16_swap_b32 v244, v247
    v_permlane16_swap_b32 v245, v248
    v_add_f32 v243, v243, v246
    v_mfma_f32_16x16x32_bf16 v[64:67], v[204:207], v[200:203], v[64:67]
    v_add_f32 v244, v244, v247
    v_add_f32 v245, v245, v248
    v_mov_b32 v246, v243
    v_mov_b32 v247, v244
    s_waitcnt lgkmcnt(12)
    v_mfma_f32_16x16x32_bf16 v[4:7], v[208:211], v[192:195], v[4:7]
    v_mov_b32 v248, v245
    v_permlane32_swap_b32 v243, v246
    v_permlane32_swap_b32 v244, v247
    v_permlane32_swap_b32 v245, v248
    v_mfma_f32_16x16x32_bf16 v[36:39], v[208:211], v[196:199], v[36:39]
    v_add_f32 v243, v243, v246
    v_add_f32 v244, v244, v247
    v_add_f32 v245, v245, v248
    v_cmp_ngt_f32 vcc, s56, v243
    v_mfma_f32_16x16x32_bf16 v[68:71], v[208:211], v[200:203], v[68:71]
    s_or_b64 s[48:49], s[48:49], vcc
    v_rcp_f32 v243, v243
    s_waitcnt lgkmcnt(10)
    v_mfma_f32_16x16x32_bf16 v[8:11], v[212:215], v[192:195], v[8:11]
    v_cmp_ngt_f32 vcc, s56, v244
    s_or_b64 s[48:49], s[48:49], vcc
    v_rcp_f32 v244, v244
    v_mfma_f32_16x16x32_bf16 v[40:43], v[212:215], v[196:199], v[40:43]
    v_cmp_ngt_f32 vcc, s56, v245
    s_or_b64 s[48:49], s[48:49], vcc
    v_rcp_f32 v245, v245
    v_mfma_f32_16x16x32_bf16 v[72:75], v[212:215], v[200:203], v[72:75]
    v_mul_f32 v0, v0, v243
    v_mul_f32 v1, v1, v243
    v_mul_f32 v2, v2, v243
    v_mul_f32 v3, v3, v243
    v_mul_f32 v4, v4, v243
    s_waitcnt lgkmcnt(6)
    v_mfma_f32_16x16x32_bf16 v[12:15], v[216:219], v[192:195], v[12:15]
    v_mul_f32 v5, v5, v243
    v_mul_f32 v6, v6, v243
    v_mul_f32 v7, v7, v243
    v_cvt_pk_bf16_f32 v0, v0, v1
    v_mfma_f32_16x16x32_bf16 v[44:47], v[216:219], v[196:199], v[44:47]
    v_cvt_pk_bf16_f32 v1, v2, v3
    v_cvt_pk_bf16_f32 v2, v4, v5
    v_cvt_pk_bf16_f32 v3, v6, v7
    v_mul_f32 v32, v32, v244
    v_mul_f32 v33, v33, v244
    v_mfma_f32_16x16x32_bf16 v[76:79], v[216:219], v[200:203], v[76:79]
    v_mul_f32 v34, v34, v244
    v_mul_f32 v35, v35, v244
    v_mul_f32 v36, v36, v244
    v_mul_f32 v37, v37, v244
    v_mfma_f32_16x16x32_bf16 v[16:19], v[220:223], v[192:195], v[16:19]
    v_mul_f32 v38, v38, v244
    v_mul_f32 v39, v39, v244
    v_cvt_pk_bf16_f32 v32, v32, v33
    v_cvt_pk_bf16_f32 v33, v34, v35
    v_cvt_pk_bf16_f32 v34, v36, v37
    v_mfma_f32_16x16x32_bf16 v[48:51], v[220:223], v[196:199], v[48:51]
    v_cvt_pk_bf16_f32 v35, v38, v39
    v_mul_f32 v64, v64, v245
    v_mul_f32 v65, v65, v245
    v_mul_f32 v66, v66, v245
    v_mfma_f32_16x16x32_bf16 v[80:83], v[220:223], v[200:203], v[80:83]
    v_mul_f32 v67, v67, v245
    v_mul_f32 v68, v68, v245
    v_mul_f32 v69, v69, v245
    v_mul_f32 v70, v70, v245
    v_mul_f32 v71, v71, v245
    s_waitcnt lgkmcnt(4)
    v_mfma_f32_16x16x32_bf16 v[20:23], v[224:227], v[192:195], v[20:23]
    v_cvt_pk_bf16_f32 v64, v64, v65
    v_cvt_pk_bf16_f32 v65, v66, v67
    v_cvt_pk_bf16_f32 v66, v68, v69
    v_cvt_pk_bf16_f32 v67, v70, v71
    v_mfma_f32_16x16x32_bf16 v[52:55], v[224:227], v[196:199], v[52:55]
    v_mul_f32 v8, v8, v243
    v_mul_f32 v9, v9, v243
    v_mul_f32 v10, v10, v243
    v_mul_f32 v11, v11, v243
    v_mul_f32 v12, v12, v243
    v_mfma_f32_16x16x32_bf16 v[84:87], v[224:227], v[200:203], v[84:87]
    v_mul_f32 v13, v13, v243
    v_mul_f32 v14, v14, v243
    v_mul_f32 v15, v15, v243
    v_cvt_pk_bf16_f32 v8, v8, v9
    s_waitcnt lgkmcnt(2)
    v_mfma_f32_16x16x32_bf16 v[24:27], v[228:231], v[192:195], v[24:27]
    v_cvt_pk_bf16_f32 v9, v10, v11
    v_cvt_pk_bf16_f32 v10, v12, v13
    v_cvt_pk_bf16_f32 v11, v14, v15
    v_mul_f32 v40, v40, v244
    v_mul_f32 v41, v41, v244
    v_mfma_f32_16x16x32_bf16 v[56:59], v[228:231], v[196:199], v[56:59]
    v_mul_f32 v42, v42, v244
    v_mul_f32 v43, v43, v244
    v_mul_f32 v44, v44, v244
    v_mul_f32 v45, v45, v244
    v_mfma_f32_16x16x32_bf16 v[88:91], v[228:231], v[200:203], v[88:91]
    v_mul_f32 v46, v46, v244
    v_mul_f32 v47, v47, v244
    v_cvt_pk_bf16_f32 v40, v40, v41
    v_cvt_pk_bf16_f32 v41, v42, v43
    v_cvt_pk_bf16_f32 v42, v44, v45
    s_waitcnt lgkmcnt(0)
    v_mfma_f32_16x16x32_bf16 v[28:31], v[232:235], v[192:195], v[28:31]
    v_cvt_pk_bf16_f32 v43, v46, v47
    v_mul_f32 v72, v72, v245
    v_mul_f32 v73, v73, v245
    v_mul_f32 v74, v74, v245
    v_mfma_f32_16x16x32_bf16 v[60:63], v[232:235], v[196:199], v[60:63]
    v_mul_f32 v75, v75, v245
    v_mul_f32 v76, v76, v245
    v_mul_f32 v77, v77, v245
    v_mul_f32 v78, v78, v245
    v_mul_f32 v79, v79, v245
    v_mfma_f32_16x16x32_bf16 v[92:95], v[232:235], v[200:203], v[92:95]
    v_cvt_pk_bf16_f32 v72, v72, v73
    v_cvt_pk_bf16_f32 v73, v74, v75
    v_cvt_pk_bf16_f32 v74, v76, v77
    v_cvt_pk_bf16_f32 v75, v78, v79
    v_xor_b32 v237, 0x800, v237
    s_waitcnt lgkmcnt(0)
    s_barrier
    ds_read_b128 v[204:207], v236 offset:0
    ds_read_b128 v[96:99], v239 offset:0
    ds_read_b128 v[112:115], v239 offset:4096
    ds_read_b128 v[128:131], v239 offset:8192
    ds_read_b128 v[208:211], v236 offset:64
    ds_read_b128 v[100:103], v239 offset:1024
    ds_read_b128 v[116:119], v239 offset:5120
    ds_read_b128 v[132:135], v239 offset:9216
    s_waitcnt lgkmcnt(6)
    v_mfma_f32_16x16x32_bf16 v[144:147], v[204:207], v[96:99], 0
    ds_read_b128 v[212:215], v236 offset:128
    ds_read_b128 v[104:107], v239 offset:2048
    s_waitcnt lgkmcnt(7)
    v_mfma_f32_16x16x32_bf16 v[148:151], v[204:207], v[112:115], 0
    ds_read_b128 v[120:123], v239 offset:6144
    s_waitcnt lgkmcnt(7)
    v_mfma_f32_16x16x32_bf16 v[152:155], v[204:207], v[128:131], 0
    ds_read_b128 v[136:139], v239 offset:10240
    s_waitcnt lgkmcnt(6)
    v_mfma_f32_16x16x32_bf16 v[144:147], v[208:211], v[100:103], v[144:147]
    ds_read_b128 v[216:219], v236 offset:192
    s_waitcnt lgkmcnt(6)
    v_mfma_f32_16x16x32_bf16 v[148:151], v[208:211], v[116:119], v[148:151]
    ds_read_b128 v[108:111], v239 offset:3072
    s_waitcnt lgkmcnt(6)
    v_mfma_f32_16x16x32_bf16 v[152:155], v[208:211], v[132:135], v[152:155]
    ds_read_b128 v[124:127], v239 offset:7168
    ds_read_b128 v[140:143], v239 offset:11264
    s_waitcnt lgkmcnt(6)
    v_mfma_f32_16x16x32_bf16 v[144:147], v[212:215], v[104:107], v[144:147]
    ds_read_b128 v[220:223], v236 offset:512
    s_waitcnt lgkmcnt(6)
    v_mfma_f32_16x16x32_bf16 v[148:151], v[212:215], v[120:123], v[148:151]
    ds_read_b128 v[224:227], v236 offset:576
    s_waitcnt lgkmcnt(6)
    v_mfma_f32_16x16x32_bf16 v[152:155], v[212:215], v[136:139], v[152:155]
    ds_read_b128 v[228:231], v236 offset:640
    s_waitcnt lgkmcnt(5)
    v_mfma_f32_16x16x32_bf16 v[144:147], v[216:219], v[108:111], v[144:147]
    ds_read_b128 v[232:235], v236 offset:704
    s_waitcnt lgkmcnt(5)
    v_mfma_f32_16x16x32_bf16 v[148:151], v[216:219], v[124:127], v[148:151]
    s_waitcnt lgkmcnt(4)
    v_mfma_f32_16x16x32_bf16 v[152:155], v[216:219], v[140:143], v[152:155]
    s_nop 2
    v_max3_f32 v171, v144, v145, v146
    s_nop 1
    v_max3_f32 v175, v148, v149, v150
    s_nop 0
    v_max3_f32 v179, v152, v153, v154
    v_max_f32 v171, v171, v147
    v_max_f32 v175, v175, v151
    v_max_f32 v179, v179, v155
    ds_write_b128 v239, v[0:3] offset:0
    v_mov_b32 v168, v171
    v_mov_b32 v172, v175
    v_mov_b32 v176, v179
    v_permlane16_swap_b32 v171, v168
    v_permlane16_swap_b32 v175, v172
    v_permlane16_swap_b32 v179, v176
    v_max_f32 v171, v171, v168
    v_max_f32 v175, v175, v172
    v_max_f32 v179, v179, v176
    v_mov_b32 v168, v171
    v_mov_b32 v172, v175
    v_mov_b32 v176, v179
    ds_write_b128 v239, v[32:35] offset:4096
    v_permlane32_swap_b32 v171, v168
    v_permlane32_swap_b32 v175, v172
    v_permlane32_swap_b32 v179, v176
    v_max_f32 v171, v171, v168
    v_max_f32 v175, v175, v172
    v_max_f32 v179, v179, v176
    v_sub_f32 v168, 0, v171
    v_sub_f32 v172, 0, v175
    v_sub_f32 v176, 0, v179
    v_sub_f32 v169, 0, v171
    v_sub_f32 v173, 0, v175
    v_sub_f32 v177, 0, v179
    ds_write_b128 v239, v[64:67] offset:8192
    v_sub_f32 v170, 0, v171
    v_sub_f32 v174, 0, v175
    v_sub_f32 v178, 0, v179
    v_sub_f32 v171, 0, v171
    v_sub_f32 v175, 0, v175
    v_sub_f32 v179, 0, v179
    s_waitcnt lgkmcnt(6)
    v_mfma_f32_16x16x32_bf16 v[156:159], v[220:223], v[96:99], v[168:171]
    v_add_f32 v144, v144, v168
    v_add_f32 v145, v145, v168
    v_add_f32 v146, v146, v168
    v_add_f32 v147, v147, v168
    v_add_f32 v148, v148, v172
    v_mfma_f32_16x16x32_bf16 v[160:163], v[220:223], v[112:115], v[172:175]
    v_add_f32 v149, v149, v172
    v_add_f32 v150, v150, v172
    ds_write_b128 v239, v[8:11] offset:1024
    v_mfma_f32_16x16x32_bf16 v[164:167], v[220:223], v[128:131], v[176:179]
    v_add_f32 v151, v151, v172
    v_add_f32 v152, v152, v176
    v_add_f32 v153, v153, v176
    v_add_f32 v154, v154, v176
    v_add_f32 v155, v155, v176
    s_waitcnt lgkmcnt(6)
    v_mfma_f32_16x16x32_bf16 v[156:159], v[224:227], v[100:103], v[156:159]
    v_exp_f32 v144, v144
    v_exp_f32 v145, v145
    v_exp_f32 v146, v146
    v_mfma_f32_16x16x32_bf16 v[160:163], v[224:227], v[116:119], v[160:163]
    v_exp_f32 v147, v147
    v_add_f32 v240, v144, v145
    v_exp_f32 v148, v148
    v_mfma_f32_16x16x32_bf16 v[164:167], v[224:227], v[132:135], v[164:167]
    v_cvt_pk_bf16_f32 v180, v144, v145
    v_exp_f32 v149, v149
    s_waitcnt lgkmcnt(5)
    v_mfma_f32_16x16x32_bf16 v[156:159], v[228:231], v[104:107], v[156:159]
    ds_write_b128 v239, v[40:43] offset:5120
    v_add_f32 v240, v240, v146
    v_mfma_f32_16x16x32_bf16 v[160:163], v[228:231], v[120:123], v[160:163]
    v_exp_f32 v150, v150
    v_add_f32 v240, v240, v147
    v_exp_f32 v151, v151
    v_cvt_pk_bf16_f32 v181, v146, v147
    v_mfma_f32_16x16x32_bf16 v[164:167], v[228:231], v[136:139], v[164:167]
    v_add_f32 v241, v148, v149
    v_exp_f32 v152, v152
    v_cvt_pk_bf16_f32 v184, v148, v149
    v_exp_f32 v153, v153
    s_waitcnt lgkmcnt(5)
    v_mfma_f32_16x16x32_bf16 v[156:159], v[232:235], v[108:111], v[156:159]
    v_add_f32 v241, v241, v150
    v_exp_f32 v154, v154
    v_add_f32 v241, v241, v151
    v_exp_f32 v155, v155
    v_mfma_f32_16x16x32_bf16 v[160:163], v[232:235], v[124:127], v[160:163]
    ds_write_b128 v239, v[72:75] offset:9216
    v_cvt_pk_bf16_f32 v185, v150, v151
    v_mfma_f32_16x16x32_bf16 v[164:167], v[232:235], v[140:143], v[164:167]
    v_add_f32 v242, v152, v153
    v_cvt_pk_bf16_f32 v188, v152, v153
    v_add_f32 v242, v242, v154
    v_add_f32 v242, v242, v155
    v_cvt_pk_bf16_f32 v189, v154, v155
    s_waitcnt lgkmcnt(0)
    s_barrier
    ds_read_b128 v[204:207], v236 offset:1024
    ds_read_b128 v[208:211], v236 offset:1088
    ds_read_b128 v[212:215], v236 offset:1152
    ds_read_b128 v[216:219], v236 offset:1216
    s_waitcnt lgkmcnt(3)
    v_mfma_f32_16x16x32_bf16 v[144:147], v[204:207], v[96:99], v[168:171]
    ds_read_b64_tr_b16 v[220:221], v237 offset:0
    ds_read_b64_tr_b16 v[222:223], v237 offset:512
    v_exp_f32 v156, v156
    v_exp_f32 v157, v157
    v_mfma_f32_16x16x32_bf16 v[148:151], v[204:207], v[112:115], v[172:175]
    v_exp_f32 v158, v158
    v_exp_f32 v159, v159
    v_mfma_f32_16x16x32_bf16 v[152:155], v[204:207], v[128:131], v[176:179]
    ds_read_b128 v[204:207], v236 offset:1536
    ds_read_b64_tr_b16 v[224:225], v237 offset:32
    ds_read_b64_tr_b16 v[226:227], v237 offset:544
    v_add_f32 v240, v240, v156
    s_waitcnt lgkmcnt(7)
    v_mfma_f32_16x16x32_bf16 v[144:147], v[208:211], v[100:103], v[144:147]
    ds_read_b64_tr_b16 v[228:229], v237 offset:64
    ds_read_b64_tr_b16 v[230:231], v237 offset:576
    v_exp_f32 v160, v160
    v_add_f32 v240, v240, v157
    v_mfma_f32_16x16x32_bf16 v[148:151], v[208:211], v[116:119], v[148:151]
    v_exp_f32 v161, v161
    v_cvt_pk_bf16_f32 v182, v156, v157
    v_add_f32 v240, v240, v158
    v_exp_f32 v162, v162
    v_mfma_f32_16x16x32_bf16 v[152:155], v[208:211], v[132:135], v[152:155]
    ds_read_b128 v[208:211], v236 offset:1600
    ds_read_b64_tr_b16 v[232:233], v237 offset:96
    ds_read_b64_tr_b16 v[234:235], v237 offset:608
    v_add_f32 v240, v240, v159
    s_waitcnt lgkmcnt(11)
    v_mfma_f32_16x16x32_bf16 v[144:147], v[212:215], v[104:107], v[144:147]
    v_exp_f32 v163, v163
    v_cvt_pk_bf16_f32 v183, v158, v159
    v_add_f32 v241, v241, v160
    v_exp_f32 v164, v164
    v_mfma_f32_16x16x32_bf16 v[148:151], v[212:215], v[120:123], v[148:151]
    v_add_f32 v241, v241, v161
    v_exp_f32 v165, v165
    v_cvt_pk_bf16_f32 v186, v160, v161
    v_mfma_f32_16x16x32_bf16 v[152:155], v[212:215], v[136:139], v[152:155]
    ds_read_b128 v[212:215], v236 offset:1664
    v_add_f32 v241, v241, v162
    v_exp_f32 v166, v166
    v_add_f32 v241, v241, v163
    s_waitcnt lgkmcnt(11)
    v_mfma_f32_16x16x32_bf16 v[144:147], v[216:219], v[108:111], v[144:147]
    v_exp_f32 v167, v167
    v_cvt_pk_bf16_f32 v187, v162, v163
    v_add_f32 v242, v242, v164
    v_mfma_f32_16x16x32_bf16 v[148:151], v[216:219], v[124:127], v[148:151]
    v_add_f32 v242, v242, v165
    v_cvt_pk_bf16_f32 v190, v164, v165
    v_add_f32 v242, v242, v166
    v_add_f32 v242, v242, v167
    v_cvt_pk_bf16_f32 v191, v166, v167
    v_mfma_f32_16x16x32_bf16 v[152:155], v[216:219], v[140:143], v[152:155]
    ds_read_b128 v[216:219], v236 offset:1728
    s_waitcnt lgkmcnt(2)
    v_mfma_f32_16x16x32_bf16 v[0:3], v[220:223], v[180:183], 0
    v_mfma_f32_16x16x32_bf16 v[32:35], v[220:223], v[184:187], 0
    v_mfma_f32_16x16x32_bf16 v[64:67], v[220:223], v[188:191], 0
    ds_read_b64_tr_b16 v[220:221], v237 offset:128
    ds_read_b64_tr_b16 v[222:223], v237 offset:640
    v_mul_f32 v16, v16, v243
    v_exp_f32 v144, v144
    v_mul_f32 v17, v17, v243
    v_mfma_f32_16x16x32_bf16 v[4:7], v[224:227], v[180:183], 0
    v_mul_f32 v18, v18, v243
    v_mul_f32 v19, v19, v243
    v_exp_f32 v145, v145
    v_mul_f32 v20, v20, v243
    v_mul_f32 v21, v21, v243
    v_exp_f32 v146, v146
    v_mfma_f32_16x16x32_bf16 v[36:39], v[224:227], v[184:187], 0
    v_mul_f32 v22, v22, v243
    v_mul_f32 v23, v23, v243
    v_cvt_pk_bf16_f32 v16, v16, v17
    v_exp_f32 v147, v147
    v_cvt_pk_bf16_f32 v17, v18, v19
    v_mfma_f32_16x16x32_bf16 v[68:71], v[224:227], v[188:191], 0
    ds_read_b64_tr_b16 v[224:225], v237 offset:160
    ds_read_b64_tr_b16 v[226:227], v237 offset:672
    v_cvt_pk_bf16_f32 v18, v20, v21
    v_cvt_pk_bf16_f32 v19, v22, v23
    v_add_f32 v240, v240, v144
    v_mfma_f32_16x16x32_bf16 v[8:11], v[228:231], v[180:183], 0
    ds_write_b128 v239, v[16:19] offset:2048
    v_mul_f32 v48, v48, v244
    v_exp_f32 v148, v148
    v_mul_f32 v49, v49, v244
    v_mfma_f32_16x16x32_bf16 v[40:43], v[228:231], v[184:187], 0
    v_mul_f32 v50, v50, v244
    v_mul_f32 v51, v51, v244
    v_add_f32 v240, v240, v145
    v_mul_f32 v52, v52, v244
    v_mul_f32 v53, v53, v244
    v_exp_f32 v149, v149
    v_mfma_f32_16x16x32_bf16 v[72:75], v[228:231], v[188:191], 0
    ds_read_b64_tr_b16 v[228:229], v237 offset:192
    ds_read_b64_tr_b16 v[230:231], v237 offset:704
    v_mul_f32 v54, v54, v244
    v_mul_f32 v55, v55, v244
    v_cvt_pk_bf16_f32 v48, v48, v49
    v_cvt_pk_bf16_f32 v192, v144, v145
    v_mfma_f32_16x16x32_bf16 v[12:15], v[232:235], v[180:183], 0
    v_cvt_pk_bf16_f32 v49, v50, v51
    v_cvt_pk_bf16_f32 v50, v52, v53
    v_cvt_pk_bf16_f32 v51, v54, v55
    v_add_f32 v240, v240, v146
    ds_write_b128 v239, v[48:51] offset:6144
    v_mfma_f32_16x16x32_bf16 v[44:47], v[232:235], v[184:187], 0
    v_mul_f32 v80, v80, v245
    v_exp_f32 v150, v150
    v_mul_f32 v81, v81, v245
    v_mul_f32 v82, v82, v245
    v_mfma_f32_16x16x32_bf16 v[76:79], v[232:235], v[188:191], 0
    ds_read_b64_tr_b16 v[232:233], v237 offset:224
    ds_read_b64_tr_b16 v[234:235], v237 offset:736
    v_mul_f32 v83, v83, v245
    v_add_f32 v240, v240, v147
    v_mul_f32 v84, v84, v245
    v_mul_f32 v85, v85, v245
    s_waitcnt lgkmcnt(10)
    v_mfma_f32_16x16x32_bf16 v[156:159], v[204:207], v[96:99], v[168:171]
    v_exp_f32 v151, v151
    v_mul_f32 v86, v86, v245
    v_mul_f32 v87, v87, v245
    v_cvt_pk_bf16_f32 v80, v80, v81
    v_cvt_pk_bf16_f32 v193, v146, v147
    v_cvt_pk_bf16_f32 v81, v82, v83
    v_cvt_pk_bf16_f32 v82, v84, v85
    v_mfma_f32_16x16x32_bf16 v[160:163], v[204:207], v[112:115], v[172:175]
    v_cvt_pk_bf16_f32 v83, v86, v87
    v_add_f32 v241, v241, v148
    ds_write_b128 v239, v[80:83] offset:10240
    v_mfma_f32_16x16x32_bf16 v[164:167], v[204:207], v[128:131], v[176:179]
    v_mul_f32 v24, v24, v243
    v_exp_f32 v152, v152
    v_mul_f32 v25, v25, v243
    v_mul_f32 v26, v26, v243
    v_mul_f32 v27, v27, v243
    v_add_f32 v241, v241, v149
    v_mfma_f32_16x16x32_bf16 v[156:159], v[208:211], v[100:103], v[156:159]
    v_mul_f32 v28, v28, v243
    v_mul_f32 v29, v29, v243
    v_exp_f32 v153, v153
    v_mul_f32 v30, v30, v243
    v_mul_f32 v31, v31, v243
    v_cvt_pk_bf16_f32 v24, v24, v25
    v_mfma_f32_16x16x32_bf16 v[160:163], v[208:211], v[116:119], v[160:163]
    v_cvt_pk_bf16_f32 v196, v148, v149
    v_cvt_pk_bf16_f32 v25, v26, v27
    v_cvt_pk_bf16_f32 v26, v28, v29
    v_cvt_pk_bf16_f32 v27, v30, v31
    v_add_f32 v241, v241, v150
    v_mfma_f32_16x16x32_bf16 v[164:167], v[208:211], v[132:135], v[164:167]
    ds_write_b128 v239, v[24:27] offset:3072
    v_mul_f32 v56, v56, v244
    v_exp_f32 v154, v154
    v_mul_f32 v57, v57, v244
    v_mfma_f32_16x16x32_bf16 v[156:159], v[212:215], v[104:107], v[156:159]
    v_mul_f32 v58, v58, v244
    v_mul_f32 v59, v59, v244
    v_add_f32 v241, v241, v151
    v_mul_f32 v60, v60, v244
    v_mul_f32 v61, v61, v244
    v_exp_f32 v155, v155
    v_mfma_f32_16x16x32_bf16 v[160:163], v[212:215], v[120:123], v[160:163]
    v_mul_f32 v62, v62, v244
    v_mul_f32 v63, v63, v244
    v_cvt_pk_bf16_f32 v56, v56, v57
    v_cvt_pk_bf16_f32 v197, v150, v151
    v_cvt_pk_bf16_f32 v57, v58, v59
    v_cvt_pk_bf16_f32 v58, v60, v61
    v_mfma_f32_16x16x32_bf16 v[164:167], v[212:215], v[136:139], v[164:167]
    v_cvt_pk_bf16_f32 v59, v62, v63
    v_add_f32 v242, v242, v152
    ds_write_b128 v239, v[56:59] offset:7168
    v_mul_f32 v88, v88, v245
    v_mfma_f32_16x16x32_bf16 v[156:159], v[216:219], v[108:111], v[156:159]
    v_add_f32 v242, v242, v153
    v_mul_f32 v89, v89, v245
    v_mul_f32 v90, v90, v245
    v_mul_f32 v91, v91, v245
    v_cvt_pk_bf16_f32 v200, v152, v153
    v_mul_f32 v92, v92, v245
    v_mul_f32 v93, v93, v245
    v_mfma_f32_16x16x32_bf16 v[160:163], v[216:219], v[124:127], v[160:163]
    v_add_f32 v242, v242, v154
    v_mul_f32 v94, v94, v245
    v_mul_f32 v95, v95, v245
    v_cvt_pk_bf16_f32 v88, v88, v89
    v_add_f32 v242, v242, v155
    v_cvt_pk_bf16_f32 v89, v90, v91
    v_mfma_f32_16x16x32_bf16 v[164:167], v[216:219], v[140:143], v[164:167]
    v_cvt_pk_bf16_f32 v90, v92, v93
    v_cvt_pk_bf16_f32 v91, v94, v95
    v_cvt_pk_bf16_f32 v201, v154, v155
    ds_write_b128 v239, v[88:91] offset:11264
    v_xor_b32 v236, 0x800, v236
    s_waitcnt lgkmcnt(0)
    s_barrier
    s_branch L_A3_e1
L_A3_last:
    ds_read_b64_tr_b16 v[204:205], v237 offset:1024
    ds_read_b64_tr_b16 v[206:207], v237 offset:1536
    s_nop 1
    v_mfma_f32_16x16x32_bf16 v[16:19], v[220:223], v[180:183], v[16:19]
    ds_read_b64_tr_b16 v[208:209], v237 offset:1056
    ds_read_b64_tr_b16 v[210:211], v237 offset:1568
    v_mfma_f32_16x16x32_bf16 v[48:51], v[220:223], v[184:187], v[48:51]
    ds_read_b64_tr_b16 v[212:213], v237 offset:1088
    ds_read_b64_tr_b16 v[214:215], v237 offset:1600
    v_exp_f32 v156, v156
    v_exp_f32 v157, v157
    v_mfma_f32_16x16x32_bf16 v[80:83], v[220:223], v[188:191], v[80:83]
    ds_read_b64_tr_b16 v[220:221], v237 offset:1152
    ds_read_b64_tr_b16 v[222:223], v237 offset:1664
    ds_read_b64_tr_b16 v[216:217], v237 offset:1120
    ds_read_b64_tr_b16 v[218:219], v237 offset:1632
    v_exp_f32 v158, v158
    v_mfma_f32_16x16x32_bf16 v[20:23], v[224:227], v[180:183], v[20:23]
    v_exp_f32 v159, v159
    v_add_f32 v240, v240, v156
    v_exp_f32 v160, v160
    v_mfma_f32_16x16x32_bf16 v[52:55], v[224:227], v[184:187], v[52:55]
    v_add_f32 v240, v240, v157
    v_exp_f32 v161, v161
    v_cvt_pk_bf16_f32 v194, v156, v157
    v_mfma_f32_16x16x32_bf16 v[84:87], v[224:227], v[188:191], v[84:87]
    ds_read_b64_tr_b16 v[224:225], v237 offset:1184
    ds_read_b64_tr_b16 v[226:227], v237 offset:1696
    v_add_f32 v240, v240, v158
    v_exp_f32 v162, v162
    v_mfma_f32_16x16x32_bf16 v[24:27], v[228:231], v[180:183], v[24:27]
    v_add_f32 v240, v240, v159
    v_exp_f32 v163, v163
    v_cvt_pk_bf16_f32 v195, v158, v159
    v_add_f32 v241, v241, v160
    v_mfma_f32_16x16x32_bf16 v[56:59], v[228:231], v[184:187], v[56:59]
    v_exp_f32 v164, v164
    v_add_f32 v241, v241, v161
    v_exp_f32 v165, v165
    v_cvt_pk_bf16_f32 v198, v160, v161
    v_mfma_f32_16x16x32_bf16 v[88:91], v[228:231], v[188:191], v[88:91]
    ds_read_b64_tr_b16 v[228:229], v237 offset:1216
    ds_read_b64_tr_b16 v[230:231], v237 offset:1728
    v_add_f32 v241, v241, v162
    v_exp_f32 v166, v166
    v_mfma_f32_16x16x32_bf16 v[28:31], v[232:235], v[180:183], v[28:31]
    v_add_f32 v241, v241, v163
    v_exp_f32 v167, v167
    v_cvt_pk_bf16_f32 v199, v162, v163
    v_add_f32 v242, v242, v164
    v_mfma_f32_16x16x32_bf16 v[60:63], v[232:235], v[184:187], v[60:63]
    v_add_f32 v242, v242, v165
    v_cvt_pk_bf16_f32 v202, v164, v165
    v_add_f32 v242, v242, v166
    v_add_f32 v242, v242, v167
    v_cvt_pk_bf16_f32 v203, v166, v167
    v_mfma_f32_16x16x32_bf16 v[92:95], v[232:235], v[188:191], v[92:95]
    ds_read_b64_tr_b16 v[232:233], v237 offset:1248
    ds_read_b64_tr_b16 v[234:235], v237 offset:1760
    v_mov_b32 v243, v240
    v_mov_b32 v244, v241
    v_mov_b32 v245, v242
    s_waitcnt lgkmcnt(14)
    v_mfma_f32_16x16x32_bf16 v[0:3], v[204:207], v[192:195], v[0:3]
    v_mov_b32 v246, v243
    v_mov_b32 v247, v244
    v_mov_b32 v248, v245
    v_mfma_f32_16x16x32_bf16 v[32:35], v[204:207], v[196:199], v[32:35]
    v_permlane16_swap_b32 v243, v246
    v_permlane16_swap_b32 v244, v247
    v_permlane16_swap_b32 v245, v248
    v_add_f32 v243, v243, v246
    v_mfma_f32_16x16x32_bf16 v[64:67], v[204:207], v[200:203], v[64:67]
    v_add_f32 v244, v244, v247
    v_add_f32 v245, v245, v248
    v_mov_b32 v246, v243
    v_mov_b32 v247, v244
    s_waitcnt lgkmcnt(12)
    v_mfma_f32_16x16x32_bf16 v[4:7], v[208:211], v[192:195], v[4:7]
    v_mov_b32 v248, v245
    v_permlane32_swap_b32 v243, v246
    v_permlane32_swap_b32 v244, v247
    v_permlane32_swap_b32 v245, v248
    v_mfma_f32_16x16x32_bf16 v[36:39], v[208:211], v[196:199], v[36:39]
    v_add_f32 v243, v243, v246
    v_add_f32 v244, v244, v247
    v_add_f32 v245, v245, v248
    v_cmp_ngt_f32 vcc, s56, v243
    v_mfma_f32_16x16x32_bf16 v[68:71], v[208:211], v[200:203], v[68:71]
    s_or_b64 s[48:49], s[48:49], vcc
    v_rcp_f32 v243, v243
    s_waitcnt lgkmcnt(10)
    v_mfma_f32_16x16x32_bf16 v[8:11], v[212:215], v[192:195], v[8:11]
    v_cmp_ngt_f32 vcc, s56, v244
    s_or_b64 s[48:49], s[48:49], vcc
    v_rcp_f32 v244, v244
    v_mfma_f32_16x16x32_bf16 v[40:43], v[212:215], v[196:199], v[40:43]
    v_cmp_ngt_f32 vcc, s56, v245
    s_or_b64 s[48:49], s[48:49], vcc
    v_rcp_f32 v245, v245
    v_mfma_f32_16x16x32_bf16 v[72:75], v[212:215], v[200:203], v[72:75]
    s_cmp_lg_u64 s[48:49], 0
    s_cselect_b32 s36, 1, 0
    s_lshl_b32 s37, s34, 2
    v_mov_b32 v250, s36
    v_mov_b32 v251, s37
    ds_write_b32 v251, v250 offset:8192
    s_waitcnt lgkmcnt(7)
    v_mfma_f32_16x16x32_bf16 v[12:15], v[216:219], v[192:195], v[12:15]
    v_mul_f32 v0, v0, v243
    v_mul_f32 v1, v1, v243
    v_mul_f32 v2, v2, v243
    v_mul_f32 v3, v3, v243
    v_mul_f32 v4, v4, v243
    v_mul_f32 v5, v5, v243
    v_mul_f32 v6, v6, v243
    v_mfma_f32_16x16x32_bf16 v[44:47], v[216:219], v[196:199], v[44:47]
    v_mul_f32 v7, v7, v243
    v_cvt_pk_bf16_f32 v0, v0, v1
    v_cvt_pk_bf16_f32 v1, v2, v3
    v_cvt_pk_bf16_f32 v2, v4, v5
    v_cvt_pk_bf16_f32 v3, v6, v7
    v_mfma_f32_16x16x32_bf16 v[76:79], v[216:219], v[200:203], v[76:79]
    s_waitcnt vmcnt(0) lgkmcnt(0)
    s_barrier
    v_mov_b32 v251, 0
    ds_read_b128 v[204:207], v251 offset:8192
    s_waitcnt lgkmcnt(0)
    v_or_b32 v204, v204, v205
    v_or_b32 v206, v206, v207
    v_or_b32 v204, v204, v206
    s_nop 0
    v_readfirstlane_b32 s86, v204
    v_mfma_f32_16x16x32_bf16 v[16:19], v[220:223], v[192:195], v[16:19]
    ds_write_b128 v238, v[0:3] offset:1024
    v_mul_f32 v32, v32, v244
    v_mul_f32 v33, v33, v244
    v_mul_f32 v34, v34, v244
    v_mul_f32 v35, v35, v244
    v_mul_f32 v36, v36, v244
    v_mfma_f32_16x16x32_bf16 v[48:51], v[220:223], v[196:199], v[48:51]
    v_mul_f32 v37, v37, v244
    v_mul_f32 v38, v38, v244
    v_mul_f32 v39, v39, v244
    v_cvt_pk_bf16_f32 v32, v32, v33
    v_cvt_pk_bf16_f32 v33, v34, v35
    v_cvt_pk_bf16_f32 v34, v36, v37
    v_mfma_f32_16x16x32_bf16 v[80:83], v[220:223], v[200:203], v[80:83]
    v_cvt_pk_bf16_f32 v35, v38, v39
    ds_write_b128 v238, v[32:35] offset:9216
    v_mul_f32 v64, v64, v245
    v_mul_f32 v65, v65, v245
    v_mfma_f32_16x16x32_bf16 v[20:23], v[224:227], v[192:195], v[20:23]
    v_mul_f32 v66, v66, v245
    v_mul_f32 v67, v67, v245
    v_mul_f32 v68, v68, v245
    v_mul_f32 v69, v69, v245
    v_mul_f32 v70, v70, v245
    v_mul_f32 v71, v71, v245
    v_cvt_pk_bf16_f32 v64, v64, v65
    v_mfma_f32_16x16x32_bf16 v[52:55], v[224:227], v[196:199], v[52:55]
    v_cvt_pk_bf16_f32 v65, v66, v67
    v_cvt_pk_bf16_f32 v66, v68, v69
    v_cvt_pk_bf16_f32 v67, v70, v71
    ds_write_b128 v238, v[64:67] offset:17408
    v_mfma_f32_16x16x32_bf16 v[84:87], v[224:227], v[200:203], v[84:87]
    v_mul_f32 v8, v8, v243
    v_mul_f32 v9, v9, v243
    v_mul_f32 v10, v10, v243
    v_mul_f32 v11, v11, v243
    v_mul_f32 v12, v12, v243
    v_mul_f32 v13, v13, v243
    v_mul_f32 v14, v14, v243
    v_mfma_f32_16x16x32_bf16 v[24:27], v[228:231], v[192:195], v[24:27]
    v_mul_f32 v15, v15, v243
    v_cvt_pk_bf16_f32 v8, v8, v9
    v_cvt_pk_bf16_f32 v9, v10, v11
    v_cvt_pk_bf16_f32 v10, v12, v13
    v_cvt_pk_bf16_f32 v11, v14, v15
    v_mfma_f32_16x16x32_bf16 v[56:59], v[228:231], v[196:199], v[56:59]
    ds_write_b128 v238, v[8:11] offset:2048
    v_mul_f32 v40, v40, v244
    v_mul_f32 v41, v41, v244
    v_mul_f32 v42, v42, v244
    v_mul_f32 v43, v43, v244
    v_mul_f32 v44, v44, v244
    v_mfma_f32_16x16x32_bf16 v[88:91], v[228:231], v[200:203], v[88:91]
    v_mul_f32 v45, v45, v244
    v_mul_f32 v46, v46, v244
    v_mul_f32 v47, v47, v244
    v_cvt_pk_bf16_f32 v40, v40, v41
    v_cvt_pk_bf16_f32 v41, v42, v43
    v_cvt_pk_bf16_f32 v42, v44, v45
    v_mfma_f32_16x16x32_bf16 v[28:31], v[232:235], v[192:195], v[28:31]
    v_cvt_pk_bf16_f32 v43, v46, v47
    ds_write_b128 v238, v[40:43] offset:10240
    v_mul_f32 v72, v72, v245
    v_mul_f32 v73, v73, v245
    v_mfma_f32_16x16x32_bf16 v[60:63], v[232:235], v[196:199], v[60:63]
    v_mul_f32 v74, v74, v245
    v_mul_f32 v75, v75, v245
    v_mul_f32 v76, v76, v245
    v_mul_f32 v77, v77, v245
    v_mul_f32 v78, v78, v245
    v_mul_f32 v79, v79, v245
    v_cvt_pk_bf16_f32 v72, v72, v73
    v_mfma_f32_16x16x32_bf16 v[92:95], v[232:235], v[200:203], v[92:95]
    v_cvt_pk_bf16_f32 v73, v74, v75
    v_cvt_pk_bf16_f32 v74, v76, v77
    v_cvt_pk_bf16_f32 v75, v78, v79
    ds_write_b128 v238, v[72:75] offset:18432
    v_mul_f32 v16, v16, v243
    v_mul_f32 v17, v17, v243
    v_mul_f32 v18, v18, v243
    v_mul_f32 v19, v19, v243
    v_mul_f32 v20, v20, v243
    v_mul_f32 v21, v21, v243
    v_mul_f32 v22, v22, v243
    v_mul_f32 v23, v23, v243
    v_cvt_pk_bf16_f32 v16, v16, v17
    v_cvt_pk_bf16_f32 v17, v18, v19
    v_cvt_pk_bf16_f32 v18, v20, v21
    v_cvt_pk_bf16_f32 v19, v22, v23
    s_barrier
    ds_write_b128 v238, v[16:19] offset:0
    v_mul_f32 v48, v48, v244
    v_mul_f32 v49, v49, v244
    v_mul_f32 v50, v50, v244
    v_mul_f32 v51, v51, v244
    v_mul_f32 v52, v52, v244
    v_mul_f32 v53, v53, v244
    v_mul_f32 v54, v54, v244
    v_mul_f32 v55, v55, v244
    v_cvt_pk_bf16_f32 v48, v48, v49
    v_cvt_pk_bf16_f32 v49, v50, v51
    v_cvt_pk_bf16_f32 v50, v52, v53
    v_cvt_pk_bf16_f32 v51, v54, v55
    ds_write_b128 v238, v[48:51] offset:8192
    v_mul_f32 v80, v80, v245
    v_mul_f32 v81, v81, v245
    v_mul_f32 v82, v82, v245
    v_mul_f32 v83, v83, v245
    v_mul_f32 v84, v84, v245
    v_mul_f32 v85, v85, v245
    v_mul_f32 v86, v86, v245
    v_mul_f32 v87, v87, v245
    v_cvt_pk_bf16_f32 v80, v80, v81
    v_cvt_pk_bf16_f32 v81, v82, v83
    v_cvt_pk_bf16_f32 v82, v84, v85
    v_cvt_pk_bf16_f32 v83, v86, v87
    ds_write_b128 v238, v[80:83] offset:16384
    v_mul_f32 v24, v24, v243
    v_mul_f32 v25, v25, v243
    v_mul_f32 v26, v26, v243
    v_mul_f32 v27, v27, v243
    v_mul_f32 v28, v28, v243
    v_mul_f32 v29, v29, v243
    v_mul_f32 v30, v30, v243
    v_mul_f32 v31, v31, v243
    v_cvt_pk_bf16_f32 v24, v24, v25
    v_cvt_pk_bf16_f32 v25, v26, v27
    v_cvt_pk_bf16_f32 v26, v28, v29
    v_cvt_pk_bf16_f32 v27, v30, v31
    ds_write_b128 v238, v[24:27] offset:7168
    v_mul_f32 v56, v56, v244
    v_mul_f32 v57, v57, v244
    v_mul_f32 v58, v58, v244
    v_mul_f32 v59, v59, v244
    v_mul_f32 v60, v60, v244
    v_mul_f32 v61, v61, v244
    v_mul_f32 v62, v62, v244
    v_mul_f32 v63, v63, v244
    v_cvt_pk_bf16_f32 v56, v56, v57
    v_cvt_pk_bf16_f32 v57, v58, v59
    v_cvt_pk_bf16_f32 v58, v60, v61
    v_cvt_pk_bf16_f32 v59, v62, v63
    ds_write_b128 v238, v[56:59] offset:15360
    v_mul_f32 v88, v88, v245
    v_mul_f32 v89, v89, v245
    v_mul_f32 v90, v90, v245
    v_mul_f32 v91, v91, v245
    v_mul_f32 v92, v92, v245
    v_mul_f32 v93, v93, v245
    v_mul_f32 v94, v94, v245
    v_mul_f32 v95, v95, v245
    v_cvt_pk_bf16_f32 v88, v88, v89
    v_cvt_pk_bf16_f32 v89, v90, v91
    v_cvt_pk_bf16_f32 v90, v92, v93
    v_cvt_pk_bf16_f32 v91, v94, v95
    ds_write_b128 v238, v[88:91] offset:23552
    s_waitcnt lgkmcnt(0)
    s_barrier
    s_branch L_tail
L_A2:
    s_setprio 0
    v_mbcnt_lo_u32_b32 v250, -1, 0
    v_mbcnt_hi_u32_b32 v250, -1, v250
    s_mul_i32 s41, s31, 163840
    s_and_b32 s42, s29, 3
    s_mul_i32 s42, s42, 40960
    s_add_u32 s41, s41, s42
    s_lshl_b32 s42, s34, 7
    s_add_u32 s41, s41, s42
    v_lshlrev_b32 v251, 10, v250
    v_mov_b32 v252, 0x400000
    v_cmp_gt_u32 vcc, 40, v250
    s_nop 1
    v_cndmask_b32 v251, v252, v251, vcc
    buffer_load_dword v249, v251, s[16:19], s41 offen offset:256
    s_lshr_b32 s41, s29, 2
    s_lshl_b32 s41, s41, 13
    s_and_b32 s42, s34, 1
    s_lshl_b32 s42, s42, 21
    s_add_u32 s41, s41, s42
    s_lshl_b32 s42, s32, 10
    s_add_u32 s41, s41, s42
    s_add_u32 s42, s32, 0
    s_and_b32 s42, s42, 3
    s_lshl_b32 s42, s42, 8
    s_add_u32 s41, s41, s42
    v_lshrrev_b32 v251, 1, v250
    v_lshlrev_b32 v251, 16, v251
    v_and_b32 v252, 1, v250
    v_lshl_add_u32 v251, v252, 7, v251
    buffer_load_dword v249, v251, s[12:15], s41 offen
    s_lshl_b32 s35, s34, 1
    s_add_u32 s35, s35, 2
    v_bfe_u32 v251, v250, 2, 3
    v_mul_u32_u24 v233, 8224, v251
    v_lshrrev_b32 v252, 5, v250
    v_lshl_add_u32 v233, v252, 9, v233
    v_and_b32 v252, 3, v250
    v_lshl_add_u32 v233, v252, 4, v233
    s_nop 0
    v_and_b32 v251, 0, v251
    v_lshl_add_u32 v233, v251, 3, v233
    v_add_u32 v233, 0, v233
    s_lshl_b32 s36, s35, 11
    s_add_u32 s36, s36, 65760
    v_and_b32 v251, 15, v250
    v_lshrrev_b32 v252, 4, v250
    v_lshrrev_b32 v253, 1, v251
    v_xor_b32 v253, v252, v253
    v_lshlrev_b32 v253, 4, v253
    v_lshl_add_u32 v240, v251, 7, v253
    v_xor_b32 v241, 64, v240
    v_add_u32 v240, s36, v240
    v_add_u32 v241, s36, v241
    v_mov_b32 v232, v233
    v_mov_b32 v234, v240
    v_and_b32 v251, 7, v250
    v_mul_u32_u24 v236, 8224, v251
    v_bfe_u32 v251, v250, 3, 1
    v_lshl_add_u32 v236, v251, 8, v236
    v_lshrrev_b32 v252, 4, v250
    v_lshl_add_u32 v236, v252, 4, v236
    v_bfe_u32 v251, v250, 2, 3
    v_mul_u32_u24 v237, 8224, v251
    v_lshrrev_b32 v251, 5, v250
    v_lshl_add_u32 v237, v251, 8, v237
    v_and_b32 v251, 3, v250
    v_lshl_add_u32 v237, v251, 3, v237
    v_add_u32 v237, 4096, v237
    v_lshlrev_b32 v238, 4, v250
    s_lshl_b32 s36, s35, 12
    s_add_u32 s36, s36, 122880
    v_add_u32 v239, s36, v238
    s_lshl_b32 s36, s35, 13
    v_add_u32 v238, s36, v238
    s_mov_b32 s56, 0x5f800000
    s_mov_b32 s57, 0x3e0293ee
    s_mov_b64 s[48:49], 0
    s_mov_b32 s50, 0
    s_mov_b32 s51, 0
    s_mov_b32 s52, 0
    s_waitcnt lgkmcnt(0)
    s_barrier
    ds_read_b128 v[176:179], v234 offset:0
    ds_read_b128 v[180:183], v234 offset:2048
    ds_read_b64_tr_b16 v[144:145], v232 offset:0
    ds_read_b64_tr_b16 v[146:147], v232 offset:256
    ds_read_b64_tr_b16 v[148:149], v232 offset:8
    ds_read_b64_tr_b16 v[150:151], v232 offset:264
    ds_read_b64_tr_b16 v[152:153], v232 offset:64
    ds_read_b64_tr_b16 v[154:155], v232 offset:320
    ds_read_b64_tr_b16 v[156:157], v232 offset:72
    ds_read_b64_tr_b16 v[158:159], v232 offset:328
    ds_read_b64_tr_b16 v[160:161], v232 offset:128
    ds_read_b64_tr_b16 v[162:163], v232 offset:384
    ds_read_b64_tr_b16 v[164:165], v232 offset:136
    ds_read_b64_tr_b16 v[166:167], v232 offset:392
    ds_read_b64_tr_b16 v[168:169], v232 offset:192
    ds_read_b64_tr_b16 v[170:171], v232 offset:448
    ds_read_b64_tr_b16 v[172:173], v232 offset:200
    ds_read_b64_tr_b16 v[174:175], v232 offset:456
    s_add_u32 s52, s52, 1
    s_and_b32 s53, s52, 7
    s_lshl_b32 s53, s53, 10
    s_bfe_u32 s54, s52, 0x20001
    s_mul_i32 s55, s54, 20480
    s_cmp_ge_u32 s54, 2
    s_cselect_b32 s54, 16160, 0
    s_add_u32 s55, s55, s54
    v_add_u32 v232, s53, v233
    v_add_u32 v234, s55, v241
    s_waitcnt lgkmcnt(0)
    s_barrier
    ds_read_b128 v[220:223], v234 offset:0
    ds_read_b128 v[224:227], v234 offset:2048
    v_mfma_f32_16x16x32_bf16 v[0:3], v[144:147], v[176:179], 0
    ds_read_b64_tr_b16 v[188:189], v232 offset:0
    ds_read_b64_tr_b16 v[190:191], v232 offset:256
    s_add_u32 s52, s52, 1
    s_and_b32 s53, s52, 7
    s_lshl_b32 s53, s53, 10
    s_bfe_u32 s54, s52, 0x20001
    s_mul_i32 s55, s54, 20480
    s_cmp_ge_u32 s54, 2
    s_cselect_b32 s54, 16160, 0
    s_add_u32 s55, s55, s54
    v_mfma_f32_16x16x32_bf16 v[32:35], v[144:147], v[180:183], 0
    ds_read_b64_tr_b16 v[192:193], v232 offset:8
    v_mfma_f32_16x16x32_bf16 v[4:7], v[148:151], v[176:179], 0
    ds_read_b64_tr_b16 v[194:195], v232 offset:264
    ds_read_b64_tr_b16 v[196:197], v232 offset:64
    v_mfma_f32_16x16x32_bf16 v[36:39], v[148:151], v[180:183], 0
    ds_read_b64_tr_b16 v[198:199], v232 offset:320
    ds_read_b64_tr_b16 v[200:201], v232 offset:72
    v_mfma_f32_16x16x32_bf16 v[8:11], v[152:155], v[176:179], 0
    ds_read_b64_tr_b16 v[202:203], v232 offset:328
    v_mfma_f32_16x16x32_bf16 v[40:43], v[152:155], v[180:183], 0
    ds_read_b64_tr_b16 v[204:205], v232 offset:128
    ds_read_b64_tr_b16 v[206:207], v232 offset:384
    v_mfma_f32_16x16x32_bf16 v[12:15], v[156:159], v[176:179], 0
    ds_read_b64_tr_b16 v[208:209], v232 offset:136
    ds_read_b64_tr_b16 v[210:211], v232 offset:392
    v_mfma_f32_16x16x32_bf16 v[44:47], v[156:159], v[180:183], 0
    ds_read_b64_tr_b16 v[212:213], v232 offset:192
    v_mfma_f32_16x16x32_bf16 v[16:19], v[160:163], v[176:179], 0
    ds_read_b64_tr_b16 v[214:215], v232 offset:448
    ds_read_b64_tr_b16 v[216:217], v232 offset:200
    v_mfma_f32_16x16x32_bf16 v[48:51], v[160:163], v[180:183], 0
    ds_read_b64_tr_b16 v[218:219], v232 offset:456
    v_mfma_f32_16x16x32_bf16 v[20:23], v[164:167], v[176:179], 0
    v_mfma_f32_16x16x32_bf16 v[52:55], v[164:167], v[180:183], 0
    v_mfma_f32_16x16x32_bf16 v[24:27], v[168:171], v[176:179], 0
    v_mfma_f32_16x16x32_bf16 v[56:59], v[168:171], v[180:183], 0
    v_mfma_f32_16x16x32_bf16 v[28:31], v[172:175], v[176:179], 0
    v_mfma_f32_16x16x32_bf16 v[60:63], v[172:175], v[180:183], 0
    v_add_u32 v232, s53, v233
    v_add_u32 v234, s55, v240
    s_waitcnt lgkmcnt(0)
    s_barrier
L_A2_pg:
    s_cmp_lg_u32 s52, 4
    s_cbranch_scc1 L_A2_np1
    s_lshr_b32 s41, s29, 2
    s_lshl_b32 s41, s41, 13
    s_and_b32 s42, s34, 1
    s_lshl_b32 s42, s42, 21
    s_add_u32 s41, s41, s42
    s_lshl_b32 s42, s32, 10
    s_add_u32 s41, s41, s42
    s_add_u32 s42, s32, 1
    s_and_b32 s42, s42, 3
    s_lshl_b32 s42, s42, 8
    s_add_u32 s41, s41, s42
    v_lshrrev_b32 v251, 1, v250
    v_lshlrev_b32 v251, 16, v251
    v_and_b32 v252, 1, v250
    v_lshl_add_u32 v251, v252, 7, v251
    buffer_load_dword v249, v251, s[12:15], s41 offen
L_A2_np1:
    ds_read_b128 v[176:179], v234 offset:0
    ds_read_b128 v[180:183], v234 offset:2048
    v_mfma_f32_16x16x32_bf16 v[0:3], v[188:191], v[220:223], v[0:3]
    ds_read_b64_tr_b16 v[144:145], v232 offset:0
    ds_read_b64_tr_b16 v[146:147], v232 offset:256
    s_add_u32 s52, s52, 1
    s_and_b32 s53, s52, 7
    s_lshl_b32 s53, s53, 10
    s_bfe_u32 s54, s52, 0x20001
    s_mul_i32 s55, s54, 20480
    s_cmp_ge_u32 s54, 2
    s_cselect_b32 s54, 16160, 0
    s_add_u32 s55, s55, s54
    v_mfma_f32_16x16x32_bf16 v[32:35], v[188:191], v[224:227], v[32:35]
    ds_read_b64_tr_b16 v[148:149], v232 offset:8
    v_mfma_f32_16x16x32_bf16 v[4:7], v[192:195], v[220:223], v[4:7]
    ds_read_b64_tr_b16 v[150:151], v232 offset:264
    ds_read_b64_tr_b16 v[152:153], v232 offset:64
    v_mfma_f32_16x16x32_bf16 v[36:39], v[192:195], v[224:227], v[36:39]
    ds_read_b64_tr_b16 v[154:155], v232 offset:320
    ds_read_b64_tr_b16 v[156:157], v232 offset:72
    v_mfma_f32_16x16x32_bf16 v[8:11], v[196:199], v[220:223], v[8:11]
    ds_read_b64_tr_b16 v[158:159], v232 offset:328
    v_mfma_f32_16x16x32_bf16 v[40:43], v[196:199], v[224:227], v[40:43]
    ds_read_b64_tr_b16 v[160:161], v232 offset:128
    ds_read_b64_tr_b16 v[162:163], v232 offset:384
    v_mfma_f32_16x16x32_bf16 v[12:15], v[200:203], v[220:223], v[12:15]
    ds_read_b64_tr_b16 v[164:165], v232 offset:136
    ds_read_b64_tr_b16 v[166:167], v232 offset:392
    v_mfma_f32_16x16x32_bf16 v[44:47], v[200:203], v[224:227], v[44:47]
    ds_read_b64_tr_b16 v[168:169], v232 offset:192
    v_mfma_f32_16x16x32_bf16 v[16:19], v[204:207], v[220:223], v[16:19]
    ds_read_b64_tr_b16 v[170:171], v232 offset:448
    ds_read_b64_tr_b16 v[172:173], v232 offset:200
    v_mfma_f32_16x16x32_bf16 v[48:51], v[204:207], v[224:227], v[48:51]
    ds_read_b64_tr_b16 v[174:175], v232 offset:456
    v_mfma_f32_16x16x32_bf16 v[20:23], v[208:211], v[220:223], v[20:23]
    v_mfma_f32_16x16x32_bf16 v[52:55], v[208:211], v[224:227], v[52:55]
    v_mfma_f32_16x16x32_bf16 v[24:27], v[212:215], v[220:223], v[24:27]
    v_mfma_f32_16x16x32_bf16 v[56:59], v[212:215], v[224:227], v[56:59]
    v_mfma_f32_16x16x32_bf16 v[28:31], v[216:219], v[220:223], v[28:31]
    v_mfma_f32_16x16x32_bf16 v[60:63], v[216:219], v[224:227], v[60:63]
    v_add_u32 v232, s53, v233
    v_add_u32 v234, s55, v241
    s_waitcnt lgkmcnt(0)
    s_barrier
    ds_read_b128 v[220:223], v234 offset:0
    ds_read_b128 v[224:227], v234 offset:2048
    v_mfma_f32_16x16x32_bf16 v[0:3], v[144:147], v[176:179], v[0:3]
    ds_read_b64_tr_b16 v[188:189], v232 offset:0
    ds_read_b64_tr_b16 v[190:191], v232 offset:256
    s_add_u32 s52, s52, 1
    s_and_b32 s53, s52, 7
    s_lshl_b32 s53, s53, 10
    s_bfe_u32 s54, s52, 0x20001
    s_mul_i32 s55, s54, 20480
    s_cmp_ge_u32 s54, 2
    s_cselect_b32 s54, 16160, 0
    s_add_u32 s55, s55, s54
    v_mfma_f32_16x16x32_bf16 v[32:35], v[144:147], v[180:183], v[32:35]
    ds_read_b64_tr_b16 v[192:193], v232 offset:8
    v_mfma_f32_16x16x32_bf16 v[4:7], v[148:151], v[176:179], v[4:7]
    ds_read_b64_tr_b16 v[194:195], v232 offset:264
    ds_read_b64_tr_b16 v[196:197], v232 offset:64
    v_mfma_f32_16x16x32_bf16 v[36:39], v[148:151], v[180:183], v[36:39]
    ds_read_b64_tr_b16 v[198:199], v232 offset:320
    ds_read_b64_tr_b16 v[200:201], v232 offset:72
    v_mfma_f32_16x16x32_bf16 v[8:11], v[152:155], v[176:179], v[8:11]
    ds_read_b64_tr_b16 v[202:203], v232 offset:328
    v_mfma_f32_16x16x32_bf16 v[40:43], v[152:155], v[180:183], v[40:43]
    ds_read_b64_tr_b16 v[204:205], v232 offset:128
    ds_read_b64_tr_b16 v[206:207], v232 offset:384
    v_mfma_f32_16x16x32_bf16 v[12:15], v[156:159], v[176:179], v[12:15]
    ds_read_b64_tr_b16 v[208:209], v232 offset:136
    ds_read_b64_tr_b16 v[210:211], v232 offset:392
    v_mfma_f32_16x16x32_bf16 v[44:47], v[156:159], v[180:183], v[44:47]
    ds_read_b64_tr_b16 v[212:213], v232 offset:192
    v_mfma_f32_16x16x32_bf16 v[16:19], v[160:163], v[176:179], v[16:19]
    ds_read_b64_tr_b16 v[214:215], v232 offset:448
    ds_read_b64_tr_b16 v[216:217], v232 offset:200
    v_mfma_f32_16x16x32_bf16 v[48:51], v[160:163], v[180:183], v[48:51]
    ds_read_b64_tr_b16 v[218:219], v232 offset:456
    v_mfma_f32_16x16x32_bf16 v[20:23], v[164:167], v[176:179], v[20:23]
    v_mfma_f32_16x16x32_bf16 v[52:55], v[164:167], v[180:183], v[52:55]
    v_mfma_f32_16x16x32_bf16 v[24:27], v[168:171], v[176:179], v[24:27]
    v_mfma_f32_16x16x32_bf16 v[56:59], v[168:171], v[180:183], v[56:59]
    v_mfma_f32_16x16x32_bf16 v[28:31], v[172:175], v[176:179], v[28:31]
    v_mfma_f32_16x16x32_bf16 v[60:63], v[172:175], v[180:183], v[60:63]
    v_add_u32 v232, s53, v233
    v_add_u32 v234, s55, v240
    s_waitcnt lgkmcnt(0)
    s_barrier
    s_cmp_lt_u32 s52, 16
    s_cbranch_scc1 L_A2_pg
    s_waitcnt vmcnt(0)
    v_lshlrev_b32 v249, 4, v250
    s_lshl_b32 s58, s31, 5
    s_lshl_b32 s36, s32, 2
    s_add_u32 s58, s58, s36
    s_lshl_b32 s58, s58, 17

    s_mov_b32 s47, s29
    s_and_b32 s36, s34, 1
    s_lshl_b32 s59, s36, 12
    s_sub_u32 s60, 4, s36
    s_lshr_b32 s61, s60, 4
    s_add_u32 s61, s61, s32
    s_and_b32 s61, s61, 3
    s_lshl_b32 s61, s61, 17
    s_add_u32 s62, s60, s47
    s_and_b32 s62, s62, 15
    s_lshl_b32 s62, s62, 13
    s_add_u32 s61, s61, s62
    s_add_u32 s61, s61, s58
    s_and_b32 s62, s60, 3
    s_lshl_b32 s62, s62, 10
    s_add_u32 s71, s62, s59
    s_cmp_ge_i32 s60, 64
    s_cselect_b32 s61, 0x4000000, s61
    s_cselect_b32 s71, 0x30000, s71
    s_add_u32 s62, s61, 4096
    s_add_u32 s60, s60, 1
    v_mfma_f32_16x16x32_bf16 v[0:3], v[188:191], v[220:223], v[0:3]
    v_mfma_f32_16x16x32_bf16 v[4:7], v[192:195], v[220:223], v[4:7]
    v_mfma_f32_16x16x32_bf16 v[8:11], v[196:199], v[220:223], v[8:11]
    v_mfma_f32_16x16x32_bf16 v[12:15], v[200:203], v[220:223], v[12:15]
    v_mfma_f32_16x16x32_bf16 v[16:19], v[204:207], v[220:223], v[16:19]
    v_mfma_f32_16x16x32_bf16 v[20:23], v[208:211], v[220:223], v[20:23]
    v_mfma_f32_16x16x32_bf16 v[24:27], v[212:215], v[220:223], v[24:27]
    v_mfma_f32_16x16x32_bf16 v[28:31], v[216:219], v[220:223], v[28:31]
    v_mfma_f32_16x16x32_bf16 v[32:35], v[188:191], v[224:227], v[32:35]
    v_mfma_f32_16x16x32_bf16 v[36:39], v[192:195], v[224:227], v[36:39]
    v_mul_f32 v0, s57, v0
    v_mul_f32 v1, s57, v1
    v_mul_f32 v2, s57, v2
    v_mul_f32 v3, s57, v3
    v_mul_f32 v4, s57, v4
    v_mul_f32 v5, s57, v5
    v_mul_f32 v6, s57, v6
    v_mfma_f32_16x16x32_bf16 v[40:43], v[196:199], v[224:227], v[40:43]
    v_mul_f32 v7, s57, v7
    v_cvt_pk_bf16_f32 v96, v0, v1
    v_cvt_pk_bf16_f32 v97, v2, v3
    v_cvt_pk_bf16_f32 v98, v4, v5
    v_cvt_pk_bf16_f32 v99, v6, v7
    v_mul_f32 v8, s57, v8
    v_mul_f32 v9, s57, v9
    v_mfma_f32_16x16x32_bf16 v[44:47], v[200:203], v[224:227], v[44:47]
    v_mul_f32 v10, s57, v10
    v_mul_f32 v11, s57, v11
    v_mul_f32 v12, s57, v12
    v_mul_f32 v13, s57, v13
    v_mul_f32 v14, s57, v14
    v_mul_f32 v15, s57, v15
    v_cvt_pk_bf16_f32 v100, v8, v9
    v_mfma_f32_16x16x32_bf16 v[48:51], v[204:207], v[224:227], v[48:51]
    v_cvt_pk_bf16_f32 v101, v10, v11
    v_cvt_pk_bf16_f32 v102, v12, v13
    v_cvt_pk_bf16_f32 v103, v14, v15
    v_mul_f32 v16, s57, v16
    v_mul_f32 v17, s57, v17
    v_mul_f32 v18, s57, v18
    v_mul_f32 v19, s57, v19
    v_mfma_f32_16x16x32_bf16 v[52:55], v[208:211], v[224:227], v[52:55]
    v_mul_f32 v20, s57, v20
    v_mul_f32 v21, s57, v21
    v_mul_f32 v22, s57, v22
    v_mul_f32 v23, s57, v23
    v_cvt_pk_bf16_f32 v104, v16, v17
    v_cvt_pk_bf16_f32 v105, v18, v19
    v_cvt_pk_bf16_f32 v106, v20, v21
    v_mfma_f32_16x16x32_bf16 v[56:59], v[212:215], v[224:227], v[56:59]
    v_cvt_pk_bf16_f32 v107, v22, v23
    v_mul_f32 v24, s57, v24
    v_mul_f32 v25, s57, v25
    v_mul_f32 v26, s57, v26
    v_mul_f32 v27, s57, v27
    v_mul_f32 v28, s57, v28
    v_mul_f32 v29, s57, v29
    v_mfma_f32_16x16x32_bf16 v[60:63], v[216:219], v[224:227], v[60:63]
    v_mul_f32 v30, s57, v30
    v_mul_f32 v31, s57, v31
    v_cvt_pk_bf16_f32 v108, v24, v25
    v_cvt_pk_bf16_f32 v109, v26, v27
    v_cvt_pk_bf16_f32 v110, v28, v29
    v_cvt_pk_bf16_f32 v111, v30, v31
    v_mul_f32 v32, s57, v32
    v_mul_f32 v33, s57, v33
    v_mul_f32 v34, s57, v34
    v_mul_f32 v35, s57, v35
    v_mul_f32 v36, s57, v36
    v_mul_f32 v37, s57, v37
    v_mul_f32 v38, s57, v38
    v_mul_f32 v39, s57, v39
    v_cvt_pk_bf16_f32 v112, v32, v33
    v_cvt_pk_bf16_f32 v113, v34, v35
    v_cvt_pk_bf16_f32 v114, v36, v37
    v_cvt_pk_bf16_f32 v115, v38, v39
    v_mul_f32 v40, s57, v40
    v_mul_f32 v41, s57, v41
    v_mul_f32 v42, s57, v42
    v_mul_f32 v43, s57, v43
    v_mul_f32 v44, s57, v44
    v_mul_f32 v45, s57, v45
    v_mul_f32 v46, s57, v46
    v_mul_f32 v47, s57, v47
    v_cvt_pk_bf16_f32 v116, v40, v41
    v_cvt_pk_bf16_f32 v117, v42, v43
    v_cvt_pk_bf16_f32 v118, v44, v45
    v_cvt_pk_bf16_f32 v119, v46, v47
    v_mul_f32 v48, s57, v48
    v_mul_f32 v49, s57, v49
    v_mul_f32 v50, s57, v50
    v_mul_f32 v51, s57, v51
    v_mul_f32 v52, s57, v52
    v_mul_f32 v53, s57, v53
    v_mul_f32 v54, s57, v54
    v_mul_f32 v55, s57, v55
    v_cvt_pk_bf16_f32 v120, v48, v49
    v_cvt_pk_bf16_f32 v121, v50, v51
    v_cvt_pk_bf16_f32 v122, v52, v53
    v_cvt_pk_bf16_f32 v123, v54, v55
    v_mul_f32 v56, s57, v56
    v_mul_f32 v57, s57, v57
    v_mul_f32 v58, s57, v58
    v_mul_f32 v59, s57, v59
    v_mul_f32 v60, s57, v60
    v_mul_f32 v61, s57, v61
    v_mul_f32 v62, s57, v62
    v_mul_f32 v63, s57, v63
    v_cvt_pk_bf16_f32 v124, v56, v57
    v_cvt_pk_bf16_f32 v125, v58, v59
    v_cvt_pk_bf16_f32 v126, v60, v61
    v_cvt_pk_bf16_f32 v127, v62, v63
    s_waitcnt lgkmcnt(0)
    s_barrier
    s_cmp_lg_u32 s87, 0
    s_cbranch_scc1 L_A2_care
    ds_read_b128 v[204:207], v236 offset:0
    ds_read_b128 v[208:211], v236 offset:64
    ds_read_b128 v[212:215], v236 offset:128
    ds_read_b128 v[216:219], v236 offset:192
    ds_read_b128 v[220:223], v236 offset:512
    ds_read_b128 v[224:227], v236 offset:576
    ds_read_b128 v[228:231], v236 offset:640
    ds_read_b128 v[232:235], v236 offset:704
    s_waitcnt lgkmcnt(7)
    v_mfma_f32_16x16x32_bf16 v[144:147], v[204:207], v[96:99], 0
    v_mfma_f32_16x16x32_bf16 v[148:151], v[204:207], v[112:115], 0
    s_waitcnt lgkmcnt(6)
    v_mfma_f32_16x16x32_bf16 v[144:147], v[208:211], v[100:103], v[144:147]
    v_mfma_f32_16x16x32_bf16 v[148:151], v[208:211], v[116:119], v[148:151]
    s_waitcnt lgkmcnt(5)
    v_mfma_f32_16x16x32_bf16 v[144:147], v[212:215], v[104:107], v[144:147]
    v_mfma_f32_16x16x32_bf16 v[148:151], v[212:215], v[120:123], v[148:151]
    s_waitcnt lgkmcnt(4)
    v_mfma_f32_16x16x32_bf16 v[144:147], v[216:219], v[108:111], v[144:147]
    v_mfma_f32_16x16x32_bf16 v[148:151], v[216:219], v[124:127], v[148:151]
    s_nop 6
    v_max3_f32 v171, v144, v145, v146
    v_max3_f32 v175, v148, v149, v150
    v_max_f32 v171, v171, v147
    v_max_f32 v175, v175, v151
    v_mov_b32 v168, v171
    v_mov_b32 v172, v175
    s_nop 0
    v_permlane16_swap_b32 v171, v168
    v_permlane16_swap_b32 v175, v172
    v_max_f32 v171, v171, v168
    v_max_f32 v175, v175, v172
    v_mov_b32 v168, v171
    v_mov_b32 v172, v175
    s_nop 0
    v_permlane32_swap_b32 v171, v168
    v_permlane32_swap_b32 v175, v172
    v_max_f32 v171, v171, v168
    v_max_f32 v175, v175, v172
    v_sub_f32 v168, 0, v171
    v_sub_f32 v172, 0, v175
    v_sub_f32 v169, 0, v171
    v_sub_f32 v173, 0, v175
    v_sub_f32 v170, 0, v171
    v_sub_f32 v174, 0, v175
    v_sub_f32 v171, 0, v171
    v_sub_f32 v175, 0, v175
    s_waitcnt lgkmcnt(3)
    v_mfma_f32_16x16x32_bf16 v[156:159], v[220:223], v[96:99], v[168:171]
    v_add_f32 v144, v144, v168
    v_add_f32 v145, v145, v168
    v_add_f32 v146, v146, v168
    v_add_f32 v147, v147, v168
    v_mfma_f32_16x16x32_bf16 v[160:163], v[220:223], v[112:115], v[172:175]
    v_add_f32 v148, v148, v172
    v_add_f32 v149, v149, v172
    v_add_f32 v150, v150, v172
    v_add_f32 v151, v151, v172
    s_waitcnt lgkmcnt(2)
    v_mfma_f32_16x16x32_bf16 v[156:159], v[224:227], v[100:103], v[156:159]
    v_exp_f32 v144, v144
    v_exp_f32 v145, v145
    v_mfma_f32_16x16x32_bf16 v[160:163], v[224:227], v[116:119], v[160:163]
    v_exp_f32 v146, v146
    v_exp_f32 v147, v147
    v_add_f32 v240, v144, v145
    s_waitcnt lgkmcnt(1)
    v_mfma_f32_16x16x32_bf16 v[156:159], v[228:231], v[104:107], v[156:159]
    v_exp_f32 v148, v148
    v_cvt_pk_bf16_f32 v180, v144, v145
    v_exp_f32 v149, v149
    v_mfma_f32_16x16x32_bf16 v[160:163], v[228:231], v[120:123], v[160:163]
    v_add_f32 v240, v240, v146
    v_exp_f32 v150, v150
    v_add_f32 v240, v240, v147
    s_waitcnt lgkmcnt(0)
    v_mfma_f32_16x16x32_bf16 v[156:159], v[232:235], v[108:111], v[156:159]
    v_exp_f32 v151, v151
    v_cvt_pk_bf16_f32 v181, v146, v147
    v_add_f32 v241, v148, v149
    v_mfma_f32_16x16x32_bf16 v[160:163], v[232:235], v[124:127], v[160:163]
    v_cvt_pk_bf16_f32 v184, v148, v149
    v_add_f32 v241, v241, v150
    v_add_f32 v241, v241, v151
    v_cvt_pk_bf16_f32 v185, v150, v151
    s_waitcnt vmcnt(12) lgkmcnt(0)
    s_barrier
    ds_read_b128 v[204:207], v236 offset:1024
    ds_read_b128 v[208:211], v236 offset:1088
    ds_read_b128 v[212:215], v236 offset:1152
    ds_read_b128 v[216:219], v236 offset:1216
    s_waitcnt lgkmcnt(3)
    v_mfma_f32_16x16x32_bf16 v[144:147], v[204:207], v[96:99], v[168:171]
    ds_read_b64_tr_b16 v[220:221], v237 offset:0
    ds_read_b64_tr_b16 v[222:223], v237 offset:512
    v_exp_f32 v156, v156
    v_exp_f32 v157, v157
    v_mfma_f32_16x16x32_bf16 v[148:151], v[204:207], v[112:115], v[172:175]
    ds_read_b128 v[204:207], v236 offset:1536
    ds_read_b64_tr_b16 v[224:225], v237 offset:32
    ds_read_b64_tr_b16 v[226:227], v237 offset:544
    v_exp_f32 v158, v158
    s_add_u32 m0, s71, 14400
    s_waitcnt lgkmcnt(7)
    v_mfma_f32_16x16x32_bf16 v[144:147], v[208:211], v[100:103], v[144:147]
    buffer_load_dwordx4 v249, s[8:11], s61 offen offset:2048 nt lds
    ds_read_b64_tr_b16 v[228:229], v237 offset:64
    ds_read_b64_tr_b16 v[230:231], v237 offset:576
    v_exp_f32 v159, v159
    v_add_f32 v240, v240, v156
    v_mfma_f32_16x16x32_bf16 v[148:151], v[208:211], v[116:119], v[148:151]
    ds_read_b128 v[208:211], v236 offset:1600
    ds_read_b64_tr_b16 v[232:233], v237 offset:96
    ds_read_b64_tr_b16 v[234:235], v237 offset:608
    v_exp_f32 v160, v160
    v_add_f32 v240, v240, v157
    s_add_u32 m0, s71, 21600
    s_waitcnt lgkmcnt(11)
    v_mfma_f32_16x16x32_bf16 v[144:147], v[212:215], v[104:107], v[144:147]
    buffer_load_dwordx4 v249, s[8:11], s61 offen offset:3072 nt lds
    v_exp_f32 v161, v161
    v_cvt_pk_bf16_f32 v182, v156, v157
    v_add_f32 v240, v240, v158
    v_exp_f32 v162, v162
    v_mfma_f32_16x16x32_bf16 v[148:151], v[212:215], v[120:123], v[148:151]
    ds_read_b128 v[212:215], v236 offset:1664
    v_add_f32 v240, v240, v159
    v_exp_f32 v163, v163
    v_cvt_pk_bf16_f32 v183, v158, v159
    v_add_f32 v241, v241, v160
    s_waitcnt lgkmcnt(11)
    v_mfma_f32_16x16x32_bf16 v[144:147], v[216:219], v[108:111], v[144:147]
    v_add_f32 v241, v241, v161
    v_cvt_pk_bf16_f32 v186, v160, v161
    v_add_f32 v241, v241, v162
    v_add_f32 v241, v241, v163
    v_cvt_pk_bf16_f32 v187, v162, v163
    s_add_u32 m0, s71, 32896
    v_mfma_f32_16x16x32_bf16 v[148:151], v[216:219], v[124:127], v[148:151]
    buffer_load_dwordx4 v249, s[8:11], s62 offen nt lds
    ds_read_b128 v[216:219], v236 offset:1728
    s_waitcnt lgkmcnt(2)
    v_mfma_f32_16x16x32_bf16 v[0:3], v[220:223], v[180:183], 0
    v_mfma_f32_16x16x32_bf16 v[32:35], v[220:223], v[184:187], 0
    ds_read_b64_tr_b16 v[220:221], v237 offset:128
    ds_read_b64_tr_b16 v[222:223], v237 offset:640
    s_add_u32 m0, s71, 40096
    v_mfma_f32_16x16x32_bf16 v[4:7], v[224:227], v[180:183], 0
    buffer_load_dwordx4 v249, s[8:11], s62 offen offset:1024 nt lds
    v_exp_f32 v144, v144
    v_mfma_f32_16x16x32_bf16 v[36:39], v[224:227], v[184:187], 0
    ds_read_b64_tr_b16 v[224:225], v237 offset:160
    ds_read_b64_tr_b16 v[226:227], v237 offset:672
    v_exp_f32 v145, v145
    s_add_u32 m0, s71, 47296
    v_mfma_f32_16x16x32_bf16 v[8:11], v[228:231], v[180:183], 0
    buffer_load_dwordx4 v249, s[8:11], s62 offen offset:2048 nt lds
    v_exp_f32 v146, v146
    v_mfma_f32_16x16x32_bf16 v[40:43], v[228:231], v[184:187], 0
    ds_read_b64_tr_b16 v[228:229], v237 offset:192
    ds_read_b64_tr_b16 v[230:231], v237 offset:704
    v_exp_f32 v147, v147
    v_mfma_f32_16x16x32_bf16 v[12:15], v[232:235], v[180:183], 0
    v_add_f32 v240, v240, v144
    s_add_u32 m0, s71, 54496
    v_mfma_f32_16x16x32_bf16 v[44:47], v[232:235], v[184:187], 0
    buffer_load_dwordx4 v249, s[8:11], s62 offen offset:3072 nt lds
    ds_read_b64_tr_b16 v[232:233], v237 offset:224
    ds_read_b64_tr_b16 v[234:235], v237 offset:736
    v_exp_f32 v148, v148
    s_waitcnt lgkmcnt(8)
    v_mfma_f32_16x16x32_bf16 v[156:159], v[204:207], v[96:99], v[168:171]
    v_add_f32 v240, v240, v145
    v_mfma_f32_16x16x32_bf16 v[160:163], v[204:207], v[112:115], v[172:175]
    v_exp_f32 v149, v149
    v_cvt_pk_bf16_f32 v192, v144, v145
    v_mfma_f32_16x16x32_bf16 v[156:159], v[208:211], v[100:103], v[156:159]
    v_add_f32 v240, v240, v146
    v_exp_f32 v150, v150
    s_lshr_b32 s61, s60, 4
    s_add_u32 s61, s61, s32
    s_and_b32 s61, s61, 3
    s_lshl_b32 s61, s61, 17
    s_add_u32 s62, s60, s47
    s_and_b32 s62, s62, 15
    s_lshl_b32 s62, s62, 13
    s_add_u32 s61, s61, s62
    s_add_u32 s61, s61, s58
    v_mfma_f32_16x16x32_bf16 v[160:163], v[208:211], v[116:119], v[160:163]
    v_add_f32 v240, v240, v147
    s_and_b32 s62, s60, 3
    s_lshl_b32 s62, s62, 10
    s_add_u32 s71, s62, s59
    s_cmp_ge_i32 s60, 64
    s_cselect_b32 s61, 0x4000000, s61
    s_cselect_b32 s71, 0x30000, s71
    s_add_u32 s62, s61, 4096
    s_add_u32 s60, s60, 1
    v_mfma_f32_16x16x32_bf16 v[156:159], v[212:215], v[104:107], v[156:159]
    v_exp_f32 v151, v151
    v_cvt_pk_bf16_f32 v193, v146, v147
    v_mfma_f32_16x16x32_bf16 v[160:163], v[212:215], v[120:123], v[160:163]
    v_add_f32 v241, v241, v148
    v_add_f32 v241, v241, v149
    v_mfma_f32_16x16x32_bf16 v[156:159], v[216:219], v[108:111], v[156:159]
    v_cvt_pk_bf16_f32 v196, v148, v149
    v_add_f32 v241, v241, v150
    v_mfma_f32_16x16x32_bf16 v[160:163], v[216:219], v[124:127], v[160:163]
    v_add_f32 v241, v241, v151
    v_cvt_pk_bf16_f32 v197, v150, v151
    v_xor_b32 v236, 0x800, v236
    s_waitcnt vmcnt(12) lgkmcnt(0)
    s_barrier
L_A2_e1:
    s_mov_b32 s51, 0
    s_cmp_lg_u32 s50, 1
    s_cbranch_scc1 L_A2_pk0
    ds_read_b128 v[64:67], v239 offset:0
    ds_read_b128 v[68:71], v239 offset:1024
    ds_read_b128 v[72:75], v239 offset:2048
    ds_read_b128 v[76:79], v239 offset:3072
    ds_read_b128 v[80:83], v239 offset:4096
    ds_read_b128 v[84:87], v239 offset:5120
    ds_read_b128 v[88:91], v239 offset:6144
    ds_read_b128 v[92:95], v239 offset:7168
L_A2_pk0:
    s_cmp_lg_u32 s50, 2
    s_cbranch_scc1 L_A2_pk1
    ds_read_b128 v[128:131], v239 offset:0
    ds_read_b128 v[132:135], v239 offset:1024
    ds_read_b128 v[136:139], v239 offset:2048
    ds_read_b128 v[140:143], v239 offset:3072
    ds_read_b128 v[152:155], v239 offset:4096
    ds_read_b128 v[164:167], v239 offset:5120
    ds_read_b128 v[176:179], v239 offset:6144
    ds_read_b128 v[188:191], v239 offset:7168
L_A2_pk1:
    s_cmp_lg_u32 s50, 3
    s_cbranch_scc1 L_A2_pk2
    v_subrev_u32 v248, 40960, v239
    ds_write_b128 v248, v[128:131] offset:0
    ds_write_b128 v248, v[132:135] offset:1024
    ds_write_b128 v248, v[136:139] offset:2048
    ds_write_b128 v248, v[140:143] offset:3072
    ds_write_b128 v248, v[152:155] offset:4096
    ds_write_b128 v248, v[164:167] offset:5120
    ds_write_b128 v248, v[176:179] offset:6144
    ds_write_b128 v248, v[188:191] offset:7168
L_A2_pk2:
    ds_read_b128 v[204:207], v236 offset:0
    ds_read_b128 v[208:211], v236 offset:64
    ds_read_b128 v[212:215], v236 offset:128
    v_mfma_f32_16x16x32_bf16 v[16:19], v[220:223], v[180:183], 0
    ds_read_b128 v[216:219], v236 offset:192
    v_mfma_f32_16x16x32_bf16 v[48:51], v[220:223], v[184:187], 0
    ds_read_b64_tr_b16 v[220:221], v237 offset:1024
    ds_read_b64_tr_b16 v[222:223], v237 offset:1536
    v_exp_f32 v156, v156
    s_add_u32 m0, s71, 14400
    v_mfma_f32_16x16x32_bf16 v[20:23], v[224:227], v[180:183], 0
    buffer_load_dwordx4 v249, s[8:11], s61 offen offset:2048 nt lds
    v_exp_f32 v157, v157
    v_mfma_f32_16x16x32_bf16 v[52:55], v[224:227], v[184:187], 0
    ds_read_b64_tr_b16 v[224:225], v237 offset:1056
    ds_read_b64_tr_b16 v[226:227], v237 offset:1568
    v_exp_f32 v158, v158
    v_mfma_f32_16x16x32_bf16 v[24:27], v[228:231], v[180:183], 0
    v_exp_f32 v159, v159
    v_mfma_f32_16x16x32_bf16 v[56:59], v[228:231], v[184:187], 0
    ds_read_b64_tr_b16 v[228:229], v237 offset:1088
    ds_read_b64_tr_b16 v[230:231], v237 offset:1600
    v_add_f32 v240, v240, v156
    s_add_u32 m0, s71, 21600
    v_mfma_f32_16x16x32_bf16 v[28:31], v[232:235], v[180:183], 0
    buffer_load_dwordx4 v249, s[8:11], s61 offen offset:3072 nt lds
    v_exp_f32 v160, v160
    v_mfma_f32_16x16x32_bf16 v[60:63], v[232:235], v[184:187], 0
    ds_read_b64_tr_b16 v[232:233], v237 offset:1120
    ds_read_b64_tr_b16 v[234:235], v237 offset:1632
    v_add_f32 v240, v240, v157
    s_waitcnt lgkmcnt(8)
    v_mfma_f32_16x16x32_bf16 v[144:147], v[204:207], v[96:99], v[168:171]
    v_exp_f32 v161, v161
    v_cvt_pk_bf16_f32 v194, v156, v157
    v_mfma_f32_16x16x32_bf16 v[148:151], v[204:207], v[112:115], v[172:175]
    ds_read_b128 v[204:207], v236 offset:512
    v_add_f32 v240, v240, v158
    v_exp_f32 v162, v162
    s_add_u32 m0, s71, 32896
    v_mfma_f32_16x16x32_bf16 v[144:147], v[208:211], v[100:103], v[144:147]
    buffer_load_dwordx4 v249, s[8:11], s62 offen nt lds
    v_add_f32 v240, v240, v159
    v_mfma_f32_16x16x32_bf16 v[148:151], v[208:211], v[116:119], v[148:151]
    ds_read_b128 v[208:211], v236 offset:576
    v_exp_f32 v163, v163
    v_mfma_f32_16x16x32_bf16 v[144:147], v[212:215], v[104:107], v[144:147]
    v_cvt_pk_bf16_f32 v195, v158, v159
    v_add_f32 v241, v241, v160
    v_mfma_f32_16x16x32_bf16 v[148:151], v[212:215], v[120:123], v[148:151]
    v_add_f32 v241, v241, v161
    v_cvt_pk_bf16_f32 v198, v160, v161
    v_add_f32 v241, v241, v162
    s_add_u32 m0, s71, 40096
    v_mfma_f32_16x16x32_bf16 v[144:147], v[216:219], v[108:111], v[144:147]
    buffer_load_dwordx4 v249, s[8:11], s62 offen offset:1024 nt lds
    v_add_f32 v241, v241, v163
    v_cvt_pk_bf16_f32 v199, v162, v163
    v_mfma_f32_16x16x32_bf16 v[148:151], v[216:219], v[124:127], v[148:151]
    ds_read_b128 v[216:219], v236 offset:704
    s_waitcnt lgkmcnt(3)
    v_mfma_f32_16x16x32_bf16 v[0:3], v[220:223], v[192:195], v[0:3]
    ds_read_b128 v[212:215], v236 offset:640
    v_mfma_f32_16x16x32_bf16 v[32:35], v[220:223], v[196:199], v[32:35]
    ds_read_b64_tr_b16 v[220:221], v237 offset:1152
    ds_read_b64_tr_b16 v[222:223], v237 offset:1664
    s_add_u32 m0, s71, 47296
    v_mfma_f32_16x16x32_bf16 v[4:7], v[224:227], v[192:195], v[4:7]
    buffer_load_dwordx4 v249, s[8:11], s62 offen offset:2048 nt lds
    v_exp_f32 v144, v144
    v_mfma_f32_16x16x32_bf16 v[36:39], v[224:227], v[196:199], v[36:39]
    v_exp_f32 v145, v145
    v_mfma_f32_16x16x32_bf16 v[8:11], v[228:231], v[192:195], v[8:11]
    v_exp_f32 v146, v146
    v_mfma_f32_16x16x32_bf16 v[40:43], v[228:231], v[196:199], v[40:43]
    ds_read_b64_tr_b16 v[224:225], v237 offset:1184
    ds_read_b64_tr_b16 v[226:227], v237 offset:1696
    ds_read_b64_tr_b16 v[228:229], v237 offset:1216
    ds_read_b64_tr_b16 v[230:231], v237 offset:1728
    s_add_u32 m0, s71, 54496
    v_mfma_f32_16x16x32_bf16 v[12:15], v[232:235], v[192:195], v[12:15]
    buffer_load_dwordx4 v249, s[8:11], s62 offen offset:3072 nt lds
    v_exp_f32 v147, v147
    v_mfma_f32_16x16x32_bf16 v[44:47], v[232:235], v[196:199], v[44:47]
    ds_read_b64_tr_b16 v[232:233], v237 offset:1248
    ds_read_b64_tr_b16 v[234:235], v237 offset:1760
    v_add_f32 v240, v240, v144
    v_exp_f32 v148, v148
    s_waitcnt lgkmcnt(8)
    v_mfma_f32_16x16x32_bf16 v[156:159], v[204:207], v[96:99], v[168:171]
    v_add_f32 v240, v240, v145
    v_mfma_f32_16x16x32_bf16 v[160:163], v[204:207], v[112:115], v[172:175]
    v_exp_f32 v149, v149
    v_cvt_pk_bf16_f32 v180, v144, v145
    v_add_f32 v240, v240, v146
    v_mfma_f32_16x16x32_bf16 v[156:159], v[208:211], v[100:103], v[156:159]
    v_exp_f32 v150, v150
    s_lshr_b32 s61, s60, 4
    s_add_u32 s61, s61, s32
    s_and_b32 s61, s61, 3
    s_lshl_b32 s61, s61, 17
    s_add_u32 s62, s60, s47
    s_and_b32 s62, s62, 15
    s_lshl_b32 s62, s62, 13
    s_add_u32 s61, s61, s62
    s_add_u32 s61, s61, s58
    v_mfma_f32_16x16x32_bf16 v[160:163], v[208:211], v[116:119], v[160:163]
    v_add_f32 v240, v240, v147
    s_and_b32 s62, s60, 3
    s_lshl_b32 s62, s62, 10
    s_add_u32 s71, s62, s59
    s_cmp_ge_i32 s60, 64
    s_cselect_b32 s61, 0x4000000, s61
    s_cselect_b32 s71, 0x30000, s71
    s_add_u32 s62, s61, 4096
    s_add_u32 s60, s60, 1
    v_mfma_f32_16x16x32_bf16 v[156:159], v[212:215], v[104:107], v[156:159]
    v_exp_f32 v151, v151
    v_cvt_pk_bf16_f32 v181, v146, v147
    v_add_f32 v241, v241, v148
    v_mfma_f32_16x16x32_bf16 v[160:163], v[212:215], v[120:123], v[160:163]
    v_add_f32 v241, v241, v149
    v_mfma_f32_16x16x32_bf16 v[156:159], v[216:219], v[108:111], v[156:159]
    v_cvt_pk_bf16_f32 v184, v148, v149
    v_add_f32 v241, v241, v150
    v_mfma_f32_16x16x32_bf16 v[160:163], v[216:219], v[124:127], v[160:163]
    v_add_f32 v241, v241, v151
    v_cvt_pk_bf16_f32 v185, v150, v151
    v_xor_b32 v237, 0x800, v237
    s_waitcnt vmcnt(12) lgkmcnt(0)
    s_barrier
L_A2_loop:
    ds_read_b128 v[204:207], v236 offset:1024
    ds_read_b128 v[208:211], v236 offset:1088
    ds_read_b128 v[212:215], v236 offset:1152
    s_nop 0
    v_mfma_f32_16x16x32_bf16 v[16:19], v[220:223], v[192:195], v[16:19]
    ds_read_b128 v[216:219], v236 offset:1216
    v_mfma_f32_16x16x32_bf16 v[48:51], v[220:223], v[196:199], v[48:51]
    ds_read_b64_tr_b16 v[220:221], v237 offset:0
    ds_read_b64_tr_b16 v[222:223], v237 offset:512
    v_exp_f32 v156, v156
    s_add_u32 m0, s71, 14400
    v_mfma_f32_16x16x32_bf16 v[20:23], v[224:227], v[192:195], v[20:23]
    buffer_load_dwordx4 v249, s[8:11], s61 offen offset:2048 nt lds
    v_exp_f32 v157, v157
    v_mfma_f32_16x16x32_bf16 v[52:55], v[224:227], v[196:199], v[52:55]
    ds_read_b64_tr_b16 v[224:225], v237 offset:32
    ds_read_b64_tr_b16 v[226:227], v237 offset:544
    v_exp_f32 v158, v158
    v_mfma_f32_16x16x32_bf16 v[24:27], v[228:231], v[192:195], v[24:27]
    v_exp_f32 v159, v159
    v_mfma_f32_16x16x32_bf16 v[56:59], v[228:231], v[196:199], v[56:59]
    ds_read_b64_tr_b16 v[228:229], v237 offset:64
    ds_read_b64_tr_b16 v[230:231], v237 offset:576
    v_add_f32 v240, v240, v156
    s_add_u32 m0, s71, 21600
    v_mfma_f32_16x16x32_bf16 v[28:31], v[232:235], v[192:195], v[28:31]
    buffer_load_dwordx4 v249, s[8:11], s61 offen offset:3072 nt lds
    v_exp_f32 v160, v160
    v_mfma_f32_16x16x32_bf16 v[60:63], v[232:235], v[196:199], v[60:63]
    ds_read_b64_tr_b16 v[232:233], v237 offset:96
    ds_read_b64_tr_b16 v[234:235], v237 offset:608
    v_add_f32 v240, v240, v157
    s_waitcnt lgkmcnt(8)
    v_mfma_f32_16x16x32_bf16 v[144:147], v[204:207], v[96:99], v[168:171]
    v_exp_f32 v161, v161
    v_cvt_pk_bf16_f32 v182, v156, v157
    v_mfma_f32_16x16x32_bf16 v[148:151], v[204:207], v[112:115], v[172:175]
    ds_read_b128 v[204:207], v236 offset:1536
    v_add_f32 v240, v240, v158
    v_exp_f32 v162, v162
    s_add_u32 m0, s71, 32896
    v_mfma_f32_16x16x32_bf16 v[144:147], v[208:211], v[100:103], v[144:147]
    buffer_load_dwordx4 v249, s[8:11], s62 offen nt lds
    v_add_f32 v240, v240, v159
    v_mfma_f32_16x16x32_bf16 v[148:151], v[208:211], v[116:119], v[148:151]
    ds_read_b128 v[208:211], v236 offset:1600
    v_exp_f32 v163, v163
    v_mfma_f32_16x16x32_bf16 v[144:147], v[212:215], v[104:107], v[144:147]
    v_cvt_pk_bf16_f32 v183, v158, v159
    v_add_f32 v241, v241, v160
    v_mfma_f32_16x16x32_bf16 v[148:151], v[212:215], v[120:123], v[148:151]
    v_add_f32 v241, v241, v161
    v_cvt_pk_bf16_f32 v186, v160, v161
    v_add_f32 v241, v241, v162
    s_add_u32 m0, s71, 40096
    v_mfma_f32_16x16x32_bf16 v[144:147], v[216:219], v[108:111], v[144:147]
    buffer_load_dwordx4 v249, s[8:11], s62 offen offset:1024 nt lds
    v_add_f32 v241, v241, v163
    v_cvt_pk_bf16_f32 v187, v162, v163
    v_mfma_f32_16x16x32_bf16 v[148:151], v[216:219], v[124:127], v[148:151]
    ds_read_b128 v[216:219], v236 offset:1728
    s_waitcnt lgkmcnt(3)
    v_mfma_f32_16x16x32_bf16 v[0:3], v[220:223], v[180:183], v[0:3]
    ds_read_b128 v[212:215], v236 offset:1664
    v_mfma_f32_16x16x32_bf16 v[32:35], v[220:223], v[184:187], v[32:35]
    ds_read_b64_tr_b16 v[220:221], v237 offset:128
    ds_read_b64_tr_b16 v[222:223], v237 offset:640
    s_add_u32 m0, s71, 47296
    v_mfma_f32_16x16x32_bf16 v[4:7], v[224:227], v[180:183], v[4:7]
    buffer_load_dwordx4 v249, s[8:11], s62 offen offset:2048 nt lds
    v_exp_f32 v144, v144
    v_mfma_f32_16x16x32_bf16 v[36:39], v[224:227], v[184:187], v[36:39]
    v_exp_f32 v145, v145
    v_mfma_f32_16x16x32_bf16 v[8:11], v[228:231], v[180:183], v[8:11]
    v_exp_f32 v146, v146
    v_mfma_f32_16x16x32_bf16 v[40:43], v[228:231], v[184:187], v[40:43]
    ds_read_b64_tr_b16 v[224:225], v237 offset:160
    ds_read_b64_tr_b16 v[226:227], v237 offset:672
    ds_read_b64_tr_b16 v[228:229], v237 offset:192
    ds_read_b64_tr_b16 v[230:231], v237 offset:704
    s_add_u32 m0, s71, 54496
    v_mfma_f32_16x16x32_bf16 v[12:15], v[232:235], v[180:183], v[12:15]
    buffer_load_dwordx4 v249, s[8:11], s62 offen offset:3072 nt lds
    v_exp_f32 v147, v147
    v_mfma_f32_16x16x32_bf16 v[44:47], v[232:235], v[184:187], v[44:47]
    ds_read_b64_tr_b16 v[232:233], v237 offset:224
    ds_read_b64_tr_b16 v[234:235], v237 offset:736
    v_add_f32 v240, v240, v144
    v_exp_f32 v148, v148
    s_waitcnt lgkmcnt(8)
    v_mfma_f32_16x16x32_bf16 v[156:159], v[204:207], v[96:99], v[168:171]
    v_add_f32 v240, v240, v145
    v_mfma_f32_16x16x32_bf16 v[160:163], v[204:207], v[112:115], v[172:175]
    v_exp_f32 v149, v149
    v_cvt_pk_bf16_f32 v192, v144, v145
    v_add_f32 v240, v240, v146
    v_mfma_f32_16x16x32_bf16 v[156:159], v[208:211], v[100:103], v[156:159]
    v_exp_f32 v150, v150
    s_lshr_b32 s61, s60, 4
    s_add_u32 s61, s61, s32
    s_and_b32 s61, s61, 3
    s_lshl_b32 s61, s61, 17
    s_add_u32 s62, s60, s47
    s_and_b32 s62, s62, 15
    s_lshl_b32 s62, s62, 13
    s_add_u32 s61, s61, s62
    s_add_u32 s61, s61, s58
    v_mfma_f32_16x16x32_bf16 v[160:163], v[208:211], v[116:119], v[160:163]
    v_add_f32 v240, v240, v147
    s_and_b32 s62, s60, 3
    s_lshl_b32 s62, s62, 10
    s_add_u32 s71, s62, s59
    s_cmp_ge_i32 s60, 64
    s_cselect_b32 s61, 0x4000000, s61
    s_cselect_b32 s71, 0x30000, s71
    s_add_u32 s62, s61, 4096
    s_add_u32 s60, s60, 1
    v_mfma_f32_16x16x32_bf16 v[156:159], v[212:215], v[104:107], v[156:159]
    v_exp_f32 v151, v151
    v_cvt_pk_bf16_f32 v193, v146, v147
    v_add_f32 v241, v241, v148
    v_mfma_f32_16x16x32_bf16 v[160:163], v[212:215], v[120:123], v[160:163]
    v_add_f32 v241, v241, v149
    v_mfma_f32_16x16x32_bf16 v[156:159], v[216:219], v[108:111], v[156:159]
    v_cvt_pk_bf16_f32 v196, v148, v149
    v_add_f32 v241, v241, v150
    v_mfma_f32_16x16x32_bf16 v[160:163], v[216:219], v[124:127], v[160:163]
    v_add_f32 v241, v241, v151
    v_cvt_pk_bf16_f32 v197, v150, v151
    v_xor_b32 v236, 0x800, v236
    s_waitcnt vmcnt(12) lgkmcnt(0)
    s_barrier
    s_cmp_eq_u32 s51, 6
    s_cbranch_scc1 L_A2_e15
    s_add_u32 s51, s51, 1
    ds_read_b128 v[204:207], v236 offset:0
    ds_read_b128 v[208:211], v236 offset:64
    ds_read_b128 v[212:215], v236 offset:128
    s_nop 0
    v_mfma_f32_16x16x32_bf16 v[16:19], v[220:223], v[180:183], v[16:19]
    ds_read_b128 v[216:219], v236 offset:192
    v_mfma_f32_16x16x32_bf16 v[48:51], v[220:223], v[184:187], v[48:51]
    ds_read_b64_tr_b16 v[220:221], v237 offset:1024
    ds_read_b64_tr_b16 v[222:223], v237 offset:1536
    v_exp_f32 v156, v156
    s_add_u32 m0, s71, 14400
    v_mfma_f32_16x16x32_bf16 v[20:23], v[224:227], v[180:183], v[20:23]
    buffer_load_dwordx4 v249, s[8:11], s61 offen offset:2048 nt lds
    v_exp_f32 v157, v157
    v_mfma_f32_16x16x32_bf16 v[52:55], v[224:227], v[184:187], v[52:55]
    ds_read_b64_tr_b16 v[224:225], v237 offset:1056
    ds_read_b64_tr_b16 v[226:227], v237 offset:1568
    v_exp_f32 v158, v158
    v_mfma_f32_16x16x32_bf16 v[24:27], v[228:231], v[180:183], v[24:27]
    v_exp_f32 v159, v159
    v_mfma_f32_16x16x32_bf16 v[56:59], v[228:231], v[184:187], v[56:59]
    ds_read_b64_tr_b16 v[228:229], v237 offset:1088
    ds_read_b64_tr_b16 v[230:231], v237 offset:1600
    v_add_f32 v240, v240, v156
    s_add_u32 m0, s71, 21600
    v_mfma_f32_16x16x32_bf16 v[28:31], v[232:235], v[180:183], v[28:31]
    buffer_load_dwordx4 v249, s[8:11], s61 offen offset:3072 nt lds
    v_exp_f32 v160, v160
    v_mfma_f32_16x16x32_bf16 v[60:63], v[232:235], v[184:187], v[60:63]
    ds_read_b64_tr_b16 v[232:233], v237 offset:1120
    ds_read_b64_tr_b16 v[234:235], v237 offset:1632
    v_add_f32 v240, v240, v157
    s_waitcnt lgkmcnt(8)
    v_mfma_f32_16x16x32_bf16 v[144:147], v[204:207], v[96:99], v[168:171]
    v_exp_f32 v161, v161
    v_cvt_pk_bf16_f32 v194, v156, v157
    v_mfma_f32_16x16x32_bf16 v[148:151], v[204:207], v[112:115], v[172:175]
    ds_read_b128 v[204:207], v236 offset:512
    v_add_f32 v240, v240, v158
    v_exp_f32 v162, v162
    s_add_u32 m0, s71, 32896
    v_mfma_f32_16x16x32_bf16 v[144:147], v[208:211], v[100:103], v[144:147]
    buffer_load_dwordx4 v249, s[8:11], s62 offen nt lds
    v_add_f32 v240, v240, v159
    v_mfma_f32_16x16x32_bf16 v[148:151], v[208:211], v[116:119], v[148:151]
    ds_read_b128 v[208:211], v236 offset:576
    v_exp_f32 v163, v163
    v_mfma_f32_16x16x32_bf16 v[144:147], v[212:215], v[104:107], v[144:147]
    v_cvt_pk_bf16_f32 v195, v158, v159
    v_add_f32 v241, v241, v160
    v_mfma_f32_16x16x32_bf16 v[148:151], v[212:215], v[120:123], v[148:151]
    v_add_f32 v241, v241, v161
    v_cvt_pk_bf16_f32 v198, v160, v161
    v_add_f32 v241, v241, v162
    s_add_u32 m0, s71, 40096
    v_mfma_f32_16x16x32_bf16 v[144:147], v[216:219], v[108:111], v[144:147]
    buffer_load_dwordx4 v249, s[8:11], s62 offen offset:1024 nt lds
    v_add_f32 v241, v241, v163
    v_cvt_pk_bf16_f32 v199, v162, v163
    v_mfma_f32_16x16x32_bf16 v[148:151], v[216:219], v[124:127], v[148:151]
    ds_read_b128 v[216:219], v236 offset:704
    s_waitcnt lgkmcnt(3)
    v_mfma_f32_16x16x32_bf16 v[0:3], v[220:223], v[192:195], v[0:3]
    ds_read_b128 v[212:215], v236 offset:640
    v_mfma_f32_16x16x32_bf16 v[32:35], v[220:223], v[196:199], v[32:35]
    ds_read_b64_tr_b16 v[220:221], v237 offset:1152
    ds_read_b64_tr_b16 v[222:223], v237 offset:1664
    s_add_u32 m0, s71, 47296
    v_mfma_f32_16x16x32_bf16 v[4:7], v[224:227], v[192:195], v[4:7]
    buffer_load_dwordx4 v249, s[8:11], s62 offen offset:2048 nt lds
    v_exp_f32 v144, v144
    v_mfma_f32_16x16x32_bf16 v[36:39], v[224:227], v[196:199], v[36:39]
    v_exp_f32 v145, v145
    v_mfma_f32_16x16x32_bf16 v[8:11], v[228:231], v[192:195], v[8:11]
    v_exp_f32 v146, v146
    v_mfma_f32_16x16x32_bf16 v[40:43], v[228:231], v[196:199], v[40:43]
    ds_read_b64_tr_b16 v[224:225], v237 offset:1184
    ds_read_b64_tr_b16 v[226:227], v237 offset:1696
    ds_read_b64_tr_b16 v[228:229], v237 offset:1216
    ds_read_b64_tr_b16 v[230:231], v237 offset:1728
    s_add_u32 m0, s71, 54496
    v_mfma_f32_16x16x32_bf16 v[12:15], v[232:235], v[192:195], v[12:15]
    buffer_load_dwordx4 v249, s[8:11], s62 offen offset:3072 nt lds
    v_exp_f32 v147, v147
    v_mfma_f32_16x16x32_bf16 v[44:47], v[232:235], v[196:199], v[44:47]
    ds_read_b64_tr_b16 v[232:233], v237 offset:1248
    ds_read_b64_tr_b16 v[234:235], v237 offset:1760
    v_add_f32 v240, v240, v144
    v_exp_f32 v148, v148
    s_waitcnt lgkmcnt(8)
    v_mfma_f32_16x16x32_bf16 v[156:159], v[204:207], v[96:99], v[168:171]
    v_add_f32 v240, v240, v145
    v_mfma_f32_16x16x32_bf16 v[160:163], v[204:207], v[112:115], v[172:175]
    v_exp_f32 v149, v149
    v_cvt_pk_bf16_f32 v180, v144, v145
    v_add_f32 v240, v240, v146
    v_mfma_f32_16x16x32_bf16 v[156:159], v[208:211], v[100:103], v[156:159]
    v_exp_f32 v150, v150
    s_lshr_b32 s61, s60, 4
    s_add_u32 s61, s61, s32
    s_and_b32 s61, s61, 3
    s_lshl_b32 s61, s61, 17
    s_add_u32 s62, s60, s47
    s_and_b32 s62, s62, 15
    s_lshl_b32 s62, s62, 13
    s_add_u32 s61, s61, s62
    s_add_u32 s61, s61, s58
    v_mfma_f32_16x16x32_bf16 v[160:163], v[208:211], v[116:119], v[160:163]
    v_add_f32 v240, v240, v147
    s_and_b32 s62, s60, 3
    s_lshl_b32 s62, s62, 10
    s_add_u32 s71, s62, s59
    s_cmp_ge_i32 s60, 64
    s_cselect_b32 s61, 0x4000000, s61
    s_cselect_b32 s71, 0x30000, s71
    s_add_u32 s62, s61, 4096
    s_add_u32 s60, s60, 1
    v_mfma_f32_16x16x32_bf16 v[156:159], v[212:215], v[104:107], v[156:159]
    v_exp_f32 v151, v151
    v_cvt_pk_bf16_f32 v181, v146, v147
    v_add_f32 v241, v241, v148
    v_mfma_f32_16x16x32_bf16 v[160:163], v[212:215], v[120:123], v[160:163]
    v_add_f32 v241, v241, v149
    v_mfma_f32_16x16x32_bf16 v[156:159], v[216:219], v[108:111], v[156:159]
    v_cvt_pk_bf16_f32 v184, v148, v149
    v_add_f32 v241, v241, v150
    v_mfma_f32_16x16x32_bf16 v[160:163], v[216:219], v[124:127], v[160:163]
    v_add_f32 v241, v241, v151
    v_cvt_pk_bf16_f32 v185, v150, v151
    v_xor_b32 v237, 0x800, v237
    s_waitcnt vmcnt(12) lgkmcnt(0)
    s_barrier
    s_branch L_A2_loop
L_A2_e15:
    s_cmp_eq_u32 s50, 3
    s_cbranch_scc1 L_A2_last
    s_add_u32 s50, s50, 1
    ds_read_b64_tr_b16 v[204:205], v237 offset:1024
    ds_read_b64_tr_b16 v[206:207], v237 offset:1536
    s_nop 1
    v_mfma_f32_16x16x32_bf16 v[16:19], v[220:223], v[180:183], v[16:19]
    ds_read_b64_tr_b16 v[208:209], v237 offset:1056
    ds_read_b64_tr_b16 v[210:211], v237 offset:1568
    v_mfma_f32_16x16x32_bf16 v[48:51], v[220:223], v[184:187], v[48:51]
    ds_read_b64_tr_b16 v[220:221], v237 offset:1152
    ds_read_b64_tr_b16 v[222:223], v237 offset:1664
    ds_read_b64_tr_b16 v[212:213], v237 offset:1088
    ds_read_b64_tr_b16 v[214:215], v237 offset:1600
    v_exp_f32 v156, v156
    s_add_u32 m0, s71, 14400
    v_mfma_f32_16x16x32_bf16 v[20:23], v[224:227], v[180:183], v[20:23]
    buffer_load_dwordx4 v249, s[8:11], s61 offen offset:2048 nt lds
    ds_read_b64_tr_b16 v[216:217], v237 offset:1120
    ds_read_b64_tr_b16 v[218:219], v237 offset:1632
    v_exp_f32 v157, v157
    v_exp_f32 v158, v158
    v_mfma_f32_16x16x32_bf16 v[52:55], v[224:227], v[184:187], v[52:55]
    ds_read_b64_tr_b16 v[224:225], v237 offset:1184
    ds_read_b64_tr_b16 v[226:227], v237 offset:1696
    v_exp_f32 v159, v159
    v_add_f32 v240, v240, v156
    v_exp_f32 v160, v160
    s_add_u32 m0, s71, 21600
    v_mfma_f32_16x16x32_bf16 v[24:27], v[228:231], v[180:183], v[24:27]
    buffer_load_dwordx4 v249, s[8:11], s61 offen offset:3072 nt lds
    v_add_f32 v240, v240, v157
    v_exp_f32 v161, v161
    v_cvt_pk_bf16_f32 v194, v156, v157
    v_add_f32 v240, v240, v158
    v_exp_f32 v162, v162
    v_mfma_f32_16x16x32_bf16 v[56:59], v[228:231], v[184:187], v[56:59]
    ds_read_b64_tr_b16 v[228:229], v237 offset:1216
    ds_read_b64_tr_b16 v[230:231], v237 offset:1728
    v_add_f32 v240, v240, v159
    v_exp_f32 v163, v163
    v_cvt_pk_bf16_f32 v195, v158, v159
    v_mfma_f32_16x16x32_bf16 v[28:31], v[232:235], v[180:183], v[28:31]
    v_add_f32 v241, v241, v160
    v_add_f32 v241, v241, v161
    v_cvt_pk_bf16_f32 v198, v160, v161
    v_add_f32 v241, v241, v162
    v_add_f32 v241, v241, v163
    v_cvt_pk_bf16_f32 v199, v162, v163
    s_add_u32 m0, s71, 32896
    v_mfma_f32_16x16x32_bf16 v[60:63], v[232:235], v[184:187], v[60:63]
    buffer_load_dwordx4 v249, s[8:11], s62 offen nt lds
    ds_read_b64_tr_b16 v[232:233], v237 offset:1248
    ds_read_b64_tr_b16 v[234:235], v237 offset:1760
    v_mov_b32 v243, v240
    v_mov_b32 v244, v241
    v_mov_b32 v246, v243
    s_waitcnt lgkmcnt(14)
    v_mfma_f32_16x16x32_bf16 v[0:3], v[204:207], v[192:195], v[0:3]
    v_mov_b32 v247, v244
    v_permlane16_swap_b32 v243, v246
    s_nop 0
    v_permlane16_swap_b32 v244, v247
    v_add_f32 v243, v243, v246
    v_add_f32 v244, v244, v247
    v_mfma_f32_16x16x32_bf16 v[32:35], v[204:207], v[196:199], v[32:35]
    v_mov_b32 v246, v243
    v_mov_b32 v247, v244
    s_nop 0
    v_permlane32_swap_b32 v243, v246
    v_permlane32_swap_b32 v244, v247
    v_add_f32 v243, v243, v246
    s_add_u32 m0, s71, 40096
    s_waitcnt lgkmcnt(12)
    v_mfma_f32_16x16x32_bf16 v[4:7], v[208:211], v[192:195], v[4:7]
    buffer_load_dwordx4 v249, s[8:11], s62 offen offset:1024 nt lds
    v_add_f32 v244, v244, v247
    v_cmp_ngt_f32 vcc, s56, v243
    s_or_b64 s[48:49], s[48:49], vcc
    v_rcp_f32 v243, v243
    v_mfma_f32_16x16x32_bf16 v[36:39], v[208:211], v[196:199], v[36:39]
    v_cmp_ngt_f32 vcc, s56, v244
    s_or_b64 s[48:49], s[48:49], vcc
    v_rcp_f32 v244, v244
    s_add_u32 m0, s71, 47296
    s_waitcnt lgkmcnt(8)
    v_mfma_f32_16x16x32_bf16 v[8:11], v[212:215], v[192:195], v[8:11]
    buffer_load_dwordx4 v249, s[8:11], s62 offen offset:2048 nt lds
    v_mul_f32 v0, v0, v243
    v_mul_f32 v1, v1, v243
    v_mul_f32 v2, v2, v243
    v_mul_f32 v3, v3, v243
    v_mfma_f32_16x16x32_bf16 v[40:43], v[212:215], v[196:199], v[40:43]
    v_mul_f32 v4, v4, v243
    v_mul_f32 v5, v5, v243
    v_mul_f32 v6, v6, v243
    v_mul_f32 v7, v7, v243
    s_waitcnt lgkmcnt(6)
    v_mfma_f32_16x16x32_bf16 v[12:15], v[216:219], v[192:195], v[12:15]
    v_cvt_pk_bf16_f32 v0, v0, v1
    v_cvt_pk_bf16_f32 v1, v2, v3
    v_cvt_pk_bf16_f32 v2, v4, v5
    v_cvt_pk_bf16_f32 v3, v6, v7
    s_add_u32 m0, s71, 54496
    v_mfma_f32_16x16x32_bf16 v[44:47], v[216:219], v[196:199], v[44:47]
    buffer_load_dwordx4 v249, s[8:11], s62 offen offset:3072 nt lds
    v_mul_f32 v32, v32, v244
    v_mul_f32 v33, v33, v244
    v_mul_f32 v34, v34, v244
    v_mul_f32 v35, v35, v244
    v_mfma_f32_16x16x32_bf16 v[16:19], v[220:223], v[192:195], v[16:19]
    v_mul_f32 v36, v36, v244
    v_mul_f32 v37, v37, v244
    v_mul_f32 v38, v38, v244
    v_mul_f32 v39, v39, v244
    v_mfma_f32_16x16x32_bf16 v[48:51], v[220:223], v[196:199], v[48:51]
    v_cvt_pk_bf16_f32 v32, v32, v33
    v_cvt_pk_bf16_f32 v33, v34, v35
    v_cvt_pk_bf16_f32 v34, v36, v37
    v_cvt_pk_bf16_f32 v35, v38, v39
    s_waitcnt lgkmcnt(4)
    v_mfma_f32_16x16x32_bf16 v[20:23], v[224:227], v[192:195], v[20:23]
    v_mul_f32 v8, v8, v243
    v_mul_f32 v9, v9, v243
    v_mul_f32 v10, v10, v243
    v_mul_f32 v11, v11, v243
    s_lshr_b32 s61, s60, 4
    s_add_u32 s61, s61, s32
    s_and_b32 s61, s61, 3
    s_lshl_b32 s61, s61, 17
    s_add_u32 s62, s60, s47
    s_and_b32 s62, s62, 15
    s_lshl_b32 s62, s62, 13
    s_add_u32 s61, s61, s62
    s_add_u32 s61, s61, s58
    v_mfma_f32_16x16x32_bf16 v[52:55], v[224:227], v[196:199], v[52:55]
    v_mul_f32 v12, v12, v243
    v_mul_f32 v13, v13, v243
    v_mul_f32 v14, v14, v243
    v_mul_f32 v15, v15, v243
    s_and_b32 s62, s60, 3
    s_lshl_b32 s62, s62, 10
    s_add_u32 s71, s62, s59
    s_cmp_ge_i32 s60, 64
    s_cselect_b32 s61, 0x4000000, s61
    s_cselect_b32 s71, 0x30000, s71
    s_add_u32 s62, s61, 4096
    s_add_u32 s60, s60, 1
    s_waitcnt lgkmcnt(2)
    v_mfma_f32_16x16x32_bf16 v[24:27], v[228:231], v[192:195], v[24:27]
    v_cvt_pk_bf16_f32 v8, v8, v9
    v_cvt_pk_bf16_f32 v9, v10, v11
    v_cvt_pk_bf16_f32 v10, v12, v13
    v_cvt_pk_bf16_f32 v11, v14, v15
    v_mfma_f32_16x16x32_bf16 v[56:59], v[228:231], v[196:199], v[56:59]
    v_mul_f32 v40, v40, v244
    v_mul_f32 v41, v41, v244
    v_mul_f32 v42, v42, v244
    v_mul_f32 v43, v43, v244
    s_waitcnt lgkmcnt(0)
    v_mfma_f32_16x16x32_bf16 v[28:31], v[232:235], v[192:195], v[28:31]
    v_mul_f32 v44, v44, v244
    v_mul_f32 v45, v45, v244
    v_mul_f32 v46, v46, v244
    v_mul_f32 v47, v47, v244
    v_mfma_f32_16x16x32_bf16 v[60:63], v[232:235], v[196:199], v[60:63]
    v_cvt_pk_bf16_f32 v40, v40, v41
    v_cvt_pk_bf16_f32 v41, v42, v43
    v_cvt_pk_bf16_f32 v42, v44, v45
    v_cvt_pk_bf16_f32 v43, v46, v47
    v_xor_b32 v237, 0x800, v237
    s_waitcnt vmcnt(12) lgkmcnt(0)
    s_barrier
    ds_read_b128 v[204:207], v236 offset:0
    ds_read_b128 v[96:99], v239 offset:0
    ds_read_b128 v[112:115], v239 offset:4096
    ds_read_b128 v[208:211], v236 offset:64
    ds_read_b128 v[100:103], v239 offset:1024
    ds_read_b128 v[116:119], v239 offset:5120
    s_waitcnt lgkmcnt(4)
    v_mfma_f32_16x16x32_bf16 v[144:147], v[204:207], v[96:99], 0
    ds_read_b128 v[212:215], v236 offset:128
    ds_read_b128 v[104:107], v239 offset:2048
    s_waitcnt lgkmcnt(5)
    v_mfma_f32_16x16x32_bf16 v[148:151], v[204:207], v[112:115], 0
    ds_read_b128 v[120:123], v239 offset:6144
    ds_read_b128 v[216:219], v236 offset:192
    s_waitcnt lgkmcnt(5)
    v_mfma_f32_16x16x32_bf16 v[144:147], v[208:211], v[100:103], v[144:147]
    ds_read_b128 v[108:111], v239 offset:3072
    s_waitcnt lgkmcnt(5)
    v_mfma_f32_16x16x32_bf16 v[148:151], v[208:211], v[116:119], v[148:151]
    ds_read_b128 v[124:127], v239 offset:7168
    ds_read_b128 v[220:223], v236 offset:512
    s_waitcnt lgkmcnt(5)
    v_mfma_f32_16x16x32_bf16 v[144:147], v[212:215], v[104:107], v[144:147]
    ds_read_b128 v[224:227], v236 offset:576
    ds_read_b128 v[228:231], v236 offset:640
    s_waitcnt lgkmcnt(6)
    v_mfma_f32_16x16x32_bf16 v[148:151], v[212:215], v[120:123], v[148:151]
    ds_read_b128 v[232:235], v236 offset:704
    s_waitcnt lgkmcnt(5)
    v_mfma_f32_16x16x32_bf16 v[144:147], v[216:219], v[108:111], v[144:147]
    s_waitcnt lgkmcnt(4)
    v_mfma_f32_16x16x32_bf16 v[148:151], v[216:219], v[124:127], v[148:151]
    s_nop 5
    v_max3_f32 v171, v144, v145, v146
    s_nop 0
    v_max3_f32 v175, v148, v149, v150
    v_max_f32 v171, v171, v147
    v_max_f32 v175, v175, v151
    v_mov_b32 v168, v171
    v_mov_b32 v172, v175
    ds_write_b128 v239, v[0:3] offset:0
    v_permlane16_swap_b32 v171, v168
    v_permlane16_swap_b32 v175, v172
    v_max_f32 v171, v171, v168
    v_max_f32 v175, v175, v172
    v_mov_b32 v168, v171
    v_mov_b32 v172, v175
    s_nop 0
    v_permlane32_swap_b32 v171, v168
    v_permlane32_swap_b32 v175, v172
    v_max_f32 v171, v171, v168
    v_max_f32 v175, v175, v172
    v_sub_f32 v168, 0, v171
    v_sub_f32 v172, 0, v175
    ds_write_b128 v239, v[32:35] offset:4096
    v_sub_f32 v169, 0, v171
    v_sub_f32 v173, 0, v175
    v_sub_f32 v170, 0, v171
    v_sub_f32 v174, 0, v175
    v_sub_f32 v171, 0, v171
    v_sub_f32 v175, 0, v175
    s_waitcnt lgkmcnt(5)
    v_mfma_f32_16x16x32_bf16 v[156:159], v[220:223], v[96:99], v[168:171]
    v_add_f32 v144, v144, v168
    v_add_f32 v145, v145, v168
    v_add_f32 v146, v146, v168
    v_add_f32 v147, v147, v168
    v_add_f32 v148, v148, v172
    v_mfma_f32_16x16x32_bf16 v[160:163], v[220:223], v[112:115], v[172:175]
    v_add_f32 v149, v149, v172
    v_add_f32 v150, v150, v172
    ds_write_b128 v239, v[8:11] offset:1024
    s_waitcnt lgkmcnt(5)
    v_mfma_f32_16x16x32_bf16 v[156:159], v[224:227], v[100:103], v[156:159]
    v_add_f32 v151, v151, v172
    v_exp_f32 v144, v144
    v_exp_f32 v145, v145
    v_mfma_f32_16x16x32_bf16 v[160:163], v[224:227], v[116:119], v[160:163]
    v_exp_f32 v146, v146
    v_exp_f32 v147, v147
    v_add_f32 v240, v144, v145
    s_waitcnt lgkmcnt(4)
    v_mfma_f32_16x16x32_bf16 v[156:159], v[228:231], v[104:107], v[156:159]
    v_exp_f32 v148, v148
    v_cvt_pk_bf16_f32 v180, v144, v145
    v_exp_f32 v149, v149
    v_mfma_f32_16x16x32_bf16 v[160:163], v[228:231], v[120:123], v[160:163]
    v_add_f32 v240, v240, v146
    v_exp_f32 v150, v150
    v_add_f32 v240, v240, v147
    v_exp_f32 v151, v151
    s_waitcnt lgkmcnt(3)
    v_mfma_f32_16x16x32_bf16 v[156:159], v[232:235], v[108:111], v[156:159]
    ds_write_b128 v239, v[40:43] offset:5120
    v_cvt_pk_bf16_f32 v181, v146, v147
    v_mfma_f32_16x16x32_bf16 v[160:163], v[232:235], v[124:127], v[160:163]
    v_add_f32 v241, v148, v149
    v_cvt_pk_bf16_f32 v184, v148, v149
    v_add_f32 v241, v241, v150
    v_add_f32 v241, v241, v151
    v_cvt_pk_bf16_f32 v185, v150, v151
    s_waitcnt vmcnt(12) lgkmcnt(0)
    s_barrier
    ds_read_b128 v[204:207], v236 offset:1024
    ds_read_b128 v[208:211], v236 offset:1088
    ds_read_b128 v[212:215], v236 offset:1152
    ds_read_b128 v[216:219], v236 offset:1216
    s_waitcnt lgkmcnt(3)
    v_mfma_f32_16x16x32_bf16 v[144:147], v[204:207], v[96:99], v[168:171]
    ds_read_b64_tr_b16 v[220:221], v237 offset:0
    ds_read_b64_tr_b16 v[222:223], v237 offset:512
    v_exp_f32 v156, v156
    v_exp_f32 v157, v157
    v_mfma_f32_16x16x32_bf16 v[148:151], v[204:207], v[112:115], v[172:175]
    ds_read_b128 v[204:207], v236 offset:1536
    ds_read_b64_tr_b16 v[224:225], v237 offset:32
    ds_read_b64_tr_b16 v[226:227], v237 offset:544
    v_exp_f32 v158, v158
    s_add_u32 m0, s71, 14400
    s_waitcnt lgkmcnt(7)
    v_mfma_f32_16x16x32_bf16 v[144:147], v[208:211], v[100:103], v[144:147]
    buffer_load_dwordx4 v249, s[8:11], s61 offen offset:2048 nt lds
    ds_read_b64_tr_b16 v[228:229], v237 offset:64
    ds_read_b64_tr_b16 v[230:231], v237 offset:576
    v_exp_f32 v159, v159
    v_add_f32 v240, v240, v156
    v_mfma_f32_16x16x32_bf16 v[148:151], v[208:211], v[116:119], v[148:151]
    ds_read_b128 v[208:211], v236 offset:1600
    ds_read_b64_tr_b16 v[232:233], v237 offset:96
    ds_read_b64_tr_b16 v[234:235], v237 offset:608
    v_exp_f32 v160, v160
    v_add_f32 v240, v240, v157
    s_add_u32 m0, s71, 21600
    s_waitcnt lgkmcnt(11)
    v_mfma_f32_16x16x32_bf16 v[144:147], v[212:215], v[104:107], v[144:147]
    buffer_load_dwordx4 v249, s[8:11], s61 offen offset:3072 nt lds
    v_exp_f32 v161, v161
    v_cvt_pk_bf16_f32 v182, v156, v157
    v_add_f32 v240, v240, v158
    v_exp_f32 v162, v162
    v_mfma_f32_16x16x32_bf16 v[148:151], v[212:215], v[120:123], v[148:151]
    ds_read_b128 v[212:215], v236 offset:1664
    v_add_f32 v240, v240, v159
    v_exp_f32 v163, v163
    v_cvt_pk_bf16_f32 v183, v158, v159
    v_add_f32 v241, v241, v160
    s_waitcnt lgkmcnt(11)
    v_mfma_f32_16x16x32_bf16 v[144:147], v[216:219], v[108:111], v[144:147]
    v_add_f32 v241, v241, v161
    v_cvt_pk_bf16_f32 v186, v160, v161
    v_add_f32 v241, v241, v162
    v_add_f32 v241, v241, v163
    v_cvt_pk_bf16_f32 v187, v162, v163
    s_add_u32 m0, s71, 32896
    v_mfma_f32_16x16x32_bf16 v[148:151], v[216:219], v[124:127], v[148:151]
    buffer_load_dwordx4 v249, s[8:11], s62 offen nt lds
    ds_read_b128 v[216:219], v236 offset:1728
    s_waitcnt lgkmcnt(2)
    v_mfma_f32_16x16x32_bf16 v[0:3], v[220:223], v[180:183], 0
    v_mfma_f32_16x16x32_bf16 v[32:35], v[220:223], v[184:187], 0
    ds_read_b64_tr_b16 v[220:221], v237 offset:128
    ds_read_b64_tr_b16 v[222:223], v237 offset:640
    s_add_u32 m0, s71, 40096
    v_mfma_f32_16x16x32_bf16 v[4:7], v[224:227], v[180:183], 0
    buffer_load_dwordx4 v249, s[8:11], s62 offen offset:1024 nt lds
    v_mul_f32 v16, v16, v243
    v_exp_f32 v144, v144
    v_mul_f32 v17, v17, v243
    v_mul_f32 v18, v18, v243
    v_mul_f32 v19, v19, v243
    v_exp_f32 v145, v145
    v_mfma_f32_16x16x32_bf16 v[36:39], v[224:227], v[184:187], 0
    ds_read_b64_tr_b16 v[224:225], v237 offset:160
    ds_read_b64_tr_b16 v[226:227], v237 offset:672
    v_mul_f32 v20, v20, v243
    v_mul_f32 v21, v21, v243
    v_exp_f32 v146, v146
    s_add_u32 m0, s71, 47296
    v_mfma_f32_16x16x32_bf16 v[8:11], v[228:231], v[180:183], 0
    buffer_load_dwordx4 v249, s[8:11], s62 offen offset:2048 nt lds
    v_mul_f32 v22, v22, v243
    v_mul_f32 v23, v23, v243
    v_cvt_pk_bf16_f32 v16, v16, v17
    v_exp_f32 v147, v147
    v_cvt_pk_bf16_f32 v17, v18, v19
    v_cvt_pk_bf16_f32 v18, v20, v21
    v_mfma_f32_16x16x32_bf16 v[40:43], v[228:231], v[184:187], 0
    ds_read_b64_tr_b16 v[228:229], v237 offset:192
    ds_read_b64_tr_b16 v[230:231], v237 offset:704
    v_cvt_pk_bf16_f32 v19, v22, v23
    v_add_f32 v240, v240, v144
    ds_write_b128 v239, v[16:19] offset:2048
    v_mfma_f32_16x16x32_bf16 v[12:15], v[232:235], v[180:183], 0
    v_mul_f32 v48, v48, v244
    v_exp_f32 v148, v148
    v_mul_f32 v49, v49, v244
    v_mul_f32 v50, v50, v244
    v_mul_f32 v51, v51, v244
    s_add_u32 m0, s71, 54496
    v_mfma_f32_16x16x32_bf16 v[44:47], v[232:235], v[184:187], 0
    buffer_load_dwordx4 v249, s[8:11], s62 offen offset:3072 nt lds
    ds_read_b64_tr_b16 v[232:233], v237 offset:224
    ds_read_b64_tr_b16 v[234:235], v237 offset:736
    v_add_f32 v240, v240, v145
    v_mul_f32 v52, v52, v244
    v_mul_f32 v53, v53, v244
    v_exp_f32 v149, v149
    s_waitcnt lgkmcnt(9)
    v_mfma_f32_16x16x32_bf16 v[156:159], v[204:207], v[96:99], v[168:171]
    v_mul_f32 v54, v54, v244
    v_mul_f32 v55, v55, v244
    v_cvt_pk_bf16_f32 v48, v48, v49
    v_cvt_pk_bf16_f32 v192, v144, v145
    v_cvt_pk_bf16_f32 v49, v50, v51
    v_cvt_pk_bf16_f32 v50, v52, v53
    v_mfma_f32_16x16x32_bf16 v[160:163], v[204:207], v[112:115], v[172:175]
    v_cvt_pk_bf16_f32 v51, v54, v55
    v_add_f32 v240, v240, v146
    ds_write_b128 v239, v[48:51] offset:6144
    v_mul_f32 v24, v24, v243
    v_mfma_f32_16x16x32_bf16 v[156:159], v[208:211], v[100:103], v[156:159]
    v_exp_f32 v150, v150
    v_mul_f32 v25, v25, v243
    v_mul_f32 v26, v26, v243
    v_mul_f32 v27, v27, v243
    v_add_f32 v240, v240, v147
    v_mul_f32 v28, v28, v243
    v_mul_f32 v29, v29, v243
    s_lshr_b32 s61, s60, 4
    s_add_u32 s61, s61, s32
    s_and_b32 s61, s61, 3
    s_lshl_b32 s61, s61, 17
    s_add_u32 s62, s60, s47
    s_and_b32 s62, s62, 15
    s_lshl_b32 s62, s62, 13
    s_add_u32 s61, s61, s62
    s_add_u32 s61, s61, s58
    v_mfma_f32_16x16x32_bf16 v[160:163], v[208:211], v[116:119], v[160:163]
    v_exp_f32 v151, v151
    v_mul_f32 v30, v30, v243
    v_mul_f32 v31, v31, v243
    v_cvt_pk_bf16_f32 v24, v24, v25
    v_cvt_pk_bf16_f32 v193, v146, v147
    v_cvt_pk_bf16_f32 v25, v26, v27
    s_and_b32 s62, s60, 3
    s_lshl_b32 s62, s62, 10
    s_add_u32 s71, s62, s59
    s_cmp_ge_i32 s60, 64
    s_cselect_b32 s61, 0x4000000, s61
    s_cselect_b32 s71, 0x30000, s71
    s_add_u32 s62, s61, 4096
    s_add_u32 s60, s60, 1
    v_mfma_f32_16x16x32_bf16 v[156:159], v[212:215], v[104:107], v[156:159]
    v_cvt_pk_bf16_f32 v26, v28, v29
    v_cvt_pk_bf16_f32 v27, v30, v31
    v_add_f32 v241, v241, v148
    ds_write_b128 v239, v[24:27] offset:3072
    v_mfma_f32_16x16x32_bf16 v[160:163], v[212:215], v[120:123], v[160:163]
    v_mul_f32 v56, v56, v244
    v_add_f32 v241, v241, v149
    v_mul_f32 v57, v57, v244
    v_mul_f32 v58, v58, v244
    v_mul_f32 v59, v59, v244
    v_cvt_pk_bf16_f32 v196, v148, v149
    v_mul_f32 v60, v60, v244
    v_mfma_f32_16x16x32_bf16 v[156:159], v[216:219], v[108:111], v[156:159]
    v_mul_f32 v61, v61, v244
    v_add_f32 v241, v241, v150
    v_mul_f32 v62, v62, v244
    v_mul_f32 v63, v63, v244
    v_cvt_pk_bf16_f32 v56, v56, v57
    v_add_f32 v241, v241, v151
    v_cvt_pk_bf16_f32 v57, v58, v59
    v_mfma_f32_16x16x32_bf16 v[160:163], v[216:219], v[124:127], v[160:163]
    v_cvt_pk_bf16_f32 v58, v60, v61
    v_cvt_pk_bf16_f32 v59, v62, v63
    v_cvt_pk_bf16_f32 v197, v150, v151
    ds_write_b128 v239, v[56:59] offset:7168
    v_xor_b32 v236, 0x800, v236
    s_waitcnt vmcnt(12) lgkmcnt(0)
    s_barrier
    s_branch L_A2_e1
L_A2_last:
    ds_read_b64_tr_b16 v[204:205], v237 offset:1024
    ds_read_b64_tr_b16 v[206:207], v237 offset:1536
    s_nop 1
    v_mfma_f32_16x16x32_bf16 v[16:19], v[220:223], v[180:183], v[16:19]
    ds_read_b64_tr_b16 v[208:209], v237 offset:1056
    ds_read_b64_tr_b16 v[210:211], v237 offset:1568
    ds_write_b128 v238, v[64:67] offset:3072
    ds_write_b128 v238, v[68:71] offset:4096
    ds_write_b128 v238, v[72:75] offset:5120
    v_mfma_f32_16x16x32_bf16 v[48:51], v[220:223], v[184:187], v[48:51]
    ds_read_b64_tr_b16 v[220:221], v237 offset:1152
    ds_read_b64_tr_b16 v[222:223], v237 offset:1664
    ds_read_b64_tr_b16 v[212:213], v237 offset:1088
    ds_read_b64_tr_b16 v[214:215], v237 offset:1600
    v_exp_f32 v156, v156
    v_mfma_f32_16x16x32_bf16 v[20:23], v[224:227], v[180:183], v[20:23]
    ds_read_b64_tr_b16 v[216:217], v237 offset:1120
    ds_read_b64_tr_b16 v[218:219], v237 offset:1632
    v_exp_f32 v157, v157
    v_exp_f32 v158, v158
    v_mfma_f32_16x16x32_bf16 v[52:55], v[224:227], v[184:187], v[52:55]
    ds_read_b64_tr_b16 v[224:225], v237 offset:1184
    ds_read_b64_tr_b16 v[226:227], v237 offset:1696
    v_exp_f32 v159, v159
    v_add_f32 v240, v240, v156
    v_exp_f32 v160, v160
    v_mfma_f32_16x16x32_bf16 v[24:27], v[228:231], v[180:183], v[24:27]
    v_add_f32 v240, v240, v157
    v_exp_f32 v161, v161
    v_cvt_pk_bf16_f32 v194, v156, v157
    v_add_f32 v240, v240, v158
    v_exp_f32 v162, v162
    v_mfma_f32_16x16x32_bf16 v[56:59], v[228:231], v[184:187], v[56:59]
    ds_read_b64_tr_b16 v[228:229], v237 offset:1216
    ds_read_b64_tr_b16 v[230:231], v237 offset:1728
    v_add_f32 v240, v240, v159
    v_exp_f32 v163, v163
    v_cvt_pk_bf16_f32 v195, v158, v159
    v_mfma_f32_16x16x32_bf16 v[28:31], v[232:235], v[180:183], v[28:31]
    v_add_f32 v241, v241, v160
    v_add_f32 v241, v241, v161
    v_cvt_pk_bf16_f32 v198, v160, v161
    v_add_f32 v241, v241, v162
    v_add_f32 v241, v241, v163
    v_cvt_pk_bf16_f32 v199, v162, v163
    v_mfma_f32_16x16x32_bf16 v[60:63], v[232:235], v[184:187], v[60:63]
    ds_read_b64_tr_b16 v[232:233], v237 offset:1248
    ds_read_b64_tr_b16 v[234:235], v237 offset:1760
    v_mov_b32 v243, v240
    v_mov_b32 v244, v241
    v_mov_b32 v246, v243
    ds_write_b128 v238, v[76:79] offset:6144
    s_waitcnt lgkmcnt(15)
    v_mfma_f32_16x16x32_bf16 v[0:3], v[204:207], v[192:195], v[0:3]
    v_mov_b32 v247, v244
    v_permlane16_swap_b32 v243, v246
    s_nop 0
    v_permlane16_swap_b32 v244, v247
    v_add_f32 v243, v243, v246
    v_add_f32 v244, v244, v247
    ds_write_b128 v238, v[80:83] offset:11264
    v_mfma_f32_16x16x32_bf16 v[32:35], v[204:207], v[196:199], v[32:35]
    v_mov_b32 v246, v243
    v_mov_b32 v247, v244
    s_nop 0
    v_permlane32_swap_b32 v243, v246
    v_permlane32_swap_b32 v244, v247
    v_add_f32 v243, v243, v246
    ds_write_b128 v238, v[84:87] offset:12288
    s_waitcnt lgkmcnt(15)
    v_mfma_f32_16x16x32_bf16 v[4:7], v[208:211], v[192:195], v[4:7]
    v_add_f32 v244, v244, v247
    v_cmp_ngt_f32 vcc, s56, v243
    s_or_b64 s[48:49], s[48:49], vcc
    v_rcp_f32 v243, v243
    v_mfma_f32_16x16x32_bf16 v[36:39], v[208:211], v[196:199], v[36:39]
    v_cmp_ngt_f32 vcc, s56, v244
    s_or_b64 s[48:49], s[48:49], vcc
    v_rcp_f32 v244, v244
    ds_write_b128 v238, v[88:91] offset:13312
    ds_write_b128 v238, v[92:95] offset:14336
    s_waitcnt lgkmcnt(13)
    v_mfma_f32_16x16x32_bf16 v[8:11], v[212:215], v[192:195], v[8:11]
    s_cmp_lg_u64 s[48:49], 0
    s_cselect_b32 s36, 1, 0
    s_lshl_b32 s37, s34, 2
    v_mov_b32 v250, s36
    v_mov_b32 v251, s37
    ds_write_b32 v251, v250 offset:8192
    v_mfma_f32_16x16x32_bf16 v[40:43], v[212:215], v[196:199], v[40:43]
    v_mul_f32 v0, v0, v243
    v_mul_f32 v1, v1, v243
    v_mul_f32 v2, v2, v243
    v_mul_f32 v3, v3, v243
    v_mul_f32 v4, v4, v243
    v_mul_f32 v5, v5, v243
    s_waitcnt lgkmcnt(12)
    v_mfma_f32_16x16x32_bf16 v[12:15], v[216:219], v[192:195], v[12:15]
    v_mul_f32 v6, v6, v243
    v_mul_f32 v7, v7, v243
    v_cvt_pk_bf16_f32 v0, v0, v1
    v_cvt_pk_bf16_f32 v1, v2, v3
    v_cvt_pk_bf16_f32 v2, v4, v5
    v_cvt_pk_bf16_f32 v3, v6, v7
    v_mfma_f32_16x16x32_bf16 v[44:47], v[216:219], v[196:199], v[44:47]
    s_waitcnt vmcnt(0) lgkmcnt(0)
    s_barrier
    v_mov_b32 v251, 0
    ds_read_b128 v[204:207], v251 offset:8192
    s_waitcnt lgkmcnt(0)
    v_or_b32 v204, v204, v205
    v_or_b32 v206, v206, v207
    v_or_b32 v204, v204, v206
    s_nop 0
    v_readfirstlane_b32 s86, v204
    v_mfma_f32_16x16x32_bf16 v[16:19], v[220:223], v[192:195], v[16:19]
    ds_write_b128 v238, v[0:3] offset:1024
    v_mul_f32 v32, v32, v244
    v_mul_f32 v33, v33, v244
    v_mul_f32 v34, v34, v244
    v_mfma_f32_16x16x32_bf16 v[48:51], v[220:223], v[196:199], v[48:51]
    v_mul_f32 v35, v35, v244
    v_mul_f32 v36, v36, v244
    v_mul_f32 v37, v37, v244
    v_mul_f32 v38, v38, v244
    v_mul_f32 v39, v39, v244
    v_cvt_pk_bf16_f32 v32, v32, v33
    v_cvt_pk_bf16_f32 v33, v34, v35
    v_mfma_f32_16x16x32_bf16 v[20:23], v[224:227], v[192:195], v[20:23]
    v_cvt_pk_bf16_f32 v34, v36, v37
    v_cvt_pk_bf16_f32 v35, v38, v39
    ds_write_b128 v238, v[32:35] offset:9216
    v_mfma_f32_16x16x32_bf16 v[52:55], v[224:227], v[196:199], v[52:55]
    v_mul_f32 v8, v8, v243
    v_mul_f32 v9, v9, v243
    v_mul_f32 v10, v10, v243
    v_mul_f32 v11, v11, v243
    v_mul_f32 v12, v12, v243
    v_mul_f32 v13, v13, v243
    v_mfma_f32_16x16x32_bf16 v[24:27], v[228:231], v[192:195], v[24:27]
    v_mul_f32 v14, v14, v243
    v_mul_f32 v15, v15, v243
    v_cvt_pk_bf16_f32 v8, v8, v9
    v_cvt_pk_bf16_f32 v9, v10, v11
    v_cvt_pk_bf16_f32 v10, v12, v13
    v_cvt_pk_bf16_f32 v11, v14, v15
    v_mfma_f32_16x16x32_bf16 v[56:59], v[228:231], v[196:199], v[56:59]
    ds_write_b128 v238, v[8:11] offset:2048
    v_mul_f32 v40, v40, v244
    v_mul_f32 v41, v41, v244
    v_mul_f32 v42, v42, v244
    v_mfma_f32_16x16x32_bf16 v[28:31], v[232:235], v[192:195], v[28:31]
    v_mul_f32 v43, v43, v244
    v_mul_f32 v44, v44, v244
    v_mul_f32 v45, v45, v244
    v_mul_f32 v46, v46, v244
    v_mul_f32 v47, v47, v244
    v_cvt_pk_bf16_f32 v40, v40, v41
    v_cvt_pk_bf16_f32 v41, v42, v43
    v_mfma_f32_16x16x32_bf16 v[60:63], v[232:235], v[196:199], v[60:63]
    v_cvt_pk_bf16_f32 v42, v44, v45
    v_cvt_pk_bf16_f32 v43, v46, v47
    ds_write_b128 v238, v[40:43] offset:10240
    v_mul_f32 v16, v16, v243
    v_mul_f32 v17, v17, v243
    v_mul_f32 v18, v18, v243
    v_mul_f32 v19, v19, v243
    v_mul_f32 v20, v20, v243
    v_mul_f32 v21, v21, v243
    v_mul_f32 v22, v22, v243
    v_mul_f32 v23, v23, v243
    v_cvt_pk_bf16_f32 v16, v16, v17
    v_cvt_pk_bf16_f32 v17, v18, v19
    v_cvt_pk_bf16_f32 v18, v20, v21
    v_cvt_pk_bf16_f32 v19, v22, v23
    s_barrier
    ds_write_b128 v238, v[16:19] offset:0
    v_mul_f32 v48, v48, v244
    v_mul_f32 v49, v49, v244
    v_mul_f32 v50, v50, v244
    v_mul_f32 v51, v51, v244
    v_mul_f32 v52, v52, v244
    v_mul_f32 v53, v53, v244
    v_mul_f32 v54, v54, v244
    v_mul_f32 v55, v55, v244
    v_cvt_pk_bf16_f32 v48, v48, v49
    v_cvt_pk_bf16_f32 v49, v50, v51
    v_cvt_pk_bf16_f32 v50, v52, v53
    v_cvt_pk_bf16_f32 v51, v54, v55
    ds_write_b128 v238, v[48:51] offset:8192
    v_mul_f32 v24, v24, v243
    v_mul_f32 v25, v25, v243
    v_mul_f32 v26, v26, v243
    v_mul_f32 v27, v27, v243
    v_mul_f32 v28, v28, v243
    v_mul_f32 v29, v29, v243
    v_mul_f32 v30, v30, v243
    v_mul_f32 v31, v31, v243
    v_cvt_pk_bf16_f32 v24, v24, v25
    v_cvt_pk_bf16_f32 v25, v26, v27
    v_cvt_pk_bf16_f32 v26, v28, v29
    v_cvt_pk_bf16_f32 v27, v30, v31
    ds_write_b128 v238, v[24:27] offset:7168
    v_mul_f32 v56, v56, v244
    v_mul_f32 v57, v57, v244
    v_mul_f32 v58, v58, v244
    v_mul_f32 v59, v59, v244
    v_mul_f32 v60, v60, v244
    v_mul_f32 v61, v61, v244
    v_mul_f32 v62, v62, v244
    v_mul_f32 v63, v63, v244
    v_cvt_pk_bf16_f32 v56, v56, v57
    v_cvt_pk_bf16_f32 v57, v58, v59
    v_cvt_pk_bf16_f32 v58, v60, v61
    v_cvt_pk_bf16_f32 v59, v62, v63
    ds_write_b128 v238, v[56:59] offset:15360
    s_waitcnt vmcnt(12) lgkmcnt(0)
    s_barrier
    s_branch L_tail
L_tail:
    s_cmp_lg_u32 s87, 0
    s_cbranch_scc1 L_tail_go
    s_cmp_eq_u32 s86, 0
    s_cbranch_scc1 L_tail_go
    s_mov_b32 s87, 1
    s_waitcnt vmcnt(0)
    s_branch L_start
L_tail_go:
    v_mbcnt_lo_u32_b32 v248, -1, 0
    v_mbcnt_hi_u32_b32 v248, -1, v248
    v_lshlrev_b32 v248, 4, v248
    s_mul_i32 s68, s30, 4259840
    s_lshl_b32 s67, s32, 15
    s_add_u32 s68, s68, s67
    s_lshl_b32 s67, s34, 11
    s_add_u32 s68, s68, s67
    s_add_u32 s68, s68, 41943040
    s_lshl_b32 s40, s30, 4
    s_add_u32 s40, s40, s31
    s_lshl_b32 s69, s40, 3
    s_add_u32 s69, s69, s32
    s_lshl_b32 s69, s69, 4
    s_add_u32 s69, s69, s34
    s_mul_i32 s69, s69, 10240

    s_lshl_b32 s41, s40, 13
    s_add_u32 s41, s41, 54525952
    s_lshl_b32 s70, s34, 9
    s_add_u32 s70, s70, s41
    s_lshl_b32 s67, s32, 6
    s_add_u32 s70, s70, s67
    s_setprio 2
    s_mov_b32 s65, 0
    s_cmp_ge_u32 s34, 4
    s_cbranch_scc1 L_ptail
    s_add_u32 s67, s68, 0
    buffer_load_dwordx4 v[0:3], v248, s[20:23], s67 offen sc1
    s_add_u32 s67, s68, 266240
    buffer_load_dwordx4 v[8:11], v248, s[20:23], s67 offen sc1
    s_add_u32 s67, s68, 532480
    buffer_load_dwordx4 v[16:19], v248, s[20:23], s67 offen sc1
    s_add_u32 s67, s68, 798720
    buffer_load_dwordx4 v[24:27], v248, s[20:23], s67 offen sc1
    s_add_u32 s67, s68, 3194880
    buffer_load_dwordx4 v[32:35], v248, s[20:23], s67 offen sc1
    s_add_u32 s67, s68, 3461120
    buffer_load_dwordx4 v[40:43], v248, s[20:23], s67 offen sc1
    s_add_u32 s67, s68, 3727360
    buffer_load_dwordx4 v[48:51], v248, s[20:23], s67 offen sc1
    s_add_u32 s67, s68, 3993600
    buffer_load_dwordx4 v[56:59], v248, s[20:23], s67 offen sc1
    s_add_u32 s67, s68, 0
    buffer_load_dwordx4 v[4:7], v248, s[20:23], s67 offen offset:1024 sc1
    s_add_u32 s67, s68, 266240
    buffer_load_dwordx4 v[12:15], v248, s[20:23], s67 offen offset:1024 sc1
    s_add_u32 s67, s68, 532480
    buffer_load_dwordx4 v[20:23], v248, s[20:23], s67 offen offset:1024 sc1
    s_add_u32 s67, s68, 798720
    buffer_load_dwordx4 v[28:31], v248, s[20:23], s67 offen offset:1024 sc1
    s_add_u32 s67, s68, 3194880
    buffer_load_dwordx4 v[36:39], v248, s[20:23], s67 offen offset:1024 sc1
    s_add_u32 s67, s68, 3461120
    buffer_load_dwordx4 v[44:47], v248, s[20:23], s67 offen offset:1024 sc1
    s_add_u32 s67, s68, 3727360
    buffer_load_dwordx4 v[52:55], v248, s[20:23], s67 offen offset:1024 sc1
    s_add_u32 s67, s68, 3993600
    buffer_load_dwordx4 v[60:63], v248, s[20:23], s67 offen offset:1024 sc1
    s_add_u32 s67, s68, 1064960
    buffer_load_dwordx4 v[64:67], v248, s[20:23], s67 offen sc1
    s_add_u32 s67, s68, 1331200
    buffer_load_dwordx4 v[72:75], v248, s[20:23], s67 offen sc1
    s_add_u32 s67, s68, 1597440
    buffer_load_dwordx4 v[80:83], v248, s[20:23], s67 offen sc1
    s_add_u32 s67, s68, 1863680
    buffer_load_dwordx4 v[88:91], v248, s[20:23], s67 offen sc1
    s_add_u32 s67, s68, 2129920
    buffer_load_dwordx4 v[96:99], v248, s[20:23], s67 offen sc1
    s_add_u32 s67, s68, 2396160
    buffer_load_dwordx4 v[104:107], v248, s[20:23], s67 offen sc1
    s_add_u32 s67, s68, 2662400
    buffer_load_dwordx4 v[112:115], v248, s[20:23], s67 offen sc1
    s_add_u32 s67, s68, 2928640
    buffer_load_dwordx4 v[120:123], v248, s[20:23], s67 offen sc1
    s_add_u32 s67, s68, 1064960
    buffer_load_dwordx4 v[68:71], v248, s[20:23], s67 offen offset:1024 sc1
    s_add_u32 s67, s68, 1331200
    buffer_load_dwordx4 v[76:79], v248, s[20:23], s67 offen offset:1024 sc1
    s_add_u32 s67, s68, 1597440
    buffer_load_dwordx4 v[84:87], v248, s[20:23], s67 offen offset:1024 sc1
    s_add_u32 s67, s68, 1863680
    buffer_load_dwordx4 v[92:95], v248, s[20:23], s67 offen offset:1024 sc1
    s_add_u32 s67, s68, 2129920
    buffer_load_dwordx4 v[100:103], v248, s[20:23], s67 offen offset:1024 sc1
    s_add_u32 s67, s68, 2396160
    buffer_load_dwordx4 v[108:111], v248, s[20:23], s67 offen offset:1024 sc1
    s_add_u32 s67, s68, 2662400
    buffer_load_dwordx4 v[116:119], v248, s[20:23], s67 offen offset:1024 sc1
    s_add_u32 s67, s68, 2928640
    buffer_load_dwordx4 v[124:127], v248, s[20:23], s67 offen offset:1024 sc1
    v_mov_b32 v144, 1
    v_mov_b32 v145, 0
L_job_go:
    v_mov_b32 v249, v248
    v_add_u32 v253, 81920, v248
    s_mov_b32 s64, 0
    ds_read_b128 v[160:163], v249 offset:3072
    ds_read_b128 v[164:167], v249 offset:4096
    ds_read_b128 v[168:171], v249 offset:5120
    ds_read_b128 v[172:175], v249 offset:6144
    ds_read_b128 v[176:179], v249 offset:1024
    ds_read_b128 v[180:183], v249 offset:2048
    ds_read_b128 v[184:187], v249 offset:0
    ds_read_b128 v[188:191], v249 offset:7168
    v_add_u32 v249, 0x2000, v249
    s_waitcnt vmcnt(31)
    s_waitcnt lgkmcnt(7)
    v_mfma_f32_16x16x32_bf16 v[128:131], v[0:3], v[160:163], 0
    ds_read_b128 v[192:195], v253 offset:0
    s_waitcnt vmcnt(30)
    s_waitcnt lgkmcnt(7)
    v_mfma_f32_16x16x32_bf16 v[128:131], v[8:11], v[164:167], v[128:131]
    ds_read_b128 v[196:199], v253 offset:1024
    s_waitcnt vmcnt(29)
    s_waitcnt lgkmcnt(7)
    v_mfma_f32_16x16x32_bf16 v[128:131], v[16:19], v[168:171], v[128:131]
    ds_read_b128 v[200:203], v253 offset:2048
    s_waitcnt vmcnt(28)
    s_waitcnt lgkmcnt(7)
    v_mfma_f32_16x16x32_bf16 v[128:131], v[24:27], v[172:175], v[128:131]
    ds_read_b128 v[204:207], v253 offset:3072
    s_waitcnt vmcnt(27)
    s_waitcnt lgkmcnt(7)
    v_mfma_f32_16x16x32_bf16 v[128:131], v[32:35], v[176:179], v[128:131]
    ds_read_b128 v[208:211], v253 offset:40960
    s_waitcnt vmcnt(26)
    s_waitcnt lgkmcnt(7)
    v_mfma_f32_16x16x32_bf16 v[128:131], v[40:43], v[180:183], v[128:131]
    ds_read_b128 v[212:215], v253 offset:41984
    s_waitcnt vmcnt(25)
    s_waitcnt lgkmcnt(7)
    v_mfma_f32_16x16x32_bf16 v[128:131], v[48:51], v[184:187], v[128:131]
    ds_read_b128 v[216:219], v253 offset:43008
    s_waitcnt vmcnt(24)
    s_waitcnt lgkmcnt(7)
    v_mfma_f32_16x16x32_bf16 v[128:131], v[56:59], v[188:191], v[128:131]
    ds_read_b128 v[220:223], v253 offset:44032
    v_add_u32 v253, 0x1000, v253
    s_waitcnt vmcnt(23)
    v_mfma_f32_16x16x32_bf16 v[132:135], v[4:7], v[160:163], 0
    s_waitcnt vmcnt(22)
    v_mfma_f32_16x16x32_bf16 v[132:135], v[12:15], v[164:167], v[132:135]
    s_waitcnt vmcnt(21)
    v_mfma_f32_16x16x32_bf16 v[132:135], v[20:23], v[168:171], v[132:135]
    s_waitcnt vmcnt(20)
    v_mfma_f32_16x16x32_bf16 v[132:135], v[28:31], v[172:175], v[132:135]
    s_waitcnt vmcnt(19)
    v_mfma_f32_16x16x32_bf16 v[132:135], v[36:39], v[176:179], v[132:135]
    s_waitcnt vmcnt(18)
    v_mfma_f32_16x16x32_bf16 v[132:135], v[44:47], v[180:183], v[132:135]
    s_waitcnt vmcnt(17)
    v_mfma_f32_16x16x32_bf16 v[132:135], v[52:55], v[184:187], v[132:135]
    s_waitcnt vmcnt(16)
    v_mfma_f32_16x16x32_bf16 v[132:135], v[60:63], v[188:191], v[132:135]
    s_waitcnt vmcnt(15)
    s_waitcnt lgkmcnt(7)
    v_mfma_f32_16x16x32_bf16 v[128:131], v[64:67], v[192:195], v[128:131]
    ds_read_b128 v[160:163], v249 offset:3072
    s_waitcnt vmcnt(14)
    s_waitcnt lgkmcnt(7)
    v_mfma_f32_16x16x32_bf16 v[128:131], v[72:75], v[196:199], v[128:131]
    ds_read_b128 v[164:167], v249 offset:4096
    s_waitcnt vmcnt(13)
    s_waitcnt lgkmcnt(7)
    v_mfma_f32_16x16x32_bf16 v[128:131], v[80:83], v[200:203], v[128:131]
    ds_read_b128 v[168:171], v249 offset:5120
    s_waitcnt vmcnt(12)
    s_waitcnt lgkmcnt(7)
    v_mfma_f32_16x16x32_bf16 v[128:131], v[88:91], v[204:207], v[128:131]
    ds_read_b128 v[172:175], v249 offset:6144
    s_waitcnt vmcnt(11)
    s_waitcnt lgkmcnt(7)
    v_mfma_f32_16x16x32_bf16 v[128:131], v[96:99], v[208:211], v[128:131]
    ds_read_b128 v[176:179], v249 offset:1024
    s_waitcnt vmcnt(10)
    s_waitcnt lgkmcnt(7)
    v_mfma_f32_16x16x32_bf16 v[128:131], v[104:107], v[212:215], v[128:131]
    ds_read_b128 v[180:183], v249 offset:2048
    s_waitcnt vmcnt(9)
    s_waitcnt lgkmcnt(7)
    v_mfma_f32_16x16x32_bf16 v[128:131], v[112:115], v[216:219], v[128:131]
    ds_read_b128 v[184:187], v249 offset:0
    s_waitcnt vmcnt(8)
    s_waitcnt lgkmcnt(7)
    v_mfma_f32_16x16x32_bf16 v[128:131], v[120:123], v[220:223], v[128:131]
    ds_read_b128 v[188:191], v249 offset:7168
    v_add_u32 v249, 0x2000, v249
    s_waitcnt vmcnt(7)
    v_mfma_f32_16x16x32_bf16 v[132:135], v[68:71], v[192:195], v[132:135]
    s_waitcnt vmcnt(6)
    v_mfma_f32_16x16x32_bf16 v[132:135], v[76:79], v[196:199], v[132:135]
    s_waitcnt vmcnt(5)
    v_mfma_f32_16x16x32_bf16 v[132:135], v[84:87], v[200:203], v[132:135]
    s_waitcnt vmcnt(4)
    v_mfma_f32_16x16x32_bf16 v[132:135], v[92:95], v[204:207], v[132:135]
    s_waitcnt vmcnt(3)
    v_mfma_f32_16x16x32_bf16 v[132:135], v[100:103], v[208:211], v[132:135]
    s_waitcnt vmcnt(2)
    v_mfma_f32_16x16x32_bf16 v[132:135], v[108:111], v[212:215], v[132:135]
    s_waitcnt vmcnt(1)
    v_mfma_f32_16x16x32_bf16 v[132:135], v[116:119], v[216:219], v[132:135]
    s_waitcnt vmcnt(0)
    v_mfma_f32_16x16x32_bf16 v[132:135], v[124:127], v[220:223], v[132:135]
    s_cmp_eq_u32 s65, 0
    s_cbranch_scc1 L_jq
    s_mov_b64 exec, 1
    buffer_store_dword v144, v145, s[20:23], s70 offen sc1
    s_mov_b64 exec, -1
    s_add_u32 s70, s70, 6144
L_jq:
    s_waitcnt lgkmcnt(7)
    v_mfma_f32_16x16x32_bf16 v[136:139], v[0:3], v[160:163], 0
    ds_read_b128 v[192:195], v253 offset:0
    s_waitcnt lgkmcnt(7)
    v_mfma_f32_16x16x32_bf16 v[136:139], v[8:11], v[164:167], v[136:139]
    ds_read_b128 v[196:199], v253 offset:1024
    s_waitcnt lgkmcnt(7)
    v_mfma_f32_16x16x32_bf16 v[136:139], v[16:19], v[168:171], v[136:139]
    ds_read_b128 v[200:203], v253 offset:2048
    s_waitcnt lgkmcnt(7)
    v_mfma_f32_16x16x32_bf16 v[136:139], v[24:27], v[172:175], v[136:139]
    ds_read_b128 v[204:207], v253 offset:3072
    s_waitcnt lgkmcnt(7)
    v_mfma_f32_16x16x32_bf16 v[136:139], v[32:35], v[176:179], v[136:139]
    ds_read_b128 v[208:211], v253 offset:40960
    s_waitcnt lgkmcnt(7)
    v_mfma_f32_16x16x32_bf16 v[136:139], v[40:43], v[180:183], v[136:139]
    ds_read_b128 v[212:215], v253 offset:41984
    s_waitcnt lgkmcnt(7)
    v_mfma_f32_16x16x32_bf16 v[136:139], v[48:51], v[184:187], v[136:139]
    ds_read_b128 v[216:219], v253 offset:43008
    s_waitcnt lgkmcnt(7)
    v_mfma_f32_16x16x32_bf16 v[136:139], v[56:59], v[188:191], v[136:139]
    ds_read_b128 v[220:223], v253 offset:44032
    v_add_u32 v253, 0x1000, v253
    v_mfma_f32_16x16x32_bf16 v[140:143], v[4:7], v[160:163], 0
    v_mfma_f32_16x16x32_bf16 v[140:143], v[12:15], v[164:167], v[140:143]
    v_mfma_f32_16x16x32_bf16 v[140:143], v[20:23], v[168:171], v[140:143]
    v_cvt_pk_bf16_f32 v128, v128, v129
    v_mfma_f32_16x16x32_bf16 v[140:143], v[28:31], v[172:175], v[140:143]
    v_cvt_pk_bf16_f32 v129, v130, v131
    v_mfma_f32_16x16x32_bf16 v[140:143], v[36:39], v[176:179], v[140:143]
    v_cvt_pk_bf16_f32 v130, v132, v133
    v_mfma_f32_16x16x32_bf16 v[140:143], v[44:47], v[180:183], v[140:143]
    v_cvt_pk_bf16_f32 v131, v134, v135
    v_mfma_f32_16x16x32_bf16 v[140:143], v[52:55], v[184:187], v[140:143]
    buffer_store_dwordx4 v[128:131], v248, s[20:23], s69 offen sc1
    v_mfma_f32_16x16x32_bf16 v[140:143], v[60:63], v[188:191], v[140:143]
    s_add_u32 s69, s69, 1024
    s_waitcnt lgkmcnt(7)
    v_mfma_f32_16x16x32_bf16 v[136:139], v[64:67], v[192:195], v[136:139]
    ds_read_b128 v[160:163], v249 offset:3072
    s_waitcnt lgkmcnt(7)
    v_mfma_f32_16x16x32_bf16 v[136:139], v[72:75], v[196:199], v[136:139]
    ds_read_b128 v[164:167], v249 offset:4096
    s_waitcnt lgkmcnt(7)
    v_mfma_f32_16x16x32_bf16 v[136:139], v[80:83], v[200:203], v[136:139]
    ds_read_b128 v[168:171], v249 offset:5120
    s_waitcnt lgkmcnt(7)
    v_mfma_f32_16x16x32_bf16 v[136:139], v[88:91], v[204:207], v[136:139]
    ds_read_b128 v[172:175], v249 offset:6144
    s_waitcnt lgkmcnt(7)
    v_mfma_f32_16x16x32_bf16 v[136:139], v[96:99], v[208:211], v[136:139]
    ds_read_b128 v[176:179], v249 offset:1024
    s_waitcnt lgkmcnt(7)
    v_mfma_f32_16x16x32_bf16 v[136:139], v[104:107], v[212:215], v[136:139]
    ds_read_b128 v[180:183], v249 offset:2048
    s_waitcnt lgkmcnt(7)
    v_mfma_f32_16x16x32_bf16 v[136:139], v[112:115], v[216:219], v[136:139]
    ds_read_b128 v[184:187], v249 offset:0
    s_waitcnt lgkmcnt(7)
    v_mfma_f32_16x16x32_bf16 v[136:139], v[120:123], v[220:223], v[136:139]
    ds_read_b128 v[188:191], v249 offset:7168
    v_add_u32 v249, 0x2000, v249
    v_mfma_f32_16x16x32_bf16 v[140:143], v[68:71], v[192:195], v[140:143]
    v_mfma_f32_16x16x32_bf16 v[140:143], v[76:79], v[196:199], v[140:143]
    v_mfma_f32_16x16x32_bf16 v[140:143], v[84:87], v[200:203], v[140:143]
    v_mfma_f32_16x16x32_bf16 v[140:143], v[92:95], v[204:207], v[140:143]
    v_mfma_f32_16x16x32_bf16 v[140:143], v[100:103], v[208:211], v[140:143]
    v_mfma_f32_16x16x32_bf16 v[140:143], v[108:111], v[212:215], v[140:143]
    v_mfma_f32_16x16x32_bf16 v[140:143], v[116:119], v[216:219], v[140:143]
    v_mfma_f32_16x16x32_bf16 v[140:143], v[124:127], v[220:223], v[140:143]
    s_waitcnt lgkmcnt(7)
    v_mfma_f32_16x16x32_bf16 v[128:131], v[0:3], v[160:163], 0
    ds_read_b128 v[192:195], v253 offset:0
    s_waitcnt lgkmcnt(7)
    v_mfma_f32_16x16x32_bf16 v[128:131], v[8:11], v[164:167], v[128:131]
    ds_read_b128 v[196:199], v253 offset:1024
    s_waitcnt lgkmcnt(7)
    v_mfma_f32_16x16x32_bf16 v[128:131], v[16:19], v[168:171], v[128:131]
    ds_read_b128 v[200:203], v253 offset:2048
    s_waitcnt lgkmcnt(7)
    v_mfma_f32_16x16x32_bf16 v[128:131], v[24:27], v[172:175], v[128:131]
    ds_read_b128 v[204:207], v253 offset:3072
    s_waitcnt lgkmcnt(7)
    v_mfma_f32_16x16x32_bf16 v[128:131], v[32:35], v[176:179], v[128:131]
    ds_read_b128 v[208:211], v253 offset:40960
    s_waitcnt lgkmcnt(7)
    v_mfma_f32_16x16x32_bf16 v[128:131], v[40:43], v[180:183], v[128:131]
    ds_read_b128 v[212:215], v253 offset:41984
    s_waitcnt lgkmcnt(7)
    v_mfma_f32_16x16x32_bf16 v[128:131], v[48:51], v[184:187], v[128:131]
    ds_read_b128 v[216:219], v253 offset:43008
    s_waitcnt lgkmcnt(7)
    v_mfma_f32_16x16x32_bf16 v[128:131], v[56:59], v[188:191], v[128:131]
    ds_read_b128 v[220:223], v253 offset:44032
    v_add_u32 v253, 0x1000, v253
    v_mfma_f32_16x16x32_bf16 v[132:135], v[4:7], v[160:163], 0
    v_mfma_f32_16x16x32_bf16 v[132:135], v[12:15], v[164:167], v[132:135]
    v_mfma_f32_16x16x32_bf16 v[132:135], v[20:23], v[168:171], v[132:135]
    v_cvt_pk_bf16_f32 v136, v136, v137
    v_mfma_f32_16x16x32_bf16 v[132:135], v[28:31], v[172:175], v[132:135]
    v_cvt_pk_bf16_f32 v137, v138, v139
    v_mfma_f32_16x16x32_bf16 v[132:135], v[36:39], v[176:179], v[132:135]
    v_cvt_pk_bf16_f32 v138, v140, v141
    v_mfma_f32_16x16x32_bf16 v[132:135], v[44:47], v[180:183], v[132:135]
    v_cvt_pk_bf16_f32 v139, v142, v143
    v_mfma_f32_16x16x32_bf16 v[132:135], v[52:55], v[184:187], v[132:135]
    buffer_store_dwordx4 v[136:139], v248, s[20:23], s69 offen sc1
    v_mfma_f32_16x16x32_bf16 v[132:135], v[60:63], v[188:191], v[132:135]
    s_add_u32 s69, s69, 1024
    s_waitcnt lgkmcnt(7)
    v_mfma_f32_16x16x32_bf16 v[128:131], v[64:67], v[192:195], v[128:131]
    ds_read_b128 v[160:163], v249 offset:3072
    s_waitcnt lgkmcnt(7)
    v_mfma_f32_16x16x32_bf16 v[128:131], v[72:75], v[196:199], v[128:131]
    ds_read_b128 v[164:167], v249 offset:4096
    s_waitcnt lgkmcnt(7)
    v_mfma_f32_16x16x32_bf16 v[128:131], v[80:83], v[200:203], v[128:131]
    ds_read_b128 v[168:171], v249 offset:5120
    s_waitcnt lgkmcnt(7)
    v_mfma_f32_16x16x32_bf16 v[128:131], v[88:91], v[204:207], v[128:131]
    ds_read_b128 v[172:175], v249 offset:6144
    s_waitcnt lgkmcnt(7)
    v_mfma_f32_16x16x32_bf16 v[128:131], v[96:99], v[208:211], v[128:131]
    ds_read_b128 v[176:179], v249 offset:1024
    s_waitcnt lgkmcnt(7)
    v_mfma_f32_16x16x32_bf16 v[128:131], v[104:107], v[212:215], v[128:131]
    ds_read_b128 v[180:183], v249 offset:2048
    s_waitcnt lgkmcnt(7)
    v_mfma_f32_16x16x32_bf16 v[128:131], v[112:115], v[216:219], v[128:131]
    ds_read_b128 v[184:187], v249 offset:0
    s_waitcnt lgkmcnt(7)
    v_mfma_f32_16x16x32_bf16 v[128:131], v[120:123], v[220:223], v[128:131]
    ds_read_b128 v[188:191], v249 offset:7168
    v_add_u32 v249, 0x2000, v249
    v_mfma_f32_16x16x32_bf16 v[132:135], v[68:71], v[192:195], v[132:135]
    v_mfma_f32_16x16x32_bf16 v[132:135], v[76:79], v[196:199], v[132:135]
    v_mfma_f32_16x16x32_bf16 v[132:135], v[84:87], v[200:203], v[132:135]
    v_mfma_f32_16x16x32_bf16 v[132:135], v[92:95], v[204:207], v[132:135]
    v_mfma_f32_16x16x32_bf16 v[132:135], v[100:103], v[208:211], v[132:135]
    v_mfma_f32_16x16x32_bf16 v[132:135], v[108:111], v[212:215], v[132:135]
    v_mfma_f32_16x16x32_bf16 v[132:135], v[116:119], v[216:219], v[132:135]
    v_mfma_f32_16x16x32_bf16 v[132:135], v[124:127], v[220:223], v[132:135]
    s_add_u32 s64, s64, 1
    s_cmp_lt_u32 s64, 4
    s_cbranch_scc1 L_jq
    s_cmp_eq_u32 s65, 0
    s_cbranch_scc1 L_jroll
    s_waitcnt lgkmcnt(7)
    v_mfma_f32_16x16x32_bf16 v[136:139], v[0:3], v[160:163], 0
    ds_read_b128 v[192:195], v253 offset:0
    s_waitcnt lgkmcnt(7)
    v_mfma_f32_16x16x32_bf16 v[136:139], v[8:11], v[164:167], v[136:139]
    ds_read_b128 v[196:199], v253 offset:1024
    s_waitcnt lgkmcnt(7)
    v_mfma_f32_16x16x32_bf16 v[136:139], v[16:19], v[168:171], v[136:139]
    ds_read_b128 v[200:203], v253 offset:2048
    s_waitcnt lgkmcnt(7)
    v_mfma_f32_16x16x32_bf16 v[136:139], v[24:27], v[172:175], v[136:139]
    ds_read_b128 v[204:207], v253 offset:3072
    s_waitcnt lgkmcnt(7)
    v_mfma_f32_16x16x32_bf16 v[136:139], v[32:35], v[176:179], v[136:139]
    ds_read_b128 v[208:211], v253 offset:40960
    s_waitcnt lgkmcnt(7)
    v_mfma_f32_16x16x32_bf16 v[136:139], v[40:43], v[180:183], v[136:139]
    ds_read_b128 v[212:215], v253 offset:41984
    s_waitcnt lgkmcnt(7)
    v_mfma_f32_16x16x32_bf16 v[136:139], v[48:51], v[184:187], v[136:139]
    ds_read_b128 v[216:219], v253 offset:43008
    s_waitcnt lgkmcnt(7)
    v_mfma_f32_16x16x32_bf16 v[136:139], v[56:59], v[188:191], v[136:139]
    ds_read_b128 v[220:223], v253 offset:44032
    v_add_u32 v253, 0x1000, v253
    v_mfma_f32_16x16x32_bf16 v[140:143], v[4:7], v[160:163], 0
    v_mfma_f32_16x16x32_bf16 v[140:143], v[12:15], v[164:167], v[140:143]
    v_mfma_f32_16x16x32_bf16 v[140:143], v[20:23], v[168:171], v[140:143]
    v_cvt_pk_bf16_f32 v128, v128, v129
    v_mfma_f32_16x16x32_bf16 v[140:143], v[28:31], v[172:175], v[140:143]
    v_cvt_pk_bf16_f32 v129, v130, v131
    v_mfma_f32_16x16x32_bf16 v[140:143], v[36:39], v[176:179], v[140:143]
    v_cvt_pk_bf16_f32 v130, v132, v133
    v_mfma_f32_16x16x32_bf16 v[140:143], v[44:47], v[180:183], v[140:143]
    v_cvt_pk_bf16_f32 v131, v134, v135
    v_mfma_f32_16x16x32_bf16 v[140:143], v[52:55], v[184:187], v[140:143]
    buffer_store_dwordx4 v[128:131], v248, s[20:23], s69 offen sc1
    v_mfma_f32_16x16x32_bf16 v[140:143], v[60:63], v[188:191], v[140:143]
    s_add_u32 s69, s69, 1024
    s_waitcnt lgkmcnt(7)
    v_mfma_f32_16x16x32_bf16 v[136:139], v[64:67], v[192:195], v[136:139]
    s_waitcnt lgkmcnt(6)
    v_mfma_f32_16x16x32_bf16 v[136:139], v[72:75], v[196:199], v[136:139]
    s_waitcnt lgkmcnt(5)
    v_mfma_f32_16x16x32_bf16 v[136:139], v[80:83], v[200:203], v[136:139]
    s_waitcnt lgkmcnt(4)
    v_mfma_f32_16x16x32_bf16 v[136:139], v[88:91], v[204:207], v[136:139]
    s_waitcnt lgkmcnt(3)
    v_mfma_f32_16x16x32_bf16 v[136:139], v[96:99], v[208:211], v[136:139]
    s_waitcnt lgkmcnt(2)
    v_mfma_f32_16x16x32_bf16 v[136:139], v[104:107], v[212:215], v[136:139]
    s_waitcnt lgkmcnt(1)
    v_mfma_f32_16x16x32_bf16 v[136:139], v[112:115], v[216:219], v[136:139]
    s_waitcnt lgkmcnt(0)
    v_mfma_f32_16x16x32_bf16 v[136:139], v[120:123], v[220:223], v[136:139]
    v_add_u32 v249, 0x2000, v249
    v_mfma_f32_16x16x32_bf16 v[140:143], v[68:71], v[192:195], v[140:143]
    v_mfma_f32_16x16x32_bf16 v[140:143], v[76:79], v[196:199], v[140:143]
    v_mfma_f32_16x16x32_bf16 v[140:143], v[84:87], v[200:203], v[140:143]
    v_mfma_f32_16x16x32_bf16 v[140:143], v[92:95], v[204:207], v[140:143]
    v_mfma_f32_16x16x32_bf16 v[140:143], v[100:103], v[208:211], v[140:143]
    v_mfma_f32_16x16x32_bf16 v[140:143], v[108:111], v[212:215], v[140:143]
    v_mfma_f32_16x16x32_bf16 v[140:143], v[116:119], v[216:219], v[140:143]
    v_mfma_f32_16x16x32_bf16 v[140:143], v[124:127], v[220:223], v[140:143]
    v_cvt_pk_bf16_f32 v136, v136, v137
    v_cvt_pk_bf16_f32 v137, v138, v139
    s_nop 5
    v_cvt_pk_bf16_f32 v138, v140, v141
    v_cvt_pk_bf16_f32 v139, v142, v143
    buffer_store_dwordx4 v[136:139], v248, s[20:23], s69 offen sc1
    s_add_u32 s69, s69, 1024
    s_branch L_jobs_done
L_jroll:
    s_add_u32 s68, s68, 24576
    s_waitcnt lgkmcnt(7)
    v_mfma_f32_16x16x32_bf16 v[136:139], v[0:3], v[160:163], 0
    s_add_u32 s67, s68, 0
    buffer_load_dwordx4 v[0:3], v248, s[20:23], s67 offen sc1
    ds_read_b128 v[192:195], v253 offset:0
    s_waitcnt lgkmcnt(7)
    v_mfma_f32_16x16x32_bf16 v[136:139], v[8:11], v[164:167], v[136:139]
    s_add_u32 s67, s68, 266240
    buffer_load_dwordx4 v[8:11], v248, s[20:23], s67 offen sc1
    ds_read_b128 v[196:199], v253 offset:1024
    s_waitcnt lgkmcnt(7)
    v_mfma_f32_16x16x32_bf16 v[136:139], v[16:19], v[168:171], v[136:139]
    s_add_u32 s67, s68, 532480
    buffer_load_dwordx4 v[16:19], v248, s[20:23], s67 offen sc1
    ds_read_b128 v[200:203], v253 offset:2048
    s_waitcnt lgkmcnt(7)
    v_mfma_f32_16x16x32_bf16 v[136:139], v[24:27], v[172:175], v[136:139]
    s_add_u32 s67, s68, 798720
    buffer_load_dwordx4 v[24:27], v248, s[20:23], s67 offen sc1
    ds_read_b128 v[204:207], v253 offset:3072
    s_waitcnt lgkmcnt(7)
    v_mfma_f32_16x16x32_bf16 v[136:139], v[32:35], v[176:179], v[136:139]
    s_add_u32 s67, s68, 3194880
    buffer_load_dwordx4 v[32:35], v248, s[20:23], s67 offen sc1
    ds_read_b128 v[208:211], v253 offset:40960
    s_waitcnt lgkmcnt(7)
    v_mfma_f32_16x16x32_bf16 v[136:139], v[40:43], v[180:183], v[136:139]
    s_add_u32 s67, s68, 3461120
    buffer_load_dwordx4 v[40:43], v248, s[20:23], s67 offen sc1
    ds_read_b128 v[212:215], v253 offset:41984
    s_waitcnt lgkmcnt(7)
    v_mfma_f32_16x16x32_bf16 v[136:139], v[48:51], v[184:187], v[136:139]
    s_add_u32 s67, s68, 3727360
    buffer_load_dwordx4 v[48:51], v248, s[20:23], s67 offen sc1
    ds_read_b128 v[216:219], v253 offset:43008
    s_waitcnt lgkmcnt(7)
    v_mfma_f32_16x16x32_bf16 v[136:139], v[56:59], v[188:191], v[136:139]
    s_add_u32 s67, s68, 3993600
    buffer_load_dwordx4 v[56:59], v248, s[20:23], s67 offen sc1
    ds_read_b128 v[220:223], v253 offset:44032
    v_add_u32 v253, 0x1000, v253
    v_mfma_f32_16x16x32_bf16 v[140:143], v[4:7], v[160:163], 0
    s_add_u32 s67, s68, 0
    buffer_load_dwordx4 v[4:7], v248, s[20:23], s67 offen offset:1024 sc1
    v_mfma_f32_16x16x32_bf16 v[140:143], v[12:15], v[164:167], v[140:143]
    s_add_u32 s67, s68, 266240
    buffer_load_dwordx4 v[12:15], v248, s[20:23], s67 offen offset:1024 sc1
    v_mfma_f32_16x16x32_bf16 v[140:143], v[20:23], v[168:171], v[140:143]
    s_add_u32 s67, s68, 532480
    buffer_load_dwordx4 v[20:23], v248, s[20:23], s67 offen offset:1024 sc1
    v_cvt_pk_bf16_f32 v128, v128, v129
    v_mfma_f32_16x16x32_bf16 v[140:143], v[28:31], v[172:175], v[140:143]
    s_add_u32 s67, s68, 798720
    buffer_load_dwordx4 v[28:31], v248, s[20:23], s67 offen offset:1024 sc1
    v_cvt_pk_bf16_f32 v129, v130, v131
    v_mfma_f32_16x16x32_bf16 v[140:143], v[36:39], v[176:179], v[140:143]
    s_add_u32 s67, s68, 3194880
    buffer_load_dwordx4 v[36:39], v248, s[20:23], s67 offen offset:1024 sc1
    v_cvt_pk_bf16_f32 v130, v132, v133
    v_mfma_f32_16x16x32_bf16 v[140:143], v[44:47], v[180:183], v[140:143]
    s_add_u32 s67, s68, 3461120
    buffer_load_dwordx4 v[44:47], v248, s[20:23], s67 offen offset:1024 sc1
    v_cvt_pk_bf16_f32 v131, v134, v135
    v_mfma_f32_16x16x32_bf16 v[140:143], v[52:55], v[184:187], v[140:143]
    s_add_u32 s67, s68, 3727360
    buffer_load_dwordx4 v[52:55], v248, s[20:23], s67 offen offset:1024 sc1
    v_mfma_f32_16x16x32_bf16 v[140:143], v[60:63], v[188:191], v[140:143]
    s_add_u32 s67, s68, 3993600
    buffer_load_dwordx4 v[60:63], v248, s[20:23], s67 offen offset:1024 sc1
    s_waitcnt lgkmcnt(7)
    v_mfma_f32_16x16x32_bf16 v[136:139], v[64:67], v[192:195], v[136:139]
    s_add_u32 s67, s68, 1064960
    buffer_load_dwordx4 v[64:67], v248, s[20:23], s67 offen sc1
    s_waitcnt lgkmcnt(6)
    v_mfma_f32_16x16x32_bf16 v[136:139], v[72:75], v[196:199], v[136:139]
    s_add_u32 s67, s68, 1331200
    buffer_load_dwordx4 v[72:75], v248, s[20:23], s67 offen sc1
    s_waitcnt lgkmcnt(5)
    v_mfma_f32_16x16x32_bf16 v[136:139], v[80:83], v[200:203], v[136:139]
    s_add_u32 s67, s68, 1597440
    buffer_load_dwordx4 v[80:83], v248, s[20:23], s67 offen sc1
    s_waitcnt lgkmcnt(4)
    v_mfma_f32_16x16x32_bf16 v[136:139], v[88:91], v[204:207], v[136:139]
    s_add_u32 s67, s68, 1863680
    buffer_load_dwordx4 v[88:91], v248, s[20:23], s67 offen sc1
    s_waitcnt lgkmcnt(3)
    v_mfma_f32_16x16x32_bf16 v[136:139], v[96:99], v[208:211], v[136:139]
    s_add_u32 s67, s68, 2129920
    buffer_load_dwordx4 v[96:99], v248, s[20:23], s67 offen sc1
    s_waitcnt lgkmcnt(2)
    v_mfma_f32_16x16x32_bf16 v[136:139], v[104:107], v[212:215], v[136:139]
    s_add_u32 s67, s68, 2396160
    buffer_load_dwordx4 v[104:107], v248, s[20:23], s67 offen sc1
    s_waitcnt lgkmcnt(1)
    v_mfma_f32_16x16x32_bf16 v[136:139], v[112:115], v[216:219], v[136:139]
    s_add_u32 s67, s68, 2662400
    buffer_load_dwordx4 v[112:115], v248, s[20:23], s67 offen sc1
    s_waitcnt lgkmcnt(0)
    v_mfma_f32_16x16x32_bf16 v[136:139], v[120:123], v[220:223], v[136:139]
    s_add_u32 s67, s68, 2928640
    buffer_load_dwordx4 v[120:123], v248, s[20:23], s67 offen sc1
    v_add_u32 v249, 0x2000, v249
    v_mfma_f32_16x16x32_bf16 v[140:143], v[68:71], v[192:195], v[140:143]
    s_add_u32 s67, s68, 1064960
    buffer_load_dwordx4 v[68:71], v248, s[20:23], s67 offen offset:1024 sc1
    v_mfma_f32_16x16x32_bf16 v[140:143], v[76:79], v[196:199], v[140:143]
    s_add_u32 s67, s68, 1331200
    buffer_load_dwordx4 v[76:79], v248, s[20:23], s67 offen offset:1024 sc1
    v_mfma_f32_16x16x32_bf16 v[140:143], v[84:87], v[200:203], v[140:143]
    s_add_u32 s67, s68, 1597440
    buffer_load_dwordx4 v[84:87], v248, s[20:23], s67 offen offset:1024 sc1
    v_mfma_f32_16x16x32_bf16 v[140:143], v[92:95], v[204:207], v[140:143]
    s_add_u32 s67, s68, 1863680
    buffer_load_dwordx4 v[92:95], v248, s[20:23], s67 offen offset:1024 sc1
    v_mfma_f32_16x16x32_bf16 v[140:143], v[100:103], v[208:211], v[140:143]
    s_add_u32 s67, s68, 2129920
    buffer_load_dwordx4 v[100:103], v248, s[20:23], s67 offen offset:1024 sc1
    v_mfma_f32_16x16x32_bf16 v[140:143], v[108:111], v[212:215], v[140:143]
    s_add_u32 s67, s68, 2396160
    buffer_load_dwordx4 v[108:111], v248, s[20:23], s67 offen offset:1024 sc1
    v_mfma_f32_16x16x32_bf16 v[140:143], v[116:119], v[216:219], v[140:143]
    s_add_u32 s67, s68, 2662400
    buffer_load_dwordx4 v[116:119], v248, s[20:23], s67 offen offset:1024 sc1
    v_mfma_f32_16x16x32_bf16 v[140:143], v[124:127], v[220:223], v[140:143]
    s_add_u32 s67, s68, 2928640
    buffer_load_dwordx4 v[124:127], v248, s[20:23], s67 offen offset:1024 sc1
    buffer_store_dwordx4 v[128:131], v248, s[20:23], s69 offen sc1
    s_add_u32 s69, s69, 1024
    v_cvt_pk_bf16_f32 v136, v136, v137
    v_cvt_pk_bf16_f32 v137, v138, v139
    s_nop 1
    v_cvt_pk_bf16_f32 v138, v140, v141
    v_cvt_pk_bf16_f32 v139, v142, v143
    buffer_store_dwordx4 v[136:139], v248, s[20:23], s69 offen sc1
    s_add_u32 s69, s69, 1024
    s_mov_b32 s65, 1
    s_setprio 0
    s_add_u32 s69, s69, 112640
    s_branch L_job_go
L_ptail:
    s_setprio 3
    ds_read_b128 v[224:227], v248 offset:3072
    ds_read_b128 v[228:231], v248 offset:4096
    ds_read_b128 v[232:235], v248 offset:5120
    ds_read_b128 v[236:239], v248 offset:6144
    ds_read_b128 v[240:243], v248 offset:1024
    s_waitcnt vmcnt(14)
    s_waitcnt lgkmcnt(4)
    v_mfma_f32_16x16x32_bf16 v[0:3], v[176:179], v[224:227], v[0:3]
    ds_read_b128 v[244:247], v248 offset:2048
    v_mfma_f32_16x16x32_bf16 v[4:7], v[180:183], v[224:227], v[4:7]
    s_waitcnt vmcnt(12)
    s_waitcnt lgkmcnt(4)
    v_mfma_f32_16x16x32_bf16 v[0:3], v[184:187], v[228:231], v[0:3]
    ds_read_b128 v[224:227], v248 offset:0
    v_mfma_f32_16x16x32_bf16 v[4:7], v[188:191], v[228:231], v[4:7]
    s_waitcnt vmcnt(10)
    s_waitcnt lgkmcnt(4)
    v_mfma_f32_16x16x32_bf16 v[0:3], v[192:195], v[232:235], v[0:3]
    ds_read_b128 v[228:231], v248 offset:7168
    v_mfma_f32_16x16x32_bf16 v[4:7], v[196:199], v[232:235], v[4:7]
    s_waitcnt vmcnt(8)
    s_waitcnt lgkmcnt(4)
    v_mfma_f32_16x16x32_bf16 v[0:3], v[200:203], v[236:239], v[0:3]
    ds_read_b128 v[232:235], v248 offset:11264
    v_mfma_f32_16x16x32_bf16 v[4:7], v[204:207], v[236:239], v[4:7]
    s_waitcnt vmcnt(6)
    s_waitcnt lgkmcnt(4)
    v_mfma_f32_16x16x32_bf16 v[0:3], v[208:211], v[240:243], v[0:3]
    ds_read_b128 v[236:239], v248 offset:12288
    v_mfma_f32_16x16x32_bf16 v[4:7], v[212:215], v[240:243], v[4:7]
    s_waitcnt vmcnt(4)
    s_waitcnt lgkmcnt(4)
    v_mfma_f32_16x16x32_bf16 v[0:3], v[216:219], v[244:247], v[0:3]
    ds_read_b128 v[240:243], v248 offset:13312
    v_mfma_f32_16x16x32_bf16 v[4:7], v[220:223], v[244:247], v[4:7]
    s_waitcnt vmcnt(2)
    s_waitcnt lgkmcnt(4)
    v_mfma_f32_16x16x32_bf16 v[0:3], v[160:163], v[224:227], v[0:3]
    ds_read_b128 v[244:247], v248 offset:14336
    v_mfma_f32_16x16x32_bf16 v[4:7], v[164:167], v[224:227], v[4:7]
    s_waitcnt vmcnt(0)
    s_waitcnt lgkmcnt(4)
    v_mfma_f32_16x16x32_bf16 v[0:3], v[168:171], v[228:231], v[0:3]
    ds_read_b128 v[224:227], v248 offset:9216
    v_mfma_f32_16x16x32_bf16 v[4:7], v[172:175], v[228:231], v[4:7]
    s_waitcnt lgkmcnt(4)
    v_mfma_f32_16x16x32_bf16 v[16:19], v[176:179], v[232:235], v[16:19]
    ds_read_b128 v[228:231], v248 offset:10240
    v_mfma_f32_16x16x32_bf16 v[20:23], v[180:183], v[232:235], v[20:23]
    s_waitcnt lgkmcnt(4)
    v_mfma_f32_16x16x32_bf16 v[16:19], v[184:187], v[236:239], v[16:19]
    ds_read_b128 v[232:235], v248 offset:8192
    v_mfma_f32_16x16x32_bf16 v[20:23], v[188:191], v[236:239], v[20:23]
    s_waitcnt lgkmcnt(4)
    v_mfma_f32_16x16x32_bf16 v[16:19], v[192:195], v[240:243], v[16:19]
    ds_read_b128 v[236:239], v248 offset:15360
    v_cvt_pk_bf16_f32 v0, v0, v1
    v_mfma_f32_16x16x32_bf16 v[20:23], v[196:199], v[240:243], v[20:23]
    v_cvt_pk_bf16_f32 v1, v2, v3
    s_waitcnt lgkmcnt(4)
    v_mfma_f32_16x16x32_bf16 v[16:19], v[200:203], v[244:247], v[16:19]
    ds_read_b128 v[240:243], v248 offset:19456
    v_cvt_pk_bf16_f32 v2, v4, v5
    v_mfma_f32_16x16x32_bf16 v[20:23], v[204:207], v[244:247], v[20:23]
    v_cvt_pk_bf16_f32 v3, v6, v7
    s_waitcnt lgkmcnt(4)
    v_mfma_f32_16x16x32_bf16 v[16:19], v[208:211], v[224:227], v[16:19]
    ds_read_b128 v[244:247], v248 offset:20480
    buffer_store_dwordx4 v[0:3], v248, s[20:23], s69 offen sc1
    s_add_u32 s69, s69, 1024
    v_mfma_f32_16x16x32_bf16 v[20:23], v[212:215], v[224:227], v[20:23]
    s_add_u32 s67, s68, 8192
    buffer_load_dwordx4 v[0:3], v248, s[20:23], s67 offen sc1
    buffer_load_dwordx4 v[4:7], v248, s[20:23], s67 offen offset:1024 sc1
    s_waitcnt lgkmcnt(4)
    v_mfma_f32_16x16x32_bf16 v[16:19], v[216:219], v[228:231], v[16:19]
    ds_read_b128 v[224:227], v248 offset:21504
    v_mfma_f32_16x16x32_bf16 v[20:23], v[220:223], v[228:231], v[20:23]
    s_waitcnt lgkmcnt(4)
    v_mfma_f32_16x16x32_bf16 v[16:19], v[160:163], v[232:235], v[16:19]
    ds_read_b128 v[228:231], v248 offset:22528
    v_mfma_f32_16x16x32_bf16 v[20:23], v[164:167], v[232:235], v[20:23]
    s_waitcnt lgkmcnt(4)
    v_mfma_f32_16x16x32_bf16 v[16:19], v[168:171], v[236:239], v[16:19]
    ds_read_b128 v[232:235], v248 offset:17408
    v_mfma_f32_16x16x32_bf16 v[20:23], v[172:175], v[236:239], v[20:23]
    s_waitcnt lgkmcnt(4)
    v_mfma_f32_16x16x32_bf16 v[32:35], v[176:179], v[240:243], v[32:35]
    ds_read_b128 v[236:239], v248 offset:18432
    v_mfma_f32_16x16x32_bf16 v[36:39], v[180:183], v[240:243], v[36:39]
    s_waitcnt lgkmcnt(4)
    v_mfma_f32_16x16x32_bf16 v[32:35], v[184:187], v[244:247], v[32:35]
    ds_read_b128 v[240:243], v248 offset:16384
    v_mfma_f32_16x16x32_bf16 v[36:39], v[188:191], v[244:247], v[36:39]
    s_waitcnt lgkmcnt(4)
    v_mfma_f32_16x16x32_bf16 v[32:35], v[192:195], v[224:227], v[32:35]
    ds_read_b128 v[244:247], v248 offset:23552
    v_cvt_pk_bf16_f32 v16, v16, v17
    v_mfma_f32_16x16x32_bf16 v[36:39], v[196:199], v[224:227], v[36:39]
    v_cvt_pk_bf16_f32 v17, v18, v19
    s_waitcnt lgkmcnt(4)
    v_mfma_f32_16x16x32_bf16 v[32:35], v[200:203], v[228:231], v[32:35]
    ds_read_b128 v[224:227], v248 offset:27648
    v_cvt_pk_bf16_f32 v18, v20, v21
    v_mfma_f32_16x16x32_bf16 v[36:39], v[204:207], v[228:231], v[36:39]
    v_cvt_pk_bf16_f32 v19, v22, v23
    s_waitcnt lgkmcnt(4)
    v_mfma_f32_16x16x32_bf16 v[32:35], v[208:211], v[232:235], v[32:35]
    ds_read_b128 v[228:231], v248 offset:28672
    buffer_store_dwordx4 v[16:19], v248, s[20:23], s69 offen sc1
    s_add_u32 s69, s69, 1024
    v_mfma_f32_16x16x32_bf16 v[36:39], v[212:215], v[232:235], v[36:39]
    s_add_u32 s67, s68, 274432
    buffer_load_dwordx4 v[16:19], v248, s[20:23], s67 offen sc1
    buffer_load_dwordx4 v[20:23], v248, s[20:23], s67 offen offset:1024 sc1
    s_waitcnt lgkmcnt(4)
    v_mfma_f32_16x16x32_bf16 v[32:35], v[216:219], v[236:239], v[32:35]
    ds_read_b128 v[232:235], v248 offset:29696
    v_mfma_f32_16x16x32_bf16 v[36:39], v[220:223], v[236:239], v[36:39]
    s_waitcnt lgkmcnt(4)
    v_mfma_f32_16x16x32_bf16 v[32:35], v[160:163], v[240:243], v[32:35]
    ds_read_b128 v[236:239], v248 offset:30720
    v_mfma_f32_16x16x32_bf16 v[36:39], v[164:167], v[240:243], v[36:39]
    s_waitcnt lgkmcnt(4)
    v_mfma_f32_16x16x32_bf16 v[32:35], v[168:171], v[244:247], v[32:35]
    ds_read_b128 v[240:243], v248 offset:25600
    v_mfma_f32_16x16x32_bf16 v[36:39], v[172:175], v[244:247], v[36:39]
    s_waitcnt lgkmcnt(4)
    v_mfma_f32_16x16x32_bf16 v[48:51], v[176:179], v[224:227], v[48:51]
    ds_read_b128 v[244:247], v248 offset:26624
    v_mfma_f32_16x16x32_bf16 v[52:55], v[180:183], v[224:227], v[52:55]
    s_waitcnt lgkmcnt(4)
    v_mfma_f32_16x16x32_bf16 v[48:51], v[184:187], v[228:231], v[48:51]
    ds_read_b128 v[224:227], v248 offset:24576
    v_mfma_f32_16x16x32_bf16 v[52:55], v[188:191], v[228:231], v[52:55]
    s_waitcnt lgkmcnt(4)
    v_mfma_f32_16x16x32_bf16 v[48:51], v[192:195], v[232:235], v[48:51]
    ds_read_b128 v[228:231], v248 offset:31744
    v_cvt_pk_bf16_f32 v32, v32, v33
    v_mfma_f32_16x16x32_bf16 v[52:55], v[196:199], v[232:235], v[52:55]
    v_cvt_pk_bf16_f32 v33, v34, v35
    s_waitcnt lgkmcnt(4)
    v_mfma_f32_16x16x32_bf16 v[48:51], v[200:203], v[236:239], v[48:51]
    ds_read_b128 v[232:235], v248 offset:35840
    v_cvt_pk_bf16_f32 v34, v36, v37
    v_mfma_f32_16x16x32_bf16 v[52:55], v[204:207], v[236:239], v[52:55]
    v_cvt_pk_bf16_f32 v35, v38, v39
    s_waitcnt lgkmcnt(4)
    v_mfma_f32_16x16x32_bf16 v[48:51], v[208:211], v[240:243], v[48:51]
    ds_read_b128 v[236:239], v248 offset:36864
    buffer_store_dwordx4 v[32:35], v248, s[20:23], s69 offen sc1
    s_add_u32 s69, s69, 1024
    v_mfma_f32_16x16x32_bf16 v[52:55], v[212:215], v[240:243], v[52:55]
    s_add_u32 s67, s68, 540672
    buffer_load_dwordx4 v[32:35], v248, s[20:23], s67 offen sc1
    buffer_load_dwordx4 v[36:39], v248, s[20:23], s67 offen offset:1024 sc1
    s_waitcnt lgkmcnt(4)
    v_mfma_f32_16x16x32_bf16 v[48:51], v[216:219], v[244:247], v[48:51]
    ds_read_b128 v[240:243], v248 offset:37888
    v_mfma_f32_16x16x32_bf16 v[52:55], v[220:223], v[244:247], v[52:55]
    s_waitcnt lgkmcnt(4)
    v_mfma_f32_16x16x32_bf16 v[48:51], v[160:163], v[224:227], v[48:51]
    ds_read_b128 v[244:247], v248 offset:38912
    v_mfma_f32_16x16x32_bf16 v[52:55], v[164:167], v[224:227], v[52:55]
    s_waitcnt lgkmcnt(4)
    v_mfma_f32_16x16x32_bf16 v[48:51], v[168:171], v[228:231], v[48:51]
    ds_read_b128 v[224:227], v248 offset:33792
    v_mfma_f32_16x16x32_bf16 v[52:55], v[172:175], v[228:231], v[52:55]
    s_waitcnt lgkmcnt(4)
    v_mfma_f32_16x16x32_bf16 v[64:67], v[176:179], v[232:235], v[64:67]
    ds_read_b128 v[228:231], v248 offset:34816
    v_mfma_f32_16x16x32_bf16 v[68:71], v[180:183], v[232:235], v[68:71]
    s_waitcnt lgkmcnt(4)
    v_mfma_f32_16x16x32_bf16 v[64:67], v[184:187], v[236:239], v[64:67]
    ds_read_b128 v[232:235], v248 offset:32768
    v_mfma_f32_16x16x32_bf16 v[68:71], v[188:191], v[236:239], v[68:71]
    s_waitcnt lgkmcnt(4)
    v_mfma_f32_16x16x32_bf16 v[64:67], v[192:195], v[240:243], v[64:67]
    ds_read_b128 v[236:239], v248 offset:39936
    v_cvt_pk_bf16_f32 v48, v48, v49
    v_mfma_f32_16x16x32_bf16 v[68:71], v[196:199], v[240:243], v[68:71]
    v_cvt_pk_bf16_f32 v49, v50, v51
    s_waitcnt lgkmcnt(4)
    v_mfma_f32_16x16x32_bf16 v[64:67], v[200:203], v[244:247], v[64:67]
    ds_read_b128 v[240:243], v248 offset:44032
    v_cvt_pk_bf16_f32 v50, v52, v53
    v_mfma_f32_16x16x32_bf16 v[68:71], v[204:207], v[244:247], v[68:71]
    v_cvt_pk_bf16_f32 v51, v54, v55
    s_waitcnt lgkmcnt(4)
    v_mfma_f32_16x16x32_bf16 v[64:67], v[208:211], v[224:227], v[64:67]
    ds_read_b128 v[244:247], v248 offset:45056
    buffer_store_dwordx4 v[48:51], v248, s[20:23], s69 offen sc1
    s_add_u32 s69, s69, 1024
    v_mfma_f32_16x16x32_bf16 v[68:71], v[212:215], v[224:227], v[68:71]
    s_add_u32 s67, s68, 806912
    buffer_load_dwordx4 v[48:51], v248, s[20:23], s67 offen sc1
    buffer_load_dwordx4 v[52:55], v248, s[20:23], s67 offen offset:1024 sc1
    s_waitcnt lgkmcnt(4)
    v_mfma_f32_16x16x32_bf16 v[64:67], v[216:219], v[228:231], v[64:67]
    ds_read_b128 v[224:227], v248 offset:46080
    v_mfma_f32_16x16x32_bf16 v[68:71], v[220:223], v[228:231], v[68:71]
    s_waitcnt lgkmcnt(4)
    v_mfma_f32_16x16x32_bf16 v[64:67], v[160:163], v[232:235], v[64:67]
    ds_read_b128 v[228:231], v248 offset:47104
    v_mfma_f32_16x16x32_bf16 v[68:71], v[164:167], v[232:235], v[68:71]
    s_waitcnt lgkmcnt(4)
    v_mfma_f32_16x16x32_bf16 v[64:67], v[168:171], v[236:239], v[64:67]
    ds_read_b128 v[232:235], v248 offset:41984
    v_mfma_f32_16x16x32_bf16 v[68:71], v[172:175], v[236:239], v[68:71]
    s_waitcnt lgkmcnt(4)
    v_mfma_f32_16x16x32_bf16 v[80:83], v[176:179], v[240:243], v[80:83]
    ds_read_b128 v[236:239], v248 offset:43008
    v_mfma_f32_16x16x32_bf16 v[84:87], v[180:183], v[240:243], v[84:87]
    s_waitcnt lgkmcnt(4)
    v_mfma_f32_16x16x32_bf16 v[80:83], v[184:187], v[244:247], v[80:83]
    ds_read_b128 v[240:243], v248 offset:40960
    v_mfma_f32_16x16x32_bf16 v[84:87], v[188:191], v[244:247], v[84:87]
    s_waitcnt lgkmcnt(4)
    v_mfma_f32_16x16x32_bf16 v[80:83], v[192:195], v[224:227], v[80:83]
    ds_read_b128 v[244:247], v248 offset:48128
    v_cvt_pk_bf16_f32 v64, v64, v65
    v_mfma_f32_16x16x32_bf16 v[84:87], v[196:199], v[224:227], v[84:87]
    v_cvt_pk_bf16_f32 v65, v66, v67
    s_waitcnt lgkmcnt(4)
    v_mfma_f32_16x16x32_bf16 v[80:83], v[200:203], v[228:231], v[80:83]
    ds_read_b128 v[224:227], v248 offset:52224
    v_cvt_pk_bf16_f32 v66, v68, v69
    v_mfma_f32_16x16x32_bf16 v[84:87], v[204:207], v[228:231], v[84:87]
    v_cvt_pk_bf16_f32 v67, v70, v71
    s_waitcnt lgkmcnt(4)
    v_mfma_f32_16x16x32_bf16 v[80:83], v[208:211], v[232:235], v[80:83]
    ds_read_b128 v[228:231], v248 offset:53248
    buffer_store_dwordx4 v[64:67], v248, s[20:23], s69 offen sc1
    s_add_u32 s69, s69, 1024
    v_mfma_f32_16x16x32_bf16 v[84:87], v[212:215], v[232:235], v[84:87]
    s_add_u32 s67, s68, 3203072
    buffer_load_dwordx4 v[64:67], v248, s[20:23], s67 offen sc1
    buffer_load_dwordx4 v[68:71], v248, s[20:23], s67 offen offset:1024 sc1
    s_waitcnt lgkmcnt(4)
    v_mfma_f32_16x16x32_bf16 v[80:83], v[216:219], v[236:239], v[80:83]
    ds_read_b128 v[232:235], v248 offset:54272
    v_mfma_f32_16x16x32_bf16 v[84:87], v[220:223], v[236:239], v[84:87]
    s_waitcnt lgkmcnt(4)
    v_mfma_f32_16x16x32_bf16 v[80:83], v[160:163], v[240:243], v[80:83]
    ds_read_b128 v[236:239], v248 offset:55296
    v_mfma_f32_16x16x32_bf16 v[84:87], v[164:167], v[240:243], v[84:87]
    s_waitcnt lgkmcnt(4)
    v_mfma_f32_16x16x32_bf16 v[80:83], v[168:171], v[244:247], v[80:83]
    ds_read_b128 v[240:243], v248 offset:50176
    v_mfma_f32_16x16x32_bf16 v[84:87], v[172:175], v[244:247], v[84:87]
    s_waitcnt lgkmcnt(4)
    v_mfma_f32_16x16x32_bf16 v[96:99], v[176:179], v[224:227], v[96:99]
    ds_read_b128 v[244:247], v248 offset:51200
    v_mfma_f32_16x16x32_bf16 v[100:103], v[180:183], v[224:227], v[100:103]
    s_waitcnt lgkmcnt(4)
    v_mfma_f32_16x16x32_bf16 v[96:99], v[184:187], v[228:231], v[96:99]
    ds_read_b128 v[224:227], v248 offset:49152
    v_mfma_f32_16x16x32_bf16 v[100:103], v[188:191], v[228:231], v[100:103]
    s_waitcnt lgkmcnt(4)
    v_mfma_f32_16x16x32_bf16 v[96:99], v[192:195], v[232:235], v[96:99]
    ds_read_b128 v[228:231], v248 offset:56320
    v_cvt_pk_bf16_f32 v80, v80, v81
    v_mfma_f32_16x16x32_bf16 v[100:103], v[196:199], v[232:235], v[100:103]
    v_cvt_pk_bf16_f32 v81, v82, v83
    s_waitcnt lgkmcnt(4)
    v_mfma_f32_16x16x32_bf16 v[96:99], v[200:203], v[236:239], v[96:99]
    ds_read_b128 v[232:235], v248 offset:60416
    v_cvt_pk_bf16_f32 v82, v84, v85
    v_mfma_f32_16x16x32_bf16 v[100:103], v[204:207], v[236:239], v[100:103]
    v_cvt_pk_bf16_f32 v83, v86, v87
    s_waitcnt lgkmcnt(4)
    v_mfma_f32_16x16x32_bf16 v[96:99], v[208:211], v[240:243], v[96:99]
    ds_read_b128 v[236:239], v248 offset:61440
    buffer_store_dwordx4 v[80:83], v248, s[20:23], s69 offen sc1
    s_add_u32 s69, s69, 1024
    v_mfma_f32_16x16x32_bf16 v[100:103], v[212:215], v[240:243], v[100:103]
    s_add_u32 s67, s68, 3469312
    buffer_load_dwordx4 v[80:83], v248, s[20:23], s67 offen sc1
    buffer_load_dwordx4 v[84:87], v248, s[20:23], s67 offen offset:1024 sc1
    s_waitcnt lgkmcnt(4)
    v_mfma_f32_16x16x32_bf16 v[96:99], v[216:219], v[244:247], v[96:99]
    ds_read_b128 v[240:243], v248 offset:62464
    v_mfma_f32_16x16x32_bf16 v[100:103], v[220:223], v[244:247], v[100:103]
    s_waitcnt lgkmcnt(4)
    v_mfma_f32_16x16x32_bf16 v[96:99], v[160:163], v[224:227], v[96:99]
    ds_read_b128 v[244:247], v248 offset:63488
    v_mfma_f32_16x16x32_bf16 v[100:103], v[164:167], v[224:227], v[100:103]
    s_waitcnt lgkmcnt(4)
    v_mfma_f32_16x16x32_bf16 v[96:99], v[168:171], v[228:231], v[96:99]
    ds_read_b128 v[224:227], v248 offset:58368
    v_mfma_f32_16x16x32_bf16 v[100:103], v[172:175], v[228:231], v[100:103]
    s_waitcnt lgkmcnt(4)
    v_mfma_f32_16x16x32_bf16 v[112:115], v[176:179], v[232:235], v[112:115]
    ds_read_b128 v[228:231], v248 offset:59392
    v_mfma_f32_16x16x32_bf16 v[116:119], v[180:183], v[232:235], v[116:119]
    s_waitcnt lgkmcnt(4)
    v_mfma_f32_16x16x32_bf16 v[112:115], v[184:187], v[236:239], v[112:115]
    ds_read_b128 v[232:235], v248 offset:57344
    v_mfma_f32_16x16x32_bf16 v[116:119], v[188:191], v[236:239], v[116:119]
    s_waitcnt lgkmcnt(4)
    v_mfma_f32_16x16x32_bf16 v[112:115], v[192:195], v[240:243], v[112:115]
    ds_read_b128 v[236:239], v248 offset:64512
    v_cvt_pk_bf16_f32 v96, v96, v97
    v_mfma_f32_16x16x32_bf16 v[116:119], v[196:199], v[240:243], v[116:119]
    v_cvt_pk_bf16_f32 v97, v98, v99
    s_waitcnt lgkmcnt(4)
    v_mfma_f32_16x16x32_bf16 v[112:115], v[200:203], v[244:247], v[112:115]
    ds_read_b128 v[240:243], v249 offset:3072
    v_cvt_pk_bf16_f32 v98, v100, v101
    v_mfma_f32_16x16x32_bf16 v[116:119], v[204:207], v[244:247], v[116:119]
    v_cvt_pk_bf16_f32 v99, v102, v103
    s_waitcnt lgkmcnt(4)
    v_mfma_f32_16x16x32_bf16 v[112:115], v[208:211], v[224:227], v[112:115]
    ds_read_b128 v[244:247], v249 offset:4096
    buffer_store_dwordx4 v[96:99], v248, s[20:23], s69 offen sc1
    s_add_u32 s69, s69, 1024
    v_mfma_f32_16x16x32_bf16 v[116:119], v[212:215], v[224:227], v[116:119]
    s_add_u32 s67, s68, 3735552
    buffer_load_dwordx4 v[96:99], v248, s[20:23], s67 offen sc1
    buffer_load_dwordx4 v[100:103], v248, s[20:23], s67 offen offset:1024 sc1
    s_waitcnt lgkmcnt(4)
    v_mfma_f32_16x16x32_bf16 v[112:115], v[216:219], v[228:231], v[112:115]
    ds_read_b128 v[224:227], v249 offset:5120
    v_mfma_f32_16x16x32_bf16 v[116:119], v[220:223], v[228:231], v[116:119]
    s_waitcnt lgkmcnt(4)
    v_mfma_f32_16x16x32_bf16 v[112:115], v[160:163], v[232:235], v[112:115]
    ds_read_b128 v[228:231], v249 offset:6144
    v_mfma_f32_16x16x32_bf16 v[116:119], v[164:167], v[232:235], v[116:119]
    s_waitcnt lgkmcnt(4)
    v_mfma_f32_16x16x32_bf16 v[112:115], v[168:171], v[236:239], v[112:115]
    ds_read_b128 v[232:235], v249 offset:1024
    v_mfma_f32_16x16x32_bf16 v[116:119], v[172:175], v[236:239], v[116:119]
    s_waitcnt lgkmcnt(4)
    v_mfma_f32_16x16x32_bf16 v[128:131], v[176:179], v[240:243], v[128:131]
    ds_read_b128 v[236:239], v249 offset:2048
    v_mfma_f32_16x16x32_bf16 v[132:135], v[180:183], v[240:243], v[132:135]
    s_waitcnt lgkmcnt(4)
    v_mfma_f32_16x16x32_bf16 v[128:131], v[184:187], v[244:247], v[128:131]
    ds_read_b128 v[240:243], v249 offset:0
    v_mfma_f32_16x16x32_bf16 v[132:135], v[188:191], v[244:247], v[132:135]
    s_waitcnt lgkmcnt(4)
    v_mfma_f32_16x16x32_bf16 v[128:131], v[192:195], v[224:227], v[128:131]
    ds_read_b128 v[244:247], v249 offset:7168
    v_cvt_pk_bf16_f32 v112, v112, v113
    v_mfma_f32_16x16x32_bf16 v[132:135], v[196:199], v[224:227], v[132:135]
    v_cvt_pk_bf16_f32 v113, v114, v115
    s_waitcnt lgkmcnt(4)
    v_mfma_f32_16x16x32_bf16 v[128:131], v[200:203], v[228:231], v[128:131]
    ds_read_b128 v[224:227], v249 offset:11264
    v_cvt_pk_bf16_f32 v114, v116, v117
    v_mfma_f32_16x16x32_bf16 v[132:135], v[204:207], v[228:231], v[132:135]
    v_cvt_pk_bf16_f32 v115, v118, v119
    s_waitcnt lgkmcnt(4)
    v_mfma_f32_16x16x32_bf16 v[128:131], v[208:211], v[232:235], v[128:131]
    ds_read_b128 v[228:231], v249 offset:12288
    buffer_store_dwordx4 v[112:115], v248, s[20:23], s69 offen sc1
    s_add_u32 s69, s69, 1024
    v_mfma_f32_16x16x32_bf16 v[132:135], v[212:215], v[232:235], v[132:135]
    s_add_u32 s67, s68, 4001792
    buffer_load_dwordx4 v[112:115], v248, s[20:23], s67 offen sc1
    buffer_load_dwordx4 v[116:119], v248, s[20:23], s67 offen offset:1024 sc1
    s_waitcnt lgkmcnt(4)
    v_mfma_f32_16x16x32_bf16 v[128:131], v[216:219], v[236:239], v[128:131]
    ds_read_b128 v[232:235], v249 offset:13312
    v_mfma_f32_16x16x32_bf16 v[132:135], v[220:223], v[236:239], v[132:135]
    s_setprio 1
    s_waitcnt lgkmcnt(4)
    v_mfma_f32_16x16x32_bf16 v[128:131], v[160:163], v[240:243], v[128:131]
    ds_read_b128 v[236:239], v249 offset:14336
    v_mfma_f32_16x16x32_bf16 v[132:135], v[164:167], v[240:243], v[132:135]
    s_waitcnt lgkmcnt(4)
    v_mfma_f32_16x16x32_bf16 v[128:131], v[168:171], v[244:247], v[128:131]
    ds_read_b128 v[240:243], v249 offset:9216
    v_mfma_f32_16x16x32_bf16 v[132:135], v[172:175], v[244:247], v[132:135]
    s_waitcnt lgkmcnt(4)
    v_mfma_f32_16x16x32_bf16 v[144:147], v[176:179], v[224:227], v[144:147]
    ds_read_b128 v[244:247], v249 offset:10240
    v_mfma_f32_16x16x32_bf16 v[148:151], v[180:183], v[224:227], v[148:151]
    s_waitcnt lgkmcnt(4)
    v_mfma_f32_16x16x32_bf16 v[144:147], v[184:187], v[228:231], v[144:147]
    ds_read_b128 v[224:227], v249 offset:8192
    v_mfma_f32_16x16x32_bf16 v[148:151], v[188:191], v[228:231], v[148:151]
    s_waitcnt lgkmcnt(4)
    v_mfma_f32_16x16x32_bf16 v[144:147], v[192:195], v[232:235], v[144:147]
    ds_read_b128 v[228:231], v249 offset:15360
    v_cvt_pk_bf16_f32 v128, v128, v129
    v_mfma_f32_16x16x32_bf16 v[148:151], v[196:199], v[232:235], v[148:151]
    v_cvt_pk_bf16_f32 v129, v130, v131
    s_waitcnt lgkmcnt(4)
    v_mfma_f32_16x16x32_bf16 v[144:147], v[200:203], v[236:239], v[144:147]
    ds_read_b128 v[232:235], v248 offset:3072
    v_cvt_pk_bf16_f32 v130, v132, v133
    v_mfma_f32_16x16x32_bf16 v[148:151], v[204:207], v[236:239], v[148:151]
    v_cvt_pk_bf16_f32 v131, v134, v135
    s_waitcnt lgkmcnt(4)
    v_mfma_f32_16x16x32_bf16 v[144:147], v[208:211], v[240:243], v[144:147]
    ds_read_b128 v[236:239], v248 offset:4096
    buffer_store_dwordx4 v[128:131], v248, s[20:23], s69 offen sc1
    s_add_u32 s69, s69, 1024
    v_mfma_f32_16x16x32_bf16 v[148:151], v[212:215], v[240:243], v[148:151]
    s_waitcnt lgkmcnt(4)
    v_mfma_f32_16x16x32_bf16 v[144:147], v[216:219], v[244:247], v[144:147]
    ds_read_b128 v[240:243], v248 offset:5120
    v_mfma_f32_16x16x32_bf16 v[148:151], v[220:223], v[244:247], v[148:151]
    s_waitcnt lgkmcnt(4)
    v_mfma_f32_16x16x32_bf16 v[144:147], v[160:163], v[224:227], v[144:147]
    ds_read_b128 v[244:247], v248 offset:6144
    v_mfma_f32_16x16x32_bf16 v[148:151], v[164:167], v[224:227], v[148:151]
    s_waitcnt lgkmcnt(4)
    v_mfma_f32_16x16x32_bf16 v[144:147], v[168:171], v[228:231], v[144:147]
    ds_read_b128 v[224:227], v248 offset:1024
    v_mfma_f32_16x16x32_bf16 v[148:151], v[172:175], v[228:231], v[148:151]
    s_waitcnt vmcnt(22)
    s_waitcnt lgkmcnt(4)
    v_mfma_f32_16x16x32_bf16 v[8:11], v[0:3], v[232:235], v[8:11]
    ds_read_b128 v[228:231], v248 offset:2048
    v_mfma_f32_16x16x32_bf16 v[12:15], v[4:7], v[232:235], v[12:15]
    s_waitcnt vmcnt(19)
    s_waitcnt lgkmcnt(4)
    v_mfma_f32_16x16x32_bf16 v[8:11], v[16:19], v[236:239], v[8:11]
    ds_read_b128 v[232:235], v248 offset:0
    v_mfma_f32_16x16x32_bf16 v[12:15], v[20:23], v[236:239], v[12:15]
    s_waitcnt vmcnt(16)
    s_waitcnt lgkmcnt(4)
    v_mfma_f32_16x16x32_bf16 v[8:11], v[32:35], v[240:243], v[8:11]
    ds_read_b128 v[236:239], v248 offset:7168
    v_cvt_pk_bf16_f32 v144, v144, v145
    v_mfma_f32_16x16x32_bf16 v[12:15], v[36:39], v[240:243], v[12:15]
    v_cvt_pk_bf16_f32 v145, v146, v147
    s_waitcnt vmcnt(13)
    s_waitcnt lgkmcnt(4)
    v_mfma_f32_16x16x32_bf16 v[8:11], v[48:51], v[244:247], v[8:11]
    ds_read_b128 v[240:243], v248 offset:11264
    v_cvt_pk_bf16_f32 v146, v148, v149
    v_mfma_f32_16x16x32_bf16 v[12:15], v[52:55], v[244:247], v[12:15]
    v_cvt_pk_bf16_f32 v147, v150, v151
    s_waitcnt vmcnt(10)
    s_waitcnt lgkmcnt(4)
    v_mfma_f32_16x16x32_bf16 v[8:11], v[64:67], v[224:227], v[8:11]
    ds_read_b128 v[244:247], v248 offset:12288
    buffer_store_dwordx4 v[144:147], v248, s[20:23], s69 offen sc1
    s_add_u32 s69, s69, 31744
    v_mfma_f32_16x16x32_bf16 v[12:15], v[68:71], v[224:227], v[12:15]
    s_waitcnt vmcnt(8)
    s_waitcnt lgkmcnt(4)
    v_mfma_f32_16x16x32_bf16 v[8:11], v[80:83], v[228:231], v[8:11]
    ds_read_b128 v[224:227], v248 offset:13312
    v_mfma_f32_16x16x32_bf16 v[12:15], v[84:87], v[228:231], v[12:15]
    s_waitcnt vmcnt(5)
    s_waitcnt lgkmcnt(4)
    v_mfma_f32_16x16x32_bf16 v[8:11], v[96:99], v[232:235], v[8:11]
    ds_read_b128 v[228:231], v248 offset:14336
    v_mfma_f32_16x16x32_bf16 v[12:15], v[100:103], v[232:235], v[12:15]
    s_waitcnt vmcnt(2)
    s_waitcnt lgkmcnt(4)
    v_mfma_f32_16x16x32_bf16 v[8:11], v[112:115], v[236:239], v[8:11]
    ds_read_b128 v[232:235], v248 offset:9216
    v_mfma_f32_16x16x32_bf16 v[12:15], v[116:119], v[236:239], v[12:15]
    s_waitcnt lgkmcnt(4)
    v_mfma_f32_16x16x32_bf16 v[24:27], v[0:3], v[240:243], v[24:27]
    ds_read_b128 v[236:239], v248 offset:10240
    v_mfma_f32_16x16x32_bf16 v[28:31], v[4:7], v[240:243], v[28:31]
    s_waitcnt lgkmcnt(4)
    v_mfma_f32_16x16x32_bf16 v[24:27], v[16:19], v[244:247], v[24:27]
    ds_read_b128 v[240:243], v248 offset:8192
    v_mfma_f32_16x16x32_bf16 v[28:31], v[20:23], v[244:247], v[28:31]
    s_waitcnt lgkmcnt(4)
    v_mfma_f32_16x16x32_bf16 v[24:27], v[32:35], v[224:227], v[24:27]
    ds_read_b128 v[244:247], v248 offset:15360
    v_cvt_pk_bf16_f32 v8, v8, v9
    v_mfma_f32_16x16x32_bf16 v[28:31], v[36:39], v[224:227], v[28:31]
    v_cvt_pk_bf16_f32 v9, v10, v11
    s_waitcnt lgkmcnt(4)
    v_mfma_f32_16x16x32_bf16 v[24:27], v[48:51], v[228:231], v[24:27]
    ds_read_b128 v[224:227], v248 offset:19456
    v_cvt_pk_bf16_f32 v10, v12, v13
    v_mfma_f32_16x16x32_bf16 v[28:31], v[52:55], v[228:231], v[28:31]
    v_cvt_pk_bf16_f32 v11, v14, v15
    s_waitcnt lgkmcnt(4)
    v_mfma_f32_16x16x32_bf16 v[24:27], v[64:67], v[232:235], v[24:27]
    ds_read_b128 v[228:231], v248 offset:20480
    buffer_store_dwordx4 v[8:11], v248, s[20:23], s69 offen sc1
    s_add_u32 s69, s69, 1024
    v_mfma_f32_16x16x32_bf16 v[28:31], v[68:71], v[232:235], v[28:31]
    s_waitcnt lgkmcnt(4)
    v_mfma_f32_16x16x32_bf16 v[24:27], v[80:83], v[236:239], v[24:27]
    ds_read_b128 v[232:235], v248 offset:21504
    v_mfma_f32_16x16x32_bf16 v[28:31], v[84:87], v[236:239], v[28:31]
    s_waitcnt lgkmcnt(4)
    v_mfma_f32_16x16x32_bf16 v[24:27], v[96:99], v[240:243], v[24:27]
    ds_read_b128 v[236:239], v248 offset:22528
    v_mfma_f32_16x16x32_bf16 v[28:31], v[100:103], v[240:243], v[28:31]
    s_waitcnt lgkmcnt(4)
    v_mfma_f32_16x16x32_bf16 v[24:27], v[112:115], v[244:247], v[24:27]
    ds_read_b128 v[240:243], v248 offset:17408
    v_mfma_f32_16x16x32_bf16 v[28:31], v[116:119], v[244:247], v[28:31]
    s_waitcnt lgkmcnt(4)
    v_mfma_f32_16x16x32_bf16 v[40:43], v[0:3], v[224:227], v[40:43]
    ds_read_b128 v[244:247], v248 offset:18432
    v_mfma_f32_16x16x32_bf16 v[44:47], v[4:7], v[224:227], v[44:47]
    s_waitcnt lgkmcnt(4)
    v_mfma_f32_16x16x32_bf16 v[40:43], v[16:19], v[228:231], v[40:43]
    ds_read_b128 v[224:227], v248 offset:16384
    v_mfma_f32_16x16x32_bf16 v[44:47], v[20:23], v[228:231], v[44:47]
    s_waitcnt lgkmcnt(4)
    v_mfma_f32_16x16x32_bf16 v[40:43], v[32:35], v[232:235], v[40:43]
    ds_read_b128 v[228:231], v248 offset:23552
    v_cvt_pk_bf16_f32 v24, v24, v25
    v_mfma_f32_16x16x32_bf16 v[44:47], v[36:39], v[232:235], v[44:47]
    v_cvt_pk_bf16_f32 v25, v26, v27
    s_waitcnt lgkmcnt(4)
    v_mfma_f32_16x16x32_bf16 v[40:43], v[48:51], v[236:239], v[40:43]
    ds_read_b128 v[232:235], v248 offset:27648
    v_cvt_pk_bf16_f32 v26, v28, v29
    v_mfma_f32_16x16x32_bf16 v[44:47], v[52:55], v[236:239], v[44:47]
    v_cvt_pk_bf16_f32 v27, v30, v31
    s_waitcnt lgkmcnt(4)
    v_mfma_f32_16x16x32_bf16 v[40:43], v[64:67], v[240:243], v[40:43]
    ds_read_b128 v[236:239], v248 offset:28672
    buffer_store_dwordx4 v[24:27], v248, s[20:23], s69 offen sc1
    s_add_u32 s69, s69, 1024
    v_mfma_f32_16x16x32_bf16 v[44:47], v[68:71], v[240:243], v[44:47]
    v_mov_b32 v160, 1
    v_mov_b32 v161, 0
    s_waitcnt vmcnt(2)
    s_mov_b64 exec, 1
    buffer_store_dword v160, v161, s[20:23], s70 offen sc1
    s_mov_b64 exec, -1
    s_add_u32 s70, s70, 2048
    s_waitcnt lgkmcnt(4)
    v_mfma_f32_16x16x32_bf16 v[40:43], v[80:83], v[244:247], v[40:43]
    ds_read_b128 v[240:243], v248 offset:29696
    v_mfma_f32_16x16x32_bf16 v[44:47], v[84:87], v[244:247], v[44:47]
    s_waitcnt lgkmcnt(4)
    v_mfma_f32_16x16x32_bf16 v[40:43], v[96:99], v[224:227], v[40:43]
    ds_read_b128 v[244:247], v248 offset:30720
    v_mfma_f32_16x16x32_bf16 v[44:47], v[100:103], v[224:227], v[44:47]
    s_waitcnt lgkmcnt(4)
    v_mfma_f32_16x16x32_bf16 v[40:43], v[112:115], v[228:231], v[40:43]
    ds_read_b128 v[224:227], v248 offset:25600
    v_mfma_f32_16x16x32_bf16 v[44:47], v[116:119], v[228:231], v[44:47]
    s_waitcnt lgkmcnt(4)
    v_mfma_f32_16x16x32_bf16 v[56:59], v[0:3], v[232:235], v[56:59]
    ds_read_b128 v[228:231], v248 offset:26624
    v_mfma_f32_16x16x32_bf16 v[60:63], v[4:7], v[232:235], v[60:63]
    s_waitcnt lgkmcnt(4)
    v_mfma_f32_16x16x32_bf16 v[56:59], v[16:19], v[236:239], v[56:59]
    ds_read_b128 v[232:235], v248 offset:24576
    v_mfma_f32_16x16x32_bf16 v[60:63], v[20:23], v[236:239], v[60:63]
    s_waitcnt lgkmcnt(4)
    v_mfma_f32_16x16x32_bf16 v[56:59], v[32:35], v[240:243], v[56:59]
    ds_read_b128 v[236:239], v248 offset:31744
    v_cvt_pk_bf16_f32 v40, v40, v41
    v_mfma_f32_16x16x32_bf16 v[60:63], v[36:39], v[240:243], v[60:63]
    v_cvt_pk_bf16_f32 v41, v42, v43
    s_waitcnt lgkmcnt(4)
    v_mfma_f32_16x16x32_bf16 v[56:59], v[48:51], v[244:247], v[56:59]
    ds_read_b128 v[240:243], v248 offset:35840
    v_cvt_pk_bf16_f32 v42, v44, v45
    v_mfma_f32_16x16x32_bf16 v[60:63], v[52:55], v[244:247], v[60:63]
    v_cvt_pk_bf16_f32 v43, v46, v47
    s_waitcnt lgkmcnt(4)
    v_mfma_f32_16x16x32_bf16 v[56:59], v[64:67], v[224:227], v[56:59]
    ds_read_b128 v[244:247], v248 offset:36864
    buffer_store_dwordx4 v[40:43], v248, s[20:23], s69 offen sc1
    s_add_u32 s69, s69, 1024
    v_mfma_f32_16x16x32_bf16 v[60:63], v[68:71], v[224:227], v[60:63]
    s_waitcnt lgkmcnt(4)
    v_mfma_f32_16x16x32_bf16 v[56:59], v[80:83], v[228:231], v[56:59]
    ds_read_b128 v[224:227], v248 offset:37888
    v_mfma_f32_16x16x32_bf16 v[60:63], v[84:87], v[228:231], v[60:63]
    s_waitcnt lgkmcnt(4)
    v_mfma_f32_16x16x32_bf16 v[56:59], v[96:99], v[232:235], v[56:59]
    ds_read_b128 v[228:231], v248 offset:38912
    v_mfma_f32_16x16x32_bf16 v[60:63], v[100:103], v[232:235], v[60:63]
    s_waitcnt lgkmcnt(4)
    v_mfma_f32_16x16x32_bf16 v[56:59], v[112:115], v[236:239], v[56:59]
    ds_read_b128 v[232:235], v248 offset:33792
    v_mfma_f32_16x16x32_bf16 v[60:63], v[116:119], v[236:239], v[60:63]
    s_waitcnt lgkmcnt(4)
    v_mfma_f32_16x16x32_bf16 v[72:75], v[0:3], v[240:243], v[72:75]
    ds_read_b128 v[236:239], v248 offset:34816
    v_mfma_f32_16x16x32_bf16 v[76:79], v[4:7], v[240:243], v[76:79]
    s_waitcnt lgkmcnt(4)
    v_mfma_f32_16x16x32_bf16 v[72:75], v[16:19], v[244:247], v[72:75]
    ds_read_b128 v[240:243], v248 offset:32768
    v_mfma_f32_16x16x32_bf16 v[76:79], v[20:23], v[244:247], v[76:79]
    s_waitcnt lgkmcnt(4)
    v_mfma_f32_16x16x32_bf16 v[72:75], v[32:35], v[224:227], v[72:75]
    ds_read_b128 v[244:247], v248 offset:39936
    v_cvt_pk_bf16_f32 v56, v56, v57
    v_mfma_f32_16x16x32_bf16 v[76:79], v[36:39], v[224:227], v[76:79]
    v_cvt_pk_bf16_f32 v57, v58, v59
    s_waitcnt lgkmcnt(4)
    v_mfma_f32_16x16x32_bf16 v[72:75], v[48:51], v[228:231], v[72:75]
    ds_read_b128 v[224:227], v248 offset:44032
    v_cvt_pk_bf16_f32 v58, v60, v61
    v_mfma_f32_16x16x32_bf16 v[76:79], v[52:55], v[228:231], v[76:79]
    v_cvt_pk_bf16_f32 v59, v62, v63
    s_waitcnt lgkmcnt(4)
    v_mfma_f32_16x16x32_bf16 v[72:75], v[64:67], v[232:235], v[72:75]
    ds_read_b128 v[228:231], v248 offset:45056
    buffer_store_dwordx4 v[56:59], v248, s[20:23], s69 offen sc1
    s_add_u32 s69, s69, 1024
    v_mfma_f32_16x16x32_bf16 v[76:79], v[68:71], v[232:235], v[76:79]
    s_waitcnt lgkmcnt(4)
    v_mfma_f32_16x16x32_bf16 v[72:75], v[80:83], v[236:239], v[72:75]
    ds_read_b128 v[232:235], v248 offset:46080
    v_mfma_f32_16x16x32_bf16 v[76:79], v[84:87], v[236:239], v[76:79]
    s_waitcnt lgkmcnt(4)
    v_mfma_f32_16x16x32_bf16 v[72:75], v[96:99], v[240:243], v[72:75]
    ds_read_b128 v[236:239], v248 offset:47104
    v_mfma_f32_16x16x32_bf16 v[76:79], v[100:103], v[240:243], v[76:79]
    s_waitcnt lgkmcnt(4)
    v_mfma_f32_16x16x32_bf16 v[72:75], v[112:115], v[244:247], v[72:75]
    ds_read_b128 v[240:243], v248 offset:41984
    v_mfma_f32_16x16x32_bf16 v[76:79], v[116:119], v[244:247], v[76:79]
    s_waitcnt lgkmcnt(4)
    v_mfma_f32_16x16x32_bf16 v[88:91], v[0:3], v[224:227], v[88:91]
    ds_read_b128 v[244:247], v248 offset:43008
    v_mfma_f32_16x16x32_bf16 v[92:95], v[4:7], v[224:227], v[92:95]
    s_waitcnt lgkmcnt(4)
    v_mfma_f32_16x16x32_bf16 v[88:91], v[16:19], v[228:231], v[88:91]
    ds_read_b128 v[224:227], v248 offset:40960
    v_mfma_f32_16x16x32_bf16 v[92:95], v[20:23], v[228:231], v[92:95]
    s_waitcnt lgkmcnt(4)
    v_mfma_f32_16x16x32_bf16 v[88:91], v[32:35], v[232:235], v[88:91]
    ds_read_b128 v[228:231], v248 offset:48128
    v_cvt_pk_bf16_f32 v72, v72, v73
    v_mfma_f32_16x16x32_bf16 v[92:95], v[36:39], v[232:235], v[92:95]
    v_cvt_pk_bf16_f32 v73, v74, v75
    s_waitcnt lgkmcnt(4)
    v_mfma_f32_16x16x32_bf16 v[88:91], v[48:51], v[236:239], v[88:91]
    ds_read_b128 v[232:235], v248 offset:52224
    v_cvt_pk_bf16_f32 v74, v76, v77
    v_mfma_f32_16x16x32_bf16 v[92:95], v[52:55], v[236:239], v[92:95]
    v_cvt_pk_bf16_f32 v75, v78, v79
    s_waitcnt lgkmcnt(4)
    v_mfma_f32_16x16x32_bf16 v[88:91], v[64:67], v[240:243], v[88:91]
    ds_read_b128 v[236:239], v248 offset:53248
    buffer_store_dwordx4 v[72:75], v248, s[20:23], s69 offen sc1
    s_add_u32 s69, s69, 1024
    v_mfma_f32_16x16x32_bf16 v[92:95], v[68:71], v[240:243], v[92:95]
    s_waitcnt lgkmcnt(4)
    v_mfma_f32_16x16x32_bf16 v[88:91], v[80:83], v[244:247], v[88:91]
    ds_read_b128 v[240:243], v248 offset:54272
    v_mfma_f32_16x16x32_bf16 v[92:95], v[84:87], v[244:247], v[92:95]
    s_waitcnt lgkmcnt(4)
    v_mfma_f32_16x16x32_bf16 v[88:91], v[96:99], v[224:227], v[88:91]
    ds_read_b128 v[244:247], v248 offset:55296
    v_mfma_f32_16x16x32_bf16 v[92:95], v[100:103], v[224:227], v[92:95]
    s_waitcnt lgkmcnt(4)
    v_mfma_f32_16x16x32_bf16 v[88:91], v[112:115], v[228:231], v[88:91]
    ds_read_b128 v[224:227], v248 offset:50176
    v_mfma_f32_16x16x32_bf16 v[92:95], v[116:119], v[228:231], v[92:95]
    s_waitcnt lgkmcnt(4)
    v_mfma_f32_16x16x32_bf16 v[104:107], v[0:3], v[232:235], v[104:107]
    ds_read_b128 v[228:231], v248 offset:51200
    v_mfma_f32_16x16x32_bf16 v[108:111], v[4:7], v[232:235], v[108:111]
    s_waitcnt lgkmcnt(4)
    v_mfma_f32_16x16x32_bf16 v[104:107], v[16:19], v[236:239], v[104:107]
    ds_read_b128 v[232:235], v248 offset:49152
    v_mfma_f32_16x16x32_bf16 v[108:111], v[20:23], v[236:239], v[108:111]
    s_waitcnt lgkmcnt(4)
    v_mfma_f32_16x16x32_bf16 v[104:107], v[32:35], v[240:243], v[104:107]
    ds_read_b128 v[236:239], v248 offset:56320
    v_cvt_pk_bf16_f32 v88, v88, v89
    v_mfma_f32_16x16x32_bf16 v[108:111], v[36:39], v[240:243], v[108:111]
    v_cvt_pk_bf16_f32 v89, v90, v91
    s_waitcnt lgkmcnt(4)
    v_mfma_f32_16x16x32_bf16 v[104:107], v[48:51], v[244:247], v[104:107]
    ds_read_b128 v[240:243], v248 offset:60416
    v_cvt_pk_bf16_f32 v90, v92, v93
    v_mfma_f32_16x16x32_bf16 v[108:111], v[52:55], v[244:247], v[108:111]
    v_cvt_pk_bf16_f32 v91, v94, v95
    s_waitcnt lgkmcnt(4)
    v_mfma_f32_16x16x32_bf16 v[104:107], v[64:67], v[224:227], v[104:107]
    ds_read_b128 v[244:247], v248 offset:61440
    buffer_store_dwordx4 v[88:91], v248, s[20:23], s69 offen sc1
    s_add_u32 s69, s69, 1024
    v_mfma_f32_16x16x32_bf16 v[108:111], v[68:71], v[224:227], v[108:111]
    s_waitcnt lgkmcnt(4)
    v_mfma_f32_16x16x32_bf16 v[104:107], v[80:83], v[228:231], v[104:107]
    ds_read_b128 v[224:227], v248 offset:62464
    v_mfma_f32_16x16x32_bf16 v[108:111], v[84:87], v[228:231], v[108:111]
    s_waitcnt lgkmcnt(4)
    v_mfma_f32_16x16x32_bf16 v[104:107], v[96:99], v[232:235], v[104:107]
    ds_read_b128 v[228:231], v248 offset:63488
    v_mfma_f32_16x16x32_bf16 v[108:111], v[100:103], v[232:235], v[108:111]
    s_waitcnt lgkmcnt(4)
    v_mfma_f32_16x16x32_bf16 v[104:107], v[112:115], v[236:239], v[104:107]
    ds_read_b128 v[232:235], v248 offset:58368
    v_mfma_f32_16x16x32_bf16 v[108:111], v[116:119], v[236:239], v[108:111]
    s_waitcnt lgkmcnt(4)
    v_mfma_f32_16x16x32_bf16 v[120:123], v[0:3], v[240:243], v[120:123]
    ds_read_b128 v[236:239], v248 offset:59392
    v_mfma_f32_16x16x32_bf16 v[124:127], v[4:7], v[240:243], v[124:127]
    s_waitcnt lgkmcnt(4)
    v_mfma_f32_16x16x32_bf16 v[120:123], v[16:19], v[244:247], v[120:123]
    ds_read_b128 v[240:243], v248 offset:57344
    v_mfma_f32_16x16x32_bf16 v[124:127], v[20:23], v[244:247], v[124:127]
    s_waitcnt lgkmcnt(4)
    v_mfma_f32_16x16x32_bf16 v[120:123], v[32:35], v[224:227], v[120:123]
    ds_read_b128 v[244:247], v248 offset:64512
    v_cvt_pk_bf16_f32 v104, v104, v105
    v_mfma_f32_16x16x32_bf16 v[124:127], v[36:39], v[224:227], v[124:127]
    v_cvt_pk_bf16_f32 v105, v106, v107
    s_waitcnt lgkmcnt(4)
    v_mfma_f32_16x16x32_bf16 v[120:123], v[48:51], v[228:231], v[120:123]
    ds_read_b128 v[224:227], v249 offset:3072
    v_cvt_pk_bf16_f32 v106, v108, v109
    v_mfma_f32_16x16x32_bf16 v[124:127], v[52:55], v[228:231], v[124:127]
    v_cvt_pk_bf16_f32 v107, v110, v111
    s_waitcnt lgkmcnt(4)
    v_mfma_f32_16x16x32_bf16 v[120:123], v[64:67], v[232:235], v[120:123]
    ds_read_b128 v[228:231], v249 offset:4096
    buffer_store_dwordx4 v[104:107], v248, s[20:23], s69 offen sc1
    s_add_u32 s69, s69, 1024
    v_mfma_f32_16x16x32_bf16 v[124:127], v[68:71], v[232:235], v[124:127]
    s_waitcnt lgkmcnt(4)
    v_mfma_f32_16x16x32_bf16 v[120:123], v[80:83], v[236:239], v[120:123]
    ds_read_b128 v[232:235], v249 offset:5120
    v_mfma_f32_16x16x32_bf16 v[124:127], v[84:87], v[236:239], v[124:127]
    s_waitcnt lgkmcnt(4)
    v_mfma_f32_16x16x32_bf16 v[120:123], v[96:99], v[240:243], v[120:123]
    ds_read_b128 v[236:239], v249 offset:6144
    v_mfma_f32_16x16x32_bf16 v[124:127], v[100:103], v[240:243], v[124:127]
    s_waitcnt lgkmcnt(4)
    v_mfma_f32_16x16x32_bf16 v[120:123], v[112:115], v[244:247], v[120:123]
    ds_read_b128 v[240:243], v249 offset:1024
    v_mfma_f32_16x16x32_bf16 v[124:127], v[116:119], v[244:247], v[124:127]
    s_waitcnt lgkmcnt(4)
    v_mfma_f32_16x16x32_bf16 v[136:139], v[0:3], v[224:227], v[136:139]
    ds_read_b128 v[244:247], v249 offset:2048
    v_mfma_f32_16x16x32_bf16 v[140:143], v[4:7], v[224:227], v[140:143]
    s_waitcnt lgkmcnt(4)
    v_mfma_f32_16x16x32_bf16 v[136:139], v[16:19], v[228:231], v[136:139]
    ds_read_b128 v[224:227], v249 offset:0
    v_mfma_f32_16x16x32_bf16 v[140:143], v[20:23], v[228:231], v[140:143]
    s_waitcnt lgkmcnt(4)
    v_mfma_f32_16x16x32_bf16 v[136:139], v[32:35], v[232:235], v[136:139]
    ds_read_b128 v[228:231], v249 offset:7168
    v_cvt_pk_bf16_f32 v120, v120, v121
    v_mfma_f32_16x16x32_bf16 v[140:143], v[36:39], v[232:235], v[140:143]
    v_cvt_pk_bf16_f32 v121, v122, v123
    s_waitcnt lgkmcnt(4)
    v_mfma_f32_16x16x32_bf16 v[136:139], v[48:51], v[236:239], v[136:139]
    ds_read_b128 v[232:235], v249 offset:11264
    v_cvt_pk_bf16_f32 v122, v124, v125
    v_mfma_f32_16x16x32_bf16 v[140:143], v[52:55], v[236:239], v[140:143]
    v_cvt_pk_bf16_f32 v123, v126, v127
    s_waitcnt lgkmcnt(4)
    v_mfma_f32_16x16x32_bf16 v[136:139], v[64:67], v[240:243], v[136:139]
    ds_read_b128 v[236:239], v249 offset:12288
    buffer_store_dwordx4 v[120:123], v248, s[20:23], s69 offen sc1
    s_add_u32 s69, s69, 1024
    v_mfma_f32_16x16x32_bf16 v[140:143], v[68:71], v[240:243], v[140:143]
    s_waitcnt lgkmcnt(4)
    v_mfma_f32_16x16x32_bf16 v[136:139], v[80:83], v[244:247], v[136:139]
    ds_read_b128 v[240:243], v249 offset:13312
    v_mfma_f32_16x16x32_bf16 v[140:143], v[84:87], v[244:247], v[140:143]
    s_waitcnt lgkmcnt(4)
    v_mfma_f32_16x16x32_bf16 v[136:139], v[96:99], v[224:227], v[136:139]
    ds_read_b128 v[244:247], v249 offset:14336
    v_mfma_f32_16x16x32_bf16 v[140:143], v[100:103], v[224:227], v[140:143]
    s_waitcnt lgkmcnt(4)
    v_mfma_f32_16x16x32_bf16 v[136:139], v[112:115], v[228:231], v[136:139]
    ds_read_b128 v[224:227], v249 offset:9216
    v_mfma_f32_16x16x32_bf16 v[140:143], v[116:119], v[228:231], v[140:143]
    s_waitcnt lgkmcnt(4)
    v_mfma_f32_16x16x32_bf16 v[152:155], v[0:3], v[232:235], v[152:155]
    ds_read_b128 v[228:231], v249 offset:10240
    v_mfma_f32_16x16x32_bf16 v[156:159], v[4:7], v[232:235], v[156:159]
    s_waitcnt lgkmcnt(4)
    v_mfma_f32_16x16x32_bf16 v[152:155], v[16:19], v[236:239], v[152:155]
    ds_read_b128 v[232:235], v249 offset:8192
    v_mfma_f32_16x16x32_bf16 v[156:159], v[20:23], v[236:239], v[156:159]
    s_waitcnt lgkmcnt(4)
    v_mfma_f32_16x16x32_bf16 v[152:155], v[32:35], v[240:243], v[152:155]
    ds_read_b128 v[236:239], v249 offset:15360
    v_cvt_pk_bf16_f32 v136, v136, v137
    v_mfma_f32_16x16x32_bf16 v[156:159], v[36:39], v[240:243], v[156:159]
    v_cvt_pk_bf16_f32 v137, v138, v139
    s_waitcnt lgkmcnt(4)
    v_mfma_f32_16x16x32_bf16 v[152:155], v[48:51], v[244:247], v[152:155]
    v_cvt_pk_bf16_f32 v138, v140, v141
    v_mfma_f32_16x16x32_bf16 v[156:159], v[52:55], v[244:247], v[156:159]
    v_cvt_pk_bf16_f32 v139, v142, v143
    s_waitcnt lgkmcnt(3)
    v_mfma_f32_16x16x32_bf16 v[152:155], v[64:67], v[224:227], v[152:155]
    buffer_store_dwordx4 v[136:139], v248, s[20:23], s69 offen sc1
    s_add_u32 s69, s69, 1024
    v_mfma_f32_16x16x32_bf16 v[156:159], v[68:71], v[224:227], v[156:159]
    s_waitcnt lgkmcnt(2)
    v_mfma_f32_16x16x32_bf16 v[152:155], v[80:83], v[228:231], v[152:155]
    v_mfma_f32_16x16x32_bf16 v[156:159], v[84:87], v[228:231], v[156:159]
    s_waitcnt lgkmcnt(1)
    v_mfma_f32_16x16x32_bf16 v[152:155], v[96:99], v[232:235], v[152:155]
    v_mfma_f32_16x16x32_bf16 v[156:159], v[100:103], v[232:235], v[156:159]
    s_waitcnt lgkmcnt(0)
    v_mfma_f32_16x16x32_bf16 v[152:155], v[112:115], v[236:239], v[152:155]
    v_mfma_f32_16x16x32_bf16 v[156:159], v[116:119], v[236:239], v[156:159]
    s_nop 6
    v_cvt_pk_bf16_f32 v152, v152, v153
    v_cvt_pk_bf16_f32 v153, v154, v155
    v_cvt_pk_bf16_f32 v154, v156, v157
    v_cvt_pk_bf16_f32 v155, v158, v159
    buffer_store_dwordx4 v[152:155], v248, s[20:23], s69 offen sc1
    s_add_u32 s69, s69, 31744
    v_mov_b32 v144, 1
    v_mov_b32 v145, 0
L_jobs_done:
    s_waitcnt vmcnt(0)
    s_mov_b64 exec, 1
    buffer_store_dword v144, v145, s[20:23], s70 offen sc1
    s_mov_b64 exec, -1
    s_xor_b32 s39, s34, 4
    s_waitcnt lgkmcnt(0)
    s_cmp_ge_u32 s39, 5
    s_cbranch_scc1 L_fin
    s_setprio 0
    s_mov_b32 s8, s0
    s_mov_b32 s9, s1
    s_mov_b32 s10, 5242880
    s_mov_b32 s11, 0x20000
    v_lshrrev_b32 v2, 4, v248
    v_and_b32 v3, 7, v2
    v_lshlrev_b32 v4, 4, v3
    v_lshlrev_b32 v3, 6, v3
    s_lshl_b32 s42, s30, 7
    s_add_u32 s42, s42, s31
L_poll0:
    buffer_load_ubyte v5, v4, s[4:7], s42 offen sc1
    s_waitcnt vmcnt(0)
    v_and_b32 v5, 2, v5
    v_cmp_eq_u32 vcc, 0, v5
    s_cbranch_vccz L_poll0d
    s_sleep 16
    s_branch L_poll0
L_poll0d:
    v_and_b32 v4, 15, v2
    v_lshlrev_b32 v4, 11, v4
    v_lshrrev_b32 v5, 4, v2
    v_lshl_add_u32 v4, v5, 4, v4
    s_mov_b32 s43, 0xffff0000
    v_bfe_u32 v6, v2, 2, 2
    v_cmp_eq_u32 vcc, v6, v5
    v_and_b32 v6, 1, v2
    v_lshlrev_b32 v6, 4, v6
    v_mov_b32 v7, 0x3f80
    v_lshlrev_b32 v7, v6, v7
    v_cndmask_b32 v7, 0, v7, vcc
    v_and_b32 v6, 2, v2
    v_cmp_eq_u32 vcc, 0, v6
    v_mov_b32 v50, 0
    v_mov_b32 v51, 0
    v_cndmask_b32 v49, v7, v50, vcc
    v_cndmask_b32 v48, v50, v7, vcc
    v_mov_b32 v53, v49
    v_mov_b32 v52, v48
    s_lshr_b32 s47, s32, 1
    s_and_b32 s53, s32, 1
    s_mul_i32 s52, s53, 5
    s_lshl_b32 s42, s47, 9
    s_add_u32 s42, s42, s41
    s_add_u32 s46, s42, 6144
    s_lshl_b32 s53, s40, 7
    s_add_u32 s53, s53, s47
    s_mul_i32 s53, s53, 10240
    s_lshl_b32 s54, s52, 10
    s_add_u32 s53, s53, s54

    s_mul_i32 s54, s31, 327680
    s_lshl_b32 s52, s52, 15
    s_add_u32 s54, s54, s52
    s_lshl_b32 s52, s30, 10
    s_add_u32 s54, s54, s52
    s_lshl_b32 s52, s47, 6
    s_add_u32 s54, s54, s52
    s_mul_i32 s55, s39, 40960
    s_add_u32 s55, s55, s53
    s_add_u32 s55, s55, 4096
    s_lshl_b32 s57, s39, 8
    s_add_u32 s57, s57, s54
    s_add_u32 s57, s57, 131072
    s_cmp_ge_u32 s39, 3
    s_cselect_b32 s55, 0x8000000, s55
    s_cselect_b32 s57, 0x8000000, s57
    s_lshl_b32 s52, s39, 10
    s_add_u32 s53, s53, s52
    s_lshl_b32 s52, s39, 15
    s_add_u32 s54, s54, s52
    s_cmp_eq_u32 s39, 4
    s_cbranch_scc1 L_poll2
    v_lshrrev_b32 v5, 3, v2
    v_min_u32 v5, 2, v5
    v_lshl_add_u32 v6, v5, 11, v3
L_poll1:
    buffer_load_dword v5, v6, s[20:23], s42 offen sc1
    s_waitcnt vmcnt(0)
    v_cmp_ne_u32 vcc, 1, v5
    s_cbranch_vccz L_poll1d
    s_sleep 8
    s_branch L_poll1
L_poll1d:
    s_add_u32 s58, s53, 0
    buffer_load_dwordx4 v[64:67], v248, s[20:23], s58 offen sc1
    s_add_u32 s58, s58, 163840
    buffer_load_dwordx4 v[68:71], v248, s[20:23], s58 offen sc1
    s_add_u32 s58, s58, 163840
    buffer_load_dwordx4 v[72:75], v248, s[20:23], s58 offen sc1
    s_add_u32 s58, s58, 163840
    buffer_load_dwordx4 v[76:79], v248, s[20:23], s58 offen sc1
    s_add_u32 s58, s58, 163840
    buffer_load_dwordx4 v[80:83], v248, s[20:23], s58 offen sc1
    s_add_u32 s58, s58, 163840
    buffer_load_dwordx4 v[84:87], v248, s[20:23], s58 offen sc1
    s_add_u32 s58, s58, 163840
    buffer_load_dwordx4 v[88:91], v248, s[20:23], s58 offen sc1
    s_add_u32 s58, s58, 163840
    buffer_load_dwordx4 v[92:95], v248, s[20:23], s58 offen sc1
    s_add_u32 s58, s53, 40960
    buffer_load_dwordx4 v[96:99], v248, s[20:23], s58 offen sc1
    s_add_u32 s58, s58, 163840
    buffer_load_dwordx4 v[100:103], v248, s[20:23], s58 offen sc1
    s_add_u32 s58, s58, 163840
    buffer_load_dwordx4 v[104:107], v248, s[20:23], s58 offen sc1
    s_add_u32 s58, s58, 163840
    buffer_load_dwordx4 v[108:111], v248, s[20:23], s58 offen sc1
    s_add_u32 s58, s58, 163840
    buffer_load_dwordx4 v[112:115], v248, s[20:23], s58 offen sc1
    s_add_u32 s58, s58, 163840
    buffer_load_dwordx4 v[116:119], v248, s[20:23], s58 offen sc1
    s_add_u32 s58, s58, 163840
    buffer_load_dwordx4 v[120:123], v248, s[20:23], s58 offen sc1
    s_add_u32 s58, s58, 163840
    buffer_load_dwordx4 v[124:127], v248, s[20:23], s58 offen sc1
    s_waitcnt vmcnt(15)
    s_add_u32 s58, s53, 81920
    buffer_load_dwordx4 v[128:131], v248, s[20:23], s58 offen sc1
    v_mfma_f32_16x16x32_bf16 v[8:11], v[48:51], v[64:67], 0
    v_mfma_f32_16x16x32_bf16 v[12:15], v[50:53], v[64:67], 0
    s_waitcnt vmcnt(15)
    s_add_u32 s58, s58, 163840
    buffer_load_dwordx4 v[132:135], v248, s[20:23], s58 offen sc1
    v_mfma_f32_16x16x32_bf16 v[8:11], v[48:51], v[68:71], v[8:11]
    v_mfma_f32_16x16x32_bf16 v[12:15], v[50:53], v[68:71], v[12:15]
    s_waitcnt vmcnt(15)
    s_add_u32 s58, s58, 163840
    buffer_load_dwordx4 v[136:139], v248, s[20:23], s58 offen sc1
    v_mfma_f32_16x16x32_bf16 v[8:11], v[48:51], v[72:75], v[8:11]
    v_mfma_f32_16x16x32_bf16 v[12:15], v[50:53], v[72:75], v[12:15]
    s_waitcnt vmcnt(15)
    s_add_u32 s58, s58, 163840
    buffer_load_dwordx4 v[140:143], v248, s[20:23], s58 offen sc1
    v_mfma_f32_16x16x32_bf16 v[8:11], v[48:51], v[76:79], v[8:11]
    v_mfma_f32_16x16x32_bf16 v[12:15], v[50:53], v[76:79], v[12:15]
    s_waitcnt vmcnt(15)
    s_add_u32 s58, s58, 163840
    buffer_load_dwordx4 v[144:147], v248, s[20:23], s58 offen sc1
    v_mfma_f32_16x16x32_bf16 v[8:11], v[48:51], v[80:83], v[8:11]
    v_mfma_f32_16x16x32_bf16 v[12:15], v[50:53], v[80:83], v[12:15]
    s_waitcnt vmcnt(15)
    s_add_u32 s58, s58, 163840
    buffer_load_dwordx4 v[148:151], v248, s[20:23], s58 offen sc1
    v_mfma_f32_16x16x32_bf16 v[8:11], v[48:51], v[84:87], v[8:11]
    v_mfma_f32_16x16x32_bf16 v[12:15], v[50:53], v[84:87], v[12:15]
    s_waitcnt vmcnt(15)
    s_add_u32 s58, s58, 163840
    buffer_load_dwordx4 v[152:155], v248, s[20:23], s58 offen sc1
    v_mfma_f32_16x16x32_bf16 v[8:11], v[48:51], v[88:91], v[8:11]
    v_mfma_f32_16x16x32_bf16 v[12:15], v[50:53], v[88:91], v[12:15]
    s_waitcnt vmcnt(15)
    s_add_u32 s58, s58, 163840
    buffer_load_dwordx4 v[156:159], v248, s[20:23], s58 offen sc1
    v_mfma_f32_16x16x32_bf16 v[8:11], v[48:51], v[92:95], v[8:11]
    v_mfma_f32_16x16x32_bf16 v[12:15], v[50:53], v[92:95], v[12:15]
    s_waitcnt vmcnt(15)
    s_mov_b32 s58, s55
    buffer_load_dwordx4 v[160:163], v248, s[20:23], s58 offen sc1
    v_mfma_f32_16x16x32_bf16 v[16:19], v[48:51], v[96:99], 0
    v_mfma_f32_16x16x32_bf16 v[20:23], v[50:53], v[96:99], 0
    s_waitcnt vmcnt(15)
    s_add_u32 s58, s58, 163840
    buffer_load_dwordx4 v[164:167], v248, s[20:23], s58 offen sc1
    v_mfma_f32_16x16x32_bf16 v[16:19], v[48:51], v[100:103], v[16:19]
    v_mfma_f32_16x16x32_bf16 v[20:23], v[50:53], v[100:103], v[20:23]
    s_waitcnt vmcnt(15)
    s_add_u32 s58, s58, 163840
    buffer_load_dwordx4 v[168:171], v248, s[20:23], s58 offen sc1
    v_mfma_f32_16x16x32_bf16 v[16:19], v[48:51], v[104:107], v[16:19]
    v_mfma_f32_16x16x32_bf16 v[20:23], v[50:53], v[104:107], v[20:23]
    s_waitcnt vmcnt(15)
    s_add_u32 s58, s58, 163840
    buffer_load_dwordx4 v[172:175], v248, s[20:23], s58 offen sc1
    v_mfma_f32_16x16x32_bf16 v[16:19], v[48:51], v[108:111], v[16:19]
    v_mfma_f32_16x16x32_bf16 v[20:23], v[50:53], v[108:111], v[20:23]
    s_waitcnt vmcnt(15)
    s_add_u32 s58, s58, 163840
    buffer_load_dwordx4 v[176:179], v248, s[20:23], s58 offen sc1
    v_mfma_f32_16x16x32_bf16 v[16:19], v[48:51], v[112:115], v[16:19]
    v_mfma_f32_16x16x32_bf16 v[20:23], v[50:53], v[112:115], v[20:23]
    s_waitcnt vmcnt(15)
    s_add_u32 s58, s58, 163840
    buffer_load_dwordx4 v[180:183], v248, s[20:23], s58 offen sc1
    v_mfma_f32_16x16x32_bf16 v[16:19], v[48:51], v[116:119], v[16:19]
    v_mfma_f32_16x16x32_bf16 v[20:23], v[50:53], v[116:119], v[20:23]
    s_waitcnt vmcnt(15)
    s_add_u32 s58, s58, 163840
    buffer_load_dwordx4 v[184:187], v248, s[20:23], s58 offen sc1
    v_mfma_f32_16x16x32_bf16 v[16:19], v[48:51], v[120:123], v[16:19]
    v_mfma_f32_16x16x32_bf16 v[20:23], v[50:53], v[120:123], v[20:23]
    s_waitcnt vmcnt(15)
    s_add_u32 s58, s58, 163840
    buffer_load_dwordx4 v[188:191], v248, s[20:23], s58 offen sc1
    v_mfma_f32_16x16x32_bf16 v[16:19], v[48:51], v[124:127], v[16:19]
    v_mfma_f32_16x16x32_bf16 v[20:23], v[50:53], v[124:127], v[20:23]
    s_waitcnt vmcnt(15)
    v_mfma_f32_16x16x32_bf16 v[24:27], v[48:51], v[128:131], 0
    v_mfma_f32_16x16x32_bf16 v[28:31], v[50:53], v[128:131], 0
    s_waitcnt vmcnt(14)
    v_mfma_f32_16x16x32_bf16 v[24:27], v[48:51], v[132:135], v[24:27]
    v_mfma_f32_16x16x32_bf16 v[28:31], v[50:53], v[132:135], v[28:31]
    s_waitcnt vmcnt(13)
    v_mfma_f32_16x16x32_bf16 v[24:27], v[48:51], v[136:139], v[24:27]
    v_mfma_f32_16x16x32_bf16 v[28:31], v[50:53], v[136:139], v[28:31]
    s_waitcnt vmcnt(12)
    v_mfma_f32_16x16x32_bf16 v[24:27], v[48:51], v[140:143], v[24:27]
    v_mfma_f32_16x16x32_bf16 v[28:31], v[50:53], v[140:143], v[28:31]
    s_waitcnt vmcnt(11)
    v_mfma_f32_16x16x32_bf16 v[24:27], v[48:51], v[144:147], v[24:27]
    v_mfma_f32_16x16x32_bf16 v[28:31], v[50:53], v[144:147], v[28:31]
    s_waitcnt vmcnt(10)
    v_mfma_f32_16x16x32_bf16 v[24:27], v[48:51], v[148:151], v[24:27]
    v_mfma_f32_16x16x32_bf16 v[28:31], v[50:53], v[148:151], v[28:31]
    s_waitcnt vmcnt(9)
    v_mfma_f32_16x16x32_bf16 v[24:27], v[48:51], v[152:155], v[24:27]
    v_mfma_f32_16x16x32_bf16 v[28:31], v[50:53], v[152:155], v[28:31]
    s_waitcnt vmcnt(8)
    v_mfma_f32_16x16x32_bf16 v[24:27], v[48:51], v[156:159], v[24:27]
    v_mfma_f32_16x16x32_bf16 v[28:31], v[50:53], v[156:159], v[28:31]
    s_waitcnt vmcnt(7)
    v_mfma_f32_16x16x32_bf16 v[32:35], v[48:51], v[160:163], 0
    v_mfma_f32_16x16x32_bf16 v[36:39], v[50:53], v[160:163], 0
    s_waitcnt vmcnt(6)
    v_mfma_f32_16x16x32_bf16 v[32:35], v[48:51], v[164:167], v[32:35]
    v_mfma_f32_16x16x32_bf16 v[36:39], v[50:53], v[164:167], v[36:39]
    s_waitcnt vmcnt(5)
    v_mfma_f32_16x16x32_bf16 v[32:35], v[48:51], v[168:171], v[32:35]
    v_mfma_f32_16x16x32_bf16 v[36:39], v[50:53], v[168:171], v[36:39]
    s_waitcnt vmcnt(4)
    v_mfma_f32_16x16x32_bf16 v[32:35], v[48:51], v[172:175], v[32:35]
    v_mfma_f32_16x16x32_bf16 v[36:39], v[50:53], v[172:175], v[36:39]
    s_waitcnt vmcnt(3)
    v_mfma_f32_16x16x32_bf16 v[32:35], v[48:51], v[176:179], v[32:35]
    v_mfma_f32_16x16x32_bf16 v[36:39], v[50:53], v[176:179], v[36:39]
    s_waitcnt vmcnt(2)
    v_mfma_f32_16x16x32_bf16 v[32:35], v[48:51], v[180:183], v[32:35]
    v_mfma_f32_16x16x32_bf16 v[36:39], v[50:53], v[180:183], v[36:39]
    s_waitcnt vmcnt(1)
    v_mfma_f32_16x16x32_bf16 v[32:35], v[48:51], v[184:187], v[32:35]
    v_mfma_f32_16x16x32_bf16 v[36:39], v[50:53], v[184:187], v[36:39]
    s_waitcnt vmcnt(0)
    v_mfma_f32_16x16x32_bf16 v[32:35], v[48:51], v[188:191], v[32:35]
    v_mfma_f32_16x16x32_bf16 v[36:39], v[50:53], v[188:191], v[36:39]
    v_cvt_pk_bf16_f32 v8, v8, v9
    v_cvt_pk_bf16_f32 v9, v10, v11
    v_cvt_pk_bf16_f32 v10, v12, v13
    v_cvt_pk_bf16_f32 v11, v14, v15
    s_add_u32 s59, s54, 0
    buffer_store_dwordx4 v[8:11], v4, s[8:11], s59 offen
    v_cvt_pk_bf16_f32 v16, v16, v17
    v_cvt_pk_bf16_f32 v17, v18, v19
    v_cvt_pk_bf16_f32 v18, v20, v21
    v_cvt_pk_bf16_f32 v19, v22, v23
    s_add_u32 s59, s54, 256
    buffer_store_dwordx4 v[16:19], v4, s[8:11], s59 offen
    v_cvt_pk_bf16_f32 v24, v24, v25
    v_cvt_pk_bf16_f32 v25, v26, v27
    v_cvt_pk_bf16_f32 v26, v28, v29
    v_cvt_pk_bf16_f32 v27, v30, v31
    s_add_u32 s59, s54, 512
    buffer_store_dwordx4 v[24:27], v4, s[8:11], s59 offen
    v_cvt_pk_bf16_f32 v32, v32, v33
    v_cvt_pk_bf16_f32 v33, v34, v35
    v_cvt_pk_bf16_f32 v34, v36, v37
    v_cvt_pk_bf16_f32 v35, v38, v39
    s_mov_b32 s59, s57
    buffer_store_dwordx4 v[32:35], v4, s[8:11], s59 offen
L_poll2:
    buffer_load_dword v5, v3, s[20:23], s46 offen sc1
    s_waitcnt vmcnt(0)
    v_cmp_ne_u32 vcc, 1, v5
    s_cbranch_vccz L_poll2d
    s_sleep 8
    s_branch L_poll2
L_poll2d:
    s_add_u32 s58, s53, 122880
    buffer_load_dwordx4 v[64:67], v248, s[20:23], s58 offen sc1
    s_add_u32 s58, s58, 163840
    buffer_load_dwordx4 v[68:71], v248, s[20:23], s58 offen sc1
    s_add_u32 s58, s58, 163840
    buffer_load_dwordx4 v[72:75], v248, s[20:23], s58 offen sc1
    s_add_u32 s58, s58, 163840
    buffer_load_dwordx4 v[76:79], v248, s[20:23], s58 offen sc1
    s_add_u32 s58, s58, 163840
    buffer_load_dwordx4 v[80:83], v248, s[20:23], s58 offen sc1
    s_add_u32 s58, s58, 163840
    buffer_load_dwordx4 v[84:87], v248, s[20:23], s58 offen sc1
    s_add_u32 s58, s58, 163840
    buffer_load_dwordx4 v[88:91], v248, s[20:23], s58 offen sc1
    s_add_u32 s58, s58, 163840
    buffer_load_dwordx4 v[92:95], v248, s[20:23], s58 offen sc1
    s_waitcnt vmcnt(7)
    v_mfma_f32_16x16x32_bf16 v[8:11], v[48:51], v[64:67], 0
    v_mfma_f32_16x16x32_bf16 v[12:15], v[50:53], v[64:67], 0
    s_waitcnt vmcnt(6)
    v_mfma_f32_16x16x32_bf16 v[8:11], v[48:51], v[68:71], v[8:11]
    v_mfma_f32_16x16x32_bf16 v[12:15], v[50:53], v[68:71], v[12:15]
    s_waitcnt vmcnt(5)
    v_mfma_f32_16x16x32_bf16 v[8:11], v[48:51], v[72:75], v[8:11]
    v_mfma_f32_16x16x32_bf16 v[12:15], v[50:53], v[72:75], v[12:15]
    s_waitcnt vmcnt(4)
    v_mfma_f32_16x16x32_bf16 v[8:11], v[48:51], v[76:79], v[8:11]
    v_mfma_f32_16x16x32_bf16 v[12:15], v[50:53], v[76:79], v[12:15]
    s_waitcnt vmcnt(3)
    v_mfma_f32_16x16x32_bf16 v[8:11], v[48:51], v[80:83], v[8:11]
    v_mfma_f32_16x16x32_bf16 v[12:15], v[50:53], v[80:83], v[12:15]
    s_waitcnt vmcnt(2)
    v_mfma_f32_16x16x32_bf16 v[8:11], v[48:51], v[84:87], v[8:11]
    v_mfma_f32_16x16x32_bf16 v[12:15], v[50:53], v[84:87], v[12:15]
    s_waitcnt vmcnt(1)
    v_mfma_f32_16x16x32_bf16 v[8:11], v[48:51], v[88:91], v[8:11]
    v_mfma_f32_16x16x32_bf16 v[12:15], v[50:53], v[88:91], v[12:15]
    s_waitcnt vmcnt(0)
    v_mfma_f32_16x16x32_bf16 v[8:11], v[48:51], v[92:95], v[8:11]
    v_mfma_f32_16x16x32_bf16 v[12:15], v[50:53], v[92:95], v[12:15]
    s_nop 6
    v_cvt_pk_bf16_f32 v8, v8, v9
    v_cvt_pk_bf16_f32 v9, v10, v11
    v_cvt_pk_bf16_f32 v10, v12, v13
    v_cvt_pk_bf16_f32 v11, v14, v15
    s_add_u32 s59, s54, 768
    buffer_store_dwordx4 v[8:11], v4, s[8:11], s59 offen
L_fin:
L_k1_end:
    s_endpgm
L_code_end:
L_A3_care:
    s_nop 5
    v_mov_b32 v0, 0
    v_mov_b32 v1, 0
    v_mov_b32 v2, 0
    v_mov_b32 v3, 0
    v_mov_b32 v4, 0
    v_mov_b32 v5, 0
    v_mov_b32 v6, 0
    v_mov_b32 v7, 0
    v_mov_b32 v8, 0
    v_mov_b32 v9, 0
    v_mov_b32 v10, 0
    v_mov_b32 v11, 0
    v_mov_b32 v12, 0
    v_mov_b32 v13, 0
    v_mov_b32 v14, 0
    v_mov_b32 v15, 0
    v_mov_b32 v16, 0
    v_mov_b32 v17, 0
    v_mov_b32 v18, 0
    v_mov_b32 v19, 0
    v_mov_b32 v20, 0
    v_mov_b32 v21, 0
    v_mov_b32 v22, 0
    v_mov_b32 v23, 0
    v_mov_b32 v24, 0
    v_mov_b32 v25, 0
    v_mov_b32 v26, 0
    v_mov_b32 v27, 0
    v_mov_b32 v28, 0
    v_mov_b32 v29, 0
    v_mov_b32 v30, 0
    v_mov_b32 v31, 0
    v_mov_b32 v32, 0
    v_mov_b32 v33, 0
    v_mov_b32 v34, 0
    v_mov_b32 v35, 0
    v_mov_b32 v36, 0
    v_mov_b32 v37, 0
    v_mov_b32 v38, 0
    v_mov_b32 v39, 0
    v_mov_b32 v40, 0
    v_mov_b32 v41, 0
    v_mov_b32 v42, 0
    v_mov_b32 v43, 0
    v_mov_b32 v44, 0
    v_mov_b32 v45, 0
    v_mov_b32 v46, 0
    v_mov_b32 v47, 0
    v_mov_b32 v48, 0
    v_mov_b32 v49, 0
    v_mov_b32 v50, 0
    v_mov_b32 v51, 0
    v_mov_b32 v52, 0
    v_mov_b32 v53, 0
    v_mov_b32 v54, 0
    v_mov_b32 v55, 0
    v_mov_b32 v56, 0
    v_mov_b32 v57, 0
    v_mov_b32 v58, 0
    v_mov_b32 v59, 0
    v_mov_b32 v60, 0
    v_mov_b32 v61, 0
    v_mov_b32 v62, 0
    v_mov_b32 v63, 0
    v_mov_b32 v64, 0
    v_mov_b32 v65, 0
    v_mov_b32 v66, 0
    v_mov_b32 v67, 0
    v_mov_b32 v68, 0
    v_mov_b32 v69, 0
    v_mov_b32 v70, 0
    v_mov_b32 v71, 0
    v_mov_b32 v72, 0
    v_mov_b32 v73, 0
    v_mov_b32 v74, 0
    v_mov_b32 v75, 0
    v_mov_b32 v76, 0
    v_mov_b32 v77, 0
    v_mov_b32 v78, 0
    v_mov_b32 v79, 0
    v_mov_b32 v80, 0
    v_mov_b32 v81, 0
    v_mov_b32 v82, 0
    v_mov_b32 v83, 0
    v_mov_b32 v84, 0
    v_mov_b32 v85, 0
    v_mov_b32 v86, 0
    v_mov_b32 v87, 0
    v_mov_b32 v88, 0
    v_mov_b32 v89, 0
    v_mov_b32 v90, 0
    v_mov_b32 v91, 0
    v_mov_b32 v92, 0
    v_mov_b32 v93, 0
    v_mov_b32 v94, 0
    v_mov_b32 v95, 0
    ds_read_b128 v[204:207], v236 offset:0
    ds_read_b128 v[208:211], v236 offset:64
    ds_read_b128 v[212:215], v236 offset:128
    ds_read_b128 v[216:219], v236 offset:192
    ds_read_b128 v[220:223], v236 offset:512
    ds_read_b128 v[224:227], v236 offset:576
    ds_read_b128 v[228:231], v236 offset:640
    ds_read_b128 v[232:235], v236 offset:704
    s_waitcnt lgkmcnt(7)
    v_mfma_f32_16x16x32_bf16 v[144:147], v[204:207], v[96:99], 0
    v_mfma_f32_16x16x32_bf16 v[148:151], v[204:207], v[112:115], 0
    v_mfma_f32_16x16x32_bf16 v[152:155], v[204:207], v[128:131], 0
    s_waitcnt lgkmcnt(6)
    v_mfma_f32_16x16x32_bf16 v[144:147], v[208:211], v[100:103], v[144:147]
    v_mfma_f32_16x16x32_bf16 v[148:151], v[208:211], v[116:119], v[148:151]
    v_mfma_f32_16x16x32_bf16 v[152:155], v[208:211], v[132:135], v[152:155]
    s_waitcnt lgkmcnt(5)
    v_mfma_f32_16x16x32_bf16 v[144:147], v[212:215], v[104:107], v[144:147]
    v_mfma_f32_16x16x32_bf16 v[148:151], v[212:215], v[120:123], v[148:151]
    v_mfma_f32_16x16x32_bf16 v[152:155], v[212:215], v[136:139], v[152:155]
    s_waitcnt lgkmcnt(4)
    v_mfma_f32_16x16x32_bf16 v[144:147], v[216:219], v[108:111], v[144:147]
    v_mfma_f32_16x16x32_bf16 v[148:151], v[216:219], v[124:127], v[148:151]
    v_mfma_f32_16x16x32_bf16 v[152:155], v[216:219], v[140:143], v[152:155]
    s_waitcnt lgkmcnt(3)
    v_mfma_f32_16x16x32_bf16 v[156:159], v[220:223], v[96:99], 0
    v_mfma_f32_16x16x32_bf16 v[160:163], v[220:223], v[112:115], 0
    v_mfma_f32_16x16x32_bf16 v[164:167], v[220:223], v[128:131], 0
    s_waitcnt lgkmcnt(2)
    v_mfma_f32_16x16x32_bf16 v[156:159], v[224:227], v[100:103], v[156:159]
    v_mfma_f32_16x16x32_bf16 v[160:163], v[224:227], v[116:119], v[160:163]
    v_mfma_f32_16x16x32_bf16 v[164:167], v[224:227], v[132:135], v[164:167]
    s_waitcnt lgkmcnt(1)
    v_mfma_f32_16x16x32_bf16 v[156:159], v[228:231], v[104:107], v[156:159]
    v_mfma_f32_16x16x32_bf16 v[160:163], v[228:231], v[120:123], v[160:163]
    v_mfma_f32_16x16x32_bf16 v[164:167], v[228:231], v[136:139], v[164:167]
    s_waitcnt lgkmcnt(0)
    v_mfma_f32_16x16x32_bf16 v[156:159], v[232:235], v[108:111], v[156:159]
    v_mfma_f32_16x16x32_bf16 v[160:163], v[232:235], v[124:127], v[160:163]
    v_mfma_f32_16x16x32_bf16 v[164:167], v[232:235], v[140:143], v[164:167]
    v_max3_f32 v169, v144, v145, v146
    s_nop 4
    v_max3_f32 v169, v169, v147, v156
    v_max3_f32 v169, v169, v157, v158
    v_max_f32 v169, v169, v159
    v_mov_b32 v170, v169
    s_nop 1
    v_permlane16_swap_b32 v169, v170
    v_max_f32 v169, v169, v170
    v_mov_b32 v170, v169
    s_nop 1
    v_permlane32_swap_b32 v169, v170
    v_max_f32 v169, v169, v170
    v_mov_b32 v240, 0
    v_mov_b32 v168, v169
    v_sub_f32 v144, v144, v168
    v_sub_f32 v145, v145, v168
    v_sub_f32 v146, v146, v168
    v_sub_f32 v147, v147, v168
    v_sub_f32 v156, v156, v168
    v_sub_f32 v157, v157, v168
    v_sub_f32 v158, v158, v168
    v_sub_f32 v159, v159, v168
    v_max3_f32 v173, v148, v149, v150
    v_max3_f32 v173, v173, v151, v160
    v_max3_f32 v173, v173, v161, v162
    v_max_f32 v173, v173, v163
    v_mov_b32 v174, v173
    s_nop 1
    v_permlane16_swap_b32 v173, v174
    v_max_f32 v173, v173, v174
    v_mov_b32 v174, v173
    s_nop 1
    v_permlane32_swap_b32 v173, v174
    v_max_f32 v173, v173, v174
    v_mov_b32 v241, 0
    v_mov_b32 v172, v173
    v_sub_f32 v148, v148, v172
    v_sub_f32 v149, v149, v172
    v_sub_f32 v150, v150, v172
    v_sub_f32 v151, v151, v172
    v_sub_f32 v160, v160, v172
    v_sub_f32 v161, v161, v172
    v_sub_f32 v162, v162, v172
    v_sub_f32 v163, v163, v172
    v_max3_f32 v177, v152, v153, v154
    v_max3_f32 v177, v177, v155, v164
    v_max3_f32 v177, v177, v165, v166
    v_max_f32 v177, v177, v167
    v_mov_b32 v178, v177
    s_nop 1
    v_permlane16_swap_b32 v177, v178
    v_max_f32 v177, v177, v178
    v_mov_b32 v178, v177
    s_nop 1
    v_permlane32_swap_b32 v177, v178
    v_max_f32 v177, v177, v178
    v_mov_b32 v242, 0
    v_mov_b32 v176, v177
    v_sub_f32 v152, v152, v176
    v_sub_f32 v153, v153, v176
    v_sub_f32 v154, v154, v176
    v_sub_f32 v155, v155, v176
    v_sub_f32 v164, v164, v176
    v_sub_f32 v165, v165, v176
    v_sub_f32 v166, v166, v176
    v_sub_f32 v167, v167, v176
    v_exp_f32 v144, v144
    v_exp_f32 v145, v145
    v_exp_f32 v146, v146
    v_exp_f32 v147, v147
    v_add_f32 v240, v240, v144
    v_exp_f32 v148, v148
    v_add_f32 v240, v240, v145
    v_exp_f32 v149, v149
    v_cvt_pk_bf16_f32 v180, v144, v145
    v_add_f32 v240, v240, v146
    v_exp_f32 v150, v150
    v_add_f32 v240, v240, v147
    v_exp_f32 v151, v151
    v_cvt_pk_bf16_f32 v181, v146, v147
    v_add_f32 v241, v241, v148
    v_exp_f32 v152, v152
    v_add_f32 v241, v241, v149
    v_exp_f32 v153, v153
    v_cvt_pk_bf16_f32 v184, v148, v149
    v_add_f32 v241, v241, v150
    v_exp_f32 v154, v154
    v_add_f32 v241, v241, v151
    v_exp_f32 v155, v155
    v_cvt_pk_bf16_f32 v185, v150, v151
    v_add_f32 v242, v242, v152
    v_add_f32 v242, v242, v153
    v_cvt_pk_bf16_f32 v188, v152, v153
    v_add_f32 v242, v242, v154
    v_add_f32 v242, v242, v155
    v_cvt_pk_bf16_f32 v189, v154, v155
    v_exp_f32 v156, v156
    v_exp_f32 v157, v157
    v_exp_f32 v158, v158
    v_exp_f32 v159, v159
    v_add_f32 v240, v240, v156
    v_exp_f32 v160, v160
    v_add_f32 v240, v240, v157
    v_exp_f32 v161, v161
    v_cvt_pk_bf16_f32 v182, v156, v157
    v_add_f32 v240, v240, v158
    v_exp_f32 v162, v162
    v_add_f32 v240, v240, v159
    v_exp_f32 v163, v163
    v_cvt_pk_bf16_f32 v183, v158, v159
    v_add_f32 v241, v241, v160
    v_exp_f32 v164, v164
    v_add_f32 v241, v241, v161
    v_exp_f32 v165, v165
    v_cvt_pk_bf16_f32 v186, v160, v161
    v_add_f32 v241, v241, v162
    v_exp_f32 v166, v166
    v_add_f32 v241, v241, v163
    v_exp_f32 v167, v167
    v_cvt_pk_bf16_f32 v187, v162, v163
    v_add_f32 v242, v242, v164
    v_add_f32 v242, v242, v165
    v_cvt_pk_bf16_f32 v190, v164, v165
    v_add_f32 v242, v242, v166
    v_add_f32 v242, v242, v167
    v_cvt_pk_bf16_f32 v191, v166, v167
    s_waitcnt lgkmcnt(0)
    s_barrier
L_A3_cu:
    s_mov_b32 s51, 0
L_A3_cl:
    s_and_b32 s36, s51, 3
    s_lshl_b32 s36, s36, 10
    s_add_u32 s51, s51, 1
    s_and_b32 s37, s51, 3
    s_lshl_b32 s37, s37, 10
    v_add_u32 v251, s36, v237
    v_add_u32 v250, s37, v236
    ds_read_b64_tr_b16 v[204:205], v251 offset:0
    ds_read_b64_tr_b16 v[206:207], v251 offset:512
    ds_read_b64_tr_b16 v[220:221], v251 offset:128
    ds_read_b64_tr_b16 v[222:223], v251 offset:640
    ds_read_b64_tr_b16 v[208:209], v251 offset:32
    ds_read_b64_tr_b16 v[210:211], v251 offset:544
    ds_read_b64_tr_b16 v[224:225], v251 offset:160
    ds_read_b64_tr_b16 v[226:227], v251 offset:672
    ds_read_b64_tr_b16 v[212:213], v251 offset:64
    ds_read_b64_tr_b16 v[214:215], v251 offset:576
    ds_read_b64_tr_b16 v[228:229], v251 offset:192
    ds_read_b64_tr_b16 v[230:231], v251 offset:704
    ds_read_b64_tr_b16 v[216:217], v251 offset:96
    ds_read_b64_tr_b16 v[218:219], v251 offset:608
    ds_read_b64_tr_b16 v[232:233], v251 offset:224
    ds_read_b64_tr_b16 v[234:235], v251 offset:736
    s_waitcnt lgkmcnt(14)
    v_mfma_f32_16x16x32_bf16 v[0:3], v[204:207], v[180:183], v[0:3]
    v_mfma_f32_16x16x32_bf16 v[32:35], v[204:207], v[184:187], v[32:35]
    v_mfma_f32_16x16x32_bf16 v[64:67], v[204:207], v[188:191], v[64:67]
    s_waitcnt lgkmcnt(10)
    v_mfma_f32_16x16x32_bf16 v[4:7], v[208:211], v[180:183], v[4:7]
    v_mfma_f32_16x16x32_bf16 v[36:39], v[208:211], v[184:187], v[36:39]
    v_mfma_f32_16x16x32_bf16 v[68:71], v[208:211], v[188:191], v[68:71]
    s_waitcnt lgkmcnt(6)
    v_mfma_f32_16x16x32_bf16 v[8:11], v[212:215], v[180:183], v[8:11]
    v_mfma_f32_16x16x32_bf16 v[40:43], v[212:215], v[184:187], v[40:43]
    v_mfma_f32_16x16x32_bf16 v[72:75], v[212:215], v[188:191], v[72:75]
    s_waitcnt lgkmcnt(2)
    v_mfma_f32_16x16x32_bf16 v[12:15], v[216:219], v[180:183], v[12:15]
    v_mfma_f32_16x16x32_bf16 v[44:47], v[216:219], v[184:187], v[44:47]
    v_mfma_f32_16x16x32_bf16 v[76:79], v[216:219], v[188:191], v[76:79]
    v_mfma_f32_16x16x32_bf16 v[16:19], v[220:223], v[180:183], v[16:19]
    v_mfma_f32_16x16x32_bf16 v[48:51], v[220:223], v[184:187], v[48:51]
    v_mfma_f32_16x16x32_bf16 v[80:83], v[220:223], v[188:191], v[80:83]
    v_mfma_f32_16x16x32_bf16 v[20:23], v[224:227], v[180:183], v[20:23]
    v_mfma_f32_16x16x32_bf16 v[52:55], v[224:227], v[184:187], v[52:55]
    v_mfma_f32_16x16x32_bf16 v[84:87], v[224:227], v[188:191], v[84:87]
    v_mfma_f32_16x16x32_bf16 v[24:27], v[228:231], v[180:183], v[24:27]
    v_mfma_f32_16x16x32_bf16 v[56:59], v[228:231], v[184:187], v[56:59]
    v_mfma_f32_16x16x32_bf16 v[88:91], v[228:231], v[188:191], v[88:91]
    s_waitcnt lgkmcnt(0)
    v_mfma_f32_16x16x32_bf16 v[28:31], v[232:235], v[180:183], v[28:31]
    v_mfma_f32_16x16x32_bf16 v[60:63], v[232:235], v[184:187], v[60:63]
    v_mfma_f32_16x16x32_bf16 v[92:95], v[232:235], v[188:191], v[92:95]
    ds_read_b128 v[204:207], v250 offset:0
    ds_read_b128 v[208:211], v250 offset:64
    ds_read_b128 v[212:215], v250 offset:128
    ds_read_b128 v[216:219], v250 offset:192
    ds_read_b128 v[220:223], v250 offset:512
    ds_read_b128 v[224:227], v250 offset:576
    ds_read_b128 v[228:231], v250 offset:640
    ds_read_b128 v[232:235], v250 offset:704
    s_waitcnt lgkmcnt(7)
    v_mfma_f32_16x16x32_bf16 v[144:147], v[204:207], v[96:99], 0
    v_mfma_f32_16x16x32_bf16 v[148:151], v[204:207], v[112:115], 0
    v_mfma_f32_16x16x32_bf16 v[152:155], v[204:207], v[128:131], 0
    s_waitcnt lgkmcnt(6)
    v_mfma_f32_16x16x32_bf16 v[144:147], v[208:211], v[100:103], v[144:147]
    v_mfma_f32_16x16x32_bf16 v[148:151], v[208:211], v[116:119], v[148:151]
    v_mfma_f32_16x16x32_bf16 v[152:155], v[208:211], v[132:135], v[152:155]
    s_waitcnt lgkmcnt(5)
    v_mfma_f32_16x16x32_bf16 v[144:147], v[212:215], v[104:107], v[144:147]
    v_mfma_f32_16x16x32_bf16 v[148:151], v[212:215], v[120:123], v[148:151]
    v_mfma_f32_16x16x32_bf16 v[152:155], v[212:215], v[136:139], v[152:155]
    s_waitcnt lgkmcnt(4)
    v_mfma_f32_16x16x32_bf16 v[144:147], v[216:219], v[108:111], v[144:147]
    v_mfma_f32_16x16x32_bf16 v[148:151], v[216:219], v[124:127], v[148:151]
    v_mfma_f32_16x16x32_bf16 v[152:155], v[216:219], v[140:143], v[152:155]
    s_waitcnt lgkmcnt(3)
    v_mfma_f32_16x16x32_bf16 v[156:159], v[220:223], v[96:99], 0
    v_mfma_f32_16x16x32_bf16 v[160:163], v[220:223], v[112:115], 0
    v_mfma_f32_16x16x32_bf16 v[164:167], v[220:223], v[128:131], 0
    s_waitcnt lgkmcnt(2)
    v_mfma_f32_16x16x32_bf16 v[156:159], v[224:227], v[100:103], v[156:159]
    v_mfma_f32_16x16x32_bf16 v[160:163], v[224:227], v[116:119], v[160:163]
    v_mfma_f32_16x16x32_bf16 v[164:167], v[224:227], v[132:135], v[164:167]
    s_waitcnt lgkmcnt(1)
    v_mfma_f32_16x16x32_bf16 v[156:159], v[228:231], v[104:107], v[156:159]
    v_mfma_f32_16x16x32_bf16 v[160:163], v[228:231], v[120:123], v[160:163]
    v_mfma_f32_16x16x32_bf16 v[164:167], v[228:231], v[136:139], v[164:167]
    s_waitcnt lgkmcnt(0)
    v_mfma_f32_16x16x32_bf16 v[156:159], v[232:235], v[108:111], v[156:159]
    v_mfma_f32_16x16x32_bf16 v[160:163], v[232:235], v[124:127], v[160:163]
    v_mfma_f32_16x16x32_bf16 v[164:167], v[232:235], v[140:143], v[164:167]
    v_max3_f32 v169, v144, v145, v146
    s_nop 4
    v_max3_f32 v169, v169, v147, v156
    v_max3_f32 v169, v169, v157, v158
    v_max_f32 v169, v169, v159
    v_mov_b32 v170, v169
    s_nop 1
    v_permlane16_swap_b32 v169, v170
    v_max_f32 v169, v169, v170
    v_mov_b32 v170, v169
    s_nop 1
    v_permlane32_swap_b32 v169, v170
    v_max_f32 v169, v169, v170
    v_max_f32 v169, v169, v168
    v_sub_f32 v171, v168, v169
    v_exp_f32 v171, v171
    s_nop 0
    v_mul_f32 v240, v240, v171
    v_mul_f32 v0, v0, v171
    v_mul_f32 v1, v1, v171
    v_mul_f32 v2, v2, v171
    v_mul_f32 v3, v3, v171
    v_mul_f32 v4, v4, v171
    v_mul_f32 v5, v5, v171
    v_mul_f32 v6, v6, v171
    v_mul_f32 v7, v7, v171
    v_mul_f32 v8, v8, v171
    v_mul_f32 v9, v9, v171
    v_mul_f32 v10, v10, v171
    v_mul_f32 v11, v11, v171
    v_mul_f32 v12, v12, v171
    v_mul_f32 v13, v13, v171
    v_mul_f32 v14, v14, v171
    v_mul_f32 v15, v15, v171
    v_mul_f32 v16, v16, v171
    v_mul_f32 v17, v17, v171
    v_mul_f32 v18, v18, v171
    v_mul_f32 v19, v19, v171
    v_mul_f32 v20, v20, v171
    v_mul_f32 v21, v21, v171
    v_mul_f32 v22, v22, v171
    v_mul_f32 v23, v23, v171
    v_mul_f32 v24, v24, v171
    v_mul_f32 v25, v25, v171
    v_mul_f32 v26, v26, v171
    v_mul_f32 v27, v27, v171
    v_mul_f32 v28, v28, v171
    v_mul_f32 v29, v29, v171
    v_mul_f32 v30, v30, v171
    v_mul_f32 v31, v31, v171
    v_mov_b32 v168, v169
    v_sub_f32 v144, v144, v168
    v_sub_f32 v145, v145, v168
    v_sub_f32 v146, v146, v168
    v_sub_f32 v147, v147, v168
    v_sub_f32 v156, v156, v168
    v_sub_f32 v157, v157, v168
    v_sub_f32 v158, v158, v168
    v_sub_f32 v159, v159, v168
    v_max3_f32 v173, v148, v149, v150
    v_max3_f32 v173, v173, v151, v160
    v_max3_f32 v173, v173, v161, v162
    v_max_f32 v173, v173, v163
    v_mov_b32 v174, v173
    s_nop 1
    v_permlane16_swap_b32 v173, v174
    v_max_f32 v173, v173, v174
    v_mov_b32 v174, v173
    s_nop 1
    v_permlane32_swap_b32 v173, v174
    v_max_f32 v173, v173, v174
    v_max_f32 v173, v173, v172
    v_sub_f32 v175, v172, v173
    v_exp_f32 v175, v175
    s_nop 0
    v_mul_f32 v241, v241, v175
    v_mul_f32 v32, v32, v175
    v_mul_f32 v33, v33, v175
    v_mul_f32 v34, v34, v175
    v_mul_f32 v35, v35, v175
    v_mul_f32 v36, v36, v175
    v_mul_f32 v37, v37, v175
    v_mul_f32 v38, v38, v175
    v_mul_f32 v39, v39, v175
    v_mul_f32 v40, v40, v175
    v_mul_f32 v41, v41, v175
    v_mul_f32 v42, v42, v175
    v_mul_f32 v43, v43, v175
    v_mul_f32 v44, v44, v175
    v_mul_f32 v45, v45, v175
    v_mul_f32 v46, v46, v175
    v_mul_f32 v47, v47, v175
    v_mul_f32 v48, v48, v175
    v_mul_f32 v49, v49, v175
    v_mul_f32 v50, v50, v175
    v_mul_f32 v51, v51, v175
    v_mul_f32 v52, v52, v175
    v_mul_f32 v53, v53, v175
    v_mul_f32 v54, v54, v175
    v_mul_f32 v55, v55, v175
    v_mul_f32 v56, v56, v175
    v_mul_f32 v57, v57, v175
    v_mul_f32 v58, v58, v175
    v_mul_f32 v59, v59, v175
    v_mul_f32 v60, v60, v175
    v_mul_f32 v61, v61, v175
    v_mul_f32 v62, v62, v175
    v_mul_f32 v63, v63, v175
    v_mov_b32 v172, v173
    v_sub_f32 v148, v148, v172
    v_sub_f32 v149, v149, v172
    v_sub_f32 v150, v150, v172
    v_sub_f32 v151, v151, v172
    v_sub_f32 v160, v160, v172
    v_sub_f32 v161, v161, v172
    v_sub_f32 v162, v162, v172
    v_sub_f32 v163, v163, v172
    v_max3_f32 v177, v152, v153, v154
    v_max3_f32 v177, v177, v155, v164
    v_max3_f32 v177, v177, v165, v166
    v_max_f32 v177, v177, v167
    v_mov_b32 v178, v177
    s_nop 1
    v_permlane16_swap_b32 v177, v178
    v_max_f32 v177, v177, v178
    v_mov_b32 v178, v177
    s_nop 1
    v_permlane32_swap_b32 v177, v178
    v_max_f32 v177, v177, v178
    v_max_f32 v177, v177, v176
    v_sub_f32 v179, v176, v177
    v_exp_f32 v179, v179
    s_nop 0
    v_mul_f32 v242, v242, v179
    v_mul_f32 v64, v64, v179
    v_mul_f32 v65, v65, v179
    v_mul_f32 v66, v66, v179
    v_mul_f32 v67, v67, v179
    v_mul_f32 v68, v68, v179
    v_mul_f32 v69, v69, v179
    v_mul_f32 v70, v70, v179
    v_mul_f32 v71, v71, v179
    v_mul_f32 v72, v72, v179
    v_mul_f32 v73, v73, v179
    v_mul_f32 v74, v74, v179
    v_mul_f32 v75, v75, v179
    v_mul_f32 v76, v76, v179
    v_mul_f32 v77, v77, v179
    v_mul_f32 v78, v78, v179
    v_mul_f32 v79, v79, v179
    v_mul_f32 v80, v80, v179
    v_mul_f32 v81, v81, v179
    v_mul_f32 v82, v82, v179
    v_mul_f32 v83, v83, v179
    v_mul_f32 v84, v84, v179
    v_mul_f32 v85, v85, v179
    v_mul_f32 v86, v86, v179
    v_mul_f32 v87, v87, v179
    v_mul_f32 v88, v88, v179
    v_mul_f32 v89, v89, v179
    v_mul_f32 v90, v90, v179
    v_mul_f32 v91, v91, v179
    v_mul_f32 v92, v92, v179
    v_mul_f32 v93, v93, v179
    v_mul_f32 v94, v94, v179
    v_mul_f32 v95, v95, v179
    v_mov_b32 v176, v177
    v_sub_f32 v152, v152, v176
    v_sub_f32 v153, v153, v176
    v_sub_f32 v154, v154, v176
    v_sub_f32 v155, v155, v176
    v_sub_f32 v164, v164, v176
    v_sub_f32 v165, v165, v176
    v_sub_f32 v166, v166, v176
    v_sub_f32 v167, v167, v176
    v_exp_f32 v144, v144
    v_exp_f32 v145, v145
    v_exp_f32 v146, v146
    v_exp_f32 v147, v147
    v_add_f32 v240, v240, v144
    v_exp_f32 v148, v148
    v_add_f32 v240, v240, v145
    v_exp_f32 v149, v149
    v_cvt_pk_bf16_f32 v180, v144, v145
    v_add_f32 v240, v240, v146
    v_exp_f32 v150, v150
    v_add_f32 v240, v240, v147
    v_exp_f32 v151, v151
    v_cvt_pk_bf16_f32 v181, v146, v147
    v_add_f32 v241, v241, v148
    v_exp_f32 v152, v152
    v_add_f32 v241, v241, v149
    v_exp_f32 v153, v153
    v_cvt_pk_bf16_f32 v184, v148, v149
    v_add_f32 v241, v241, v150
    v_exp_f32 v154, v154
    v_add_f32 v241, v241, v151
    v_exp_f32 v155, v155
    v_cvt_pk_bf16_f32 v185, v150, v151
    v_add_f32 v242, v242, v152
    v_add_f32 v242, v242, v153
    v_cvt_pk_bf16_f32 v188, v152, v153
    v_add_f32 v242, v242, v154
    v_add_f32 v242, v242, v155
    v_cvt_pk_bf16_f32 v189, v154, v155
    v_exp_f32 v156, v156
    v_exp_f32 v157, v157
    v_exp_f32 v158, v158
    v_exp_f32 v159, v159
    v_add_f32 v240, v240, v156
    v_exp_f32 v160, v160
    v_add_f32 v240, v240, v157
    v_exp_f32 v161, v161
    v_cvt_pk_bf16_f32 v182, v156, v157
    v_add_f32 v240, v240, v158
    v_exp_f32 v162, v162
    v_add_f32 v240, v240, v159
    v_exp_f32 v163, v163
    v_cvt_pk_bf16_f32 v183, v158, v159
    v_add_f32 v241, v241, v160
    v_exp_f32 v164, v164
    v_add_f32 v241, v241, v161
    v_exp_f32 v165, v165
    v_cvt_pk_bf16_f32 v186, v160, v161
    v_add_f32 v241, v241, v162
    v_exp_f32 v166, v166
    v_add_f32 v241, v241, v163
    v_exp_f32 v167, v167
    v_cvt_pk_bf16_f32 v187, v162, v163
    v_add_f32 v242, v242, v164
    v_add_f32 v242, v242, v165
    v_cvt_pk_bf16_f32 v190, v164, v165
    v_add_f32 v242, v242, v166
    v_add_f32 v242, v242, v167
    v_cvt_pk_bf16_f32 v191, v166, v167
    s_waitcnt lgkmcnt(0)
    s_barrier
    s_cmp_lt_u32 s51, 15
    s_cbranch_scc1 L_A3_cl
    s_cmp_eq_u32 s50, 3
    s_cbranch_scc1 L_A3_clast
    s_add_u32 s50, s50, 1
    v_add_u32 v251, 0xc00, v237
    s_nop 4
    ds_read_b64_tr_b16 v[204:205], v251 offset:0
    ds_read_b64_tr_b16 v[206:207], v251 offset:512
    ds_read_b64_tr_b16 v[220:221], v251 offset:128
    ds_read_b64_tr_b16 v[222:223], v251 offset:640
    ds_read_b64_tr_b16 v[208:209], v251 offset:32
    ds_read_b64_tr_b16 v[210:211], v251 offset:544
    ds_read_b64_tr_b16 v[224:225], v251 offset:160
    ds_read_b64_tr_b16 v[226:227], v251 offset:672
    ds_read_b64_tr_b16 v[212:213], v251 offset:64
    ds_read_b64_tr_b16 v[214:215], v251 offset:576
    ds_read_b64_tr_b16 v[228:229], v251 offset:192
    ds_read_b64_tr_b16 v[230:231], v251 offset:704
    ds_read_b64_tr_b16 v[216:217], v251 offset:96
    ds_read_b64_tr_b16 v[218:219], v251 offset:608
    ds_read_b64_tr_b16 v[232:233], v251 offset:224
    ds_read_b64_tr_b16 v[234:235], v251 offset:736
    s_waitcnt lgkmcnt(14)
    v_mfma_f32_16x16x32_bf16 v[0:3], v[204:207], v[180:183], v[0:3]
    v_mfma_f32_16x16x32_bf16 v[32:35], v[204:207], v[184:187], v[32:35]
    v_mfma_f32_16x16x32_bf16 v[64:67], v[204:207], v[188:191], v[64:67]
    s_waitcnt lgkmcnt(10)
    v_mfma_f32_16x16x32_bf16 v[4:7], v[208:211], v[180:183], v[4:7]
    v_mfma_f32_16x16x32_bf16 v[36:39], v[208:211], v[184:187], v[36:39]
    v_mfma_f32_16x16x32_bf16 v[68:71], v[208:211], v[188:191], v[68:71]
    s_waitcnt lgkmcnt(6)
    v_mfma_f32_16x16x32_bf16 v[8:11], v[212:215], v[180:183], v[8:11]
    v_mfma_f32_16x16x32_bf16 v[40:43], v[212:215], v[184:187], v[40:43]
    v_mfma_f32_16x16x32_bf16 v[72:75], v[212:215], v[188:191], v[72:75]
    s_waitcnt lgkmcnt(2)
    v_mfma_f32_16x16x32_bf16 v[12:15], v[216:219], v[180:183], v[12:15]
    v_mfma_f32_16x16x32_bf16 v[44:47], v[216:219], v[184:187], v[44:47]
    v_mfma_f32_16x16x32_bf16 v[76:79], v[216:219], v[188:191], v[76:79]
    v_mfma_f32_16x16x32_bf16 v[16:19], v[220:223], v[180:183], v[16:19]
    v_mfma_f32_16x16x32_bf16 v[48:51], v[220:223], v[184:187], v[48:51]
    v_mfma_f32_16x16x32_bf16 v[80:83], v[220:223], v[188:191], v[80:83]
    v_mfma_f32_16x16x32_bf16 v[20:23], v[224:227], v[180:183], v[20:23]
    v_mfma_f32_16x16x32_bf16 v[52:55], v[224:227], v[184:187], v[52:55]
    v_mfma_f32_16x16x32_bf16 v[84:87], v[224:227], v[188:191], v[84:87]
    v_mfma_f32_16x16x32_bf16 v[24:27], v[228:231], v[180:183], v[24:27]
    v_mfma_f32_16x16x32_bf16 v[56:59], v[228:231], v[184:187], v[56:59]
    v_mfma_f32_16x16x32_bf16 v[88:91], v[228:231], v[188:191], v[88:91]
    s_waitcnt lgkmcnt(0)
    v_mfma_f32_16x16x32_bf16 v[28:31], v[232:235], v[180:183], v[28:31]
    v_mfma_f32_16x16x32_bf16 v[60:63], v[232:235], v[184:187], v[60:63]
    v_mfma_f32_16x16x32_bf16 v[92:95], v[232:235], v[188:191], v[92:95]
    v_mov_b32 v243, v240
    v_mov_b32 v244, v241
    v_mov_b32 v245, v242
    v_mov_b32 v246, v243
    v_mov_b32 v247, v244
    v_mov_b32 v248, v245
    v_permlane16_swap_b32 v243, v246
    v_permlane16_swap_b32 v244, v247
    v_permlane16_swap_b32 v245, v248
    v_add_f32 v243, v243, v246
    v_add_f32 v244, v244, v247
    v_add_f32 v245, v245, v248
    v_mov_b32 v246, v243
    v_mov_b32 v247, v244
    v_mov_b32 v248, v245
    v_permlane32_swap_b32 v243, v246
    v_permlane32_swap_b32 v244, v247
    v_permlane32_swap_b32 v245, v248
    v_add_f32 v243, v243, v246
    v_add_f32 v244, v244, v247
    v_add_f32 v245, v245, v248
    v_cmp_ngt_f32 vcc, s56, v243
    s_or_b64 s[48:49], s[48:49], vcc
    v_rcp_f32 v243, v243
    v_cmp_ngt_f32 vcc, s56, v244
    s_or_b64 s[48:49], s[48:49], vcc
    v_rcp_f32 v244, v244
    v_cmp_ngt_f32 vcc, s56, v245
    s_or_b64 s[48:49], s[48:49], vcc
    v_rcp_f32 v245, v245
    s_waitcnt lgkmcnt(0)
    s_barrier
    s_nop 5
    ds_read_b128 v[96:99], v239 offset:0
    ds_read_b128 v[100:103], v239 offset:1024
    ds_read_b128 v[104:107], v239 offset:2048
    ds_read_b128 v[108:111], v239 offset:3072
    ds_read_b128 v[112:115], v239 offset:4096
    ds_read_b128 v[116:119], v239 offset:5120
    ds_read_b128 v[120:123], v239 offset:6144
    ds_read_b128 v[124:127], v239 offset:7168
    ds_read_b128 v[128:131], v239 offset:8192
    ds_read_b128 v[132:135], v239 offset:9216
    ds_read_b128 v[136:139], v239 offset:10240
    ds_read_b128 v[140:143], v239 offset:11264
    s_waitcnt lgkmcnt(0)
    v_mul_f32 v0, v0, v243
    v_mul_f32 v1, v1, v243
    v_mul_f32 v2, v2, v243
    v_mul_f32 v3, v3, v243
    v_mul_f32 v4, v4, v243
    v_mul_f32 v5, v5, v243
    v_mul_f32 v6, v6, v243
    v_mul_f32 v7, v7, v243
    v_cvt_pk_bf16_f32 v0, v0, v1
    v_cvt_pk_bf16_f32 v1, v2, v3
    v_cvt_pk_bf16_f32 v2, v4, v5
    v_cvt_pk_bf16_f32 v3, v6, v7
    ds_write_b128 v239, v[0:3] offset:0
    v_mul_f32 v32, v32, v244
    v_mul_f32 v33, v33, v244
    v_mul_f32 v34, v34, v244
    v_mul_f32 v35, v35, v244
    v_mul_f32 v36, v36, v244
    v_mul_f32 v37, v37, v244
    v_mul_f32 v38, v38, v244
    v_mul_f32 v39, v39, v244
    v_cvt_pk_bf16_f32 v32, v32, v33
    v_cvt_pk_bf16_f32 v33, v34, v35
    v_cvt_pk_bf16_f32 v34, v36, v37
    v_cvt_pk_bf16_f32 v35, v38, v39
    ds_write_b128 v239, v[32:35] offset:4096
    v_mul_f32 v64, v64, v245
    v_mul_f32 v65, v65, v245
    v_mul_f32 v66, v66, v245
    v_mul_f32 v67, v67, v245
    v_mul_f32 v68, v68, v245
    v_mul_f32 v69, v69, v245
    v_mul_f32 v70, v70, v245
    v_mul_f32 v71, v71, v245
    v_cvt_pk_bf16_f32 v64, v64, v65
    v_cvt_pk_bf16_f32 v65, v66, v67
    v_cvt_pk_bf16_f32 v66, v68, v69
    v_cvt_pk_bf16_f32 v67, v70, v71
    ds_write_b128 v239, v[64:67] offset:8192
    v_mul_f32 v8, v8, v243
    v_mul_f32 v9, v9, v243
    v_mul_f32 v10, v10, v243
    v_mul_f32 v11, v11, v243
    v_mul_f32 v12, v12, v243
    v_mul_f32 v13, v13, v243
    v_mul_f32 v14, v14, v243
    v_mul_f32 v15, v15, v243
    v_cvt_pk_bf16_f32 v8, v8, v9
    v_cvt_pk_bf16_f32 v9, v10, v11
    v_cvt_pk_bf16_f32 v10, v12, v13
    v_cvt_pk_bf16_f32 v11, v14, v15
    ds_write_b128 v239, v[8:11] offset:1024
    v_mul_f32 v40, v40, v244
    v_mul_f32 v41, v41, v244
    v_mul_f32 v42, v42, v244
    v_mul_f32 v43, v43, v244
    v_mul_f32 v44, v44, v244
    v_mul_f32 v45, v45, v244
    v_mul_f32 v46, v46, v244
    v_mul_f32 v47, v47, v244
    v_cvt_pk_bf16_f32 v40, v40, v41
    v_cvt_pk_bf16_f32 v41, v42, v43
    v_cvt_pk_bf16_f32 v42, v44, v45
    v_cvt_pk_bf16_f32 v43, v46, v47
    ds_write_b128 v239, v[40:43] offset:5120
    v_mul_f32 v72, v72, v245
    v_mul_f32 v73, v73, v245
    v_mul_f32 v74, v74, v245
    v_mul_f32 v75, v75, v245
    v_mul_f32 v76, v76, v245
    v_mul_f32 v77, v77, v245
    v_mul_f32 v78, v78, v245
    v_mul_f32 v79, v79, v245
    v_cvt_pk_bf16_f32 v72, v72, v73
    v_cvt_pk_bf16_f32 v73, v74, v75
    v_cvt_pk_bf16_f32 v74, v76, v77
    v_cvt_pk_bf16_f32 v75, v78, v79
    ds_write_b128 v239, v[72:75] offset:9216
    v_mul_f32 v16, v16, v243
    v_mul_f32 v17, v17, v243
    v_mul_f32 v18, v18, v243
    v_mul_f32 v19, v19, v243
    v_mul_f32 v20, v20, v243
    v_mul_f32 v21, v21, v243
    v_mul_f32 v22, v22, v243
    v_mul_f32 v23, v23, v243
    v_cvt_pk_bf16_f32 v16, v16, v17
    v_cvt_pk_bf16_f32 v17, v18, v19
    v_cvt_pk_bf16_f32 v18, v20, v21
    v_cvt_pk_bf16_f32 v19, v22, v23
    ds_write_b128 v239, v[16:19] offset:2048
    v_mul_f32 v48, v48, v244
    v_mul_f32 v49, v49, v244
    v_mul_f32 v50, v50, v244
    v_mul_f32 v51, v51, v244
    v_mul_f32 v52, v52, v244
    v_mul_f32 v53, v53, v244
    v_mul_f32 v54, v54, v244
    v_mul_f32 v55, v55, v244
    v_cvt_pk_bf16_f32 v48, v48, v49
    v_cvt_pk_bf16_f32 v49, v50, v51
    v_cvt_pk_bf16_f32 v50, v52, v53
    v_cvt_pk_bf16_f32 v51, v54, v55
    ds_write_b128 v239, v[48:51] offset:6144
    v_mul_f32 v80, v80, v245
    v_mul_f32 v81, v81, v245
    v_mul_f32 v82, v82, v245
    v_mul_f32 v83, v83, v245
    v_mul_f32 v84, v84, v245
    v_mul_f32 v85, v85, v245
    v_mul_f32 v86, v86, v245
    v_mul_f32 v87, v87, v245
    v_cvt_pk_bf16_f32 v80, v80, v81
    v_cvt_pk_bf16_f32 v81, v82, v83
    v_cvt_pk_bf16_f32 v82, v84, v85
    v_cvt_pk_bf16_f32 v83, v86, v87
    ds_write_b128 v239, v[80:83] offset:10240
    v_mul_f32 v24, v24, v243
    v_mul_f32 v25, v25, v243
    v_mul_f32 v26, v26, v243
    v_mul_f32 v27, v27, v243
    v_mul_f32 v28, v28, v243
    v_mul_f32 v29, v29, v243
    v_mul_f32 v30, v30, v243
    v_mul_f32 v31, v31, v243
    v_cvt_pk_bf16_f32 v24, v24, v25
    v_cvt_pk_bf16_f32 v25, v26, v27
    v_cvt_pk_bf16_f32 v26, v28, v29
    v_cvt_pk_bf16_f32 v27, v30, v31
    ds_write_b128 v239, v[24:27] offset:3072
    v_mul_f32 v56, v56, v244
    v_mul_f32 v57, v57, v244
    v_mul_f32 v58, v58, v244
    v_mul_f32 v59, v59, v244
    v_mul_f32 v60, v60, v244
    v_mul_f32 v61, v61, v244
    v_mul_f32 v62, v62, v244
    v_mul_f32 v63, v63, v244
    v_cvt_pk_bf16_f32 v56, v56, v57
    v_cvt_pk_bf16_f32 v57, v58, v59
    v_cvt_pk_bf16_f32 v58, v60, v61
    v_cvt_pk_bf16_f32 v59, v62, v63
    ds_write_b128 v239, v[56:59] offset:7168
    v_mul_f32 v88, v88, v245
    v_mul_f32 v89, v89, v245
    v_mul_f32 v90, v90, v245
    v_mul_f32 v91, v91, v245
    v_mul_f32 v92, v92, v245
    v_mul_f32 v93, v93, v245
    v_mul_f32 v94, v94, v245
    v_mul_f32 v95, v95, v245
    v_cvt_pk_bf16_f32 v88, v88, v89
    v_cvt_pk_bf16_f32 v89, v90, v91
    v_cvt_pk_bf16_f32 v90, v92, v93
    v_cvt_pk_bf16_f32 v91, v94, v95
    ds_write_b128 v239, v[88:91] offset:11264
    s_waitcnt lgkmcnt(0)
    v_mov_b32 v0, 0
    v_mov_b32 v1, 0
    v_mov_b32 v2, 0
    v_mov_b32 v3, 0
    v_mov_b32 v4, 0
    v_mov_b32 v5, 0
    v_mov_b32 v6, 0
    v_mov_b32 v7, 0
    v_mov_b32 v8, 0
    v_mov_b32 v9, 0
    v_mov_b32 v10, 0
    v_mov_b32 v11, 0
    v_mov_b32 v12, 0
    v_mov_b32 v13, 0
    v_mov_b32 v14, 0
    v_mov_b32 v15, 0
    v_mov_b32 v16, 0
    v_mov_b32 v17, 0
    v_mov_b32 v18, 0
    v_mov_b32 v19, 0
    v_mov_b32 v20, 0
    v_mov_b32 v21, 0
    v_mov_b32 v22, 0
    v_mov_b32 v23, 0
    v_mov_b32 v24, 0
    v_mov_b32 v25, 0
    v_mov_b32 v26, 0
    v_mov_b32 v27, 0
    v_mov_b32 v28, 0
    v_mov_b32 v29, 0
    v_mov_b32 v30, 0
    v_mov_b32 v31, 0
    v_mov_b32 v32, 0
    v_mov_b32 v33, 0
    v_mov_b32 v34, 0
    v_mov_b32 v35, 0
    v_mov_b32 v36, 0
    v_mov_b32 v37, 0
    v_mov_b32 v38, 0
    v_mov_b32 v39, 0
    v_mov_b32 v40, 0
    v_mov_b32 v41, 0
    v_mov_b32 v42, 0
    v_mov_b32 v43, 0
    v_mov_b32 v44, 0
    v_mov_b32 v45, 0
    v_mov_b32 v46, 0
    v_mov_b32 v47, 0
    v_mov_b32 v48, 0
    v_mov_b32 v49, 0
    v_mov_b32 v50, 0
    v_mov_b32 v51, 0
    v_mov_b32 v52, 0
    v_mov_b32 v53, 0
    v_mov_b32 v54, 0
    v_mov_b32 v55, 0
    v_mov_b32 v56, 0
    v_mov_b32 v57, 0
    v_mov_b32 v58, 0
    v_mov_b32 v59, 0
    v_mov_b32 v60, 0
    v_mov_b32 v61, 0
    v_mov_b32 v62, 0
    v_mov_b32 v63, 0
    v_mov_b32 v64, 0
    v_mov_b32 v65, 0
    v_mov_b32 v66, 0
    v_mov_b32 v67, 0
    v_mov_b32 v68, 0
    v_mov_b32 v69, 0
    v_mov_b32 v70, 0
    v_mov_b32 v71, 0
    v_mov_b32 v72, 0
    v_mov_b32 v73, 0
    v_mov_b32 v74, 0
    v_mov_b32 v75, 0
    v_mov_b32 v76, 0
    v_mov_b32 v77, 0
    v_mov_b32 v78, 0
    v_mov_b32 v79, 0
    v_mov_b32 v80, 0
    v_mov_b32 v81, 0
    v_mov_b32 v82, 0
    v_mov_b32 v83, 0
    v_mov_b32 v84, 0
    v_mov_b32 v85, 0
    v_mov_b32 v86, 0
    v_mov_b32 v87, 0
    v_mov_b32 v88, 0
    v_mov_b32 v89, 0
    v_mov_b32 v90, 0
    v_mov_b32 v91, 0
    v_mov_b32 v92, 0
    v_mov_b32 v93, 0
    v_mov_b32 v94, 0
    v_mov_b32 v95, 0
    ds_read_b128 v[204:207], v236 offset:0
    ds_read_b128 v[208:211], v236 offset:64
    ds_read_b128 v[212:215], v236 offset:128
    ds_read_b128 v[216:219], v236 offset:192
    ds_read_b128 v[220:223], v236 offset:512
    ds_read_b128 v[224:227], v236 offset:576
    ds_read_b128 v[228:231], v236 offset:640
    ds_read_b128 v[232:235], v236 offset:704
    s_waitcnt lgkmcnt(7)
    v_mfma_f32_16x16x32_bf16 v[144:147], v[204:207], v[96:99], 0
    v_mfma_f32_16x16x32_bf16 v[148:151], v[204:207], v[112:115], 0
    v_mfma_f32_16x16x32_bf16 v[152:155], v[204:207], v[128:131], 0
    s_waitcnt lgkmcnt(6)
    v_mfma_f32_16x16x32_bf16 v[144:147], v[208:211], v[100:103], v[144:147]
    v_mfma_f32_16x16x32_bf16 v[148:151], v[208:211], v[116:119], v[148:151]
    v_mfma_f32_16x16x32_bf16 v[152:155], v[208:211], v[132:135], v[152:155]
    s_waitcnt lgkmcnt(5)
    v_mfma_f32_16x16x32_bf16 v[144:147], v[212:215], v[104:107], v[144:147]
    v_mfma_f32_16x16x32_bf16 v[148:151], v[212:215], v[120:123], v[148:151]
    v_mfma_f32_16x16x32_bf16 v[152:155], v[212:215], v[136:139], v[152:155]
    s_waitcnt lgkmcnt(4)
    v_mfma_f32_16x16x32_bf16 v[144:147], v[216:219], v[108:111], v[144:147]
    v_mfma_f32_16x16x32_bf16 v[148:151], v[216:219], v[124:127], v[148:151]
    v_mfma_f32_16x16x32_bf16 v[152:155], v[216:219], v[140:143], v[152:155]
    s_waitcnt lgkmcnt(3)
    v_mfma_f32_16x16x32_bf16 v[156:159], v[220:223], v[96:99], 0
    v_mfma_f32_16x16x32_bf16 v[160:163], v[220:223], v[112:115], 0
    v_mfma_f32_16x16x32_bf16 v[164:167], v[220:223], v[128:131], 0
    s_waitcnt lgkmcnt(2)
    v_mfma_f32_16x16x32_bf16 v[156:159], v[224:227], v[100:103], v[156:159]
    v_mfma_f32_16x16x32_bf16 v[160:163], v[224:227], v[116:119], v[160:163]
    v_mfma_f32_16x16x32_bf16 v[164:167], v[224:227], v[132:135], v[164:167]
    s_waitcnt lgkmcnt(1)
    v_mfma_f32_16x16x32_bf16 v[156:159], v[228:231], v[104:107], v[156:159]
    v_mfma_f32_16x16x32_bf16 v[160:163], v[228:231], v[120:123], v[160:163]
    v_mfma_f32_16x16x32_bf16 v[164:167], v[228:231], v[136:139], v[164:167]
    s_waitcnt lgkmcnt(0)
    v_mfma_f32_16x16x32_bf16 v[156:159], v[232:235], v[108:111], v[156:159]
    v_mfma_f32_16x16x32_bf16 v[160:163], v[232:235], v[124:127], v[160:163]
    v_mfma_f32_16x16x32_bf16 v[164:167], v[232:235], v[140:143], v[164:167]
    v_max3_f32 v169, v144, v145, v146
    s_nop 4
    v_max3_f32 v169, v169, v147, v156
    v_max3_f32 v169, v169, v157, v158
    v_max_f32 v169, v169, v159
    v_mov_b32 v170, v169
    s_nop 1
    v_permlane16_swap_b32 v169, v170
    v_max_f32 v169, v169, v170
    v_mov_b32 v170, v169
    s_nop 1
    v_permlane32_swap_b32 v169, v170
    v_max_f32 v169, v169, v170
    v_mov_b32 v240, 0
    v_mov_b32 v168, v169
    v_sub_f32 v144, v144, v168
    v_sub_f32 v145, v145, v168
    v_sub_f32 v146, v146, v168
    v_sub_f32 v147, v147, v168
    v_sub_f32 v156, v156, v168
    v_sub_f32 v157, v157, v168
    v_sub_f32 v158, v158, v168
    v_sub_f32 v159, v159, v168
    v_max3_f32 v173, v148, v149, v150
    v_max3_f32 v173, v173, v151, v160
    v_max3_f32 v173, v173, v161, v162
    v_max_f32 v173, v173, v163
    v_mov_b32 v174, v173
    s_nop 1
    v_permlane16_swap_b32 v173, v174
    v_max_f32 v173, v173, v174
    v_mov_b32 v174, v173
    s_nop 1
    v_permlane32_swap_b32 v173, v174
    v_max_f32 v173, v173, v174
    v_mov_b32 v241, 0
    v_mov_b32 v172, v173
    v_sub_f32 v148, v148, v172
    v_sub_f32 v149, v149, v172
    v_sub_f32 v150, v150, v172
    v_sub_f32 v151, v151, v172
    v_sub_f32 v160, v160, v172
    v_sub_f32 v161, v161, v172
    v_sub_f32 v162, v162, v172
    v_sub_f32 v163, v163, v172
    v_max3_f32 v177, v152, v153, v154
    v_max3_f32 v177, v177, v155, v164
    v_max3_f32 v177, v177, v165, v166
    v_max_f32 v177, v177, v167
    v_mov_b32 v178, v177
    s_nop 1
    v_permlane16_swap_b32 v177, v178
    v_max_f32 v177, v177, v178
    v_mov_b32 v178, v177
    s_nop 1
    v_permlane32_swap_b32 v177, v178
    v_max_f32 v177, v177, v178
    v_mov_b32 v242, 0
    v_mov_b32 v176, v177
    v_sub_f32 v152, v152, v176
    v_sub_f32 v153, v153, v176
    v_sub_f32 v154, v154, v176
    v_sub_f32 v155, v155, v176
    v_sub_f32 v164, v164, v176
    v_sub_f32 v165, v165, v176
    v_sub_f32 v166, v166, v176
    v_sub_f32 v167, v167, v176
    v_exp_f32 v144, v144
    v_exp_f32 v145, v145
    v_exp_f32 v146, v146
    v_exp_f32 v147, v147
    v_add_f32 v240, v240, v144
    v_exp_f32 v148, v148
    v_add_f32 v240, v240, v145
    v_exp_f32 v149, v149
    v_cvt_pk_bf16_f32 v180, v144, v145
    v_add_f32 v240, v240, v146
    v_exp_f32 v150, v150
    v_add_f32 v240, v240, v147
    v_exp_f32 v151, v151
    v_cvt_pk_bf16_f32 v181, v146, v147
    v_add_f32 v241, v241, v148
    v_exp_f32 v152, v152
    v_add_f32 v241, v241, v149
    v_exp_f32 v153, v153
    v_cvt_pk_bf16_f32 v184, v148, v149
    v_add_f32 v241, v241, v150
    v_exp_f32 v154, v154
    v_add_f32 v241, v241, v151
    v_exp_f32 v155, v155
    v_cvt_pk_bf16_f32 v185, v150, v151
    v_add_f32 v242, v242, v152
    v_add_f32 v242, v242, v153
    v_cvt_pk_bf16_f32 v188, v152, v153
    v_add_f32 v242, v242, v154
    v_add_f32 v242, v242, v155
    v_cvt_pk_bf16_f32 v189, v154, v155
    v_exp_f32 v156, v156
    v_exp_f32 v157, v157
    v_exp_f32 v158, v158
    v_exp_f32 v159, v159
    v_add_f32 v240, v240, v156
    v_exp_f32 v160, v160
    v_add_f32 v240, v240, v157
    v_exp_f32 v161, v161
    v_cvt_pk_bf16_f32 v182, v156, v157
    v_add_f32 v240, v240, v158
    v_exp_f32 v162, v162
    v_add_f32 v240, v240, v159
    v_exp_f32 v163, v163
    v_cvt_pk_bf16_f32 v183, v158, v159
    v_add_f32 v241, v241, v160
    v_exp_f32 v164, v164
    v_add_f32 v241, v241, v161
    v_exp_f32 v165, v165
    v_cvt_pk_bf16_f32 v186, v160, v161
    v_add_f32 v241, v241, v162
    v_exp_f32 v166, v166
    v_add_f32 v241, v241, v163
    v_exp_f32 v167, v167
    v_cvt_pk_bf16_f32 v187, v162, v163
    v_add_f32 v242, v242, v164
    v_add_f32 v242, v242, v165
    v_cvt_pk_bf16_f32 v190, v164, v165
    v_add_f32 v242, v242, v166
    v_add_f32 v242, v242, v167
    v_cvt_pk_bf16_f32 v191, v166, v167
    s_waitcnt lgkmcnt(0)
    s_barrier
    s_branch L_A3_cu
L_A3_clast:
    v_add_u32 v251, 0xc00, v237
    s_nop 4
    ds_read_b64_tr_b16 v[204:205], v251 offset:0
    ds_read_b64_tr_b16 v[206:207], v251 offset:512
    ds_read_b64_tr_b16 v[220:221], v251 offset:128
    ds_read_b64_tr_b16 v[222:223], v251 offset:640
    ds_read_b64_tr_b16 v[208:209], v251 offset:32
    ds_read_b64_tr_b16 v[210:211], v251 offset:544
    ds_read_b64_tr_b16 v[224:225], v251 offset:160
    ds_read_b64_tr_b16 v[226:227], v251 offset:672
    ds_read_b64_tr_b16 v[212:213], v251 offset:64
    ds_read_b64_tr_b16 v[214:215], v251 offset:576
    ds_read_b64_tr_b16 v[228:229], v251 offset:192
    ds_read_b64_tr_b16 v[230:231], v251 offset:704
    ds_read_b64_tr_b16 v[216:217], v251 offset:96
    ds_read_b64_tr_b16 v[218:219], v251 offset:608
    ds_read_b64_tr_b16 v[232:233], v251 offset:224
    ds_read_b64_tr_b16 v[234:235], v251 offset:736
    s_waitcnt lgkmcnt(14)
    v_mfma_f32_16x16x32_bf16 v[0:3], v[204:207], v[180:183], v[0:3]
    v_mfma_f32_16x16x32_bf16 v[32:35], v[204:207], v[184:187], v[32:35]
    v_mfma_f32_16x16x32_bf16 v[64:67], v[204:207], v[188:191], v[64:67]
    s_waitcnt lgkmcnt(10)
    v_mfma_f32_16x16x32_bf16 v[4:7], v[208:211], v[180:183], v[4:7]
    v_mfma_f32_16x16x32_bf16 v[36:39], v[208:211], v[184:187], v[36:39]
    v_mfma_f32_16x16x32_bf16 v[68:71], v[208:211], v[188:191], v[68:71]
    s_waitcnt lgkmcnt(6)
    v_mfma_f32_16x16x32_bf16 v[8:11], v[212:215], v[180:183], v[8:11]
    v_mfma_f32_16x16x32_bf16 v[40:43], v[212:215], v[184:187], v[40:43]
    v_mfma_f32_16x16x32_bf16 v[72:75], v[212:215], v[188:191], v[72:75]
    s_waitcnt lgkmcnt(2)
    v_mfma_f32_16x16x32_bf16 v[12:15], v[216:219], v[180:183], v[12:15]
    v_mfma_f32_16x16x32_bf16 v[44:47], v[216:219], v[184:187], v[44:47]
    v_mfma_f32_16x16x32_bf16 v[76:79], v[216:219], v[188:191], v[76:79]
    v_mfma_f32_16x16x32_bf16 v[16:19], v[220:223], v[180:183], v[16:19]
    v_mfma_f32_16x16x32_bf16 v[48:51], v[220:223], v[184:187], v[48:51]
    v_mfma_f32_16x16x32_bf16 v[80:83], v[220:223], v[188:191], v[80:83]
    v_mfma_f32_16x16x32_bf16 v[20:23], v[224:227], v[180:183], v[20:23]
    v_mfma_f32_16x16x32_bf16 v[52:55], v[224:227], v[184:187], v[52:55]
    v_mfma_f32_16x16x32_bf16 v[84:87], v[224:227], v[188:191], v[84:87]
    v_mfma_f32_16x16x32_bf16 v[24:27], v[228:231], v[180:183], v[24:27]
    v_mfma_f32_16x16x32_bf16 v[56:59], v[228:231], v[184:187], v[56:59]
    v_mfma_f32_16x16x32_bf16 v[88:91], v[228:231], v[188:191], v[88:91]
    s_waitcnt lgkmcnt(0)
    v_mfma_f32_16x16x32_bf16 v[28:31], v[232:235], v[180:183], v[28:31]
    v_mfma_f32_16x16x32_bf16 v[60:63], v[232:235], v[184:187], v[60:63]
    v_mfma_f32_16x16x32_bf16 v[92:95], v[232:235], v[188:191], v[92:95]
    v_mov_b32 v243, v240
    v_mov_b32 v244, v241
    v_mov_b32 v245, v242
    v_mov_b32 v246, v243
    v_mov_b32 v247, v244
    v_mov_b32 v248, v245
    v_permlane16_swap_b32 v243, v246
    v_permlane16_swap_b32 v244, v247
    v_permlane16_swap_b32 v245, v248
    v_add_f32 v243, v243, v246
    v_add_f32 v244, v244, v247
    v_add_f32 v245, v245, v248
    v_mov_b32 v246, v243
    v_mov_b32 v247, v244
    v_mov_b32 v248, v245
    v_permlane32_swap_b32 v243, v246
    v_permlane32_swap_b32 v244, v247
    v_permlane32_swap_b32 v245, v248
    v_add_f32 v243, v243, v246
    v_add_f32 v244, v244, v247
    v_add_f32 v245, v245, v248
    v_cmp_ngt_f32 vcc, s56, v243
    s_or_b64 s[48:49], s[48:49], vcc
    v_rcp_f32 v243, v243
    v_cmp_ngt_f32 vcc, s56, v244
    s_or_b64 s[48:49], s[48:49], vcc
    v_rcp_f32 v244, v244
    v_cmp_ngt_f32 vcc, s56, v245
    s_or_b64 s[48:49], s[48:49], vcc
    v_rcp_f32 v245, v245
    s_waitcnt vmcnt(0) lgkmcnt(0)
    s_barrier
    s_barrier
    v_mul_f32 v0, v0, v243
    v_mul_f32 v1, v1, v243
    v_mul_f32 v2, v2, v243
    v_mul_f32 v3, v3, v243
    v_mul_f32 v4, v4, v243
    v_mul_f32 v5, v5, v243
    v_mul_f32 v6, v6, v243
    v_mul_f32 v7, v7, v243
    v_cvt_pk_bf16_f32 v0, v0, v1
    v_cvt_pk_bf16_f32 v1, v2, v3
    v_cvt_pk_bf16_f32 v2, v4, v5
    v_cvt_pk_bf16_f32 v3, v6, v7
    ds_write_b128 v238, v[0:3] offset:1024
    v_mul_f32 v32, v32, v244
    v_mul_f32 v33, v33, v244
    v_mul_f32 v34, v34, v244
    v_mul_f32 v35, v35, v244
    v_mul_f32 v36, v36, v244
    v_mul_f32 v37, v37, v244
    v_mul_f32 v38, v38, v244
    v_mul_f32 v39, v39, v244
    v_cvt_pk_bf16_f32 v32, v32, v33
    v_cvt_pk_bf16_f32 v33, v34, v35
    v_cvt_pk_bf16_f32 v34, v36, v37
    v_cvt_pk_bf16_f32 v35, v38, v39
    ds_write_b128 v238, v[32:35] offset:9216
    v_mul_f32 v64, v64, v245
    v_mul_f32 v65, v65, v245
    v_mul_f32 v66, v66, v245
    v_mul_f32 v67, v67, v245
    v_mul_f32 v68, v68, v245
    v_mul_f32 v69, v69, v245
    v_mul_f32 v70, v70, v245
    v_mul_f32 v71, v71, v245
    v_cvt_pk_bf16_f32 v64, v64, v65
    v_cvt_pk_bf16_f32 v65, v66, v67
    v_cvt_pk_bf16_f32 v66, v68, v69
    v_cvt_pk_bf16_f32 v67, v70, v71
    ds_write_b128 v238, v[64:67] offset:17408
    v_mul_f32 v8, v8, v243
    v_mul_f32 v9, v9, v243
    v_mul_f32 v10, v10, v243
    v_mul_f32 v11, v11, v243
    v_mul_f32 v12, v12, v243
    v_mul_f32 v13, v13, v243
    v_mul_f32 v14, v14, v243
    v_mul_f32 v15, v15, v243
    v_cvt_pk_bf16_f32 v8, v8, v9
    v_cvt_pk_bf16_f32 v9, v10, v11
    v_cvt_pk_bf16_f32 v10, v12, v13
    v_cvt_pk_bf16_f32 v11, v14, v15
    ds_write_b128 v238, v[8:11] offset:2048
    v_mul_f32 v40, v40, v244
    v_mul_f32 v41, v41, v244
    v_mul_f32 v42, v42, v244
    v_mul_f32 v43, v43, v244
    v_mul_f32 v44, v44, v244
    v_mul_f32 v45, v45, v244
    v_mul_f32 v46, v46, v244
    v_mul_f32 v47, v47, v244
    v_cvt_pk_bf16_f32 v40, v40, v41
    v_cvt_pk_bf16_f32 v41, v42, v43
    v_cvt_pk_bf16_f32 v42, v44, v45
    v_cvt_pk_bf16_f32 v43, v46, v47
    ds_write_b128 v238, v[40:43] offset:10240
    v_mul_f32 v72, v72, v245
    v_mul_f32 v73, v73, v245
    v_mul_f32 v74, v74, v245
    v_mul_f32 v75, v75, v245
    v_mul_f32 v76, v76, v245
    v_mul_f32 v77, v77, v245
    v_mul_f32 v78, v78, v245
    v_mul_f32 v79, v79, v245
    v_cvt_pk_bf16_f32 v72, v72, v73
    v_cvt_pk_bf16_f32 v73, v74, v75
    v_cvt_pk_bf16_f32 v74, v76, v77
    v_cvt_pk_bf16_f32 v75, v78, v79
    ds_write_b128 v238, v[72:75] offset:18432
    v_mul_f32 v16, v16, v243
    v_mul_f32 v17, v17, v243
    v_mul_f32 v18, v18, v243
    v_mul_f32 v19, v19, v243
    v_mul_f32 v20, v20, v243
    v_mul_f32 v21, v21, v243
    v_mul_f32 v22, v22, v243
    v_mul_f32 v23, v23, v243
    v_cvt_pk_bf16_f32 v16, v16, v17
    v_cvt_pk_bf16_f32 v17, v18, v19
    v_cvt_pk_bf16_f32 v18, v20, v21
    v_cvt_pk_bf16_f32 v19, v22, v23
    ds_write_b128 v238, v[16:19] offset:0
    v_mul_f32 v48, v48, v244
    v_mul_f32 v49, v49, v244
    v_mul_f32 v50, v50, v244
    v_mul_f32 v51, v51, v244
    v_mul_f32 v52, v52, v244
    v_mul_f32 v53, v53, v244
    v_mul_f32 v54, v54, v244
    v_mul_f32 v55, v55, v244
    v_cvt_pk_bf16_f32 v48, v48, v49
    v_cvt_pk_bf16_f32 v49, v50, v51
    v_cvt_pk_bf16_f32 v50, v52, v53
    v_cvt_pk_bf16_f32 v51, v54, v55
    ds_write_b128 v238, v[48:51] offset:8192
    v_mul_f32 v80, v80, v245
    v_mul_f32 v81, v81, v245
    v_mul_f32 v82, v82, v245
    v_mul_f32 v83, v83, v245
    v_mul_f32 v84, v84, v245
    v_mul_f32 v85, v85, v245
    v_mul_f32 v86, v86, v245
    v_mul_f32 v87, v87, v245
    v_cvt_pk_bf16_f32 v80, v80, v81
    v_cvt_pk_bf16_f32 v81, v82, v83
    v_cvt_pk_bf16_f32 v82, v84, v85
    v_cvt_pk_bf16_f32 v83, v86, v87
    ds_write_b128 v238, v[80:83] offset:16384
    v_mul_f32 v24, v24, v243
    v_mul_f32 v25, v25, v243
    v_mul_f32 v26, v26, v243
    v_mul_f32 v27, v27, v243
    v_mul_f32 v28, v28, v243
    v_mul_f32 v29, v29, v243
    v_mul_f32 v30, v30, v243
    v_mul_f32 v31, v31, v243
    v_cvt_pk_bf16_f32 v24, v24, v25
    v_cvt_pk_bf16_f32 v25, v26, v27
    v_cvt_pk_bf16_f32 v26, v28, v29
    v_cvt_pk_bf16_f32 v27, v30, v31
    ds_write_b128 v238, v[24:27] offset:7168
    v_mul_f32 v56, v56, v244
    v_mul_f32 v57, v57, v244
    v_mul_f32 v58, v58, v244
    v_mul_f32 v59, v59, v244
    v_mul_f32 v60, v60, v244
    v_mul_f32 v61, v61, v244
    v_mul_f32 v62, v62, v244
    v_mul_f32 v63, v63, v244
    v_cvt_pk_bf16_f32 v56, v56, v57
    v_cvt_pk_bf16_f32 v57, v58, v59
    v_cvt_pk_bf16_f32 v58, v60, v61
    v_cvt_pk_bf16_f32 v59, v62, v63
    ds_write_b128 v238, v[56:59] offset:15360
    v_mul_f32 v88, v88, v245
    v_mul_f32 v89, v89, v245
    v_mul_f32 v90, v90, v245
    v_mul_f32 v91, v91, v245
    v_mul_f32 v92, v92, v245
    v_mul_f32 v93, v93, v245
    v_mul_f32 v94, v94, v245
    v_mul_f32 v95, v95, v245
    v_cvt_pk_bf16_f32 v88, v88, v89
    v_cvt_pk_bf16_f32 v89, v90, v91
    v_cvt_pk_bf16_f32 v90, v92, v93
    v_cvt_pk_bf16_f32 v91, v94, v95
    ds_write_b128 v238, v[88:91] offset:23552
    s_waitcnt lgkmcnt(0)
    s_barrier
    s_branch L_tail
L_A2_care:
    s_nop 5
    v_mov_b32 v0, 0
    v_mov_b32 v1, 0
    v_mov_b32 v2, 0
    v_mov_b32 v3, 0
    v_mov_b32 v4, 0
    v_mov_b32 v5, 0
    v_mov_b32 v6, 0
    v_mov_b32 v7, 0
    v_mov_b32 v8, 0
    v_mov_b32 v9, 0
    v_mov_b32 v10, 0
    v_mov_b32 v11, 0
    v_mov_b32 v12, 0
    v_mov_b32 v13, 0
    v_mov_b32 v14, 0
    v_mov_b32 v15, 0
    v_mov_b32 v16, 0
    v_mov_b32 v17, 0
    v_mov_b32 v18, 0
    v_mov_b32 v19, 0
    v_mov_b32 v20, 0
    v_mov_b32 v21, 0
    v_mov_b32 v22, 0
    v_mov_b32 v23, 0
    v_mov_b32 v24, 0
    v_mov_b32 v25, 0
    v_mov_b32 v26, 0
    v_mov_b32 v27, 0
    v_mov_b32 v28, 0
    v_mov_b32 v29, 0
    v_mov_b32 v30, 0
    v_mov_b32 v31, 0
    v_mov_b32 v32, 0
    v_mov_b32 v33, 0
    v_mov_b32 v34, 0
    v_mov_b32 v35, 0
    v_mov_b32 v36, 0
    v_mov_b32 v37, 0
    v_mov_b32 v38, 0
    v_mov_b32 v39, 0
    v_mov_b32 v40, 0
    v_mov_b32 v41, 0
    v_mov_b32 v42, 0
    v_mov_b32 v43, 0
    v_mov_b32 v44, 0
    v_mov_b32 v45, 0
    v_mov_b32 v46, 0
    v_mov_b32 v47, 0
    v_mov_b32 v48, 0
    v_mov_b32 v49, 0
    v_mov_b32 v50, 0
    v_mov_b32 v51, 0
    v_mov_b32 v52, 0
    v_mov_b32 v53, 0
    v_mov_b32 v54, 0
    v_mov_b32 v55, 0
    v_mov_b32 v56, 0
    v_mov_b32 v57, 0
    v_mov_b32 v58, 0
    v_mov_b32 v59, 0
    v_mov_b32 v60, 0
    v_mov_b32 v61, 0
    v_mov_b32 v62, 0
    v_mov_b32 v63, 0
    ds_read_b128 v[204:207], v236 offset:0
    ds_read_b128 v[208:211], v236 offset:64
    ds_read_b128 v[212:215], v236 offset:128
    ds_read_b128 v[216:219], v236 offset:192
    ds_read_b128 v[220:223], v236 offset:512
    ds_read_b128 v[224:227], v236 offset:576
    ds_read_b128 v[228:231], v236 offset:640
    ds_read_b128 v[232:235], v236 offset:704
    s_waitcnt lgkmcnt(7)
    v_mfma_f32_16x16x32_bf16 v[144:147], v[204:207], v[96:99], 0
    v_mfma_f32_16x16x32_bf16 v[148:151], v[204:207], v[112:115], 0
    s_waitcnt lgkmcnt(6)
    v_mfma_f32_16x16x32_bf16 v[144:147], v[208:211], v[100:103], v[144:147]
    v_mfma_f32_16x16x32_bf16 v[148:151], v[208:211], v[116:119], v[148:151]
    s_waitcnt lgkmcnt(5)
    v_mfma_f32_16x16x32_bf16 v[144:147], v[212:215], v[104:107], v[144:147]
    v_mfma_f32_16x16x32_bf16 v[148:151], v[212:215], v[120:123], v[148:151]
    s_waitcnt lgkmcnt(4)
    v_mfma_f32_16x16x32_bf16 v[144:147], v[216:219], v[108:111], v[144:147]
    v_mfma_f32_16x16x32_bf16 v[148:151], v[216:219], v[124:127], v[148:151]
    s_waitcnt lgkmcnt(3)
    v_mfma_f32_16x16x32_bf16 v[156:159], v[220:223], v[96:99], 0
    v_mfma_f32_16x16x32_bf16 v[160:163], v[220:223], v[112:115], 0
    s_waitcnt lgkmcnt(2)
    v_mfma_f32_16x16x32_bf16 v[156:159], v[224:227], v[100:103], v[156:159]
    v_mfma_f32_16x16x32_bf16 v[160:163], v[224:227], v[116:119], v[160:163]
    s_waitcnt lgkmcnt(1)
    v_mfma_f32_16x16x32_bf16 v[156:159], v[228:231], v[104:107], v[156:159]
    v_mfma_f32_16x16x32_bf16 v[160:163], v[228:231], v[120:123], v[160:163]
    s_waitcnt lgkmcnt(0)
    v_mfma_f32_16x16x32_bf16 v[156:159], v[232:235], v[108:111], v[156:159]
    v_mfma_f32_16x16x32_bf16 v[160:163], v[232:235], v[124:127], v[160:163]
    v_max3_f32 v169, v144, v145, v146
    s_nop 5
    v_max3_f32 v169, v169, v147, v156
    v_max3_f32 v169, v169, v157, v158
    v_max_f32 v169, v169, v159
    v_mov_b32 v170, v169
    s_nop 1
    v_permlane16_swap_b32 v169, v170
    v_max_f32 v169, v169, v170
    v_mov_b32 v170, v169
    s_nop 1
    v_permlane32_swap_b32 v169, v170
    v_max_f32 v169, v169, v170
    v_mov_b32 v240, 0
    v_mov_b32 v168, v169
    v_sub_f32 v144, v144, v168
    v_sub_f32 v145, v145, v168
    v_sub_f32 v146, v146, v168
    v_sub_f32 v147, v147, v168
    v_sub_f32 v156, v156, v168
    v_sub_f32 v157, v157, v168
    v_sub_f32 v158, v158, v168
    v_sub_f32 v159, v159, v168
    v_max3_f32 v173, v148, v149, v150
    v_max3_f32 v173, v173, v151, v160
    v_max3_f32 v173, v173, v161, v162
    v_max_f32 v173, v173, v163
    v_mov_b32 v174, v173
    s_nop 1
    v_permlane16_swap_b32 v173, v174
    v_max_f32 v173, v173, v174
    v_mov_b32 v174, v173
    s_nop 1
    v_permlane32_swap_b32 v173, v174
    v_max_f32 v173, v173, v174
    v_mov_b32 v241, 0
    v_mov_b32 v172, v173
    v_sub_f32 v148, v148, v172
    v_sub_f32 v149, v149, v172
    v_sub_f32 v150, v150, v172
    v_sub_f32 v151, v151, v172
    v_sub_f32 v160, v160, v172
    v_sub_f32 v161, v161, v172
    v_sub_f32 v162, v162, v172
    v_sub_f32 v163, v163, v172
    v_exp_f32 v144, v144
    v_exp_f32 v145, v145
    v_exp_f32 v146, v146
    v_exp_f32 v147, v147
    v_add_f32 v240, v240, v144
    v_exp_f32 v148, v148
    v_add_f32 v240, v240, v145
    v_exp_f32 v149, v149
    v_cvt_pk_bf16_f32 v180, v144, v145
    v_add_f32 v240, v240, v146
    v_exp_f32 v150, v150
    v_add_f32 v240, v240, v147
    v_exp_f32 v151, v151
    v_cvt_pk_bf16_f32 v181, v146, v147
    v_add_f32 v241, v241, v148
    v_add_f32 v241, v241, v149
    v_cvt_pk_bf16_f32 v184, v148, v149
    v_add_f32 v241, v241, v150
    v_add_f32 v241, v241, v151
    v_cvt_pk_bf16_f32 v185, v150, v151
    v_exp_f32 v156, v156
    v_exp_f32 v157, v157
    v_exp_f32 v158, v158
    v_exp_f32 v159, v159
    v_add_f32 v240, v240, v156
    v_exp_f32 v160, v160
    v_add_f32 v240, v240, v157
    v_exp_f32 v161, v161
    v_cvt_pk_bf16_f32 v182, v156, v157
    v_add_f32 v240, v240, v158
    v_exp_f32 v162, v162
    v_add_f32 v240, v240, v159
    v_exp_f32 v163, v163
    v_cvt_pk_bf16_f32 v183, v158, v159
    v_add_f32 v241, v241, v160
    v_add_f32 v241, v241, v161
    v_cvt_pk_bf16_f32 v186, v160, v161
    v_add_f32 v241, v241, v162
    v_add_f32 v241, v241, v163
    v_cvt_pk_bf16_f32 v187, v162, v163
    s_waitcnt lgkmcnt(0)
    s_barrier
L_A2_cu:
    s_mov_b32 s51, 0
L_A2_cl:
    s_cmp_lg_u32 s51, 1
    s_cbranch_scc1 L_A2_cs
    s_cmp_lg_u32 s50, 1
    s_cbranch_scc1 L_A2c_pk0
    ds_read_b128 v[64:67], v239 offset:0
    ds_read_b128 v[68:71], v239 offset:1024
    ds_read_b128 v[72:75], v239 offset:2048
    ds_read_b128 v[76:79], v239 offset:3072
    ds_read_b128 v[80:83], v239 offset:4096
    ds_read_b128 v[84:87], v239 offset:5120
    ds_read_b128 v[88:91], v239 offset:6144
    ds_read_b128 v[92:95], v239 offset:7168
L_A2c_pk0:
    s_cmp_lg_u32 s50, 2
    s_cbranch_scc1 L_A2c_pk1
    ds_read_b128 v[128:131], v239 offset:0
    ds_read_b128 v[132:135], v239 offset:1024
    ds_read_b128 v[136:139], v239 offset:2048
    ds_read_b128 v[140:143], v239 offset:3072
    ds_read_b128 v[152:155], v239 offset:4096
    ds_read_b128 v[164:167], v239 offset:5120
    ds_read_b128 v[176:179], v239 offset:6144
    ds_read_b128 v[188:191], v239 offset:7168
L_A2c_pk1:
    s_cmp_lg_u32 s50, 3
    s_cbranch_scc1 L_A2c_pk2
    v_subrev_u32 v248, 40960, v239
    ds_write_b128 v248, v[128:131] offset:0
    ds_write_b128 v248, v[132:135] offset:1024
    ds_write_b128 v248, v[136:139] offset:2048
    ds_write_b128 v248, v[140:143] offset:3072
    ds_write_b128 v248, v[152:155] offset:4096
    ds_write_b128 v248, v[164:167] offset:5120
    ds_write_b128 v248, v[176:179] offset:6144
    ds_write_b128 v248, v[188:191] offset:7168
L_A2c_pk2:
L_A2_cs:
    s_and_b32 s36, s51, 3
    s_lshl_b32 s36, s36, 10
    s_add_u32 s51, s51, 1
    s_and_b32 s37, s51, 3
    s_lshl_b32 s37, s37, 10
    v_add_u32 v251, s36, v237
    v_add_u32 v250, s37, v236
    s_add_u32 m0, s71, 14400
    s_nop 0
    buffer_load_dwordx4 v249, s[8:11], s61 offen offset:2048 nt lds
    s_add_u32 m0, s71, 21600
    s_nop 0
    buffer_load_dwordx4 v249, s[8:11], s61 offen offset:3072 nt lds
    s_add_u32 m0, s71, 32896
    s_nop 0
    buffer_load_dwordx4 v249, s[8:11], s62 offen nt lds
    s_add_u32 m0, s71, 40096
    s_nop 0
    buffer_load_dwordx4 v249, s[8:11], s62 offen offset:1024 nt lds
    s_add_u32 m0, s71, 47296
    s_nop 0
    buffer_load_dwordx4 v249, s[8:11], s62 offen offset:2048 nt lds
    s_add_u32 m0, s71, 54496
    s_nop 0
    buffer_load_dwordx4 v249, s[8:11], s62 offen offset:3072 nt lds
    s_lshr_b32 s61, s60, 4
    s_add_u32 s61, s61, s32
    s_and_b32 s61, s61, 3
    s_lshl_b32 s61, s61, 17
    s_add_u32 s62, s60, s47
    s_and_b32 s62, s62, 15
    s_lshl_b32 s62, s62, 13
    s_add_u32 s61, s61, s62
    s_add_u32 s61, s61, s58
    s_and_b32 s62, s60, 3
    s_lshl_b32 s62, s62, 10
    s_add_u32 s71, s62, s59
    s_cmp_ge_i32 s60, 64
    s_cselect_b32 s61, 0x4000000, s61
    s_cselect_b32 s71, 0x30000, s71
    s_add_u32 s62, s61, 4096
    s_add_u32 s60, s60, 1
    ds_read_b64_tr_b16 v[204:205], v251 offset:0
    ds_read_b64_tr_b16 v[206:207], v251 offset:512
    ds_read_b64_tr_b16 v[220:221], v251 offset:128
    ds_read_b64_tr_b16 v[222:223], v251 offset:640
    ds_read_b64_tr_b16 v[208:209], v251 offset:32
    ds_read_b64_tr_b16 v[210:211], v251 offset:544
    ds_read_b64_tr_b16 v[224:225], v251 offset:160
    ds_read_b64_tr_b16 v[226:227], v251 offset:672
    ds_read_b64_tr_b16 v[212:213], v251 offset:64
    ds_read_b64_tr_b16 v[214:215], v251 offset:576
    ds_read_b64_tr_b16 v[228:229], v251 offset:192
    ds_read_b64_tr_b16 v[230:231], v251 offset:704
    ds_read_b64_tr_b16 v[216:217], v251 offset:96
    ds_read_b64_tr_b16 v[218:219], v251 offset:608
    ds_read_b64_tr_b16 v[232:233], v251 offset:224
    ds_read_b64_tr_b16 v[234:235], v251 offset:736
    s_waitcnt lgkmcnt(14)
    v_mfma_f32_16x16x32_bf16 v[0:3], v[204:207], v[180:183], v[0:3]
    v_mfma_f32_16x16x32_bf16 v[32:35], v[204:207], v[184:187], v[32:35]
    s_waitcnt lgkmcnt(10)
    v_mfma_f32_16x16x32_bf16 v[4:7], v[208:211], v[180:183], v[4:7]
    v_mfma_f32_16x16x32_bf16 v[36:39], v[208:211], v[184:187], v[36:39]
    s_waitcnt lgkmcnt(6)
    v_mfma_f32_16x16x32_bf16 v[8:11], v[212:215], v[180:183], v[8:11]
    v_mfma_f32_16x16x32_bf16 v[40:43], v[212:215], v[184:187], v[40:43]
    s_waitcnt lgkmcnt(2)
    v_mfma_f32_16x16x32_bf16 v[12:15], v[216:219], v[180:183], v[12:15]
    v_mfma_f32_16x16x32_bf16 v[44:47], v[216:219], v[184:187], v[44:47]
    v_mfma_f32_16x16x32_bf16 v[16:19], v[220:223], v[180:183], v[16:19]
    v_mfma_f32_16x16x32_bf16 v[48:51], v[220:223], v[184:187], v[48:51]
    v_mfma_f32_16x16x32_bf16 v[20:23], v[224:227], v[180:183], v[20:23]
    v_mfma_f32_16x16x32_bf16 v[52:55], v[224:227], v[184:187], v[52:55]
    v_mfma_f32_16x16x32_bf16 v[24:27], v[228:231], v[180:183], v[24:27]
    v_mfma_f32_16x16x32_bf16 v[56:59], v[228:231], v[184:187], v[56:59]
    s_waitcnt lgkmcnt(0)
    v_mfma_f32_16x16x32_bf16 v[28:31], v[232:235], v[180:183], v[28:31]
    v_mfma_f32_16x16x32_bf16 v[60:63], v[232:235], v[184:187], v[60:63]
    ds_read_b128 v[204:207], v250 offset:0
    ds_read_b128 v[208:211], v250 offset:64
    ds_read_b128 v[212:215], v250 offset:128
    ds_read_b128 v[216:219], v250 offset:192
    ds_read_b128 v[220:223], v250 offset:512
    ds_read_b128 v[224:227], v250 offset:576
    ds_read_b128 v[228:231], v250 offset:640
    ds_read_b128 v[232:235], v250 offset:704
    s_waitcnt lgkmcnt(7)
    v_mfma_f32_16x16x32_bf16 v[144:147], v[204:207], v[96:99], 0
    v_mfma_f32_16x16x32_bf16 v[148:151], v[204:207], v[112:115], 0
    s_waitcnt lgkmcnt(6)
    v_mfma_f32_16x16x32_bf16 v[144:147], v[208:211], v[100:103], v[144:147]
    v_mfma_f32_16x16x32_bf16 v[148:151], v[208:211], v[116:119], v[148:151]
    s_waitcnt lgkmcnt(5)
    v_mfma_f32_16x16x32_bf16 v[144:147], v[212:215], v[104:107], v[144:147]
    v_mfma_f32_16x16x32_bf16 v[148:151], v[212:215], v[120:123], v[148:151]
    s_waitcnt lgkmcnt(4)
    v_mfma_f32_16x16x32_bf16 v[144:147], v[216:219], v[108:111], v[144:147]
    v_mfma_f32_16x16x32_bf16 v[148:151], v[216:219], v[124:127], v[148:151]
    s_waitcnt lgkmcnt(3)
    v_mfma_f32_16x16x32_bf16 v[156:159], v[220:223], v[96:99], 0
    v_mfma_f32_16x16x32_bf16 v[160:163], v[220:223], v[112:115], 0
    s_waitcnt lgkmcnt(2)
    v_mfma_f32_16x16x32_bf16 v[156:159], v[224:227], v[100:103], v[156:159]
    v_mfma_f32_16x16x32_bf16 v[160:163], v[224:227], v[116:119], v[160:163]
    s_waitcnt lgkmcnt(1)
    v_mfma_f32_16x16x32_bf16 v[156:159], v[228:231], v[104:107], v[156:159]
    v_mfma_f32_16x16x32_bf16 v[160:163], v[228:231], v[120:123], v[160:163]
    s_waitcnt lgkmcnt(0)
    v_mfma_f32_16x16x32_bf16 v[156:159], v[232:235], v[108:111], v[156:159]
    v_mfma_f32_16x16x32_bf16 v[160:163], v[232:235], v[124:127], v[160:163]
    v_max3_f32 v169, v144, v145, v146
    s_nop 5
    v_max3_f32 v169, v169, v147, v156
    v_max3_f32 v169, v169, v157, v158
    v_max_f32 v169, v169, v159
    v_mov_b32 v170, v169
    s_nop 1
    v_permlane16_swap_b32 v169, v170
    v_max_f32 v169, v169, v170
    v_mov_b32 v170, v169
    s_nop 1
    v_permlane32_swap_b32 v169, v170
    v_max_f32 v169, v169, v170
    v_max_f32 v169, v169, v168
    v_sub_f32 v171, v168, v169
    v_exp_f32 v171, v171
    s_nop 0
    v_mul_f32 v240, v240, v171
    v_mul_f32 v0, v0, v171
    v_mul_f32 v1, v1, v171
    v_mul_f32 v2, v2, v171
    v_mul_f32 v3, v3, v171
    v_mul_f32 v4, v4, v171
    v_mul_f32 v5, v5, v171
    v_mul_f32 v6, v6, v171
    v_mul_f32 v7, v7, v171
    v_mul_f32 v8, v8, v171
    v_mul_f32 v9, v9, v171
    v_mul_f32 v10, v10, v171
    v_mul_f32 v11, v11, v171
    v_mul_f32 v12, v12, v171
    v_mul_f32 v13, v13, v171
    v_mul_f32 v14, v14, v171
    v_mul_f32 v15, v15, v171
    v_mul_f32 v16, v16, v171
    v_mul_f32 v17, v17, v171
    v_mul_f32 v18, v18, v171
    v_mul_f32 v19, v19, v171
    v_mul_f32 v20, v20, v171
    v_mul_f32 v21, v21, v171
    v_mul_f32 v22, v22, v171
    v_mul_f32 v23, v23, v171
    v_mul_f32 v24, v24, v171
    v_mul_f32 v25, v25, v171
    v_mul_f32 v26, v26, v171
    v_mul_f32 v27, v27, v171
    v_mul_f32 v28, v28, v171
    v_mul_f32 v29, v29, v171
    v_mul_f32 v30, v30, v171
    v_mul_f32 v31, v31, v171
    v_mov_b32 v168, v169
    v_sub_f32 v144, v144, v168
    v_sub_f32 v145, v145, v168
    v_sub_f32 v146, v146, v168
    v_sub_f32 v147, v147, v168
    v_sub_f32 v156, v156, v168
    v_sub_f32 v157, v157, v168
    v_sub_f32 v158, v158, v168
    v_sub_f32 v159, v159, v168
    v_max3_f32 v173, v148, v149, v150
    v_max3_f32 v173, v173, v151, v160
    v_max3_f32 v173, v173, v161, v162
    v_max_f32 v173, v173, v163
    v_mov_b32 v174, v173
    s_nop 1
    v_permlane16_swap_b32 v173, v174
    v_max_f32 v173, v173, v174
    v_mov_b32 v174, v173
    s_nop 1
    v_permlane32_swap_b32 v173, v174
    v_max_f32 v173, v173, v174
    v_max_f32 v173, v173, v172
    v_sub_f32 v175, v172, v173
    v_exp_f32 v175, v175
    s_nop 0
    v_mul_f32 v241, v241, v175
    v_mul_f32 v32, v32, v175
    v_mul_f32 v33, v33, v175
    v_mul_f32 v34, v34, v175
    v_mul_f32 v35, v35, v175
    v_mul_f32 v36, v36, v175
    v_mul_f32 v37, v37, v175
    v_mul_f32 v38, v38, v175
    v_mul_f32 v39, v39, v175
    v_mul_f32 v40, v40, v175
    v_mul_f32 v41, v41, v175
    v_mul_f32 v42, v42, v175
    v_mul_f32 v43, v43, v175
    v_mul_f32 v44, v44, v175
    v_mul_f32 v45, v45, v175
    v_mul_f32 v46, v46, v175
    v_mul_f32 v47, v47, v175
    v_mul_f32 v48, v48, v175
    v_mul_f32 v49, v49, v175
    v_mul_f32 v50, v50, v175
    v_mul_f32 v51, v51, v175
    v_mul_f32 v52, v52, v175
    v_mul_f32 v53, v53, v175
    v_mul_f32 v54, v54, v175
    v_mul_f32 v55, v55, v175
    v_mul_f32 v56, v56, v175
    v_mul_f32 v57, v57, v175
    v_mul_f32 v58, v58, v175
    v_mul_f32 v59, v59, v175
    v_mul_f32 v60, v60, v175
    v_mul_f32 v61, v61, v175
    v_mul_f32 v62, v62, v175
    v_mul_f32 v63, v63, v175
    v_mov_b32 v172, v173
    v_sub_f32 v148, v148, v172
    v_sub_f32 v149, v149, v172
    v_sub_f32 v150, v150, v172
    v_sub_f32 v151, v151, v172
    v_sub_f32 v160, v160, v172
    v_sub_f32 v161, v161, v172
    v_sub_f32 v162, v162, v172
    v_sub_f32 v163, v163, v172
    v_exp_f32 v144, v144
    v_exp_f32 v145, v145
    v_exp_f32 v146, v146
    v_exp_f32 v147, v147
    v_add_f32 v240, v240, v144
    v_exp_f32 v148, v148
    v_add_f32 v240, v240, v145
    v_exp_f32 v149, v149
    v_cvt_pk_bf16_f32 v180, v144, v145
    v_add_f32 v240, v240, v146
    v_exp_f32 v150, v150
    v_add_f32 v240, v240, v147
    v_exp_f32 v151, v151
    v_cvt_pk_bf16_f32 v181, v146, v147
    v_add_f32 v241, v241, v148
    v_add_f32 v241, v241, v149
    v_cvt_pk_bf16_f32 v184, v148, v149
    v_add_f32 v241, v241, v150
    v_add_f32 v241, v241, v151
    v_cvt_pk_bf16_f32 v185, v150, v151
    v_exp_f32 v156, v156
    v_exp_f32 v157, v157
    v_exp_f32 v158, v158
    v_exp_f32 v159, v159
    v_add_f32 v240, v240, v156
    v_exp_f32 v160, v160
    v_add_f32 v240, v240, v157
    v_exp_f32 v161, v161
    v_cvt_pk_bf16_f32 v182, v156, v157
    v_add_f32 v240, v240, v158
    v_exp_f32 v162, v162
    v_add_f32 v240, v240, v159
    v_exp_f32 v163, v163
    v_cvt_pk_bf16_f32 v183, v158, v159
    v_add_f32 v241, v241, v160
    v_add_f32 v241, v241, v161
    v_cvt_pk_bf16_f32 v186, v160, v161
    v_add_f32 v241, v241, v162
    v_add_f32 v241, v241, v163
    v_cvt_pk_bf16_f32 v187, v162, v163
    s_waitcnt vmcnt(12) lgkmcnt(0)
    s_barrier
    s_cmp_lt_u32 s51, 15
    s_cbranch_scc1 L_A2_cl
    s_cmp_eq_u32 s50, 3
    s_cbranch_scc1 L_A2_clast
    s_add_u32 s50, s50, 1
    s_add_u32 m0, s71, 14400
    s_nop 0
    buffer_load_dwordx4 v249, s[8:11], s61 offen offset:2048 nt lds
    s_add_u32 m0, s71, 21600
    s_nop 0
    buffer_load_dwordx4 v249, s[8:11], s61 offen offset:3072 nt lds
    s_add_u32 m0, s71, 32896
    s_nop 0
    buffer_load_dwordx4 v249, s[8:11], s62 offen nt lds
    s_add_u32 m0, s71, 40096
    s_nop 0
    buffer_load_dwordx4 v249, s[8:11], s62 offen offset:1024 nt lds
    s_add_u32 m0, s71, 47296
    s_nop 0
    buffer_load_dwordx4 v249, s[8:11], s62 offen offset:2048 nt lds
    s_add_u32 m0, s71, 54496
    s_nop 0
    buffer_load_dwordx4 v249, s[8:11], s62 offen offset:3072 nt lds
    s_lshr_b32 s61, s60, 4
    s_add_u32 s61, s61, s32
    s_and_b32 s61, s61, 3
    s_lshl_b32 s61, s61, 17
    s_add_u32 s62, s60, s47
    s_and_b32 s62, s62, 15
    s_lshl_b32 s62, s62, 13
    s_add_u32 s61, s61, s62
    s_add_u32 s61, s61, s58
    s_and_b32 s62, s60, 3
    s_lshl_b32 s62, s62, 10
    s_add_u32 s71, s62, s59
    s_cmp_ge_i32 s60, 64
    s_cselect_b32 s61, 0x4000000, s61
    s_cselect_b32 s71, 0x30000, s71
    s_add_u32 s62, s61, 4096
    s_add_u32 s60, s60, 1
    v_add_u32 v251, 0xc00, v237
    ds_read_b64_tr_b16 v[204:205], v251 offset:0
    ds_read_b64_tr_b16 v[206:207], v251 offset:512
    ds_read_b64_tr_b16 v[220:221], v251 offset:128
    ds_read_b64_tr_b16 v[222:223], v251 offset:640
    ds_read_b64_tr_b16 v[208:209], v251 offset:32
    ds_read_b64_tr_b16 v[210:211], v251 offset:544
    ds_read_b64_tr_b16 v[224:225], v251 offset:160
    ds_read_b64_tr_b16 v[226:227], v251 offset:672
    ds_read_b64_tr_b16 v[212:213], v251 offset:64
    ds_read_b64_tr_b16 v[214:215], v251 offset:576
    ds_read_b64_tr_b16 v[228:229], v251 offset:192
    ds_read_b64_tr_b16 v[230:231], v251 offset:704
    ds_read_b64_tr_b16 v[216:217], v251 offset:96
    ds_read_b64_tr_b16 v[218:219], v251 offset:608
    ds_read_b64_tr_b16 v[232:233], v251 offset:224
    ds_read_b64_tr_b16 v[234:235], v251 offset:736
    s_waitcnt lgkmcnt(14)
    v_mfma_f32_16x16x32_bf16 v[0:3], v[204:207], v[180:183], v[0:3]
    v_mfma_f32_16x16x32_bf16 v[32:35], v[204:207], v[184:187], v[32:35]
    s_waitcnt lgkmcnt(10)
    v_mfma_f32_16x16x32_bf16 v[4:7], v[208:211], v[180:183], v[4:7]
    v_mfma_f32_16x16x32_bf16 v[36:39], v[208:211], v[184:187], v[36:39]
    s_waitcnt lgkmcnt(6)
    v_mfma_f32_16x16x32_bf16 v[8:11], v[212:215], v[180:183], v[8:11]
    v_mfma_f32_16x16x32_bf16 v[40:43], v[212:215], v[184:187], v[40:43]
    s_waitcnt lgkmcnt(2)
    v_mfma_f32_16x16x32_bf16 v[12:15], v[216:219], v[180:183], v[12:15]
    v_mfma_f32_16x16x32_bf16 v[44:47], v[216:219], v[184:187], v[44:47]
    v_mfma_f32_16x16x32_bf16 v[16:19], v[220:223], v[180:183], v[16:19]
    v_mfma_f32_16x16x32_bf16 v[48:51], v[220:223], v[184:187], v[48:51]
    v_mfma_f32_16x16x32_bf16 v[20:23], v[224:227], v[180:183], v[20:23]
    v_mfma_f32_16x16x32_bf16 v[52:55], v[224:227], v[184:187], v[52:55]
    v_mfma_f32_16x16x32_bf16 v[24:27], v[228:231], v[180:183], v[24:27]
    v_mfma_f32_16x16x32_bf16 v[56:59], v[228:231], v[184:187], v[56:59]
    s_waitcnt lgkmcnt(0)
    v_mfma_f32_16x16x32_bf16 v[28:31], v[232:235], v[180:183], v[28:31]
    v_mfma_f32_16x16x32_bf16 v[60:63], v[232:235], v[184:187], v[60:63]
    v_mov_b32 v243, v240
    v_mov_b32 v244, v241
    v_mov_b32 v246, v243
    v_mov_b32 v247, v244
    s_nop 0
    v_permlane16_swap_b32 v243, v246
    v_permlane16_swap_b32 v244, v247
    v_add_f32 v243, v243, v246
    v_add_f32 v244, v244, v247
    v_mov_b32 v246, v243
    v_mov_b32 v247, v244
    s_nop 0
    v_permlane32_swap_b32 v243, v246
    v_permlane32_swap_b32 v244, v247
    v_add_f32 v243, v243, v246
    v_add_f32 v244, v244, v247
    v_cmp_ngt_f32 vcc, s56, v243
    s_or_b64 s[48:49], s[48:49], vcc
    v_rcp_f32 v243, v243
    v_cmp_ngt_f32 vcc, s56, v244
    s_or_b64 s[48:49], s[48:49], vcc
    v_rcp_f32 v244, v244
    s_waitcnt vmcnt(12) lgkmcnt(0)
    s_barrier
    s_nop 5
    ds_read_b128 v[96:99], v239 offset:0
    ds_read_b128 v[100:103], v239 offset:1024
    ds_read_b128 v[104:107], v239 offset:2048
    ds_read_b128 v[108:111], v239 offset:3072
    ds_read_b128 v[112:115], v239 offset:4096
    ds_read_b128 v[116:119], v239 offset:5120
    ds_read_b128 v[120:123], v239 offset:6144
    ds_read_b128 v[124:127], v239 offset:7168
    s_waitcnt lgkmcnt(0)
    v_mul_f32 v0, v0, v243
    v_mul_f32 v1, v1, v243
    v_mul_f32 v2, v2, v243
    v_mul_f32 v3, v3, v243
    v_mul_f32 v4, v4, v243
    v_mul_f32 v5, v5, v243
    v_mul_f32 v6, v6, v243
    v_mul_f32 v7, v7, v243
    v_cvt_pk_bf16_f32 v0, v0, v1
    v_cvt_pk_bf16_f32 v1, v2, v3
    v_cvt_pk_bf16_f32 v2, v4, v5
    v_cvt_pk_bf16_f32 v3, v6, v7
    ds_write_b128 v239, v[0:3] offset:0
    v_mul_f32 v32, v32, v244
    v_mul_f32 v33, v33, v244
    v_mul_f32 v34, v34, v244
    v_mul_f32 v35, v35, v244
    v_mul_f32 v36, v36, v244
    v_mul_f32 v37, v37, v244
    v_mul_f32 v38, v38, v244
    v_mul_f32 v39, v39, v244
    v_cvt_pk_bf16_f32 v32, v32, v33
    v_cvt_pk_bf16_f32 v33, v34, v35
    v_cvt_pk_bf16_f32 v34, v36, v37
    v_cvt_pk_bf16_f32 v35, v38, v39
    ds_write_b128 v239, v[32:35] offset:4096
    v_mul_f32 v8, v8, v243
    v_mul_f32 v9, v9, v243
    v_mul_f32 v10, v10, v243
    v_mul_f32 v11, v11, v243
    v_mul_f32 v12, v12, v243
    v_mul_f32 v13, v13, v243
    v_mul_f32 v14, v14, v243
    v_mul_f32 v15, v15, v243
    v_cvt_pk_bf16_f32 v8, v8, v9
    v_cvt_pk_bf16_f32 v9, v10, v11
    v_cvt_pk_bf16_f32 v10, v12, v13
    v_cvt_pk_bf16_f32 v11, v14, v15
    ds_write_b128 v239, v[8:11] offset:1024
    v_mul_f32 v40, v40, v244
    v_mul_f32 v41, v41, v244
    v_mul_f32 v42, v42, v244
    v_mul_f32 v43, v43, v244
    v_mul_f32 v44, v44, v244
    v_mul_f32 v45, v45, v244
    v_mul_f32 v46, v46, v244
    v_mul_f32 v47, v47, v244
    v_cvt_pk_bf16_f32 v40, v40, v41
    v_cvt_pk_bf16_f32 v41, v42, v43
    v_cvt_pk_bf16_f32 v42, v44, v45
    v_cvt_pk_bf16_f32 v43, v46, v47
    ds_write_b128 v239, v[40:43] offset:5120
    v_mul_f32 v16, v16, v243
    v_mul_f32 v17, v17, v243
    v_mul_f32 v18, v18, v243
    v_mul_f32 v19, v19, v243
    v_mul_f32 v20, v20, v243
    v_mul_f32 v21, v21, v243
    v_mul_f32 v22, v22, v243
    v_mul_f32 v23, v23, v243
    v_cvt_pk_bf16_f32 v16, v16, v17
    v_cvt_pk_bf16_f32 v17, v18, v19
    v_cvt_pk_bf16_f32 v18, v20, v21
    v_cvt_pk_bf16_f32 v19, v22, v23
    ds_write_b128 v239, v[16:19] offset:2048
    v_mul_f32 v48, v48, v244
    v_mul_f32 v49, v49, v244
    v_mul_f32 v50, v50, v244
    v_mul_f32 v51, v51, v244
    v_mul_f32 v52, v52, v244
    v_mul_f32 v53, v53, v244
    v_mul_f32 v54, v54, v244
    v_mul_f32 v55, v55, v244
    v_cvt_pk_bf16_f32 v48, v48, v49
    v_cvt_pk_bf16_f32 v49, v50, v51
    v_cvt_pk_bf16_f32 v50, v52, v53
    v_cvt_pk_bf16_f32 v51, v54, v55
    ds_write_b128 v239, v[48:51] offset:6144
    v_mul_f32 v24, v24, v243
    v_mul_f32 v25, v25, v243
    v_mul_f32 v26, v26, v243
    v_mul_f32 v27, v27, v243
    v_mul_f32 v28, v28, v243
    v_mul_f32 v29, v29, v243
    v_mul_f32 v30, v30, v243
    v_mul_f32 v31, v31, v243
    v_cvt_pk_bf16_f32 v24, v24, v25
    v_cvt_pk_bf16_f32 v25, v26, v27
    v_cvt_pk_bf16_f32 v26, v28, v29
    v_cvt_pk_bf16_f32 v27, v30, v31
    ds_write_b128 v239, v[24:27] offset:3072
    v_mul_f32 v56, v56, v244
    v_mul_f32 v57, v57, v244
    v_mul_f32 v58, v58, v244
    v_mul_f32 v59, v59, v244
    v_mul_f32 v60, v60, v244
    v_mul_f32 v61, v61, v244
    v_mul_f32 v62, v62, v244
    v_mul_f32 v63, v63, v244
    v_cvt_pk_bf16_f32 v56, v56, v57
    v_cvt_pk_bf16_f32 v57, v58, v59
    v_cvt_pk_bf16_f32 v58, v60, v61
    v_cvt_pk_bf16_f32 v59, v62, v63
    ds_write_b128 v239, v[56:59] offset:7168
    s_waitcnt lgkmcnt(0)
    v_mov_b32 v0, 0
    v_mov_b32 v1, 0
    v_mov_b32 v2, 0
    v_mov_b32 v3, 0
    v_mov_b32 v4, 0
    v_mov_b32 v5, 0
    v_mov_b32 v6, 0
    v_mov_b32 v7, 0
    v_mov_b32 v8, 0
    v_mov_b32 v9, 0
    v_mov_b32 v10, 0
    v_mov_b32 v11, 0
    v_mov_b32 v12, 0
    v_mov_b32 v13, 0
    v_mov_b32 v14, 0
    v_mov_b32 v15, 0
    v_mov_b32 v16, 0
    v_mov_b32 v17, 0
    v_mov_b32 v18, 0
    v_mov_b32 v19, 0
    v_mov_b32 v20, 0
    v_mov_b32 v21, 0
    v_mov_b32 v22, 0
    v_mov_b32 v23, 0
    v_mov_b32 v24, 0
    v_mov_b32 v25, 0
    v_mov_b32 v26, 0
    v_mov_b32 v27, 0
    v_mov_b32 v28, 0
    v_mov_b32 v29, 0
    v_mov_b32 v30, 0
    v_mov_b32 v31, 0
    v_mov_b32 v32, 0
    v_mov_b32 v33, 0
    v_mov_b32 v34, 0
    v_mov_b32 v35, 0
    v_mov_b32 v36, 0
    v_mov_b32 v37, 0
    v_mov_b32 v38, 0
    v_mov_b32 v39, 0
    v_mov_b32 v40, 0
    v_mov_b32 v41, 0
    v_mov_b32 v42, 0
    v_mov_b32 v43, 0
    v_mov_b32 v44, 0
    v_mov_b32 v45, 0
    v_mov_b32 v46, 0
    v_mov_b32 v47, 0
    v_mov_b32 v48, 0
    v_mov_b32 v49, 0
    v_mov_b32 v50, 0
    v_mov_b32 v51, 0
    v_mov_b32 v52, 0
    v_mov_b32 v53, 0
    v_mov_b32 v54, 0
    v_mov_b32 v55, 0
    v_mov_b32 v56, 0
    v_mov_b32 v57, 0
    v_mov_b32 v58, 0
    v_mov_b32 v59, 0
    v_mov_b32 v60, 0
    v_mov_b32 v61, 0
    v_mov_b32 v62, 0
    v_mov_b32 v63, 0
    ds_read_b128 v[204:207], v236 offset:0
    ds_read_b128 v[208:211], v236 offset:64
    ds_read_b128 v[212:215], v236 offset:128
    ds_read_b128 v[216:219], v236 offset:192
    ds_read_b128 v[220:223], v236 offset:512
    ds_read_b128 v[224:227], v236 offset:576
    ds_read_b128 v[228:231], v236 offset:640
    ds_read_b128 v[232:235], v236 offset:704
    s_waitcnt lgkmcnt(7)
    v_mfma_f32_16x16x32_bf16 v[144:147], v[204:207], v[96:99], 0
    v_mfma_f32_16x16x32_bf16 v[148:151], v[204:207], v[112:115], 0
    s_waitcnt lgkmcnt(6)
    v_mfma_f32_16x16x32_bf16 v[144:147], v[208:211], v[100:103], v[144:147]
    v_mfma_f32_16x16x32_bf16 v[148:151], v[208:211], v[116:119], v[148:151]
    s_waitcnt lgkmcnt(5)
    v_mfma_f32_16x16x32_bf16 v[144:147], v[212:215], v[104:107], v[144:147]
    v_mfma_f32_16x16x32_bf16 v[148:151], v[212:215], v[120:123], v[148:151]
    s_waitcnt lgkmcnt(4)
    v_mfma_f32_16x16x32_bf16 v[144:147], v[216:219], v[108:111], v[144:147]
    v_mfma_f32_16x16x32_bf16 v[148:151], v[216:219], v[124:127], v[148:151]
    s_waitcnt lgkmcnt(3)
    v_mfma_f32_16x16x32_bf16 v[156:159], v[220:223], v[96:99], 0
    v_mfma_f32_16x16x32_bf16 v[160:163], v[220:223], v[112:115], 0
    s_waitcnt lgkmcnt(2)
    v_mfma_f32_16x16x32_bf16 v[156:159], v[224:227], v[100:103], v[156:159]
    v_mfma_f32_16x16x32_bf16 v[160:163], v[224:227], v[116:119], v[160:163]
    s_waitcnt lgkmcnt(1)
    v_mfma_f32_16x16x32_bf16 v[156:159], v[228:231], v[104:107], v[156:159]
    v_mfma_f32_16x16x32_bf16 v[160:163], v[228:231], v[120:123], v[160:163]
    s_waitcnt lgkmcnt(0)
    v_mfma_f32_16x16x32_bf16 v[156:159], v[232:235], v[108:111], v[156:159]
    v_mfma_f32_16x16x32_bf16 v[160:163], v[232:235], v[124:127], v[160:163]
    v_max3_f32 v169, v144, v145, v146
    s_nop 5
    v_max3_f32 v169, v169, v147, v156
    v_max3_f32 v169, v169, v157, v158
    v_max_f32 v169, v169, v159
    v_mov_b32 v170, v169
    s_nop 1
    v_permlane16_swap_b32 v169, v170
    v_max_f32 v169, v169, v170
    v_mov_b32 v170, v169
    s_nop 1
    v_permlane32_swap_b32 v169, v170
    v_max_f32 v169, v169, v170
    v_mov_b32 v240, 0
    v_mov_b32 v168, v169
    v_sub_f32 v144, v144, v168
    v_sub_f32 v145, v145, v168
    v_sub_f32 v146, v146, v168
    v_sub_f32 v147, v147, v168
    v_sub_f32 v156, v156, v168
    v_sub_f32 v157, v157, v168
    v_sub_f32 v158, v158, v168
    v_sub_f32 v159, v159, v168
    v_max3_f32 v173, v148, v149, v150
    v_max3_f32 v173, v173, v151, v160
    v_max3_f32 v173, v173, v161, v162
    v_max_f32 v173, v173, v163
    v_mov_b32 v174, v173
    s_nop 1
    v_permlane16_swap_b32 v173, v174
    v_max_f32 v173, v173, v174
    v_mov_b32 v174, v173
    s_nop 1
    v_permlane32_swap_b32 v173, v174
    v_max_f32 v173, v173, v174
    v_mov_b32 v241, 0
    v_mov_b32 v172, v173
    v_sub_f32 v148, v148, v172
    v_sub_f32 v149, v149, v172
    v_sub_f32 v150, v150, v172
    v_sub_f32 v151, v151, v172
    v_sub_f32 v160, v160, v172
    v_sub_f32 v161, v161, v172
    v_sub_f32 v162, v162, v172
    v_sub_f32 v163, v163, v172
    v_exp_f32 v144, v144
    v_exp_f32 v145, v145
    v_exp_f32 v146, v146
    v_exp_f32 v147, v147
    v_add_f32 v240, v240, v144
    v_exp_f32 v148, v148
    v_add_f32 v240, v240, v145
    v_exp_f32 v149, v149
    v_cvt_pk_bf16_f32 v180, v144, v145
    v_add_f32 v240, v240, v146
    v_exp_f32 v150, v150
    v_add_f32 v240, v240, v147
    v_exp_f32 v151, v151
    v_cvt_pk_bf16_f32 v181, v146, v147
    v_add_f32 v241, v241, v148
    v_add_f32 v241, v241, v149
    v_cvt_pk_bf16_f32 v184, v148, v149
    v_add_f32 v241, v241, v150
    v_add_f32 v241, v241, v151
    v_cvt_pk_bf16_f32 v185, v150, v151
    v_exp_f32 v156, v156
    v_exp_f32 v157, v157
    v_exp_f32 v158, v158
    v_exp_f32 v159, v159
    v_add_f32 v240, v240, v156
    v_exp_f32 v160, v160
    v_add_f32 v240, v240, v157
    v_exp_f32 v161, v161
    v_cvt_pk_bf16_f32 v182, v156, v157
    v_add_f32 v240, v240, v158
    v_exp_f32 v162, v162
    v_add_f32 v240, v240, v159
    v_exp_f32 v163, v163
    v_cvt_pk_bf16_f32 v183, v158, v159
    v_add_f32 v241, v241, v160
    v_add_f32 v241, v241, v161
    v_cvt_pk_bf16_f32 v186, v160, v161
    v_add_f32 v241, v241, v162
    v_add_f32 v241, v241, v163
    v_cvt_pk_bf16_f32 v187, v162, v163
    s_waitcnt vmcnt(12) lgkmcnt(0)
    s_barrier
    s_branch L_A2_cu
L_A2_clast:
    v_add_u32 v251, 0xc00, v237
    s_nop 4
    ds_read_b64_tr_b16 v[204:205], v251 offset:0
    ds_read_b64_tr_b16 v[206:207], v251 offset:512
    ds_read_b64_tr_b16 v[220:221], v251 offset:128
    ds_read_b64_tr_b16 v[222:223], v251 offset:640
    ds_read_b64_tr_b16 v[208:209], v251 offset:32
    ds_read_b64_tr_b16 v[210:211], v251 offset:544
    ds_read_b64_tr_b16 v[224:225], v251 offset:160
    ds_read_b64_tr_b16 v[226:227], v251 offset:672
    ds_read_b64_tr_b16 v[212:213], v251 offset:64
    ds_read_b64_tr_b16 v[214:215], v251 offset:576
    ds_read_b64_tr_b16 v[228:229], v251 offset:192
    ds_read_b64_tr_b16 v[230:231], v251 offset:704
    ds_read_b64_tr_b16 v[216:217], v251 offset:96
    ds_read_b64_tr_b16 v[218:219], v251 offset:608
    ds_read_b64_tr_b16 v[232:233], v251 offset:224
    ds_read_b64_tr_b16 v[234:235], v251 offset:736
    s_waitcnt lgkmcnt(14)
    v_mfma_f32_16x16x32_bf16 v[0:3], v[204:207], v[180:183], v[0:3]
    v_mfma_f32_16x16x32_bf16 v[32:35], v[204:207], v[184:187], v[32:35]
    s_waitcnt lgkmcnt(10)
    v_mfma_f32_16x16x32_bf16 v[4:7], v[208:211], v[180:183], v[4:7]
    v_mfma_f32_16x16x32_bf16 v[36:39], v[208:211], v[184:187], v[36:39]
    s_waitcnt lgkmcnt(6)
    v_mfma_f32_16x16x32_bf16 v[8:11], v[212:215], v[180:183], v[8:11]
    v_mfma_f32_16x16x32_bf16 v[40:43], v[212:215], v[184:187], v[40:43]
    s_waitcnt lgkmcnt(2)
    v_mfma_f32_16x16x32_bf16 v[12:15], v[216:219], v[180:183], v[12:15]
    v_mfma_f32_16x16x32_bf16 v[44:47], v[216:219], v[184:187], v[44:47]
    v_mfma_f32_16x16x32_bf16 v[16:19], v[220:223], v[180:183], v[16:19]
    v_mfma_f32_16x16x32_bf16 v[48:51], v[220:223], v[184:187], v[48:51]
    v_mfma_f32_16x16x32_bf16 v[20:23], v[224:227], v[180:183], v[20:23]
    v_mfma_f32_16x16x32_bf16 v[52:55], v[224:227], v[184:187], v[52:55]
    v_mfma_f32_16x16x32_bf16 v[24:27], v[228:231], v[180:183], v[24:27]
    v_mfma_f32_16x16x32_bf16 v[56:59], v[228:231], v[184:187], v[56:59]
    s_waitcnt lgkmcnt(0)
    v_mfma_f32_16x16x32_bf16 v[28:31], v[232:235], v[180:183], v[28:31]
    v_mfma_f32_16x16x32_bf16 v[60:63], v[232:235], v[184:187], v[60:63]
    v_mov_b32 v243, v240
    v_mov_b32 v244, v241
    v_mov_b32 v246, v243
    v_mov_b32 v247, v244
    s_nop 0
    v_permlane16_swap_b32 v243, v246
    v_permlane16_swap_b32 v244, v247
    v_add_f32 v243, v243, v246
    v_add_f32 v244, v244, v247
    v_mov_b32 v246, v243
    v_mov_b32 v247, v244
    s_nop 0
    v_permlane32_swap_b32 v243, v246
    v_permlane32_swap_b32 v244, v247
    v_add_f32 v243, v243, v246
    v_add_f32 v244, v244, v247
    v_cmp_ngt_f32 vcc, s56, v243
    s_or_b64 s[48:49], s[48:49], vcc
    v_rcp_f32 v243, v243
    v_cmp_ngt_f32 vcc, s56, v244
    s_or_b64 s[48:49], s[48:49], vcc
    v_rcp_f32 v244, v244
    s_waitcnt vmcnt(0) lgkmcnt(0)
    s_barrier
    s_barrier
    ds_write_b128 v238, v[64:67] offset:3072
    ds_write_b128 v238, v[68:71] offset:4096
    ds_write_b128 v238, v[72:75] offset:5120
    ds_write_b128 v238, v[76:79] offset:6144
    ds_write_b128 v238, v[80:83] offset:11264
    ds_write_b128 v238, v[84:87] offset:12288
    ds_write_b128 v238, v[88:91] offset:13312
    ds_write_b128 v238, v[92:95] offset:14336
    v_mul_f32 v0, v0, v243
    v_mul_f32 v1, v1, v243
    v_mul_f32 v2, v2, v243
    v_mul_f32 v3, v3, v243
    v_mul_f32 v4, v4, v243
    v_mul_f32 v5, v5, v243
    v_mul_f32 v6, v6, v243
    v_mul_f32 v7, v7, v243
    v_cvt_pk_bf16_f32 v0, v0, v1
    v_cvt_pk_bf16_f32 v1, v2, v3
    v_cvt_pk_bf16_f32 v2, v4, v5
    v_cvt_pk_bf16_f32 v3, v6, v7
    ds_write_b128 v238, v[0:3] offset:1024
    v_mul_f32 v32, v32, v244
    v_mul_f32 v33, v33, v244
    v_mul_f32 v34, v34, v244
    v_mul_f32 v35, v35, v244
    v_mul_f32 v36, v36, v244
    v_mul_f32 v37, v37, v244
    v_mul_f32 v38, v38, v244
    v_mul_f32 v39, v39, v244
    v_cvt_pk_bf16_f32 v32, v32, v33
    v_cvt_pk_bf16_f32 v33, v34, v35
    v_cvt_pk_bf16_f32 v34, v36, v37
    v_cvt_pk_bf16_f32 v35, v38, v39
    ds_write_b128 v238, v[32:35] offset:9216
    v_mul_f32 v8, v8, v243
    v_mul_f32 v9, v9, v243
    v_mul_f32 v10, v10, v243
    v_mul_f32 v11, v11, v243
    v_mul_f32 v12, v12, v243
    v_mul_f32 v13, v13, v243
    v_mul_f32 v14, v14, v243
    v_mul_f32 v15, v15, v243
    v_cvt_pk_bf16_f32 v8, v8, v9
    v_cvt_pk_bf16_f32 v9, v10, v11
    v_cvt_pk_bf16_f32 v10, v12, v13
    v_cvt_pk_bf16_f32 v11, v14, v15
    ds_write_b128 v238, v[8:11] offset:2048
    v_mul_f32 v40, v40, v244
    v_mul_f32 v41, v41, v244
    v_mul_f32 v42, v42, v244
    v_mul_f32 v43, v43, v244
    v_mul_f32 v44, v44, v244
    v_mul_f32 v45, v45, v244
    v_mul_f32 v46, v46, v244
    v_mul_f32 v47, v47, v244
    v_cvt_pk_bf16_f32 v40, v40, v41
    v_cvt_pk_bf16_f32 v41, v42, v43
    v_cvt_pk_bf16_f32 v42, v44, v45
    v_cvt_pk_bf16_f32 v43, v46, v47
    ds_write_b128 v238, v[40:43] offset:10240
    v_mul_f32 v16, v16, v243
    v_mul_f32 v17, v17, v243
    v_mul_f32 v18, v18, v243
    v_mul_f32 v19, v19, v243
    v_mul_f32 v20, v20, v243
    v_mul_f32 v21, v21, v243
    v_mul_f32 v22, v22, v243
    v_mul_f32 v23, v23, v243
    v_cvt_pk_bf16_f32 v16, v16, v17
    v_cvt_pk_bf16_f32 v17, v18, v19
    v_cvt_pk_bf16_f32 v18, v20, v21
    v_cvt_pk_bf16_f32 v19, v22, v23
    ds_write_b128 v238, v[16:19] offset:0
    v_mul_f32 v48, v48, v244
    v_mul_f32 v49, v49, v244
    v_mul_f32 v50, v50, v244
    v_mul_f32 v51, v51, v244
    v_mul_f32 v52, v52, v244
    v_mul_f32 v53, v53, v244
    v_mul_f32 v54, v54, v244
    v_mul_f32 v55, v55, v244
    v_cvt_pk_bf16_f32 v48, v48, v49
    v_cvt_pk_bf16_f32 v49, v50, v51
    v_cvt_pk_bf16_f32 v50, v52, v53
    v_cvt_pk_bf16_f32 v51, v54, v55
    ds_write_b128 v238, v[48:51] offset:8192
    v_mul_f32 v24, v24, v243
    v_mul_f32 v25, v25, v243
    v_mul_f32 v26, v26, v243
    v_mul_f32 v27, v27, v243
    v_mul_f32 v28, v28, v243
    v_mul_f32 v29, v29, v243
    v_mul_f32 v30, v30, v243
    v_mul_f32 v31, v31, v243
    v_cvt_pk_bf16_f32 v24, v24, v25
    v_cvt_pk_bf16_f32 v25, v26, v27
    v_cvt_pk_bf16_f32 v26, v28, v29
    v_cvt_pk_bf16_f32 v27, v30, v31
    ds_write_b128 v238, v[24:27] offset:7168
    v_mul_f32 v56, v56, v244
    v_mul_f32 v57, v57, v244
    v_mul_f32 v58, v58, v244
    v_mul_f32 v59, v59, v244
    v_mul_f32 v60, v60, v244
    v_mul_f32 v61, v61, v244
    v_mul_f32 v62, v62, v244
    v_mul_f32 v63, v63, v244
    v_cvt_pk_bf16_f32 v56, v56, v57
    v_cvt_pk_bf16_f32 v57, v58, v59
    v_cvt_pk_bf16_f32 v58, v60, v61
    v_cvt_pk_bf16_f32 v59, v62, v63
    ds_write_b128 v238, v[56:59] offset:15360
    s_waitcnt lgkmcnt(0)
    s_barrier
    s_branch L_tail
.section .rodata,"a"
.p2align 6
.amdhsa_kernel concat_heads__gqa_block_cached__mha_block_cached__near_ridge_kernel
  .amdhsa_next_free_vgpr 256
  .amdhsa_next_free_sgpr 102
  .amdhsa_accum_offset 256
  .amdhsa_group_segment_fixed_size 0
  .amdhsa_kernarg_size 104
  .amdhsa_user_sgpr_count 2
  .amdhsa_user_sgpr_kernarg_segment_ptr 1
  .amdhsa_system_sgpr_workgroup_id_x 1
.end_amdhsa_kernel
```
